```python
import torch

def _softmax(x, axis=-1):
    return torch.softmax(x, dim=axis)
def _gelu(x):
    return torch.nn.functional.gelu(x, approximate="tanh")
def _silu(x):
    return torch.nn.functional.silu(x)
def _sigmoid(x):
    return torch.sigmoid(x)
def _layernorm(x, axis=-1, eps=1e-5):
    m = x.mean(dim=axis, keepdim=True)
    v = x.var(dim=axis, keepdim=True, unbiased=False)
    return (x - m) / torch.sqrt(v + eps)
def _scatter_add(tgt, idx, src, axis=0):
    return tgt.clone().index_add_(axis, idx, src)
def _segment_sum(src, seg, n):
    out = torch.zeros((n,) + src.shape[1:], dtype=src.dtype)
    return out.index_add_(0, seg, src)
def _pad(x, pw):
    flat = tuple(v for pair in reversed(pw) for v in pair)
    return torch.nn.functional.pad(x, flat)

kernel_name = 'recurrent_scan__linear_kernel_hedgehog__dense_activation_silu__prompt'

def setup_inputs():

    _w = (lambda a: (lambda t: t.to(torch.bfloat16) if t.is_floating_point() else t)(torch.as_tensor(a)))
    def _A_setup():
        B, S, D, H = 1, 2048, 576, 32
        Dh = D // H
        return {
            "x": _w((lambda *s: torch.randn(*s, dtype=torch.bfloat16) * 0.05)(B, S, D)),
            "wqkv": _w((lambda *s: torch.randn(*s, dtype=torch.bfloat16) * 0.4)(D, 3 * D)),
            "w_phi": _w((lambda *s: torch.randn(*s, dtype=torch.bfloat16) * 0.4)(H, Dh, Dh) * (Dh ** -0.5)),
            "wo": _w((lambda *s: torch.randn(*s, dtype=torch.bfloat16) * 0.2)(D, D)),
        }
    _A_in = _A_setup()

    def _B_setup():
        B, S, D, F = 1, 2048, 576, 4608
        return {
            "x": _w((lambda *s: torch.randn(*s, dtype=torch.bfloat16) * 0.05)(B, S, D)),
            "w1": _w((lambda *s: torch.randn(*s, dtype=torch.bfloat16) * 0.4)(D, F) * (D ** -0.5)),
            "w2": _w((lambda *s: torch.randn(*s, dtype=torch.bfloat16) * 0.1)(F, D) * (F ** -0.5)),
        }
    _B_in = _B_setup()

    return {
        "A_x": _A_in["x"],
        "A_wqkv": _A_in["wqkv"],
        "A_w_phi": _A_in["w_phi"],
        "A_wo": _A_in["wo"],
        "B_x": _B_in["x"],
        "B_w1": _B_in["w1"],
        "B_w2": _B_in["w2"],
    }

def reference(A_x, A_wqkv, A_w_phi, A_wo, B_x, B_w1, B_w2):
    def _A_ref(x, wqkv, w_phi, wo):
        B, S, D = x.shape
        H = 32; Dh = D // H
        qkv = (lambda x, *d: x.permute(*d))((x @ wqkv).reshape(B, S, 3, H, Dh), 2, 0, 3, 1, 4)
        q, k, v = qkv[0], qkv[1], qkv[2]
        pq = torch.einsum("bhsd,hdf->bhsf", q, w_phi)
        pk = torch.einsum("bhsd,hdf->bhsf", k, w_phi)
        phi_q = torch.concatenate([_softmax(pq, axis=-1), _softmax(-pq, axis=-1)], axis=-1)
        phi_k = torch.concatenate([_softmax(pk, axis=-1), _softmax(-pk, axis=-1)], axis=-1)
        kv = torch.einsum("bhsf,bhsd->bhfd", phi_k, v)
        z  = torch.einsum("bhsf->bhf", phi_k)
        num = torch.einsum("bhqf,bhfd->bhqd", phi_q, kv)
        den = torch.einsum("bhqf,bhf->bhq", phi_q, z)[..., None] + 1e-6
        o = num / den
        return (lambda x, *d: x.permute(*d))(o, 0, 2, 1, 3).reshape(B, S, D) @ wo

    def _B_ref(x, w1, w2):
        h = torch.einsum("bsd,df->bsf", x, w1)
        h = _silu(h)
        out = torch.einsum("bsf,fd->bsd", h, w2)
        return out

    x = A_x
    xn = _layernorm(x, axis=-1)
    s = _A_ref(xn, A_wqkv, A_w_phi, A_wo)
    g = _silu(_B_ref(xn, B_w1, B_w2))
    return x + s * g
```

```asm
; @launch grid=(256,1,1) block=(512,1,1) lds=163840
.amdgcn_target "amdgcn-amd-amdhsa--gfx950"
.text
.globl recurrent_scan__linear_kernel_hedgehog__dense_activation_silu__prompt_kernel
.p2align 8
.type recurrent_scan__linear_kernel_hedgehog__dense_activation_silu__prompt_kernel,@function
recurrent_scan__linear_kernel_hedgehog__dense_activation_silu__prompt_kernel:
s_cmp_ge_u32 s2, 256
s_cbranch_scc1 L_end
s_load_dwordx4 s[96:99], s[0:1], 0
s_load_dwordx4 s[4:7], s[0:1], 16
s_load_dwordx4 s[16:19], s[0:1], 40
s_load_dwordx4 s[36:39], s[0:1], 64
s_load_dwordx2 s[92:93], s[0:1], 56
s_memrealtime s[60:61]
v_and_b32 v1, 63, v0
v_lshrrev_b32 v255, 6, v0
s_nop 0
v_readfirstlane_b32 s44, v255
s_and_b32 s40, s2, 1
s_lshl_b32 s40, s40, 3
s_lshr_b32 s50, s2, 5
s_add_u32 s40, s40, s50
s_bfe_u32 s41, s2, 0x20001
s_bfe_u32 s3, s2, 0x20003
s_min_u32 s50, s3, 2
s_mul_i32 s45, s41, 3
s_add_u32 s45, s45, s50
s_and_b32 s42, s44, 3
s_lshr_b32 s43, s44, 2
s_lshl_b32 s48, s42, 10
s_mov_b32 s53, 0xffff0000
s_mov_b32 s54, 0x3f803f80
v_lshrrev_b32 v252, 4, v1
v_and_b32 v251, 15, v1
v_bfe_u32 v250, v1, 2, 2
v_and_b32 v249, 3, v1
v_lshlrev_b32 v248, 4, v1
v_add_u32 v247, s48, v248
v_lshrrev_b32 v255, 3, v1
v_mul_u32_u24 v246, 1152, v255
v_and_b32 v254, 7, v1
v_lshl_add_u32 v246, v254, 4, v246
s_lshl_b32 s57, s40, 3
s_add_u32 s57, s57, s44
s_mul_i32 s57, s57, 18432
s_add_u32 s58, s57, 9216
s_mov_b32 s10, 2359296
s_mov_b32 s11, 0x20000
s_waitcnt lgkmcnt(0)
s_mov_b32 s8, s96
s_mov_b32 s9, s97
s_mov_b32 s24, s38
s_mov_b32 s25, s39
s_mov_b32 s26, 268435456
s_mov_b32 s27, 0x20000
s_mov_b32 s38, 256
s_mov_b32 s39, 0x20000
s_or_b32 s50, s2, s44
s_cmp_lg_u32 s50, 0
s_cbranch_scc1 L_nw
s_or_b32 s60, s60, 1
s_mov_b64 exec, 1
v_mov_b32 v2, s60
v_mov_b32 v3, s61
buffer_store_dwordx2 v[2:3], v0, s[36:39], 0 offen sc1
s_mov_b64 exec, -1
s_nop 1
L_nw:
s_getpc_b64 s[100:101]
s_lshr_b32 s50, s2, 3
s_lshl_b32 s50, s50, 3
s_add_u32 s50, s50, s44
v_min_u32 v255, 4, v1
v_lshlrev_b32 v255, 8, v255
v_add_u32 v255, s50, v255
v_lshlrev_b32 v255, 7, v255
v_min_u32 v255, L_end-L_nw, v255
global_load_dword v2, v255, s[100:101]
s_cmp_eq_u32 s3, 3
s_cbranch_scc1 L_att
buffer_load_dwordx4 v[4:7], v246, s[8:11], s57 offen offset:0
buffer_load_dwordx4 v[40:43], v246, s[8:11], s58 offen offset:0
buffer_load_dwordx4 v[8:11], v246, s[8:11], s57 offen offset:128
buffer_load_dwordx4 v[44:47], v246, s[8:11], s58 offen offset:128
buffer_load_dwordx4 v[12:15], v246, s[8:11], s57 offen offset:256
buffer_load_dwordx4 v[48:51], v246, s[8:11], s58 offen offset:256
buffer_load_dwordx4 v[16:19], v246, s[8:11], s57 offen offset:384
buffer_load_dwordx4 v[52:55], v246, s[8:11], s58 offen offset:384
buffer_load_dwordx4 v[20:23], v246, s[8:11], s57 offen offset:512
buffer_load_dwordx4 v[56:59], v246, s[8:11], s58 offen offset:512
buffer_load_dwordx4 v[24:27], v246, s[8:11], s57 offen offset:640
buffer_load_dwordx4 v[60:63], v246, s[8:11], s58 offen offset:640
buffer_load_dwordx4 v[28:31], v246, s[8:11], s57 offen offset:768
buffer_load_dwordx4 v[64:67], v246, s[8:11], s58 offen offset:768
buffer_load_dwordx4 v[32:35], v246, s[8:11], s57 offen offset:896
buffer_load_dwordx4 v[68:71], v246, s[8:11], s58 offen offset:896
buffer_load_dwordx4 v[36:39], v246, s[8:11], s57 offen offset:1024
buffer_load_dwordx4 v[72:75], v246, s[8:11], s58 offen offset:1024
s_branch L_ffn_cut
L_att:
s_mov_b32 s32, s4
s_mov_b32 s33, s5
s_mov_b32 s34, 20736
s_mov_b32 s35, 0x20000
s_and_b32 s45, s40, 3
s_lshl_b32 s51, s41, 2
s_add_u32 s51, s51, s45
s_mul_i32 s49, s51, 1296
v_lshlrev_b32 v255, 1, v0
buffer_load_ushort v234, v255, s[32:35], s49 offen
buffer_load_ushort v233, v255, s[32:35], s49 offen offset:1024
buffer_load_dwordx4 v[4:7], v246, s[8:11], s57 offen offset:0
buffer_load_dwordx4 v[40:43], v246, s[8:11], s58 offen offset:0
buffer_load_dwordx4 v[8:11], v246, s[8:11], s57 offen offset:128
buffer_load_dwordx4 v[44:47], v246, s[8:11], s58 offen offset:128
buffer_load_dwordx4 v[12:15], v246, s[8:11], s57 offen offset:256
buffer_load_dwordx4 v[48:51], v246, s[8:11], s58 offen offset:256
buffer_load_dwordx4 v[16:19], v246, s[8:11], s57 offen offset:384
buffer_load_dwordx4 v[52:55], v246, s[8:11], s58 offen offset:384
buffer_load_dwordx4 v[20:23], v246, s[8:11], s57 offen offset:512
buffer_load_dwordx4 v[56:59], v246, s[8:11], s58 offen offset:512
buffer_load_dwordx4 v[24:27], v246, s[8:11], s57 offen offset:640
buffer_load_dwordx4 v[60:63], v246, s[8:11], s58 offen offset:640
buffer_load_dwordx4 v[28:31], v246, s[8:11], s57 offen offset:768
buffer_load_dwordx4 v[64:67], v246, s[8:11], s58 offen offset:768
buffer_load_dwordx4 v[32:35], v246, s[8:11], s57 offen offset:896
buffer_load_dwordx4 v[68:71], v246, s[8:11], s58 offen offset:896
buffer_load_dwordx4 v[36:39], v246, s[8:11], s57 offen offset:1024
buffer_load_dwordx4 v[72:75], v246, s[8:11], s58 offen offset:1024
s_getpc_b64 s[100:101]
L_pc:
s_add_u32 s100, s100, L_tbl-L_pc
s_addc_u32 s101, s101, 0
s_mov_b32 s12, s98
s_mov_b32 s13, s99
s_mov_b32 s14, 1990656
s_mov_b32 s15, 0x20000
s_mov_b32 s28, s6
s_mov_b32 s29, s7
s_mov_b32 s30, 663552
s_mov_b32 s31, 0x20000
s_mov_b32 s94, 2359296
s_mov_b32 s95, 0x20000
s_lshr_b32 s60, s40, 2
s_mul_i32 s60, s60, 5
s_add_u32 s60, s60, s44
s_cmp_lt_u32 s44, 5
s_cselect_b32 s50, s60, 99
s_cmp_lt_u32 s50, 18
s_cselect_b32 s61, 0, 1879048192
s_mul_i32 s46, s41, 442368
s_add_u32 s46, s46, 41943040
s_mul_i32 s47, s41, 165888
s_add_u32 s47, s47, 40108032
s_mul_i32 s57, s41, 288
s_add_u32 s57, s57, 2304
v_and_b32 v255, 1, v252
s_and_b32 s49, s42, 1
s_lshl_b32 s49, s49, 1
v_or_b32 v255, s49, v255
v_lshlrev_b32 v255, 1, v255
v_and_b32 v254, 7, v1
v_xor_b32 v255, v255, v254
v_lshrrev_b32 v253, 3, v1
s_lshl_b32 s49, s42, 3
v_add_u32 v253, s49, v253
v_mul_u32_u24 v246, 3456, v253
v_lshl_add_u32 v246, v255, 4, v246
v_cmp_gt_u32 vcc, 2, v255
v_mov_b32 v253, 1879048192
s_nop 0
v_cndmask_b32 v232, v253, v246, vcc
v_mov_b32 v80, 0
v_mov_b32 v81, 0
v_mov_b32 v82, 0
v_mov_b32 v83, 0
v_lshlrev_b32 v255, 4, v0
v_add_u32 v254, 157376, v255
v_add_u32 v255, 155648, v255
v_cmp_gt_u32 vcc, 8, v0
s_nop 1
v_cndmask_b32 v255, v254, v255, vcc
v_min_u32 v255, 163712, v255
ds_write_b128 v255, v[80:83]
v_mul_u32_u24 v255, 24, v0
v_mov_b32 v253, 163712
v_add_u32 v255, 155776, v255
v_cmp_gt_u32 vcc, 72, v0
s_nop 1
v_cndmask_b32 v255, v253, v255, vcc
ds_write_b16 v255, v80 offset:18
ds_write_b32 v255, v80 offset:20
s_waitcnt vmcnt(18)
v_add_u32 v255, 0, v0
v_mul_u32_u24 v254, 7282, v255
v_lshrrev_b32 v254, 16, v254
v_mul_u32_u24 v254, 6, v254
v_lshl_add_u32 v255, v255, 1, v254
v_add_u32 v255, 155776, v255
ds_write_b16 v255, v234
v_add_u32 v255, 512, v0
v_mul_u32_u24 v254, 7282, v255
v_lshrrev_b32 v254, 16, v254
v_mul_u32_u24 v254, 6, v254
v_lshl_add_u32 v255, v255, 1, v254
v_add_u32 v255, 155776, v255
v_cmp_gt_u32 vcc, 136, v0
s_nop 1
v_cndmask_b32 v255, v253, v255, vcc
ds_write_b16 v255, v233
v_and_b32 v255, 7, v1
v_lshrrev_b32 v254, 3, v1
v_xor_b32 v254, v254, v255
v_lshlrev_b32 v237, 8, v249
v_lshl_add_u32 v237, v254, 4, v237
v_lshrrev_b32 v255, 2, v255
v_lshl_add_u32 v237, v255, 13, v237
s_lshl_b32 s49, s44, 10
s_add_u32 s49, s49, 90112
v_add_u32 v237, s49, v237
v_xor_b32 v255, v251, v252
v_lshlrev_b32 v236, 8, v252
v_lshl_add_u32 v236, v255, 4, v236
s_lshl_b32 s49, s42, 11
s_add_u32 s49, s49, 90112
v_add_u32 v236, s49, v236
v_xor_b32 v235, 64, v236
s_mul_i32 s49, s42, 36864
v_add_u32 v234, s49, v248
s_mul_i32 s59, s40, 147456
s_add_u32 s59, s59, 37748736
s_lshl_b32 s49, s41, 1
s_and_b32 s49, s49, 4
s_add_u32 s49, s49, s42
s_mul_i32 s55, s40, 1769472
s_mul_i32 s50, s49, 24576
s_add_u32 s55, s55, s50
s_and_b32 s51, s41, 1
s_lshl_b32 s50, s51, 9
s_add_u32 s55, s55, s50
s_lshl_b32 s56, s40, 3
s_add_u32 s56, s56, s49
s_lshl_b32 s56, s56, 8
s_add_u32 s56, s56, 46202880
s_lshl_b32 s49, s40, 2
s_add_u32 s50, s49, s42
s_mul_i32 s4, s50, 36864
s_lshl_b32 s51, s51, 4
s_add_u32 s4, s4, s51
s_and_b32 s51, s41, 2
s_lshl_b32 s51, s51, 5
s_add_u32 s4, s4, s51
s_add_u32 s49, s49, s41
s_mul_i32 s5, s49, 36864
s_add_u32 s5, s5, 47185920
s_branch L_att_cut
L_ffn_cut:
s_mov_b32 s20, s18
s_mov_b32 s21, s19
s_mov_b32 s22, 5308416
s_mov_b32 s23, 0x20000
s_mov_b32 s18, 5308416
s_mov_b32 s19, 0x20000
s_mul_i32 s46, s45, 768
s_mul_i32 s47, s45, 442368
v_and_b32 v255, 1, v252
s_and_b32 s49, s42, 1
s_lshl_b32 s49, s49, 1
v_or_b32 v255, s49, v255
v_lshlrev_b32 v255, 1, v255
v_and_b32 v254, 7, v1
v_xor_b32 v255, v255, v254
v_lshrrev_b32 v253, 3, v1
s_lshl_b32 s49, s42, 3
v_add_u32 v253, s49, v253
v_mul_u32_u24 v246, 9216, v253
v_lshl_add_u32 v246, v255, 4, v246
v_lshlrev_b32 v255, 1, v252
v_xor_b32 v255, v255, v254
v_mul_u32_u24 v234, 1152, v253
v_lshl_add_u32 v234, v255, 4, v234
v_and_b32 v255, 7, v1
v_lshrrev_b32 v254, 3, v1
v_xor_b32 v254, v254, v255
v_lshlrev_b32 v237, 8, v249
v_lshl_add_u32 v237, v254, 4, v237
v_lshrrev_b32 v255, 2, v255
v_lshl_add_u32 v237, v255, 13, v237
s_lshl_b32 s49, s44, 10
s_add_u32 s49, s49, 90112
v_add_u32 v237, s49, v237
v_xor_b32 v255, v251, v252
v_lshlrev_b32 v236, 8, v252
v_lshl_add_u32 v236, v255, 4, v236
s_lshl_b32 s49, s42, 11
s_add_u32 s49, s49, 90112
v_add_u32 v236, s49, v236
v_xor_b32 v235, 64, v236
s_mul_i32 s55, s40, 1769472
s_mul_i32 s50, s44, 24576
s_add_u32 s55, s55, s50
s_lshl_b32 s50, s45, 10
s_add_u32 s55, s55, s50
s_lshl_b32 s56, s40, 3
s_add_u32 s56, s56, s44
s_lshl_b32 s56, s56, 8
s_lshl_b32 s50, s45, 3
s_add_u32 s56, s56, s50
s_add_u32 s56, s56, 46202880
s_mov_b32 s94, 2359296
s_mov_b32 s95, 0x20000
s_lshr_b32 s58, s42, 1
s_mul_i32 s51, s43, 6
s_lshr_b32 s50, s45, 2
s_add_u32 s50, s50, s51
s_and_b32 s49, s44, 1
s_and_b32 s51, s45, 3
s_lshl_b32 s52, s49, 2
s_add_u32 s52, s52, s51
s_mul_i32 s4, s40, 1769472
s_mul_i32 s5, s52, 24576
s_add_u32 s4, s4, s5
s_mul_i32 s5, s50, 196608
s_add_u32 s4, s4, s5
s_lshl_b32 s5, s40, 3
s_add_u32 s5, s5, s52
s_lshl_b32 s5, s5, 8
s_lshl_b32 s52, s50, 15
s_add_u32 s5, s5, s52
s_add_u32 s5, s5, 46202880
s_lshl_b32 s52, s40, 2
s_add_u32 s52, s52, s51
s_mul_i32 s6, s52, 36864
s_lshl_b32 s51, s50, 7
s_add_u32 s6, s6, s51
s_lshl_b32 s51, s49, 6
s_add_u32 s6, s6, s51
s_mul_i32 s57, s52, 36864
s_add_u32 s57, s57, 37748736
s_lshl_b32 s59, s52, 8
s_add_u32 s59, s59, 46153728
s_mul_i32 s7, s49, 331776
s_lshl_b32 s51, s50, 10
s_add_u32 s7, s7, s51
s_add_u32 s7, s7, 40108032
s_lshl_b32 s49, s58, 9
s_add_u32 s4, s4, s49
s_lshl_b32 s49, s58, 4
s_add_u32 s6, s6, s49
s_mul_i32 s49, s58, 165888
s_add_u32 s7, s7, s49
s_cmp_eq_u32 s43, 1
s_cbranch_scc1 L_ffn_c1
s_waitcnt vmcnt(17)
v_dot2_f32_bf16 v76, v4, s54, 0
v_dot2_f32_bf16 v78, v4, v4, 0
v_dot2_f32_bf16 v76, v5, s54, v76
v_dot2_f32_bf16 v78, v5, v5, v78
v_dot2_f32_bf16 v76, v6, s54, v76
v_dot2_f32_bf16 v78, v6, v6, v78
v_dot2_f32_bf16 v76, v7, s54, v76
v_dot2_f32_bf16 v78, v7, v7, v78
s_waitcnt vmcnt(16)
v_dot2_f32_bf16 v77, v40, s54, 0
v_dot2_f32_bf16 v79, v40, v40, 0
v_dot2_f32_bf16 v77, v41, s54, v77
v_dot2_f32_bf16 v79, v41, v41, v79
v_dot2_f32_bf16 v77, v42, s54, v77
v_dot2_f32_bf16 v79, v42, v42, v79
v_dot2_f32_bf16 v77, v43, s54, v77
v_dot2_f32_bf16 v79, v43, v43, v79
s_waitcnt vmcnt(15)
v_dot2_f32_bf16 v76, v8, s54, v76
v_dot2_f32_bf16 v78, v8, v8, v78
v_dot2_f32_bf16 v76, v9, s54, v76
v_dot2_f32_bf16 v78, v9, v9, v78
v_dot2_f32_bf16 v76, v10, s54, v76
v_dot2_f32_bf16 v78, v10, v10, v78
v_dot2_f32_bf16 v76, v11, s54, v76
v_dot2_f32_bf16 v78, v11, v11, v78
s_waitcnt vmcnt(14)
v_dot2_f32_bf16 v77, v44, s54, v77
v_dot2_f32_bf16 v79, v44, v44, v79
v_dot2_f32_bf16 v77, v45, s54, v77
v_dot2_f32_bf16 v79, v45, v45, v79
v_dot2_f32_bf16 v77, v46, s54, v77
v_dot2_f32_bf16 v79, v46, v46, v79
v_dot2_f32_bf16 v77, v47, s54, v77
v_dot2_f32_bf16 v79, v47, v47, v79
s_waitcnt vmcnt(13)
v_dot2_f32_bf16 v76, v12, s54, v76
v_dot2_f32_bf16 v78, v12, v12, v78
v_dot2_f32_bf16 v76, v13, s54, v76
v_dot2_f32_bf16 v78, v13, v13, v78
v_dot2_f32_bf16 v76, v14, s54, v76
v_dot2_f32_bf16 v78, v14, v14, v78
v_dot2_f32_bf16 v76, v15, s54, v76
v_dot2_f32_bf16 v78, v15, v15, v78
s_waitcnt vmcnt(12)
v_dot2_f32_bf16 v77, v48, s54, v77
v_dot2_f32_bf16 v79, v48, v48, v79
v_dot2_f32_bf16 v77, v49, s54, v77
v_dot2_f32_bf16 v79, v49, v49, v79
v_dot2_f32_bf16 v77, v50, s54, v77
v_dot2_f32_bf16 v79, v50, v50, v79
v_dot2_f32_bf16 v77, v51, s54, v77
v_dot2_f32_bf16 v79, v51, v51, v79
s_waitcnt vmcnt(11)
v_dot2_f32_bf16 v76, v16, s54, v76
v_dot2_f32_bf16 v78, v16, v16, v78
v_dot2_f32_bf16 v76, v17, s54, v76
v_dot2_f32_bf16 v78, v17, v17, v78
v_dot2_f32_bf16 v76, v18, s54, v76
v_dot2_f32_bf16 v78, v18, v18, v78
v_dot2_f32_bf16 v76, v19, s54, v76
v_dot2_f32_bf16 v78, v19, v19, v78
s_waitcnt vmcnt(10)
v_dot2_f32_bf16 v77, v52, s54, v77
v_dot2_f32_bf16 v79, v52, v52, v79
v_dot2_f32_bf16 v77, v53, s54, v77
v_dot2_f32_bf16 v79, v53, v53, v79
v_dot2_f32_bf16 v77, v54, s54, v77
v_dot2_f32_bf16 v79, v54, v54, v79
v_dot2_f32_bf16 v77, v55, s54, v77
v_dot2_f32_bf16 v79, v55, v55, v79
s_waitcnt vmcnt(9)
v_dot2_f32_bf16 v76, v20, s54, v76
v_dot2_f32_bf16 v78, v20, v20, v78
v_dot2_f32_bf16 v76, v21, s54, v76
v_dot2_f32_bf16 v78, v21, v21, v78
v_dot2_f32_bf16 v76, v22, s54, v76
v_dot2_f32_bf16 v78, v22, v22, v78
v_dot2_f32_bf16 v76, v23, s54, v76
v_dot2_f32_bf16 v78, v23, v23, v78
s_waitcnt vmcnt(8)
v_dot2_f32_bf16 v77, v56, s54, v77
v_dot2_f32_bf16 v79, v56, v56, v79
v_dot2_f32_bf16 v77, v57, s54, v77
v_dot2_f32_bf16 v79, v57, v57, v79
v_dot2_f32_bf16 v77, v58, s54, v77
v_dot2_f32_bf16 v79, v58, v58, v79
v_dot2_f32_bf16 v77, v59, s54, v77
v_dot2_f32_bf16 v79, v59, v59, v79
s_waitcnt vmcnt(7)
v_dot2_f32_bf16 v76, v24, s54, v76
v_dot2_f32_bf16 v78, v24, v24, v78
v_dot2_f32_bf16 v76, v25, s54, v76
v_dot2_f32_bf16 v78, v25, v25, v78
v_dot2_f32_bf16 v76, v26, s54, v76
v_dot2_f32_bf16 v78, v26, v26, v78
v_dot2_f32_bf16 v76, v27, s54, v76
v_dot2_f32_bf16 v78, v27, v27, v78
s_waitcnt vmcnt(6)
v_dot2_f32_bf16 v77, v60, s54, v77
v_dot2_f32_bf16 v79, v60, v60, v79
v_dot2_f32_bf16 v77, v61, s54, v77
v_dot2_f32_bf16 v79, v61, v61, v79
v_dot2_f32_bf16 v77, v62, s54, v77
v_dot2_f32_bf16 v79, v62, v62, v79
v_dot2_f32_bf16 v77, v63, s54, v77
v_dot2_f32_bf16 v79, v63, v63, v79
s_waitcnt vmcnt(5)
v_dot2_f32_bf16 v76, v28, s54, v76
v_dot2_f32_bf16 v78, v28, v28, v78
v_dot2_f32_bf16 v76, v29, s54, v76
v_dot2_f32_bf16 v78, v29, v29, v78
v_dot2_f32_bf16 v76, v30, s54, v76
v_dot2_f32_bf16 v78, v30, v30, v78
v_dot2_f32_bf16 v76, v31, s54, v76
v_dot2_f32_bf16 v78, v31, v31, v78
s_waitcnt vmcnt(4)
v_dot2_f32_bf16 v77, v64, s54, v77
v_dot2_f32_bf16 v79, v64, v64, v79
v_dot2_f32_bf16 v77, v65, s54, v77
v_dot2_f32_bf16 v79, v65, v65, v79
v_dot2_f32_bf16 v77, v66, s54, v77
v_dot2_f32_bf16 v79, v66, v66, v79
v_dot2_f32_bf16 v77, v67, s54, v77
v_dot2_f32_bf16 v79, v67, v67, v79
s_waitcnt vmcnt(3)
v_dot2_f32_bf16 v76, v32, s54, v76
v_dot2_f32_bf16 v78, v32, v32, v78
v_dot2_f32_bf16 v76, v33, s54, v76
v_dot2_f32_bf16 v78, v33, v33, v78
v_dot2_f32_bf16 v76, v34, s54, v76
v_dot2_f32_bf16 v78, v34, v34, v78
v_dot2_f32_bf16 v76, v35, s54, v76
v_dot2_f32_bf16 v78, v35, v35, v78
s_waitcnt vmcnt(2)
v_dot2_f32_bf16 v77, v68, s54, v77
v_dot2_f32_bf16 v79, v68, v68, v79
v_dot2_f32_bf16 v77, v69, s54, v77
v_dot2_f32_bf16 v79, v69, v69, v79
v_dot2_f32_bf16 v77, v70, s54, v77
v_dot2_f32_bf16 v79, v70, v70, v79
v_dot2_f32_bf16 v77, v71, s54, v77
v_dot2_f32_bf16 v79, v71, v71, v79
s_waitcnt vmcnt(1)
v_dot2_f32_bf16 v76, v36, s54, v76
v_dot2_f32_bf16 v78, v36, v36, v78
v_dot2_f32_bf16 v76, v37, s54, v76
v_dot2_f32_bf16 v78, v37, v37, v78
v_dot2_f32_bf16 v76, v38, s54, v76
v_dot2_f32_bf16 v78, v38, v38, v78
v_dot2_f32_bf16 v76, v39, s54, v76
v_dot2_f32_bf16 v78, v39, v39, v78
s_waitcnt vmcnt(0)
v_dot2_f32_bf16 v77, v72, s54, v77
v_dot2_f32_bf16 v79, v72, v72, v79
v_dot2_f32_bf16 v77, v73, s54, v77
v_dot2_f32_bf16 v79, v73, v73, v79
v_dot2_f32_bf16 v77, v74, s54, v77
v_dot2_f32_bf16 v79, v74, v74, v79
v_dot2_f32_bf16 v77, v75, s54, v77
v_dot2_f32_bf16 v79, v75, v75, v79
v_add_f32_dpp v76, v76, v76 quad_perm:[1,0,3,2] row_mask:0xf bank_mask:0xf
s_nop 0
v_add_f32_dpp v77, v77, v77 quad_perm:[1,0,3,2] row_mask:0xf bank_mask:0xf
v_add_f32_dpp v78, v78, v78 quad_perm:[1,0,3,2] row_mask:0xf bank_mask:0xf
v_add_f32_dpp v79, v79, v79 quad_perm:[1,0,3,2] row_mask:0xf bank_mask:0xf
v_add_f32_dpp v76, v76, v76 quad_perm:[2,3,0,1] row_mask:0xf bank_mask:0xf
v_add_f32_dpp v77, v77, v77 quad_perm:[2,3,0,1] row_mask:0xf bank_mask:0xf
v_add_f32_dpp v78, v78, v78 quad_perm:[2,3,0,1] row_mask:0xf bank_mask:0xf
v_add_f32_dpp v79, v79, v79 quad_perm:[2,3,0,1] row_mask:0xf bank_mask:0xf
v_add_f32_dpp v76, v76, v76 row_half_mirror row_mask:0xf bank_mask:0xf
v_add_f32_dpp v77, v77, v77 row_half_mirror row_mask:0xf bank_mask:0xf
v_add_f32_dpp v78, v78, v78 row_half_mirror row_mask:0xf bank_mask:0xf
v_add_f32_dpp v79, v79, v79 row_half_mirror row_mask:0xf bank_mask:0xf
v_mul_f32 v76, 0xbae38e39, v76
v_mul_f32 v77, 0xbae38e39, v77
v_mul_f32 v78, 0x3ae38e39, v78
v_mul_f32 v79, 0x3ae38e39, v79
v_fma_f32 v78, -v76, v76, v78
v_fma_f32 v79, -v77, v77, v79
v_max_f32 v78, 0, v78
v_max_f32 v79, 0, v79
v_add_f32 v78, 0x3727c5ac, v78
v_add_f32 v79, 0x3727c5ac, v79
v_rsq_f32 v78, v78
v_rsq_f32 v79, v79
v_mul_f32 v78, 1069066811, v78
v_mul_f32 v79, 1069066811, v79
v_mul_f32 v76, v76, v78
v_mul_f32 v77, v77, v79
v_lshlrev_b32 v245, 16, v4
v_and_b32 v244, s53, v4
v_lshlrev_b32 v243, 16, v5
v_and_b32 v242, s53, v5
v_lshlrev_b32 v241, 16, v6
v_and_b32 v240, s53, v6
v_lshlrev_b32 v239, 16, v7
v_and_b32 v238, s53, v7
v_fma_f32 v245, v245, v78, v76
v_fma_f32 v244, v244, v78, v76
v_fma_f32 v243, v243, v78, v76
v_fma_f32 v242, v242, v78, v76
v_fma_f32 v241, v241, v78, v76
v_fma_f32 v240, v240, v78, v76
v_fma_f32 v239, v239, v78, v76
v_fma_f32 v238, v238, v78, v76
v_cvt_pk_bf16_f32 v4, v245, v244
v_cvt_pk_bf16_f32 v5, v243, v242
v_cvt_pk_bf16_f32 v6, v241, v240
v_cvt_pk_bf16_f32 v7, v239, v238
ds_write_b128 v237, v[4:7] offset:0
v_lshlrev_b32 v245, 16, v40
v_and_b32 v244, s53, v40
v_lshlrev_b32 v243, 16, v41
v_and_b32 v242, s53, v41
v_lshlrev_b32 v241, 16, v42
v_and_b32 v240, s53, v42
v_lshlrev_b32 v239, 16, v43
v_and_b32 v238, s53, v43
v_fma_f32 v245, v245, v79, v77
v_fma_f32 v244, v244, v79, v77
v_fma_f32 v243, v243, v79, v77
v_fma_f32 v242, v242, v79, v77
v_fma_f32 v241, v241, v79, v77
v_fma_f32 v240, v240, v79, v77
v_fma_f32 v239, v239, v79, v77
v_fma_f32 v238, v238, v79, v77
v_cvt_pk_bf16_f32 v40, v245, v244
v_cvt_pk_bf16_f32 v41, v243, v242
v_cvt_pk_bf16_f32 v42, v241, v240
v_cvt_pk_bf16_f32 v43, v239, v238
ds_write_b128 v237, v[40:43] offset:128
v_lshlrev_b32 v245, 16, v8
v_and_b32 v244, s53, v8
v_lshlrev_b32 v243, 16, v9
v_and_b32 v242, s53, v9
v_lshlrev_b32 v241, 16, v10
v_and_b32 v240, s53, v10
v_lshlrev_b32 v239, 16, v11
v_and_b32 v238, s53, v11
v_fma_f32 v245, v245, v78, v76
v_fma_f32 v244, v244, v78, v76
v_fma_f32 v243, v243, v78, v76
v_fma_f32 v242, v242, v78, v76
v_fma_f32 v241, v241, v78, v76
v_fma_f32 v240, v240, v78, v76
v_fma_f32 v239, v239, v78, v76
v_fma_f32 v238, v238, v78, v76
v_cvt_pk_bf16_f32 v8, v245, v244
v_cvt_pk_bf16_f32 v9, v243, v242
v_cvt_pk_bf16_f32 v10, v241, v240
v_cvt_pk_bf16_f32 v11, v239, v238
ds_write_b128 v237, v[8:11] offset:16384
v_lshlrev_b32 v245, 16, v44
v_and_b32 v244, s53, v44
v_lshlrev_b32 v243, 16, v45
v_and_b32 v242, s53, v45
v_lshlrev_b32 v241, 16, v46
v_and_b32 v240, s53, v46
v_lshlrev_b32 v239, 16, v47
v_and_b32 v238, s53, v47
v_fma_f32 v245, v245, v79, v77
v_fma_f32 v244, v244, v79, v77
v_fma_f32 v243, v243, v79, v77
v_fma_f32 v242, v242, v79, v77
v_fma_f32 v241, v241, v79, v77
v_fma_f32 v240, v240, v79, v77
v_fma_f32 v239, v239, v79, v77
v_fma_f32 v238, v238, v79, v77
v_cvt_pk_bf16_f32 v44, v245, v244
v_cvt_pk_bf16_f32 v45, v243, v242
v_cvt_pk_bf16_f32 v46, v241, v240
v_cvt_pk_bf16_f32 v47, v239, v238
ds_write_b128 v237, v[44:47] offset:16512
v_lshlrev_b32 v245, 16, v12
v_and_b32 v244, s53, v12
v_lshlrev_b32 v243, 16, v13
v_and_b32 v242, s53, v13
v_lshlrev_b32 v241, 16, v14
v_and_b32 v240, s53, v14
v_lshlrev_b32 v239, 16, v15
v_and_b32 v238, s53, v15
v_fma_f32 v245, v245, v78, v76
v_fma_f32 v244, v244, v78, v76
v_fma_f32 v243, v243, v78, v76
v_fma_f32 v242, v242, v78, v76
v_fma_f32 v241, v241, v78, v76
v_fma_f32 v240, v240, v78, v76
v_fma_f32 v239, v239, v78, v76
v_fma_f32 v238, v238, v78, v76
v_cvt_pk_bf16_f32 v12, v245, v244
v_cvt_pk_bf16_f32 v13, v243, v242
v_cvt_pk_bf16_f32 v14, v241, v240
v_cvt_pk_bf16_f32 v15, v239, v238
v_lshlrev_b32 v245, 16, v48
v_and_b32 v244, s53, v48
v_lshlrev_b32 v243, 16, v49
v_and_b32 v242, s53, v49
v_lshlrev_b32 v241, 16, v50
v_and_b32 v240, s53, v50
v_lshlrev_b32 v239, 16, v51
v_and_b32 v238, s53, v51
v_fma_f32 v245, v245, v79, v77
v_fma_f32 v244, v244, v79, v77
v_fma_f32 v243, v243, v79, v77
v_fma_f32 v242, v242, v79, v77
v_fma_f32 v241, v241, v79, v77
v_fma_f32 v240, v240, v79, v77
v_fma_f32 v239, v239, v79, v77
v_fma_f32 v238, v238, v79, v77
v_cvt_pk_bf16_f32 v48, v245, v244
v_cvt_pk_bf16_f32 v49, v243, v242
v_cvt_pk_bf16_f32 v50, v241, v240
v_cvt_pk_bf16_f32 v51, v239, v238
v_lshlrev_b32 v245, 16, v16
v_and_b32 v244, s53, v16
v_lshlrev_b32 v243, 16, v17
v_and_b32 v242, s53, v17
v_lshlrev_b32 v241, 16, v18
v_and_b32 v240, s53, v18
v_lshlrev_b32 v239, 16, v19
v_and_b32 v238, s53, v19
v_fma_f32 v245, v245, v78, v76
v_fma_f32 v244, v244, v78, v76
v_fma_f32 v243, v243, v78, v76
v_fma_f32 v242, v242, v78, v76
v_fma_f32 v241, v241, v78, v76
v_fma_f32 v240, v240, v78, v76
v_fma_f32 v239, v239, v78, v76
v_fma_f32 v238, v238, v78, v76
v_cvt_pk_bf16_f32 v16, v245, v244
v_cvt_pk_bf16_f32 v17, v243, v242
v_cvt_pk_bf16_f32 v18, v241, v240
v_cvt_pk_bf16_f32 v19, v239, v238
v_lshlrev_b32 v245, 16, v52
v_and_b32 v244, s53, v52
v_lshlrev_b32 v243, 16, v53
v_and_b32 v242, s53, v53
v_lshlrev_b32 v241, 16, v54
v_and_b32 v240, s53, v54
v_lshlrev_b32 v239, 16, v55
v_and_b32 v238, s53, v55
v_fma_f32 v245, v245, v79, v77
v_fma_f32 v244, v244, v79, v77
v_fma_f32 v243, v243, v79, v77
v_fma_f32 v242, v242, v79, v77
v_fma_f32 v241, v241, v79, v77
v_fma_f32 v240, v240, v79, v77
v_fma_f32 v239, v239, v79, v77
v_fma_f32 v238, v238, v79, v77
v_cvt_pk_bf16_f32 v52, v245, v244
v_cvt_pk_bf16_f32 v53, v243, v242
v_cvt_pk_bf16_f32 v54, v241, v240
v_cvt_pk_bf16_f32 v55, v239, v238
s_add_u32 m0, s48, 0
s_add_u32 s49, s46, 0
buffer_load_dwordx4 v246, s[16:19], s49 offen lds
v_lshlrev_b32 v245, 16, v20
v_and_b32 v244, s53, v20
v_lshlrev_b32 v243, 16, v21
v_and_b32 v242, s53, v21
v_lshlrev_b32 v241, 16, v22
v_and_b32 v240, s53, v22
v_lshlrev_b32 v239, 16, v23
v_and_b32 v238, s53, v23
v_fma_f32 v245, v245, v78, v76
s_add_u32 m0, s48, 4096
s_add_u32 s49, s46, 294912
buffer_load_dwordx4 v246, s[16:19], s49 offen lds
v_fma_f32 v244, v244, v78, v76
v_fma_f32 v243, v243, v78, v76
v_fma_f32 v242, v242, v78, v76
v_fma_f32 v241, v241, v78, v76
v_fma_f32 v240, v240, v78, v76
v_fma_f32 v239, v239, v78, v76
v_fma_f32 v238, v238, v78, v76
v_cvt_pk_bf16_f32 v20, v245, v244
v_cvt_pk_bf16_f32 v21, v243, v242
s_add_u32 m0, s48, 8192
s_add_u32 s49, s46, 589824
buffer_load_dwordx4 v246, s[16:19], s49 offen lds
v_cvt_pk_bf16_f32 v22, v241, v240
v_cvt_pk_bf16_f32 v23, v239, v238
v_lshlrev_b32 v245, 16, v56
v_and_b32 v244, s53, v56
v_lshlrev_b32 v243, 16, v57
v_and_b32 v242, s53, v57
v_lshlrev_b32 v241, 16, v58
v_and_b32 v240, s53, v58
v_lshlrev_b32 v239, 16, v59
s_add_u32 m0, s48, 12288
s_add_u32 s49, s46, 884736
buffer_load_dwordx4 v246, s[16:19], s49 offen lds
v_and_b32 v238, s53, v59
v_fma_f32 v245, v245, v79, v77
v_fma_f32 v244, v244, v79, v77
v_fma_f32 v243, v243, v79, v77
v_fma_f32 v242, v242, v79, v77
v_fma_f32 v241, v241, v79, v77
v_fma_f32 v240, v240, v79, v77
v_fma_f32 v239, v239, v79, v77
v_fma_f32 v238, v238, v79, v77
s_add_u32 m0, s48, 16384
s_add_u32 s49, s46, 128
buffer_load_dwordx4 v246, s[16:19], s49 offen lds
v_cvt_pk_bf16_f32 v56, v245, v244
v_cvt_pk_bf16_f32 v57, v243, v242
v_cvt_pk_bf16_f32 v58, v241, v240
v_cvt_pk_bf16_f32 v59, v239, v238
v_lshlrev_b32 v245, 16, v24
v_and_b32 v244, s53, v24
v_lshlrev_b32 v243, 16, v25
v_and_b32 v242, s53, v25
v_lshlrev_b32 v241, 16, v26
s_add_u32 m0, s48, 20480
s_add_u32 s49, s46, 295040
buffer_load_dwordx4 v246, s[16:19], s49 offen lds
v_and_b32 v240, s53, v26
v_lshlrev_b32 v239, 16, v27
v_and_b32 v238, s53, v27
v_fma_f32 v245, v245, v78, v76
v_fma_f32 v244, v244, v78, v76
v_fma_f32 v243, v243, v78, v76
v_fma_f32 v242, v242, v78, v76
v_fma_f32 v241, v241, v78, v76
v_fma_f32 v240, v240, v78, v76
s_add_u32 m0, s48, 24576
s_add_u32 s49, s46, 589952
buffer_load_dwordx4 v246, s[16:19], s49 offen lds
v_fma_f32 v239, v239, v78, v76
v_fma_f32 v238, v238, v78, v76
v_cvt_pk_bf16_f32 v24, v245, v244
v_cvt_pk_bf16_f32 v25, v243, v242
v_cvt_pk_bf16_f32 v26, v241, v240
v_cvt_pk_bf16_f32 v27, v239, v238
v_lshlrev_b32 v245, 16, v60
v_and_b32 v244, s53, v60
v_lshlrev_b32 v243, 16, v61
s_add_u32 m0, s48, 28672
s_add_u32 s49, s46, 884864
buffer_load_dwordx4 v246, s[16:19], s49 offen lds
v_and_b32 v242, s53, v61
v_lshlrev_b32 v241, 16, v62
v_and_b32 v240, s53, v62
v_lshlrev_b32 v239, 16, v63
v_and_b32 v238, s53, v63
v_fma_f32 v245, v245, v79, v77
v_fma_f32 v244, v244, v79, v77
v_fma_f32 v243, v243, v79, v77
v_fma_f32 v242, v242, v79, v77
s_add_u32 m0, s48, 32768
s_add_u32 s49, s46, 1179648
buffer_load_dwordx4 v246, s[16:19], s49 offen lds
v_fma_f32 v241, v241, v79, v77
v_fma_f32 v240, v240, v79, v77
v_fma_f32 v239, v239, v79, v77
v_fma_f32 v238, v238, v79, v77
v_cvt_pk_bf16_f32 v60, v245, v244
v_cvt_pk_bf16_f32 v61, v243, v242
v_cvt_pk_bf16_f32 v62, v241, v240
v_cvt_pk_bf16_f32 v63, v239, v238
s_mov_b32 s12, s98
s_mov_b32 s13, s99
s_mov_b32 s14, 1990656
s_mov_b32 s15, 0x20000
v_mul_u32_u24 v255, 171, v1
v_lshrrev_b32 v255, 9, v255
v_mul_u32_u24 v254, 768, v255
v_lshl_add_u32 v254, v1, 7, v254
v_cmp_gt_u32 vcc, 54, v1
v_mov_b32 v253, 1879048192
s_nop 0
v_cndmask_b32 v254, v253, v254, vcc
s_and_b32 s50, s40, 7
s_mul_i32 s50, s50, 3
s_add_u32 s50, s50, s3
s_lshl_b32 s50, s50, 2
s_add_u32 s50, s50, s42
s_mul_i32 s50, s50, 20736
s_mul_i32 s51, s41, 288
s_and_b32 s51, s51, 0xffffff80
s_add_u32 s50, s50, s51
buffer_load_dword v233, v254, s[12:15], s50 offen
v_and_b32 v255, 1, v252
v_lshrrev_b32 v254, 1, v250
v_lshl_or_b32 v255, v255, 1, v254
v_lshlrev_b32 v255, 5, v255
v_lshl_add_u32 v254, v252, 3, v250
v_lshl_add_u32 v255, v254, 7, v255
v_lshl_add_u32 v255, v249, 3, v255
v_xor_b32 v232, 0, v255
v_add_u32 v3, 0x10000, v232
v_xor_b32 v2, 32, v255
v_add_u32 v231, 0x10000, v2
s_waitcnt vmcnt(1)
s_waitcnt lgkmcnt(0)
s_barrier
s_setprio 0
ds_read_b128 v[4:7], v236 offset:0
ds_read_b128 v[8:11], v236 offset:1024
ds_read_b64_tr_b16 v[80:81], v232 offset:0
ds_read_b64_tr_b16 v[82:83], v232 offset:512
ds_read_b64_tr_b16 v[84:85], v2 offset:0
ds_read_b64_tr_b16 v[86:87], v2 offset:512
ds_read_b64_tr_b16 v[88:89], v232 offset:4096
ds_read_b64_tr_b16 v[90:91], v232 offset:4608
ds_read_b64_tr_b16 v[92:93], v2 offset:4096
ds_read_b64_tr_b16 v[94:95], v2 offset:4608
ds_read_b128 v[40:43], v235 offset:8192
ds_read_b128 v[44:47], v235 offset:9216
ds_read_b128 v[100:103], v236 offset:16384
ds_read_b128 v[104:107], v236 offset:17408
ds_read_b128 v[108:111], v235 offset:24576
ds_read_b128 v[112:115], v235 offset:25600
s_waitcnt lgkmcnt(14)
s_waitcnt lgkmcnt(10)
v_mfma_f32_16x16x32_bf16 v[116:119], v[80:83], v[4:7], 0
ds_read_b64_tr_b16 v[96:97], v232 offset:8192
s_add_u32 m0, s48, 40960
s_add_u32 s49, s46, 1769472
buffer_load_dwordx4 v246, s[16:19], s49 offen lds
v_mfma_f32_16x16x32_bf16 v[120:123], v[80:83], v[8:11], 0
ds_read_b64_tr_b16 v[98:99], v232 offset:8704
ds_write_b128 v237, v[12:15] offset:32768
v_mfma_f32_16x16x32_bf16 v[124:127], v[84:87], v[4:7], 0
ds_read_b64_tr_b16 v[80:81], v2 offset:8192
v_mfma_f32_16x16x32_bf16 v[128:131], v[84:87], v[8:11], 0
ds_read_b64_tr_b16 v[82:83], v2 offset:8704
s_waitcnt lgkmcnt(9)
v_mfma_f32_16x16x32_bf16 v[116:119], v[88:91], v[40:43], v[116:119]
ds_read_b64_tr_b16 v[84:85], v232 offset:12288
s_add_u32 m0, s48, 49152
s_add_u32 s49, s46, 1179776
buffer_load_dwordx4 v246, s[16:19], s49 offen lds
v_mfma_f32_16x16x32_bf16 v[120:123], v[88:91], v[44:47], v[120:123]
ds_read_b64_tr_b16 v[86:87], v232 offset:12800
ds_write_b128 v237, v[48:51] offset:32896
v_mfma_f32_16x16x32_bf16 v[124:127], v[92:95], v[40:43], v[124:127]
ds_read_b64_tr_b16 v[88:89], v2 offset:12288
v_mfma_f32_16x16x32_bf16 v[128:131], v[92:95], v[44:47], v[128:131]
ds_read_b64_tr_b16 v[90:91], v2 offset:12800
s_waitcnt lgkmcnt(12)
s_waitcnt lgkmcnt(5)
v_mfma_f32_16x16x32_bf16 v[116:119], v[96:99], v[100:103], v[116:119]
ds_read_b64_tr_b16 v[92:93], v232 offset:16384
s_add_u32 m0, s48, 57344
s_add_u32 s49, s46, 1769600
buffer_load_dwordx4 v246, s[16:19], s49 offen lds
v_mfma_f32_16x16x32_bf16 v[120:123], v[96:99], v[104:107], v[120:123]
ds_read_b64_tr_b16 v[94:95], v232 offset:16896
v_mfma_f32_16x16x32_bf16 v[124:127], v[80:83], v[100:103], v[124:127]
ds_read_b64_tr_b16 v[96:97], v2 offset:16384
ds_write_b128 v237, v[16:19] offset:49152
v_mfma_f32_16x16x32_bf16 v[128:131], v[80:83], v[104:107], v[128:131]
ds_read_b64_tr_b16 v[98:99], v2 offset:16896
s_waitcnt lgkmcnt(5)
v_mfma_f32_16x16x32_bf16 v[116:119], v[84:87], v[108:111], v[116:119]
ds_read_b64_tr_b16 v[80:81], v232 offset:20480
s_add_u32 m0, s48, 65536
s_add_u32 s49, s46, 2359296
buffer_load_dwordx4 v246, s[16:19], s49 offen lds
v_mfma_f32_16x16x32_bf16 v[120:123], v[84:87], v[112:115], v[120:123]
ds_read_b64_tr_b16 v[82:83], v232 offset:20992
v_mfma_f32_16x16x32_bf16 v[124:127], v[88:91], v[108:111], v[124:127]
ds_read_b64_tr_b16 v[84:85], v2 offset:20480
v_mfma_f32_16x16x32_bf16 v[128:131], v[88:91], v[112:115], v[128:131]
ds_read_b64_tr_b16 v[86:87], v2 offset:20992
s_waitcnt lgkmcnt(4)
v_mfma_f32_16x16x32_bf16 v[132:135], v[92:95], v[4:7], 0
ds_read_b64_tr_b16 v[88:89], v232 offset:24576
s_add_u32 m0, s48, 73728
s_add_u32 s49, s46, 2949120
buffer_load_dwordx4 v246, s[16:19], s49 offen lds
v_mfma_f32_16x16x32_bf16 v[136:139], v[92:95], v[8:11], 0
ds_read_b64_tr_b16 v[90:91], v232 offset:25088
ds_write_b128 v237, v[52:55] offset:49280
v_mfma_f32_16x16x32_bf16 v[140:143], v[96:99], v[4:7], 0
ds_read_b64_tr_b16 v[92:93], v2 offset:24576
v_mfma_f32_16x16x32_bf16 v[144:147], v[96:99], v[8:11], 0
ds_read_b64_tr_b16 v[94:95], v2 offset:25088
s_waitcnt lgkmcnt(5)
v_mfma_f32_16x16x32_bf16 v[132:135], v[80:83], v[40:43], v[132:135]
ds_read_b64_tr_b16 v[96:97], v232 offset:28672
s_add_u32 m0, s48, 81920
s_add_u32 s49, s46, 2359424
buffer_load_dwordx4 v246, s[16:19], s49 offen lds
v_mfma_f32_16x16x32_bf16 v[136:139], v[80:83], v[44:47], v[136:139]
ds_read_b64_tr_b16 v[98:99], v232 offset:29184
v_mfma_f32_16x16x32_bf16 v[140:143], v[84:87], v[40:43], v[140:143]
ds_read_b64_tr_b16 v[80:81], v2 offset:28672
v_mfma_f32_16x16x32_bf16 v[144:147], v[84:87], v[44:47], v[144:147]
ds_read_b64_tr_b16 v[82:83], v2 offset:29184
s_waitcnt lgkmcnt(4)
v_mfma_f32_16x16x32_bf16 v[132:135], v[88:91], v[100:103], v[132:135]
ds_read_b64_tr_b16 v[84:85], v232 offset:32768
v_mfma_f32_16x16x32_bf16 v[136:139], v[88:91], v[104:107], v[136:139]
ds_read_b64_tr_b16 v[86:87], v232 offset:33280
v_mfma_f32_16x16x32_bf16 v[140:143], v[92:95], v[100:103], v[140:143]
ds_read_b64_tr_b16 v[88:89], v2 offset:32768
v_mfma_f32_16x16x32_bf16 v[144:147], v[92:95], v[104:107], v[144:147]
ds_read_b64_tr_b16 v[90:91], v2 offset:33280
s_waitcnt vmcnt(3)
s_barrier
s_setprio 3
ds_read_b128 v[12:15], v236 offset:32768
ds_read_b128 v[16:19], v236 offset:33792
ds_read_b128 v[48:51], v235 offset:40960
ds_read_b128 v[52:55], v235 offset:41984
ds_read_b128 v[148:151], v236 offset:49152
ds_read_b128 v[152:155], v236 offset:50176
ds_read_b128 v[156:159], v235 offset:57344
ds_read_b128 v[160:163], v235 offset:58368
s_waitcnt lgkmcnt(12)
v_mfma_f32_16x16x32_bf16 v[132:135], v[96:99], v[108:111], v[132:135]
ds_read_b64_tr_b16 v[92:93], v232 offset:36864
s_add_u32 m0, s48, 0
s_add_u32 s49, s46, 2949248
buffer_load_dwordx4 v246, s[16:19], s49 offen lds
v_mfma_f32_16x16x32_bf16 v[136:139], v[96:99], v[112:115], v[136:139]
ds_read_b64_tr_b16 v[94:95], v232 offset:37376
ds_write_b128 v237, v[20:23] offset:0
v_mfma_f32_16x16x32_bf16 v[140:143], v[80:83], v[108:111], v[140:143]
ds_read_b64_tr_b16 v[96:97], v2 offset:36864
v_mfma_f32_16x16x32_bf16 v[144:147], v[80:83], v[112:115], v[144:147]
ds_read_b64_tr_b16 v[98:99], v2 offset:37376
s_waitcnt lgkmcnt(11)
v_mfma_f32_16x16x32_bf16 v[116:119], v[84:87], v[12:15], v[116:119]
ds_read_b64_tr_b16 v[80:81], v232 offset:40960
ds_write_b128 v237, v[56:59] offset:128
v_mfma_f32_16x16x32_bf16 v[120:123], v[84:87], v[16:19], v[120:123]
ds_read_b64_tr_b16 v[82:83], v232 offset:41472
v_mfma_f32_16x16x32_bf16 v[124:127], v[88:91], v[12:15], v[124:127]
ds_read_b64_tr_b16 v[84:85], v2 offset:40960
s_add_u32 m0, s48, 8192
s_add_u32 s49, s46, 3538944
buffer_load_dwordx4 v246, s[16:19], s49 offen lds
v_mfma_f32_16x16x32_bf16 v[128:131], v[88:91], v[16:19], v[128:131]
ds_read_b64_tr_b16 v[86:87], v2 offset:41472
s_setprio 2
s_waitcnt lgkmcnt(14)
s_waitcnt lgkmcnt(5)
v_mfma_f32_16x16x32_bf16 v[116:119], v[92:95], v[48:51], v[116:119]
ds_read_b64_tr_b16 v[88:89], v232 offset:45056
v_mfma_f32_16x16x32_bf16 v[120:123], v[92:95], v[52:55], v[120:123]
ds_read_b64_tr_b16 v[90:91], v232 offset:45568
v_mfma_f32_16x16x32_bf16 v[124:127], v[96:99], v[48:51], v[124:127]
ds_read_b64_tr_b16 v[92:93], v2 offset:45056
ds_write_b128 v237, v[24:27] offset:16384
v_mfma_f32_16x16x32_bf16 v[128:131], v[96:99], v[52:55], v[128:131]
ds_read_b64_tr_b16 v[94:95], v2 offset:45568
s_waitcnt lgkmcnt(5)
v_mfma_f32_16x16x32_bf16 v[116:119], v[80:83], v[148:151], v[116:119]
ds_read_b64_tr_b16 v[96:97], v232 offset:49152
s_add_u32 m0, s48, 16384
s_add_u32 s49, s46, 4128768
buffer_load_dwordx4 v246, s[16:19], s49 offen lds
v_mfma_f32_16x16x32_bf16 v[120:123], v[80:83], v[152:155], v[120:123]
ds_read_b64_tr_b16 v[98:99], v232 offset:49664
s_setprio 1
v_mfma_f32_16x16x32_bf16 v[124:127], v[84:87], v[148:151], v[124:127]
ds_read_b64_tr_b16 v[80:81], v2 offset:49152
v_mfma_f32_16x16x32_bf16 v[128:131], v[84:87], v[152:155], v[128:131]
ds_read_b64_tr_b16 v[82:83], v2 offset:49664
s_waitcnt lgkmcnt(4)
v_mfma_f32_16x16x32_bf16 v[116:119], v[88:91], v[156:159], v[116:119]
ds_read_b64_tr_b16 v[84:85], v232 offset:53248
ds_write_b128 v237, v[60:63] offset:16512
v_mfma_f32_16x16x32_bf16 v[120:123], v[88:91], v[160:163], v[120:123]
ds_read_b64_tr_b16 v[86:87], v232 offset:53760
v_mfma_f32_16x16x32_bf16 v[124:127], v[92:95], v[156:159], v[124:127]
ds_read_b64_tr_b16 v[88:89], v2 offset:53248
s_add_u32 m0, s48, 24576
s_add_u32 s49, s46, 3539072
buffer_load_dwordx4 v246, s[16:19], s49 offen lds
v_mfma_f32_16x16x32_bf16 v[128:131], v[92:95], v[160:163], v[128:131]
ds_read_b64_tr_b16 v[90:91], v2 offset:53760
s_waitcnt lgkmcnt(5)
v_mfma_f32_16x16x32_bf16 v[132:135], v[96:99], v[12:15], v[132:135]
ds_read_b64_tr_b16 v[92:93], v232 offset:57344
v_mfma_f32_16x16x32_bf16 v[136:139], v[96:99], v[16:19], v[136:139]
ds_read_b64_tr_b16 v[94:95], v232 offset:57856
s_setprio 0
v_mfma_f32_16x16x32_bf16 v[140:143], v[80:83], v[12:15], v[140:143]
ds_read_b64_tr_b16 v[96:97], v2 offset:57344
v_mfma_f32_16x16x32_bf16 v[144:147], v[80:83], v[16:19], v[144:147]
ds_read_b64_tr_b16 v[98:99], v2 offset:57856
s_waitcnt lgkmcnt(4)
v_mfma_f32_16x16x32_bf16 v[132:135], v[84:87], v[48:51], v[132:135]
ds_read_b64_tr_b16 v[80:81], v232 offset:61440
v_mfma_f32_16x16x32_bf16 v[136:139], v[84:87], v[52:55], v[136:139]
ds_read_b64_tr_b16 v[82:83], v232 offset:61952
v_mfma_f32_16x16x32_bf16 v[140:143], v[88:91], v[48:51], v[140:143]
ds_read_b64_tr_b16 v[84:85], v2 offset:61440
v_mfma_f32_16x16x32_bf16 v[144:147], v[88:91], v[52:55], v[144:147]
ds_read_b64_tr_b16 v[86:87], v2 offset:61952
s_lshl_b32 s50, s42, 4
s_add_u32 s50, s50, 64
v_add_u32 v253, s50, v1
v_lshrrev_b32 v255, 2, v253
v_mul_u32_u24 v254, 9216, v255
v_lshl_add_u32 v254, v249, 7, v254
s_mul_i32 s50, s40, 331776
s_add_u32 s50, s50, s46
s_add_u32 s50, s50, 256
v_cmp_gt_u32 vcc, 144, v253
s_nop 0
s_and_b64 vcc, vcc, 0xffff
v_mov_b32 v253, 1879048192
v_cndmask_b32 v254, v253, v254, vcc
buffer_load_dword v233, v254, s[16:19], s50 offen
s_waitcnt vmcnt(4)
s_barrier
s_setprio 3
ds_read_b128 v[20:23], v236 offset:0
ds_read_b128 v[24:27], v236 offset:1024
ds_read_b128 v[56:59], v235 offset:8192
ds_read_b128 v[60:63], v235 offset:9216
ds_read_b128 v[164:167], v236 offset:16384
ds_read_b128 v[168:171], v236 offset:17408
ds_read_b128 v[172:175], v235 offset:24576
ds_read_b128 v[176:179], v235 offset:25600
s_waitcnt lgkmcnt(12)
v_mfma_f32_16x16x32_bf16 v[132:135], v[92:95], v[148:151], v[132:135]
ds_read_b64_tr_b16 v[88:89], v3 offset:0
s_add_u32 m0, s48, 32768
s_add_u32 s49, s46, 5013504
buffer_load_dwordx4 v246, s[16:19], s49 offen lds
v_lshlrev_b32 v245, 16, v28
v_and_b32 v244, s53, v28
v_lshlrev_b32 v243, 16, v29
v_and_b32 v242, s53, v29
v_mfma_f32_16x16x32_bf16 v[136:139], v[92:95], v[152:155], v[136:139]
ds_read_b64_tr_b16 v[90:91], v3 offset:512
v_lshlrev_b32 v241, 16, v30
v_and_b32 v240, s53, v30
v_lshlrev_b32 v239, 16, v31
v_and_b32 v238, s53, v31
v_mfma_f32_16x16x32_bf16 v[140:143], v[96:99], v[148:151], v[140:143]
ds_read_b64_tr_b16 v[92:93], v231 offset:0
v_fma_f32 v245, v245, v78, v76
v_fma_f32 v244, v244, v78, v76
v_fma_f32 v243, v243, v78, v76
v_fma_f32 v242, v242, v78, v76
v_mfma_f32_16x16x32_bf16 v[144:147], v[96:99], v[152:155], v[144:147]
ds_read_b64_tr_b16 v[94:95], v231 offset:512
v_fma_f32 v241, v241, v78, v76
v_fma_f32 v240, v240, v78, v76
v_fma_f32 v239, v239, v78, v76
s_waitcnt lgkmcnt(12)
v_mfma_f32_16x16x32_bf16 v[132:135], v[80:83], v[156:159], v[132:135]
ds_read_b64_tr_b16 v[96:97], v3 offset:4096
v_fma_f32 v238, v238, v78, v76
v_cvt_pk_bf16_f32 v28, v245, v244
v_cvt_pk_bf16_f32 v29, v243, v242
v_cvt_pk_bf16_f32 v30, v241, v240
v_mfma_f32_16x16x32_bf16 v[136:139], v[80:83], v[160:163], v[136:139]
ds_read_b64_tr_b16 v[98:99], v3 offset:4608
v_cvt_pk_bf16_f32 v31, v239, v238
ds_write_b128 v237, v[28:31] offset:32768
v_lshlrev_b32 v245, 16, v64
v_mfma_f32_16x16x32_bf16 v[140:143], v[84:87], v[156:159], v[140:143]
ds_read_b64_tr_b16 v[80:81], v231 offset:4096
v_and_b32 v244, s53, v64
v_lshlrev_b32 v243, 16, v65
v_and_b32 v242, s53, v65
v_lshlrev_b32 v241, 16, v66
v_mfma_f32_16x16x32_bf16 v[144:147], v[84:87], v[160:163], v[144:147]
ds_read_b64_tr_b16 v[82:83], v231 offset:4608
v_and_b32 v240, s53, v66
v_lshlrev_b32 v239, 16, v67
v_and_b32 v238, s53, v67
s_setprio 2
s_waitcnt lgkmcnt(15)
s_waitcnt lgkmcnt(5)
v_mfma_f32_16x16x32_bf16 v[116:119], v[88:91], v[20:23], v[116:119]
ds_read_b64_tr_b16 v[84:85], v3 offset:8192
s_add_u32 m0, s48, 40960
s_add_u32 s49, s46, 4128896
buffer_load_dwordx4 v246, s[16:19], s49 offen lds
v_fma_f32 v245, v245, v79, v77
v_fma_f32 v244, v244, v79, v77
v_fma_f32 v243, v243, v79, v77
v_mfma_f32_16x16x32_bf16 v[120:123], v[88:91], v[24:27], v[120:123]
ds_read_b64_tr_b16 v[86:87], v3 offset:8704
v_fma_f32 v242, v242, v79, v77
v_fma_f32 v241, v241, v79, v77
v_fma_f32 v240, v240, v79, v77
v_fma_f32 v239, v239, v79, v77
v_mfma_f32_16x16x32_bf16 v[124:127], v[92:95], v[20:23], v[124:127]
ds_read_b64_tr_b16 v[88:89], v231 offset:8192
v_fma_f32 v238, v238, v79, v77
v_cvt_pk_bf16_f32 v64, v245, v244
v_cvt_pk_bf16_f32 v65, v243, v242
v_cvt_pk_bf16_f32 v66, v241, v240
v_mfma_f32_16x16x32_bf16 v[128:131], v[92:95], v[24:27], v[128:131]
ds_read_b64_tr_b16 v[90:91], v231 offset:8704
v_cvt_pk_bf16_f32 v67, v239, v238
ds_write_b128 v237, v[64:67] offset:32896
v_lshlrev_b32 v245, 16, v32
s_waitcnt lgkmcnt(5)
v_mfma_f32_16x16x32_bf16 v[116:119], v[96:99], v[56:59], v[116:119]
ds_read_b64_tr_b16 v[92:93], v3 offset:12288
v_and_b32 v244, s53, v32
v_lshlrev_b32 v243, 16, v33
v_and_b32 v242, s53, v33
v_lshlrev_b32 v241, 16, v34
v_mfma_f32_16x16x32_bf16 v[120:123], v[96:99], v[60:63], v[120:123]
ds_read_b64_tr_b16 v[94:95], v3 offset:12800
v_and_b32 v240, s53, v34
v_lshlrev_b32 v239, 16, v35
v_and_b32 v238, s53, v35
s_setprio 1
v_mfma_f32_16x16x32_bf16 v[124:127], v[80:83], v[56:59], v[124:127]
ds_read_b64_tr_b16 v[96:97], v231 offset:12288
v_fma_f32 v245, v245, v78, v76
v_fma_f32 v244, v244, v78, v76
v_fma_f32 v243, v243, v78, v76
v_fma_f32 v242, v242, v78, v76
v_mfma_f32_16x16x32_bf16 v[128:131], v[80:83], v[60:63], v[128:131]
ds_read_b64_tr_b16 v[98:99], v231 offset:12800
v_fma_f32 v241, v241, v78, v76
v_fma_f32 v240, v240, v78, v76
v_fma_f32 v239, v239, v78, v76
s_waitcnt lgkmcnt(5)
v_mfma_f32_16x16x32_bf16 v[116:119], v[84:87], v[164:167], v[116:119]
ds_read_b64_tr_b16 v[80:81], v3 offset:16384
s_add_u32 m0, s48, 49152
s_add_u32 s49, s46, 4718720
buffer_load_dwordx4 v246, s[16:19], s49 offen lds
v_fma_f32 v238, v238, v78, v76
v_cvt_pk_bf16_f32 v32, v245, v244
v_cvt_pk_bf16_f32 v33, v243, v242
v_mfma_f32_16x16x32_bf16 v[120:123], v[84:87], v[168:171], v[120:123]
ds_read_b64_tr_b16 v[82:83], v3 offset:16896
v_cvt_pk_bf16_f32 v34, v241, v240
v_cvt_pk_bf16_f32 v35, v239, v238
ds_write_b128 v237, v[32:35] offset:49152
v_lshlrev_b32 v245, 16, v68
v_mfma_f32_16x16x32_bf16 v[124:127], v[88:91], v[164:167], v[124:127]
ds_read_b64_tr_b16 v[84:85], v231 offset:16384
v_and_b32 v244, s53, v68
v_lshlrev_b32 v243, 16, v69
v_and_b32 v242, s53, v69
v_lshlrev_b32 v241, 16, v70
v_mfma_f32_16x16x32_bf16 v[128:131], v[88:91], v[168:171], v[128:131]
ds_read_b64_tr_b16 v[86:87], v231 offset:16896
v_and_b32 v240, s53, v70
v_lshlrev_b32 v239, 16, v71
v_and_b32 v238, s53, v71
s_waitcnt lgkmcnt(5)
v_mfma_f32_16x16x32_bf16 v[116:119], v[92:95], v[172:175], v[116:119]
ds_read_b64_tr_b16 v[88:89], v3 offset:20480
v_fma_f32 v245, v245, v79, v77
v_fma_f32 v244, v244, v79, v77
v_fma_f32 v243, v243, v79, v77
v_fma_f32 v242, v242, v79, v77
v_mfma_f32_16x16x32_bf16 v[120:123], v[92:95], v[176:179], v[120:123]
ds_read_b64_tr_b16 v[90:91], v3 offset:20992
v_fma_f32 v241, v241, v79, v77
v_fma_f32 v240, v240, v79, v77
v_fma_f32 v239, v239, v79, v77
s_setprio 0
v_mfma_f32_16x16x32_bf16 v[124:127], v[96:99], v[172:175], v[124:127]
ds_read_b64_tr_b16 v[92:93], v231 offset:20480
v_fma_f32 v238, v238, v79, v77
v_cvt_pk_bf16_f32 v68, v245, v244
v_cvt_pk_bf16_f32 v69, v243, v242
v_cvt_pk_bf16_f32 v70, v241, v240
v_mfma_f32_16x16x32_bf16 v[128:131], v[96:99], v[176:179], v[128:131]
ds_read_b64_tr_b16 v[94:95], v231 offset:20992
v_cvt_pk_bf16_f32 v71, v239, v238
ds_write_b128 v237, v[68:71] offset:49280
s_waitcnt lgkmcnt(5)
v_mfma_f32_16x16x32_bf16 v[132:135], v[80:83], v[20:23], v[132:135]
ds_read_b64_tr_b16 v[96:97], v232 offset:0
v_mfma_f32_16x16x32_bf16 v[136:139], v[80:83], v[24:27], v[136:139]
ds_read_b64_tr_b16 v[98:99], v232 offset:512
v_mfma_f32_16x16x32_bf16 v[140:143], v[84:87], v[20:23], v[140:143]
ds_read_b64_tr_b16 v[80:81], v2 offset:0
v_mfma_f32_16x16x32_bf16 v[144:147], v[84:87], v[24:27], v[144:147]
ds_read_b64_tr_b16 v[82:83], v2 offset:512
s_waitcnt vmcnt(4)
s_waitcnt lgkmcnt(4)
s_barrier
s_setprio 3
ds_read_b128 v[28:31], v236 offset:32768
ds_read_b128 v[32:35], v236 offset:33792
ds_read_b128 v[64:67], v235 offset:40960
ds_read_b128 v[68:71], v235 offset:41984
ds_read_b128 v[180:183], v236 offset:49152
ds_read_b128 v[184:187], v236 offset:50176
ds_read_b128 v[188:191], v235 offset:57344
ds_read_b128 v[192:195], v235 offset:58368
v_mfma_f32_16x16x32_bf16 v[132:135], v[88:91], v[56:59], v[132:135]
ds_read_b64_tr_b16 v[84:85], v232 offset:4096
s_add_u32 m0, s48, 57344
s_add_u32 s49, s46, 256
buffer_load_dwordx4 v246, s[16:19], s49 offen lds
v_lshlrev_b32 v245, 16, v36
v_and_b32 v244, s53, v36
v_mfma_f32_16x16x32_bf16 v[136:139], v[88:91], v[60:63], v[136:139]
ds_read_b64_tr_b16 v[86:87], v232 offset:4608
v_lshlrev_b32 v243, 16, v37
v_and_b32 v242, s53, v37
v_mfma_f32_16x16x32_bf16 v[140:143], v[92:95], v[56:59], v[140:143]
ds_read_b64_tr_b16 v[88:89], v2 offset:4096
v_lshlrev_b32 v241, 16, v38
v_and_b32 v240, s53, v38
v_mfma_f32_16x16x32_bf16 v[144:147], v[92:95], v[60:63], v[144:147]
ds_read_b64_tr_b16 v[90:91], v2 offset:4608
v_lshlrev_b32 v239, 16, v39
v_and_b32 v238, s53, v39
s_waitcnt lgkmcnt(12)
v_mfma_f32_16x16x32_bf16 v[132:135], v[96:99], v[164:167], v[132:135]
ds_read_b64_tr_b16 v[92:93], v232 offset:8192
s_add_u32 m0, s48, 65536
s_add_u32 s49, s46, 590080
buffer_load_dwordx4 v246, s[16:19], s49 offen lds
v_fma_f32 v245, v245, v78, v76
v_mfma_f32_16x16x32_bf16 v[136:139], v[96:99], v[168:171], v[136:139]
ds_read_b64_tr_b16 v[94:95], v232 offset:8704
v_fma_f32 v244, v244, v78, v76
v_fma_f32 v243, v243, v78, v76
v_mfma_f32_16x16x32_bf16 v[140:143], v[80:83], v[164:167], v[140:143]
ds_read_b64_tr_b16 v[96:97], v2 offset:8192
v_fma_f32 v242, v242, v78, v76
v_fma_f32 v241, v241, v78, v76
v_mfma_f32_16x16x32_bf16 v[144:147], v[80:83], v[168:171], v[144:147]
ds_read_b64_tr_b16 v[98:99], v2 offset:8704
v_fma_f32 v240, v240, v78, v76
v_fma_f32 v239, v239, v78, v76
s_setprio 2
s_waitcnt lgkmcnt(4)
v_mfma_f32_16x16x32_bf16 v[132:135], v[84:87], v[172:175], v[132:135]
ds_read_b64_tr_b16 v[80:81], v232 offset:12288
s_add_u32 m0, s48, 73728
s_add_u32 s49, s46, 1179904
buffer_load_dwordx4 v246, s[16:19], s49 offen lds
v_fma_f32 v238, v238, v78, v76
v_mfma_f32_16x16x32_bf16 v[136:139], v[84:87], v[176:179], v[136:139]
ds_read_b64_tr_b16 v[82:83], v232 offset:12800
v_cvt_pk_bf16_f32 v36, v245, v244
v_cvt_pk_bf16_f32 v37, v243, v242
v_mfma_f32_16x16x32_bf16 v[140:143], v[88:91], v[172:175], v[140:143]
ds_read_b64_tr_b16 v[84:85], v2 offset:12288
v_cvt_pk_bf16_f32 v38, v241, v240
v_cvt_pk_bf16_f32 v39, v239, v238
v_mfma_f32_16x16x32_bf16 v[144:147], v[88:91], v[176:179], v[144:147]
ds_read_b64_tr_b16 v[86:87], v2 offset:12800
ds_write_b128 v237, v[36:39] offset:0
v_lshlrev_b32 v245, 16, v72
s_waitcnt lgkmcnt(5)
v_mfma_f32_16x16x32_bf16 v[116:119], v[92:95], v[28:31], v[116:119]
ds_read_b64_tr_b16 v[88:89], v232 offset:16384
s_add_u32 m0, s48, 81920
s_add_u32 s49, s46, 1769728
buffer_load_dwordx4 v246, s[16:19], s49 offen lds
v_and_b32 v244, s53, v72
v_mfma_f32_16x16x32_bf16 v[120:123], v[92:95], v[32:35], v[120:123]
ds_read_b64_tr_b16 v[90:91], v232 offset:16896
v_lshlrev_b32 v243, 16, v73
v_and_b32 v242, s53, v73
s_setprio 1
v_mfma_f32_16x16x32_bf16 v[124:127], v[96:99], v[28:31], v[124:127]
ds_read_b64_tr_b16 v[92:93], v2 offset:16384
v_lshlrev_b32 v241, 16, v74
v_and_b32 v240, s53, v74
v_mfma_f32_16x16x32_bf16 v[128:131], v[96:99], v[32:35], v[128:131]
ds_read_b64_tr_b16 v[94:95], v2 offset:16896
v_lshlrev_b32 v239, 16, v75
v_and_b32 v238, s53, v75
s_waitcnt lgkmcnt(5)
v_mfma_f32_16x16x32_bf16 v[116:119], v[80:83], v[64:67], v[116:119]
ds_read_b64_tr_b16 v[96:97], v232 offset:20480
s_add_u32 m0, s48, 110592
s_add_u32 s49, s46, 2359552
buffer_load_dwordx4 v246, s[16:19], s49 offen lds
v_fma_f32 v245, v245, v79, v77
v_fma_f32 v244, v244, v79, v77
v_mfma_f32_16x16x32_bf16 v[120:123], v[80:83], v[68:71], v[120:123]
ds_read_b64_tr_b16 v[98:99], v232 offset:20992
v_fma_f32 v243, v243, v79, v77
v_fma_f32 v242, v242, v79, v77
v_mfma_f32_16x16x32_bf16 v[124:127], v[84:87], v[64:67], v[124:127]
ds_read_b64_tr_b16 v[80:81], v2 offset:20480
v_fma_f32 v241, v241, v79, v77
v_fma_f32 v240, v240, v79, v77
v_mfma_f32_16x16x32_bf16 v[128:131], v[84:87], v[68:71], v[128:131]
ds_read_b64_tr_b16 v[82:83], v2 offset:20992
v_fma_f32 v239, v239, v79, v77
s_waitcnt lgkmcnt(4)
v_mfma_f32_16x16x32_bf16 v[116:119], v[88:91], v[180:183], v[116:119]
ds_read_b64_tr_b16 v[84:85], v232 offset:24576
s_add_u32 m0, s48, 118784
s_add_u32 s49, s46, 2949376
buffer_load_dwordx4 v246, s[16:19], s49 offen lds
v_fma_f32 v238, v238, v79, v77
v_cvt_pk_bf16_f32 v72, v245, v244
v_mfma_f32_16x16x32_bf16 v[120:123], v[88:91], v[184:187], v[120:123]
ds_read_b64_tr_b16 v[86:87], v232 offset:25088
v_cvt_pk_bf16_f32 v73, v243, v242
v_cvt_pk_bf16_f32 v74, v241, v240
s_setprio 0
v_mfma_f32_16x16x32_bf16 v[124:127], v[92:95], v[180:183], v[124:127]
ds_read_b64_tr_b16 v[88:89], v2 offset:24576
v_cvt_pk_bf16_f32 v75, v239, v238
ds_write_b128 v237, v[72:75] offset:128
v_mfma_f32_16x16x32_bf16 v[128:131], v[92:95], v[184:187], v[128:131]
ds_read_b64_tr_b16 v[90:91], v2 offset:25088
s_waitcnt lgkmcnt(5)
v_mfma_f32_16x16x32_bf16 v[116:119], v[96:99], v[188:191], v[116:119]
ds_read_b64_tr_b16 v[92:93], v232 offset:28672
v_mfma_f32_16x16x32_bf16 v[120:123], v[96:99], v[192:195], v[120:123]
ds_read_b64_tr_b16 v[94:95], v232 offset:29184
v_mfma_f32_16x16x32_bf16 v[124:127], v[80:83], v[188:191], v[124:127]
ds_read_b64_tr_b16 v[96:97], v2 offset:28672
v_mfma_f32_16x16x32_bf16 v[128:131], v[80:83], v[192:195], v[128:131]
ds_read_b64_tr_b16 v[98:99], v2 offset:29184
s_waitcnt vmcnt(5)
s_waitcnt lgkmcnt(5)
s_barrier
s_setprio 3
ds_read_b128 v[36:39], v236 offset:0
ds_read_b128 v[72:75], v236 offset:1024
ds_read_b128 v[76:79], v235 offset:8192
ds_read_b128 v[196:199], v235 offset:9216
v_mfma_f32_16x16x32_bf16 v[132:135], v[84:87], v[28:31], v[132:135]
ds_read_b64_tr_b16 v[80:81], v232 offset:32768
s_add_u32 m0, s48, 4096
s_add_u32 s49, s46, 3539200
buffer_load_dwordx4 v246, s[16:19], s49 offen lds
v_mfma_f32_16x16x32_bf16 v[136:139], v[84:87], v[32:35], v[136:139]
ds_read_b64_tr_b16 v[82:83], v232 offset:33280
s_waitcnt lgkmcnt(10)
v_mfma_f32_16x16x32_bf16 v[140:143], v[88:91], v[28:31], v[140:143]
ds_read_b64_tr_b16 v[84:85], v2 offset:32768
v_mfma_f32_16x16x32_bf16 v[144:147], v[88:91], v[32:35], v[144:147]
ds_read_b64_tr_b16 v[86:87], v2 offset:33280
s_waitcnt lgkmcnt(6)
v_mfma_f32_16x16x32_bf16 v[116:119], v[92:95], v[36:39], v[116:119]
ds_read_b64_tr_b16 v[88:89], v232 offset:36864
v_mfma_f32_16x16x32_bf16 v[120:123], v[92:95], v[72:75], v[120:123]
ds_read_b64_tr_b16 v[90:91], v232 offset:37376
v_mfma_f32_16x16x32_bf16 v[124:127], v[96:99], v[36:39], v[124:127]
ds_read_b64_tr_b16 v[92:93], v2 offset:36864
v_mfma_f32_16x16x32_bf16 v[128:131], v[96:99], v[72:75], v[128:131]
ds_read_b64_tr_b16 v[94:95], v2 offset:37376
s_setprio 2
s_waitcnt lgkmcnt(8)
s_waitcnt lgkmcnt(4)
v_mfma_f32_16x16x32_bf16 v[116:119], v[80:83], v[76:79], v[116:119]
ds_read_b64_tr_b16 v[96:97], v232 offset:40960
s_add_u32 m0, s48, 12288
s_add_u32 s49, s46, 4129024
buffer_load_dwordx4 v246, s[16:19], s49 offen lds
v_mfma_f32_16x16x32_bf16 v[120:123], v[80:83], v[196:199], v[120:123]
ds_read_b64_tr_b16 v[98:99], v232 offset:41472
v_mfma_f32_16x16x32_bf16 v[124:127], v[84:87], v[76:79], v[124:127]
ds_read_b64_tr_b16 v[80:81], v2 offset:40960
v_mfma_f32_16x16x32_bf16 v[128:131], v[84:87], v[196:199], v[128:131]
ds_read_b64_tr_b16 v[82:83], v2 offset:41472
s_waitcnt lgkmcnt(4)
v_mfma_f32_16x16x32_bf16 v[132:135], v[88:91], v[64:67], v[132:135]
ds_read_b64_tr_b16 v[84:85], v232 offset:45056
v_mfma_f32_16x16x32_bf16 v[136:139], v[88:91], v[68:71], v[136:139]
ds_read_b64_tr_b16 v[86:87], v232 offset:45568
v_mfma_f32_16x16x32_bf16 v[140:143], v[92:95], v[64:67], v[140:143]
ds_read_b64_tr_b16 v[88:89], v2 offset:45056
v_mfma_f32_16x16x32_bf16 v[144:147], v[92:95], v[68:71], v[144:147]
ds_read_b64_tr_b16 v[90:91], v2 offset:45568
s_setprio 1
s_waitcnt lgkmcnt(4)
v_mfma_f32_16x16x32_bf16 v[132:135], v[96:99], v[180:183], v[132:135]
ds_read_b64_tr_b16 v[92:93], v232 offset:49152
s_add_u32 m0, s48, 20480
s_add_u32 s49, s46, 4718848
buffer_load_dwordx4 v246, s[16:19], s49 offen lds
v_exp_f32 v235, -v116
v_mfma_f32_16x16x32_bf16 v[136:139], v[96:99], v[184:187], v[136:139]
ds_read_b64_tr_b16 v[94:95], v232 offset:49664
v_exp_f32 v245, -v117
v_exp_f32 v244, -v118
v_exp_f32 v230, -v119
v_mfma_f32_16x16x32_bf16 v[140:143], v[80:83], v[180:183], v[140:143]
ds_read_b64_tr_b16 v[96:97], v2 offset:49152
v_add_f32 v235, 1.0, v235
v_add_f32 v245, 1.0, v245
v_mfma_f32_16x16x32_bf16 v[144:147], v[80:83], v[184:187], v[144:147]
ds_read_b64_tr_b16 v[98:99], v2 offset:49664
v_add_f32 v244, 1.0, v244
v_add_f32 v230, 1.0, v230
s_waitcnt lgkmcnt(4)
v_mfma_f32_16x16x32_bf16 v[132:135], v[84:87], v[188:191], v[132:135]
ds_read_b64_tr_b16 v[80:81], v232 offset:53248
v_rcp_f32 v235, v235
v_rcp_f32 v245, v245
v_rcp_f32 v244, v244
v_mfma_f32_16x16x32_bf16 v[136:139], v[84:87], v[192:195], v[136:139]
ds_read_b64_tr_b16 v[82:83], v232 offset:53760
v_rcp_f32 v230, v230
v_mul_f32 v116, v116, v235
v_mfma_f32_16x16x32_bf16 v[140:143], v[88:91], v[188:191], v[140:143]
ds_read_b64_tr_b16 v[84:85], v2 offset:53248
v_mul_f32 v117, v117, v245
v_mul_f32 v118, v118, v244
v_mfma_f32_16x16x32_bf16 v[144:147], v[88:91], v[192:195], v[144:147]
ds_read_b64_tr_b16 v[86:87], v2 offset:53760
v_mul_f32 v119, v119, v230
v_exp_f32 v235, -v124
s_setprio 0
s_waitcnt lgkmcnt(4)
v_mfma_f32_16x16x32_bf16 v[132:135], v[92:95], v[36:39], v[132:135]
ds_read_b64_tr_b16 v[88:89], v232 offset:57344
v_exp_f32 v245, -v125
v_exp_f32 v244, -v126
v_exp_f32 v230, -v127
v_mfma_f32_16x16x32_bf16 v[136:139], v[92:95], v[72:75], v[136:139]
ds_read_b64_tr_b16 v[90:91], v232 offset:57856
v_add_f32 v235, 1.0, v235
v_add_f32 v245, 1.0, v245
v_mfma_f32_16x16x32_bf16 v[140:143], v[96:99], v[36:39], v[140:143]
ds_read_b64_tr_b16 v[92:93], v2 offset:57344
v_add_f32 v244, 1.0, v244
v_add_f32 v230, 1.0, v230
v_mfma_f32_16x16x32_bf16 v[144:147], v[96:99], v[72:75], v[144:147]
ds_read_b64_tr_b16 v[94:95], v2 offset:57856
v_rcp_f32 v235, v235
v_rcp_f32 v245, v245
s_waitcnt lgkmcnt(4)
v_mfma_f32_16x16x32_bf16 v[132:135], v[80:83], v[76:79], v[132:135]
ds_read_b64_tr_b16 v[96:97], v232 offset:61440
v_rcp_f32 v244, v244
v_rcp_f32 v230, v230
v_mul_f32 v124, v124, v235
v_mfma_f32_16x16x32_bf16 v[136:139], v[80:83], v[196:199], v[136:139]
ds_read_b64_tr_b16 v[98:99], v232 offset:61952
v_mul_f32 v125, v125, v245
v_mul_f32 v126, v126, v244
v_mfma_f32_16x16x32_bf16 v[140:143], v[84:87], v[76:79], v[140:143]
ds_read_b64_tr_b16 v[80:81], v2 offset:61440
v_mul_f32 v127, v127, v230
v_cvt_pk_bf16_f32 v116, v116, v117
v_mfma_f32_16x16x32_bf16 v[144:147], v[84:87], v[196:199], v[144:147]
ds_read_b64_tr_b16 v[82:83], v2 offset:61952
v_cvt_pk_bf16_f32 v117, v118, v119
v_cvt_pk_bf16_f32 v118, v124, v125
s_lshl_b32 s50, s42, 4
s_add_u32 s50, s50, 0
v_add_u32 v253, s50, v1
v_mul_u32_u24 v255, 2731, v253
v_lshrrev_b32 v255, 16, v255
v_mul_u32_u24 v254, 1152, v253
v_mul_u32_u24 v255, 27520, v255
v_sub_u32 v254, v254, v255
s_mul_i32 s50, s40, 27648
s_add_u32 s50, s50, s47
v_cmp_gt_u32 vcc, 216, v253
s_nop 0
s_and_b64 vcc, vcc, 0xffff
v_mov_b32 v253, 1879048192
v_cndmask_b32 v254, v253, v254, vcc
buffer_load_dword v233, v254, s[20:23], s50 offen
s_waitcnt vmcnt(4)
s_barrier
s_setprio 3
v_mov_b32 v255, 0
buffer_load_dwordx2 v[228:229], v255, s[36:39], 0 offen sc1
s_waitcnt lgkmcnt(4)
v_mfma_f32_16x16x32_bf16 v[200:203], v[88:91], v[4:7], 0
ds_read_b64_tr_b16 v[84:85], v3 offset:0
s_add_u32 m0, s48, 24576
s_add_u32 s49, s46, 384
buffer_load_dwordx4 v246, s[16:19], s49 offen lds
v_cvt_pk_bf16_f32 v119, v126, v127
v_mfma_f32_16x16x32_bf16 v[204:207], v[88:91], v[8:11], 0
ds_read_b64_tr_b16 v[86:87], v3 offset:512
v_exp_f32 v235, -v120
v_exp_f32 v245, -v121
v_mfma_f32_16x16x32_bf16 v[208:211], v[92:95], v[4:7], 0
ds_read_b64_tr_b16 v[88:89], v231 offset:0
v_exp_f32 v244, -v122
v_exp_f32 v230, -v123
v_mfma_f32_16x16x32_bf16 v[212:215], v[92:95], v[8:11], 0
ds_read_b64_tr_b16 v[90:91], v231 offset:512
v_add_f32 v235, 1.0, v235
s_waitcnt lgkmcnt(4)
v_mfma_f32_16x16x32_bf16 v[200:203], v[96:99], v[40:43], v[200:203]
ds_read_b64_tr_b16 v[92:93], v3 offset:4096
s_add_u32 m0, s48, 32768
s_add_u32 s49, s46, 590208
buffer_load_dwordx4 v246, s[16:19], s49 offen lds
v_add_f32 v245, 1.0, v245
v_add_f32 v244, 1.0, v244
v_mfma_f32_16x16x32_bf16 v[204:207], v[96:99], v[44:47], v[204:207]
ds_read_b64_tr_b16 v[94:95], v3 offset:4608
v_add_f32 v230, 1.0, v230
v_rcp_f32 v235, v235
v_mfma_f32_16x16x32_bf16 v[208:211], v[80:83], v[40:43], v[208:211]
ds_read_b64_tr_b16 v[96:97], v231 offset:4096
v_rcp_f32 v245, v245
v_rcp_f32 v244, v244
v_mfma_f32_16x16x32_bf16 v[212:215], v[80:83], v[44:47], v[212:215]
ds_read_b64_tr_b16 v[98:99], v231 offset:4608
v_rcp_f32 v230, v230
s_waitcnt lgkmcnt(4)
v_mfma_f32_16x16x32_bf16 v[200:203], v[84:87], v[100:103], v[200:203]
ds_read_b64_tr_b16 v[80:81], v3 offset:8192
s_add_u32 m0, s48, 40960
s_add_u32 s49, s46, 1180032
buffer_load_dwordx4 v246, s[16:19], s49 offen lds
v_mul_f32 v120, v120, v235
v_mul_f32 v121, v121, v245
v_mfma_f32_16x16x32_bf16 v[204:207], v[84:87], v[104:107], v[204:207]
ds_read_b64_tr_b16 v[82:83], v3 offset:8704
v_mul_f32 v122, v122, v244
v_mul_f32 v123, v123, v230
s_setprio 2
v_mfma_f32_16x16x32_bf16 v[208:211], v[88:91], v[100:103], v[208:211]
ds_read_b64_tr_b16 v[84:85], v231 offset:8192
v_exp_f32 v235, -v128
v_exp_f32 v245, -v129
v_mfma_f32_16x16x32_bf16 v[212:215], v[88:91], v[104:107], v[212:215]
ds_read_b64_tr_b16 v[86:87], v231 offset:8704
v_exp_f32 v244, -v130
s_waitcnt lgkmcnt(4)
v_mfma_f32_16x16x32_bf16 v[200:203], v[92:95], v[108:111], v[200:203]
ds_read_b64_tr_b16 v[88:89], v3 offset:12288
s_add_u32 m0, s48, 49152
s_add_u32 s49, s46, 1769856
buffer_load_dwordx4 v246, s[16:19], s49 offen lds
v_exp_f32 v230, -v131
v_add_f32 v235, 1.0, v235
v_mfma_f32_16x16x32_bf16 v[204:207], v[92:95], v[112:115], v[204:207]
ds_read_b64_tr_b16 v[90:91], v3 offset:12800
v_add_f32 v245, 1.0, v245
v_add_f32 v244, 1.0, v244
v_mfma_f32_16x16x32_bf16 v[208:211], v[96:99], v[108:111], v[208:211]
ds_read_b64_tr_b16 v[92:93], v231 offset:12288
v_add_f32 v230, 1.0, v230
v_rcp_f32 v235, v235
v_mfma_f32_16x16x32_bf16 v[212:215], v[96:99], v[112:115], v[212:215]
ds_read_b64_tr_b16 v[94:95], v231 offset:12800
v_rcp_f32 v245, v245
s_waitcnt lgkmcnt(4)
v_mfma_f32_16x16x32_bf16 v[200:203], v[80:83], v[12:15], v[200:203]
ds_read_b64_tr_b16 v[96:97], v3 offset:16384
s_add_u32 m0, s48, 90112
s_add_u32 s49, s46, 2359680
buffer_load_dwordx4 v246, s[16:19], s49 offen lds
v_rcp_f32 v244, v244
v_rcp_f32 v230, v230
v_mfma_f32_16x16x32_bf16 v[204:207], v[80:83], v[16:19], v[204:207]
ds_read_b64_tr_b16 v[98:99], v3 offset:16896
v_mul_f32 v128, v128, v235
v_mul_f32 v129, v129, v245
s_setprio 1
v_mfma_f32_16x16x32_bf16 v[208:211], v[84:87], v[12:15], v[208:211]
ds_read_b64_tr_b16 v[80:81], v231 offset:16384
v_mul_f32 v130, v130, v244
v_mul_f32 v131, v131, v230
v_mfma_f32_16x16x32_bf16 v[212:215], v[84:87], v[16:19], v[212:215]
ds_read_b64_tr_b16 v[82:83], v231 offset:16896
v_cvt_pk_bf16_f32 v120, v120, v121
s_waitcnt lgkmcnt(4)
v_mfma_f32_16x16x32_bf16 v[200:203], v[88:91], v[48:51], v[200:203]
ds_read_b64_tr_b16 v[84:85], v3 offset:40960
s_add_u32 m0, s48, 98304
s_add_u32 s49, s46, 2949504
buffer_load_dwordx4 v246, s[16:19], s49 offen lds
v_cvt_pk_bf16_f32 v121, v122, v123
v_cvt_pk_bf16_f32 v122, v128, v129
v_mfma_f32_16x16x32_bf16 v[204:207], v[88:91], v[52:55], v[204:207]
ds_read_b64_tr_b16 v[86:87], v3 offset:41472
v_cvt_pk_bf16_f32 v123, v130, v131
v_mfma_f32_16x16x32_bf16 v[208:211], v[92:95], v[48:51], v[208:211]
ds_read_b64_tr_b16 v[88:89], v231 offset:40960
v_add_u32 v255, 139264, v247
ds_write_b128 v255, v[116:119] offset:0
ds_write_b128 v255, v[120:123] offset:4096
v_mfma_f32_16x16x32_bf16 v[212:215], v[92:95], v[52:55], v[212:215]
ds_read_b64_tr_b16 v[90:91], v231 offset:41472
s_waitcnt lgkmcnt(6)
v_mfma_f32_16x16x32_bf16 v[200:203], v[96:99], v[148:151], v[200:203]
ds_read_b64_tr_b16 v[92:93], v3 offset:45056
v_mfma_f32_16x16x32_bf16 v[204:207], v[96:99], v[152:155], v[204:207]
ds_read_b64_tr_b16 v[94:95], v3 offset:45568
v_mfma_f32_16x16x32_bf16 v[208:211], v[80:83], v[148:151], v[208:211]
ds_read_b64_tr_b16 v[96:97], v231 offset:45056
v_exp_f32 v235, -v132
v_exp_f32 v230, -v133
v_mfma_f32_16x16x32_bf16 v[212:215], v[80:83], v[152:155], v[212:215]
ds_read_b64_tr_b16 v[98:99], v231 offset:45568
v_exp_f32 v245, -v134
v_exp_f32 v244, -v135
s_setprio 0
s_waitcnt lgkmcnt(4)
v_mfma_f32_16x16x32_bf16 v[200:203], v[84:87], v[156:159], v[200:203]
ds_read_b64_tr_b16 v[80:81], v3 offset:49152
v_add_f32 v235, 1.0, v235
v_add_f32 v230, 1.0, v230
v_mfma_f32_16x16x32_bf16 v[204:207], v[84:87], v[160:163], v[204:207]
ds_read_b64_tr_b16 v[82:83], v3 offset:49664
v_add_f32 v245, 1.0, v245
v_mfma_f32_16x16x32_bf16 v[208:211], v[88:91], v[156:159], v[208:211]
ds_read_b64_tr_b16 v[84:85], v231 offset:49152
v_add_f32 v244, 1.0, v244
v_rcp_f32 v235, v235
v_mfma_f32_16x16x32_bf16 v[212:215], v[88:91], v[160:163], v[212:215]
ds_read_b64_tr_b16 v[86:87], v231 offset:49664
v_rcp_f32 v230, v230
v_rcp_f32 v245, v245
s_waitcnt lgkmcnt(4)
v_mfma_f32_16x16x32_bf16 v[200:203], v[92:95], v[20:23], v[200:203]
ds_read_b64_tr_b16 v[88:89], v3 offset:53248
v_rcp_f32 v244, v244
v_mul_f32 v132, v132, v235
v_mfma_f32_16x16x32_bf16 v[204:207], v[92:95], v[24:27], v[204:207]
ds_read_b64_tr_b16 v[90:91], v3 offset:53760
v_mul_f32 v133, v133, v230
v_mfma_f32_16x16x32_bf16 v[208:211], v[96:99], v[20:23], v[208:211]
ds_read_b64_tr_b16 v[92:93], v231 offset:53248
v_mul_f32 v134, v134, v245
v_mul_f32 v135, v135, v244
v_mfma_f32_16x16x32_bf16 v[212:215], v[96:99], v[24:27], v[212:215]
ds_read_b64_tr_b16 v[94:95], v231 offset:53760
v_exp_f32 v235, -v140
s_waitcnt vmcnt(5)
s_barrier
s_setprio 3
s_waitcnt lgkmcnt(4)
v_mfma_f32_16x16x32_bf16 v[200:203], v[80:83], v[56:59], v[200:203]
ds_read_b64_tr_b16 v[96:97], v232 offset:0
s_add_u32 m0, s48, 57344
s_add_u32 s49, s46, 3539328
buffer_load_dwordx4 v246, s[16:19], s49 offen lds
v_exp_f32 v230, -v141
v_exp_f32 v245, -v142
v_mfma_f32_16x16x32_bf16 v[204:207], v[80:83], v[60:63], v[204:207]
ds_read_b64_tr_b16 v[98:99], v232 offset:512
v_exp_f32 v244, -v143
v_add_f32 v235, 1.0, v235
v_mfma_f32_16x16x32_bf16 v[208:211], v[84:87], v[56:59], v[208:211]
ds_read_b64_tr_b16 v[80:81], v2 offset:0
v_add_f32 v230, 1.0, v230
v_add_f32 v245, 1.0, v245
v_mfma_f32_16x16x32_bf16 v[212:215], v[84:87], v[60:63], v[212:215]
ds_read_b64_tr_b16 v[82:83], v2 offset:512
v_add_f32 v244, 1.0, v244
v_rcp_f32 v235, v235
s_waitcnt lgkmcnt(4)
v_mfma_f32_16x16x32_bf16 v[200:203], v[88:91], v[164:167], v[200:203]
ds_read_b64_tr_b16 v[84:85], v232 offset:4096
v_rcp_f32 v230, v230
v_rcp_f32 v245, v245
v_mfma_f32_16x16x32_bf16 v[204:207], v[88:91], v[168:171], v[204:207]
ds_read_b64_tr_b16 v[86:87], v232 offset:4608
v_rcp_f32 v244, v244
v_mfma_f32_16x16x32_bf16 v[208:211], v[92:95], v[164:167], v[208:211]
ds_read_b64_tr_b16 v[88:89], v2 offset:4096
v_mul_f32 v140, v140, v235
v_mul_f32 v141, v141, v230
v_mfma_f32_16x16x32_bf16 v[212:215], v[92:95], v[168:171], v[212:215]
ds_read_b64_tr_b16 v[90:91], v2 offset:4608
v_mul_f32 v142, v142, v245
v_mul_f32 v143, v143, v244
s_waitcnt lgkmcnt(4)
v_mfma_f32_16x16x32_bf16 v[200:203], v[96:99], v[172:175], v[200:203]
ds_read_b64_tr_b16 v[92:93], v232 offset:8192
s_add_u32 m0, s48, 65536
s_add_u32 s49, s46, 4129152
buffer_load_dwordx4 v246, s[16:19], s49 offen lds
v_cvt_pk_bf16_f32 v132, v132, v133
v_mfma_f32_16x16x32_bf16 v[204:207], v[96:99], v[176:179], v[204:207]
ds_read_b64_tr_b16 v[94:95], v232 offset:8704
v_cvt_pk_bf16_f32 v133, v134, v135
v_cvt_pk_bf16_f32 v134, v140, v141
s_setprio 2
v_mfma_f32_16x16x32_bf16 v[208:211], v[80:83], v[172:175], v[208:211]
ds_read_b64_tr_b16 v[96:97], v2 offset:8192
v_cvt_pk_bf16_f32 v135, v142, v143
v_mfma_f32_16x16x32_bf16 v[212:215], v[80:83], v[176:179], v[212:215]
ds_read_b64_tr_b16 v[98:99], v2 offset:8704
v_exp_f32 v235, -v136
v_exp_f32 v230, -v137
s_waitcnt lgkmcnt(4)
v_mfma_f32_16x16x32_bf16 v[200:203], v[84:87], v[28:31], v[200:203]
ds_read_b64_tr_b16 v[80:81], v232 offset:12288
v_exp_f32 v245, -v138
v_exp_f32 v244, -v139
v_mfma_f32_16x16x32_bf16 v[204:207], v[84:87], v[32:35], v[204:207]
ds_read_b64_tr_b16 v[82:83], v232 offset:12800
v_add_f32 v235, 1.0, v235
v_mfma_f32_16x16x32_bf16 v[208:211], v[88:91], v[28:31], v[208:211]
ds_read_b64_tr_b16 v[84:85], v2 offset:12288
v_add_f32 v230, 1.0, v230
v_add_f32 v245, 1.0, v245
v_mfma_f32_16x16x32_bf16 v[212:215], v[88:91], v[32:35], v[212:215]
ds_read_b64_tr_b16 v[86:87], v2 offset:12800
v_add_f32 v244, 1.0, v244
v_rcp_f32 v235, v235
s_waitcnt lgkmcnt(4)
v_mfma_f32_16x16x32_bf16 v[200:203], v[92:95], v[64:67], v[200:203]
ds_read_b64_tr_b16 v[88:89], v232 offset:16384
s_add_u32 m0, s48, 73728
s_add_u32 s49, s46, 4718976
buffer_load_dwordx4 v246, s[16:19], s49 offen lds
v_rcp_f32 v230, v230
v_mfma_f32_16x16x32_bf16 v[204:207], v[92:95], v[68:71], v[204:207]
ds_read_b64_tr_b16 v[90:91], v232 offset:16896
v_rcp_f32 v245, v245
v_rcp_f32 v244, v244
s_setprio 1
v_mfma_f32_16x16x32_bf16 v[208:211], v[96:99], v[64:67], v[208:211]
ds_read_b64_tr_b16 v[92:93], v2 offset:16384
v_mul_f32 v136, v136, v235
v_mul_f32 v137, v137, v230
v_mfma_f32_16x16x32_bf16 v[212:215], v[96:99], v[68:71], v[212:215]
ds_read_b64_tr_b16 v[94:95], v2 offset:16896
v_mul_f32 v138, v138, v245
v_mul_f32 v139, v139, v244
s_waitcnt lgkmcnt(4)
v_mfma_f32_16x16x32_bf16 v[200:203], v[80:83], v[180:183], v[200:203]
ds_read_b64_tr_b16 v[96:97], v232 offset:20480
v_exp_f32 v235, -v144
v_exp_f32 v230, -v145
v_mfma_f32_16x16x32_bf16 v[204:207], v[80:83], v[184:187], v[204:207]
ds_read_b64_tr_b16 v[98:99], v232 offset:20992
v_exp_f32 v245, -v146
v_exp_f32 v244, -v147
v_mfma_f32_16x16x32_bf16 v[208:211], v[84:87], v[180:183], v[208:211]
ds_read_b64_tr_b16 v[80:81], v2 offset:20480
v_add_f32 v235, 1.0, v235
v_add_f32 v230, 1.0, v230
v_mfma_f32_16x16x32_bf16 v[212:215], v[84:87], v[184:187], v[212:215]
ds_read_b64_tr_b16 v[82:83], v2 offset:20992
v_add_f32 v245, 1.0, v245
s_waitcnt lgkmcnt(4)
v_mfma_f32_16x16x32_bf16 v[200:203], v[88:91], v[188:191], v[200:203]
ds_read_b64_tr_b16 v[84:85], v3 offset:20480
s_add_u32 m0, s48, 81920
s_add_u32 s49, s46, 512
buffer_load_dwordx4 v246, s[16:19], s49 offen lds
v_add_f32 v244, 1.0, v244
v_rcp_f32 v235, v235
v_mfma_f32_16x16x32_bf16 v[204:207], v[88:91], v[192:195], v[204:207]
ds_read_b64_tr_b16 v[86:87], v3 offset:20992
v_rcp_f32 v230, v230
v_rcp_f32 v245, v245
v_mfma_f32_16x16x32_bf16 v[208:211], v[92:95], v[188:191], v[208:211]
ds_read_b64_tr_b16 v[88:89], v231 offset:20480
v_rcp_f32 v244, v244
v_mul_f32 v144, v144, v235
v_mfma_f32_16x16x32_bf16 v[212:215], v[92:95], v[192:195], v[212:215]
ds_read_b64_tr_b16 v[90:91], v231 offset:20992
v_mul_f32 v145, v145, v230
s_setprio 0
s_waitcnt lgkmcnt(4)
v_mfma_f32_16x16x32_bf16 v[200:203], v[96:99], v[36:39], v[200:203]
ds_read_b64_tr_b16 v[92:93], v232 offset:24576
v_mul_f32 v146, v146, v245
v_mul_f32 v147, v147, v244
v_mfma_f32_16x16x32_bf16 v[204:207], v[96:99], v[72:75], v[204:207]
ds_read_b64_tr_b16 v[94:95], v232 offset:25088
v_cvt_pk_bf16_f32 v136, v136, v137
v_cvt_pk_bf16_f32 v137, v138, v139
v_mfma_f32_16x16x32_bf16 v[208:211], v[80:83], v[36:39], v[208:211]
ds_read_b64_tr_b16 v[96:97], v2 offset:24576
v_cvt_pk_bf16_f32 v138, v144, v145
v_cvt_pk_bf16_f32 v139, v146, v147
v_mfma_f32_16x16x32_bf16 v[212:215], v[80:83], v[72:75], v[212:215]
ds_read_b64_tr_b16 v[98:99], v2 offset:25088
s_waitcnt lgkmcnt(4)
v_mfma_f32_16x16x32_bf16 v[200:203], v[84:87], v[76:79], v[200:203]
ds_read_b64_tr_b16 v[80:81], v232 offset:28672
v_add_u32 v255, 122880, v247
ds_write_b128 v255, v[132:135] offset:0
ds_write_b128 v255, v[136:139] offset:4096
v_mfma_f32_16x16x32_bf16 v[204:207], v[84:87], v[196:199], v[204:207]
ds_read_b64_tr_b16 v[82:83], v232 offset:29184
v_mfma_f32_16x16x32_bf16 v[208:211], v[88:91], v[76:79], v[208:211]
ds_read_b64_tr_b16 v[84:85], v2 offset:28672
v_mfma_f32_16x16x32_bf16 v[212:215], v[88:91], v[196:199], v[212:215]
ds_read_b64_tr_b16 v[86:87], v2 offset:29184
s_lshl_b32 s50, s42, 4
s_add_u32 s50, s50, 128
v_add_u32 v253, s50, v1
v_mul_u32_u24 v255, 2731, v253
v_lshrrev_b32 v255, 16, v255
v_mul_u32_u24 v254, 1152, v253
v_mul_u32_u24 v255, 27520, v255
v_sub_u32 v254, v254, v255
s_mul_i32 s50, s40, 27648
s_add_u32 s50, s50, s47
v_cmp_gt_u32 vcc, 216, v253
s_nop 0
s_and_b64 vcc, vcc, 0xffff
v_mov_b32 v253, 1879048192
v_cndmask_b32 v254, v253, v254, vcc
buffer_load_dword v233, v254, s[20:23], s50 offen
s_waitcnt vmcnt(5)
s_waitcnt lgkmcnt(3)
s_barrier
s_setprio 3
s_mov_b32 s52, 0
L_spf0_1:
v_cmp_eq_u32 vcc, 0, v228
s_nop 1
s_cmp_eq_u64 vcc, 0
s_cbranch_scc1 L_spf0_1x
s_add_u32 s52, s52, 1
s_cmp_ge_u32 s52, 0x10000
s_cbranch_scc1 L_spf0_1x
s_sleep 2
v_mov_b32 v255, 0
buffer_load_dwordx2 v[228:229], v255, s[36:39], 0 offen sc1
s_waitcnt vmcnt(0)
s_branch L_spf0_1
L_spf0_1x:
v_readfirstlane_b32 s98, v228
v_readfirstlane_b32 s99, v229
v_mfma_f32_16x16x32_bf16 v[116:119], v[92:95], v[4:7], 0
ds_read_b64_tr_b16 v[88:89], v232 offset:32768
s_add_u32 m0, s48, 4096
s_add_u32 s49, s46, 590336
buffer_load_dwordx4 v246, s[16:19], s49 offen lds
v_mfma_f32_16x16x32_bf16 v[120:123], v[92:95], v[8:11], 0
ds_read_b64_tr_b16 v[90:91], v232 offset:33280
v_mfma_f32_16x16x32_bf16 v[124:127], v[96:99], v[4:7], 0
ds_read_b64_tr_b16 v[92:93], v2 offset:32768
v_exp_f32 v235, -v200
v_mfma_f32_16x16x32_bf16 v[128:131], v[96:99], v[8:11], 0
ds_read_b64_tr_b16 v[94:95], v2 offset:33280
v_exp_f32 v245, -v201
s_waitcnt lgkmcnt(4)
v_mfma_f32_16x16x32_bf16 v[116:119], v[80:83], v[40:43], v[116:119]
ds_read_b64_tr_b16 v[96:97], v232 offset:36864
v_exp_f32 v244, -v202
v_exp_f32 v230, -v203
v_mfma_f32_16x16x32_bf16 v[120:123], v[80:83], v[44:47], v[120:123]
ds_read_b64_tr_b16 v[98:99], v232 offset:37376
v_add_f32 v235, 1.0, v235
v_mfma_f32_16x16x32_bf16 v[124:127], v[84:87], v[40:43], v[124:127]
ds_read_b64_tr_b16 v[80:81], v2 offset:36864
v_add_f32 v245, 1.0, v245
v_mfma_f32_16x16x32_bf16 v[128:131], v[84:87], v[44:47], v[128:131]
ds_read_b64_tr_b16 v[82:83], v2 offset:37376
v_add_f32 v244, 1.0, v244
s_waitcnt lgkmcnt(4)
v_mfma_f32_16x16x32_bf16 v[116:119], v[88:91], v[100:103], v[116:119]
ds_read_b64_tr_b16 v[84:85], v232 offset:40960
v_add_f32 v230, 1.0, v230
v_mfma_f32_16x16x32_bf16 v[120:123], v[88:91], v[104:107], v[120:123]
ds_read_b64_tr_b16 v[86:87], v232 offset:41472
v_rcp_f32 v235, v235
s_setprio 2
v_mfma_f32_16x16x32_bf16 v[124:127], v[92:95], v[100:103], v[124:127]
ds_read_b64_tr_b16 v[88:89], v2 offset:40960
s_add_u32 m0, s48, 12288
s_add_u32 s49, s46, 1180160
buffer_load_dwordx4 v246, s[16:19], s49 offen lds
v_rcp_f32 v245, v245
v_mfma_f32_16x16x32_bf16 v[128:131], v[92:95], v[104:107], v[128:131]
ds_read_b64_tr_b16 v[90:91], v2 offset:41472
v_rcp_f32 v244, v244
v_rcp_f32 v230, v230
s_waitcnt lgkmcnt(4)
v_mfma_f32_16x16x32_bf16 v[116:119], v[96:99], v[108:111], v[116:119]
ds_read_b64_tr_b16 v[92:93], v232 offset:45056
v_mul_f32 v200, v200, v235
v_mfma_f32_16x16x32_bf16 v[120:123], v[96:99], v[112:115], v[120:123]
ds_read_b64_tr_b16 v[94:95], v232 offset:45568
v_mul_f32 v201, v201, v245
v_mfma_f32_16x16x32_bf16 v[124:127], v[80:83], v[108:111], v[124:127]
ds_read_b64_tr_b16 v[96:97], v2 offset:45056
v_mul_f32 v202, v202, v244
v_mul_f32 v203, v203, v230
v_mfma_f32_16x16x32_bf16 v[128:131], v[80:83], v[112:115], v[128:131]
ds_read_b64_tr_b16 v[98:99], v2 offset:45568
v_exp_f32 v235, -v208
s_waitcnt lgkmcnt(4)
v_mfma_f32_16x16x32_bf16 v[116:119], v[84:87], v[12:15], v[116:119]
ds_read_b64_tr_b16 v[80:81], v232 offset:49152
v_exp_f32 v245, -v209
v_mfma_f32_16x16x32_bf16 v[120:123], v[84:87], v[16:19], v[120:123]
ds_read_b64_tr_b16 v[82:83], v232 offset:49664
v_exp_f32 v244, -v210
s_setprio 1
v_mfma_f32_16x16x32_bf16 v[124:127], v[88:91], v[12:15], v[124:127]
ds_read_b64_tr_b16 v[84:85], v2 offset:49152
v_exp_f32 v230, -v211
v_mfma_f32_16x16x32_bf16 v[128:131], v[88:91], v[16:19], v[128:131]
ds_read_b64_tr_b16 v[86:87], v2 offset:49664
v_add_f32 v235, 1.0, v235
s_waitcnt lgkmcnt(4)
v_mfma_f32_16x16x32_bf16 v[116:119], v[92:95], v[48:51], v[116:119]
ds_read_b64_tr_b16 v[88:89], v232 offset:53248
s_add_u32 m0, s48, 20480
s_add_u32 s49, s46, 1769984
buffer_load_dwordx4 v246, s[16:19], s49 offen lds
v_add_f32 v245, 1.0, v245
v_mfma_f32_16x16x32_bf16 v[120:123], v[92:95], v[52:55], v[120:123]
ds_read_b64_tr_b16 v[90:91], v232 offset:53760
v_add_f32 v244, 1.0, v244
v_add_f32 v230, 1.0, v230
v_mfma_f32_16x16x32_bf16 v[124:127], v[96:99], v[48:51], v[124:127]
ds_read_b64_tr_b16 v[92:93], v2 offset:53248
v_rcp_f32 v235, v235
v_mfma_f32_16x16x32_bf16 v[128:131], v[96:99], v[52:55], v[128:131]
ds_read_b64_tr_b16 v[94:95], v2 offset:53760
v_rcp_f32 v245, v245
s_waitcnt lgkmcnt(4)
v_mfma_f32_16x16x32_bf16 v[116:119], v[80:83], v[148:151], v[116:119]
ds_read_b64_tr_b16 v[96:97], v3 offset:24576
v_rcp_f32 v244, v244
v_rcp_f32 v230, v230
v_mfma_f32_16x16x32_bf16 v[120:123], v[80:83], v[152:155], v[120:123]
ds_read_b64_tr_b16 v[98:99], v3 offset:25088
v_mul_f32 v208, v208, v235
v_mfma_f32_16x16x32_bf16 v[124:127], v[84:87], v[148:151], v[124:127]
ds_read_b64_tr_b16 v[80:81], v231 offset:24576
v_mul_f32 v209, v209, v245
v_mfma_f32_16x16x32_bf16 v[128:131], v[84:87], v[152:155], v[128:131]
ds_read_b64_tr_b16 v[82:83], v231 offset:25088
v_mul_f32 v210, v210, v244
s_setprio 0
s_waitcnt lgkmcnt(4)
v_mfma_f32_16x16x32_bf16 v[116:119], v[88:91], v[156:159], v[116:119]
ds_read_b64_tr_b16 v[84:85], v3 offset:28672
v_mul_f32 v211, v211, v230
v_mfma_f32_16x16x32_bf16 v[120:123], v[88:91], v[160:163], v[120:123]
ds_read_b64_tr_b16 v[86:87], v3 offset:29184
v_cvt_pk_bf16_f32 v200, v200, v201
v_mfma_f32_16x16x32_bf16 v[124:127], v[92:95], v[156:159], v[124:127]
ds_read_b64_tr_b16 v[88:89], v231 offset:28672
v_cvt_pk_bf16_f32 v201, v202, v203
v_cvt_pk_bf16_f32 v202, v208, v209
v_mfma_f32_16x16x32_bf16 v[128:131], v[92:95], v[160:163], v[128:131]
ds_read_b64_tr_b16 v[90:91], v231 offset:29184
v_cvt_pk_bf16_f32 v203, v210, v211
s_waitcnt lgkmcnt(4)
v_mfma_f32_16x16x32_bf16 v[116:119], v[96:99], v[20:23], v[116:119]
ds_read_b64_tr_b16 v[92:93], v3 offset:32768
v_mfma_f32_16x16x32_bf16 v[120:123], v[96:99], v[24:27], v[120:123]
ds_read_b64_tr_b16 v[94:95], v3 offset:33280
v_exp_f32 v235, -v204
v_mfma_f32_16x16x32_bf16 v[124:127], v[80:83], v[20:23], v[124:127]
ds_read_b64_tr_b16 v[96:97], v231 offset:32768
v_exp_f32 v245, -v205
v_mfma_f32_16x16x32_bf16 v[128:131], v[80:83], v[24:27], v[128:131]
ds_read_b64_tr_b16 v[98:99], v231 offset:33280
v_exp_f32 v244, -v206
s_waitcnt vmcnt(4)
s_barrier
s_setprio 3
s_waitcnt lgkmcnt(4)
v_mfma_f32_16x16x32_bf16 v[116:119], v[84:87], v[56:59], v[116:119]
ds_read_b64_tr_b16 v[80:81], v3 offset:36864
s_add_u32 m0, s48, 24576
s_add_u32 s49, s46, 2359808
buffer_load_dwordx4 v246, s[16:19], s49 offen lds
v_exp_f32 v230, -v207
v_mfma_f32_16x16x32_bf16 v[120:123], v[84:87], v[60:63], v[120:123]
ds_read_b64_tr_b16 v[82:83], v3 offset:37376
v_add_f32 v235, 1.0, v235
v_add_f32 v245, 1.0, v245
v_mfma_f32_16x16x32_bf16 v[124:127], v[88:91], v[56:59], v[124:127]
ds_read_b64_tr_b16 v[84:85], v231 offset:36864
v_add_f32 v244, 1.0, v244
v_mfma_f32_16x16x32_bf16 v[128:131], v[88:91], v[60:63], v[128:131]
ds_read_b64_tr_b16 v[86:87], v231 offset:37376
v_add_f32 v230, 1.0, v230
s_waitcnt lgkmcnt(4)
v_mfma_f32_16x16x32_bf16 v[116:119], v[92:95], v[164:167], v[116:119]
ds_read_b64_tr_b16 v[88:89], v232 offset:57344
v_rcp_f32 v235, v235
v_mfma_f32_16x16x32_bf16 v[120:123], v[92:95], v[168:171], v[120:123]
ds_read_b64_tr_b16 v[90:91], v232 offset:57856
v_rcp_f32 v245, v245
v_mfma_f32_16x16x32_bf16 v[124:127], v[96:99], v[164:167], v[124:127]
ds_read_b64_tr_b16 v[92:93], v2 offset:57344
v_rcp_f32 v244, v244
v_rcp_f32 v230, v230
v_mfma_f32_16x16x32_bf16 v[128:131], v[96:99], v[168:171], v[128:131]
ds_read_b64_tr_b16 v[94:95], v2 offset:57856
v_mul_f32 v204, v204, v235
s_waitcnt lgkmcnt(4)
v_mfma_f32_16x16x32_bf16 v[116:119], v[80:83], v[172:175], v[116:119]
ds_read_b64_tr_b16 v[96:97], v232 offset:61440
s_add_u32 m0, s48, 32768
s_add_u32 s49, s46, 2949632
buffer_load_dwordx4 v246, s[16:19], s49 offen lds
v_mul_f32 v205, v205, v245
v_mfma_f32_16x16x32_bf16 v[120:123], v[80:83], v[176:179], v[120:123]
ds_read_b64_tr_b16 v[98:99], v232 offset:61952
v_mul_f32 v206, v206, v244
s_setprio 2
v_mfma_f32_16x16x32_bf16 v[124:127], v[84:87], v[172:175], v[124:127]
ds_read_b64_tr_b16 v[80:81], v2 offset:61440
v_mul_f32 v207, v207, v230
v_mfma_f32_16x16x32_bf16 v[128:131], v[84:87], v[176:179], v[128:131]
ds_read_b64_tr_b16 v[82:83], v2 offset:61952
v_exp_f32 v235, -v212
s_waitcnt lgkmcnt(4)
v_mfma_f32_16x16x32_bf16 v[116:119], v[88:91], v[28:31], v[116:119]
ds_read_b64_tr_b16 v[84:85], v3 offset:0
v_exp_f32 v245, -v213
v_exp_f32 v244, -v214
v_mfma_f32_16x16x32_bf16 v[120:123], v[88:91], v[32:35], v[120:123]
ds_read_b64_tr_b16 v[86:87], v3 offset:512
v_exp_f32 v230, -v215
v_mfma_f32_16x16x32_bf16 v[124:127], v[92:95], v[28:31], v[124:127]
ds_read_b64_tr_b16 v[88:89], v231 offset:0
v_add_f32 v235, 1.0, v235
v_mfma_f32_16x16x32_bf16 v[128:131], v[92:95], v[32:35], v[128:131]
ds_read_b64_tr_b16 v[90:91], v231 offset:512
v_add_f32 v245, 1.0, v245
s_waitcnt lgkmcnt(4)
v_mfma_f32_16x16x32_bf16 v[116:119], v[96:99], v[64:67], v[116:119]
ds_read_b64_tr_b16 v[92:93], v3 offset:4096
s_add_u32 m0, s48, 40960
s_add_u32 s49, s46, 3539456
buffer_load_dwordx4 v246, s[16:19], s49 offen lds
v_add_f32 v244, 1.0, v244
v_mfma_f32_16x16x32_bf16 v[120:123], v[96:99], v[68:71], v[120:123]
ds_read_b64_tr_b16 v[94:95], v3 offset:4608
v_add_f32 v230, 1.0, v230
s_setprio 1
v_mfma_f32_16x16x32_bf16 v[124:127], v[80:83], v[64:67], v[124:127]
ds_read_b64_tr_b16 v[96:97], v231 offset:4096
v_rcp_f32 v235, v235
v_rcp_f32 v245, v245
v_mfma_f32_16x16x32_bf16 v[128:131], v[80:83], v[68:71], v[128:131]
ds_read_b64_tr_b16 v[98:99], v231 offset:4608
v_rcp_f32 v244, v244
s_waitcnt lgkmcnt(4)
v_mfma_f32_16x16x32_bf16 v[116:119], v[84:87], v[180:183], v[116:119]
ds_read_b64_tr_b16 v[80:81], v3 offset:8192
v_rcp_f32 v230, v230
v_mfma_f32_16x16x32_bf16 v[120:123], v[84:87], v[184:187], v[120:123]
ds_read_b64_tr_b16 v[82:83], v3 offset:8704
v_mul_f32 v212, v212, v235
v_mfma_f32_16x16x32_bf16 v[124:127], v[88:91], v[180:183], v[124:127]
ds_read_b64_tr_b16 v[84:85], v231 offset:8192
v_mul_f32 v213, v213, v245
v_mfma_f32_16x16x32_bf16 v[128:131], v[88:91], v[184:187], v[128:131]
ds_read_b64_tr_b16 v[86:87], v231 offset:8704
v_mul_f32 v214, v214, v244
s_waitcnt lgkmcnt(4)
v_mfma_f32_16x16x32_bf16 v[116:119], v[92:95], v[188:191], v[116:119]
ds_read_b64_tr_b16 v[88:89], v3 offset:12288
s_add_u32 m0, s48, 49152
s_add_u32 s49, s46, 4129280
buffer_load_dwordx4 v246, s[16:19], s49 offen lds
v_mul_f32 v215, v215, v230
v_mfma_f32_16x16x32_bf16 v[120:123], v[92:95], v[192:195], v[120:123]
ds_read_b64_tr_b16 v[90:91], v3 offset:12800
v_cvt_pk_bf16_f32 v204, v204, v205
v_cvt_pk_bf16_f32 v205, v206, v207
v_mfma_f32_16x16x32_bf16 v[124:127], v[96:99], v[188:191], v[124:127]
ds_read_b64_tr_b16 v[92:93], v231 offset:12288
v_cvt_pk_bf16_f32 v206, v212, v213
v_mfma_f32_16x16x32_bf16 v[128:131], v[96:99], v[192:195], v[128:131]
ds_read_b64_tr_b16 v[94:95], v231 offset:12800
v_cvt_pk_bf16_f32 v207, v214, v215
s_setprio 0
s_waitcnt lgkmcnt(4)
v_mfma_f32_16x16x32_bf16 v[116:119], v[80:83], v[36:39], v[116:119]
ds_read_b64_tr_b16 v[96:97], v3 offset:16384
v_mfma_f32_16x16x32_bf16 v[120:123], v[80:83], v[72:75], v[120:123]
ds_read_b64_tr_b16 v[98:99], v3 offset:16896
v_mfma_f32_16x16x32_bf16 v[124:127], v[84:87], v[36:39], v[124:127]
ds_read_b64_tr_b16 v[80:81], v231 offset:16384
v_add_u32 v255, 106496, v247
ds_write_b128 v255, v[200:203] offset:0
ds_write_b128 v255, v[204:207] offset:4096
v_mfma_f32_16x16x32_bf16 v[128:131], v[84:87], v[72:75], v[128:131]
ds_read_b64_tr_b16 v[82:83], v231 offset:16896
s_waitcnt lgkmcnt(6)
v_mfma_f32_16x16x32_bf16 v[116:119], v[88:91], v[76:79], v[116:119]
ds_read_b64_tr_b16 v[84:85], v232 offset:0
v_mfma_f32_16x16x32_bf16 v[120:123], v[88:91], v[196:199], v[120:123]
ds_read_b64_tr_b16 v[86:87], v232 offset:512
v_mfma_f32_16x16x32_bf16 v[124:127], v[92:95], v[76:79], v[124:127]
ds_read_b64_tr_b16 v[88:89], v2 offset:0
v_mfma_f32_16x16x32_bf16 v[128:131], v[92:95], v[196:199], v[128:131]
ds_read_b64_tr_b16 v[90:91], v2 offset:512
s_waitcnt vmcnt(7)
s_waitcnt vmcnt(2)
s_waitcnt lgkmcnt(5)
s_barrier
s_setprio 3
v_mfma_f32_16x16x32_bf16 v[132:135], v[96:99], v[4:7], 0
ds_read_b64_tr_b16 v[92:93], v232 offset:4096
s_add_u32 m0, s48, 57344
s_add_u32 s49, s46, 4719104
buffer_load_dwordx4 v246, s[16:19], s49 offen lds
v_mfma_f32_16x16x32_bf16 v[136:139], v[96:99], v[8:11], 0
ds_read_b64_tr_b16 v[94:95], v232 offset:4608
s_waitcnt lgkmcnt(6)
v_mfma_f32_16x16x32_bf16 v[140:143], v[80:83], v[4:7], 0
ds_read_b64_tr_b16 v[96:97], v2 offset:4096
v_exp_f32 v245, -v116
v_mfma_f32_16x16x32_bf16 v[144:147], v[80:83], v[8:11], 0
ds_read_b64_tr_b16 v[98:99], v2 offset:4608
v_exp_f32 v244, -v117
s_waitcnt lgkmcnt(4)
v_mfma_f32_16x16x32_bf16 v[132:135], v[84:87], v[40:43], v[132:135]
ds_read_b64_tr_b16 v[80:81], v232 offset:8192
v_exp_f32 v235, -v118
v_exp_f32 v233, -v119
v_mfma_f32_16x16x32_bf16 v[136:139], v[84:87], v[44:47], v[136:139]
ds_read_b64_tr_b16 v[82:83], v232 offset:8704
v_add_f32 v245, 1.0, v245
v_add_u32 v255, 139264, v247
ds_read_b128 v[200:203], v255 offset:0
ds_read_b128 v[204:207], v255 offset:4096
v_mfma_f32_16x16x32_bf16 v[140:143], v[88:91], v[40:43], v[140:143]
ds_read_b64_tr_b16 v[84:85], v2 offset:8192
v_add_f32 v244, 1.0, v244
v_mfma_f32_16x16x32_bf16 v[144:147], v[88:91], v[44:47], v[144:147]
ds_read_b64_tr_b16 v[86:87], v2 offset:8704
v_add_f32 v235, 1.0, v235
s_waitcnt lgkmcnt(6)
v_mfma_f32_16x16x32_bf16 v[132:135], v[92:95], v[100:103], v[132:135]
ds_read_b64_tr_b16 v[88:89], v232 offset:12288
v_add_f32 v233, 1.0, v233
v_mfma_f32_16x16x32_bf16 v[136:139], v[92:95], v[104:107], v[136:139]
ds_read_b64_tr_b16 v[90:91], v232 offset:12800
v_rcp_f32 v245, v245
s_setprio 2
v_mfma_f32_16x16x32_bf16 v[140:143], v[96:99], v[100:103], v[140:143]
ds_read_b64_tr_b16 v[92:93], v2 offset:12288
s_add_u32 m0, s48, 65536
s_add_u32 s49, s46, 640
buffer_load_dwordx4 v246, s[16:19], s49 offen lds
v_rcp_f32 v244, v244
v_rcp_f32 v235, v235
v_mfma_f32_16x16x32_bf16 v[144:147], v[96:99], v[104:107], v[144:147]
ds_read_b64_tr_b16 v[94:95], v2 offset:12800
v_rcp_f32 v233, v233
v_add_u32 v255, 147456, v247
ds_read_b128 v[208:211], v255 offset:0
ds_read_b128 v[212:215], v255 offset:4096
s_waitcnt lgkmcnt(6)
v_mfma_f32_16x16x32_bf16 v[132:135], v[80:83], v[108:111], v[132:135]
ds_read_b64_tr_b16 v[96:97], v232 offset:16384
v_mul_f32 v116, v116, v245
v_mfma_f32_16x16x32_bf16 v[136:139], v[80:83], v[112:115], v[136:139]
ds_read_b64_tr_b16 v[98:99], v232 offset:16896
v_mul_f32 v117, v117, v244
v_mfma_f32_16x16x32_bf16 v[140:143], v[84:87], v[108:111], v[140:143]
ds_read_b64_tr_b16 v[80:81], v2 offset:16384
v_mul_f32 v118, v118, v235
v_mul_f32 v119, v119, v233
v_mfma_f32_16x16x32_bf16 v[144:147], v[84:87], v[112:115], v[144:147]
ds_read_b64_tr_b16 v[82:83], v2 offset:16896
v_exp_f32 v245, -v124
s_waitcnt lgkmcnt(6)
v_mfma_f32_16x16x32_bf16 v[132:135], v[88:91], v[12:15], v[132:135]
ds_read_b64_tr_b16 v[84:85], v232 offset:20480
v_exp_f32 v244, -v125
v_mfma_f32_16x16x32_bf16 v[136:139], v[88:91], v[16:19], v[136:139]
ds_read_b64_tr_b16 v[86:87], v232 offset:20992
v_exp_f32 v235, -v126
s_setprio 1
v_mfma_f32_16x16x32_bf16 v[140:143], v[92:95], v[12:15], v[140:143]
ds_read_b64_tr_b16 v[88:89], v2 offset:20480
v_exp_f32 v233, -v127
v_add_f32 v245, 1.0, v245
v_mfma_f32_16x16x32_bf16 v[144:147], v[92:95], v[16:19], v[144:147]
ds_read_b64_tr_b16 v[90:91], v2 offset:20992
v_add_u32 v255, 122880, v247
ds_read_b128 v[216:219], v255 offset:0
ds_read_b128 v[220:223], v255 offset:4096
s_waitcnt lgkmcnt(6)
v_mfma_f32_16x16x32_bf16 v[132:135], v[96:99], v[48:51], v[132:135]
ds_read_b64_tr_b16 v[92:93], v3 offset:20480
s_add_u32 m0, s48, 73728
s_add_u32 s49, s46, 590464
buffer_load_dwordx4 v246, s[16:19], s49 offen lds
v_add_f32 v244, 1.0, v244
v_mfma_f32_16x16x32_bf16 v[136:139], v[96:99], v[52:55], v[136:139]
ds_read_b64_tr_b16 v[94:95], v3 offset:20992
v_add_f32 v235, 1.0, v235
v_add_f32 v233, 1.0, v233
v_mfma_f32_16x16x32_bf16 v[140:143], v[80:83], v[48:51], v[140:143]
ds_read_b64_tr_b16 v[96:97], v231 offset:20480
v_rcp_f32 v245, v245
v_mfma_f32_16x16x32_bf16 v[144:147], v[80:83], v[52:55], v[144:147]
ds_read_b64_tr_b16 v[98:99], v231 offset:20992
v_rcp_f32 v244, v244
s_waitcnt lgkmcnt(6)
v_mfma_f32_16x16x32_bf16 v[132:135], v[84:87], v[148:151], v[132:135]
ds_read_b64_tr_b16 v[80:81], v232 offset:24576
v_rcp_f32 v235, v235
v_rcp_f32 v233, v233
v_mfma_f32_16x16x32_bf16 v[136:139], v[84:87], v[152:155], v[136:139]
ds_read_b64_tr_b16 v[82:83], v232 offset:25088
v_mul_f32 v124, v124, v245
v_add_u32 v255, 131072, v247
ds_read_b128 v[224:227], v255 offset:0
ds_read_b128 v[236:239], v255 offset:4096
v_mfma_f32_16x16x32_bf16 v[140:143], v[88:91], v[148:151], v[140:143]
ds_read_b64_tr_b16 v[84:85], v2 offset:24576
v_mul_f32 v125, v125, v244
v_mfma_f32_16x16x32_bf16 v[144:147], v[88:91], v[152:155], v[144:147]
ds_read_b64_tr_b16 v[86:87], v2 offset:25088
v_mul_f32 v126, v126, v235
s_setprio 0
s_waitcnt lgkmcnt(6)
v_mfma_f32_16x16x32_bf16 v[132:135], v[92:95], v[156:159], v[132:135]
ds_read_b64_tr_b16 v[88:89], v232 offset:28672
v_mul_f32 v127, v127, v233
v_mfma_f32_16x16x32_bf16 v[136:139], v[92:95], v[160:163], v[136:139]
ds_read_b64_tr_b16 v[90:91], v232 offset:29184
v_cvt_pk_bf16_f32 v116, v116, v117
v_mfma_f32_16x16x32_bf16 v[140:143], v[96:99], v[156:159], v[140:143]
ds_read_b64_tr_b16 v[92:93], v2 offset:28672
v_cvt_pk_bf16_f32 v117, v118, v119
v_cvt_pk_bf16_f32 v118, v124, v125
v_mfma_f32_16x16x32_bf16 v[144:147], v[96:99], v[160:163], v[144:147]
ds_read_b64_tr_b16 v[94:95], v2 offset:29184
v_cvt_pk_bf16_f32 v119, v126, v127
s_waitcnt lgkmcnt(4)
v_mfma_f32_16x16x32_bf16 v[132:135], v[80:83], v[20:23], v[132:135]
ds_read_b64_tr_b16 v[96:97], v232 offset:32768
v_mfma_f32_16x16x32_bf16 v[136:139], v[80:83], v[24:27], v[136:139]
ds_read_b64_tr_b16 v[98:99], v232 offset:33280
v_exp_f32 v245, -v120
v_mfma_f32_16x16x32_bf16 v[140:143], v[84:87], v[20:23], v[140:143]
ds_read_b64_tr_b16 v[80:81], v2 offset:32768
v_exp_f32 v244, -v121
v_mfma_f32_16x16x32_bf16 v[144:147], v[84:87], v[24:27], v[144:147]
ds_read_b64_tr_b16 v[82:83], v2 offset:33280
v_exp_f32 v235, -v122
s_waitcnt vmcnt(1)
s_barrier
s_setprio 3
s_waitcnt lgkmcnt(4)
v_mfma_f32_16x16x32_bf16 v[132:135], v[88:91], v[56:59], v[132:135]
ds_read_b64_tr_b16 v[84:85], v232 offset:36864
s_add_u32 m0, s48, 0
s_add_u32 s49, s46, 1180288
buffer_load_dwordx4 v246, s[16:19], s49 offen lds
v_exp_f32 v233, -v123
v_mfma_f32_16x16x32_bf16 v[136:139], v[88:91], v[60:63], v[136:139]
ds_read_b64_tr_b16 v[86:87], v232 offset:37376
v_add_f32 v245, 1.0, v245
v_add_f32 v244, 1.0, v244
v_mfma_f32_16x16x32_bf16 v[140:143], v[92:95], v[56:59], v[140:143]
ds_read_b64_tr_b16 v[88:89], v2 offset:36864
v_add_f32 v235, 1.0, v235
v_mfma_f32_16x16x32_bf16 v[144:147], v[92:95], v[60:63], v[144:147]
ds_read_b64_tr_b16 v[90:91], v2 offset:37376
v_add_f32 v233, 1.0, v233
s_waitcnt lgkmcnt(4)
v_mfma_f32_16x16x32_bf16 v[132:135], v[96:99], v[164:167], v[132:135]
ds_read_b64_tr_b16 v[92:93], v232 offset:40960
s_add_u32 m0, s48, 8192
s_add_u32 s49, s46, 1770112
buffer_load_dwordx4 v246, s[16:19], s49 offen lds
v_rcp_f32 v245, v245
v_mfma_f32_16x16x32_bf16 v[136:139], v[96:99], v[168:171], v[136:139]
ds_read_b64_tr_b16 v[94:95], v232 offset:41472
v_rcp_f32 v244, v244
v_mfma_f32_16x16x32_bf16 v[140:143], v[80:83], v[164:167], v[140:143]
ds_read_b64_tr_b16 v[96:97], v2 offset:40960
v_rcp_f32 v235, v235
v_rcp_f32 v233, v233
v_mfma_f32_16x16x32_bf16 v[144:147], v[80:83], v[168:171], v[144:147]
ds_read_b64_tr_b16 v[98:99], v2 offset:41472
v_mul_f32 v120, v120, v245
s_waitcnt lgkmcnt(4)
v_mfma_f32_16x16x32_bf16 v[132:135], v[84:87], v[172:175], v[132:135]
ds_read_b64_tr_b16 v[80:81], v232 offset:45056
s_add_u32 m0, s48, 16384
s_add_u32 s49, s46, 2359936
buffer_load_dwordx4 v246, s[16:19], s49 offen lds
v_mul_f32 v121, v121, v244
v_mfma_f32_16x16x32_bf16 v[136:139], v[84:87], v[176:179], v[136:139]
ds_read_b64_tr_b16 v[82:83], v232 offset:45568
v_mul_f32 v122, v122, v235
s_setprio 2
v_mfma_f32_16x16x32_bf16 v[140:143], v[88:91], v[172:175], v[140:143]
ds_read_b64_tr_b16 v[84:85], v2 offset:45056
v_mul_f32 v123, v123, v233
v_mfma_f32_16x16x32_bf16 v[144:147], v[88:91], v[176:179], v[144:147]
ds_read_b64_tr_b16 v[86:87], v2 offset:45568
v_exp_f32 v245, -v128
s_waitcnt lgkmcnt(4)
v_mfma_f32_16x16x32_bf16 v[132:135], v[92:95], v[28:31], v[132:135]
ds_read_b64_tr_b16 v[88:89], v232 offset:49152
s_add_u32 m0, s48, 24576
s_add_u32 s49, s46, 2949760
buffer_load_dwordx4 v246, s[16:19], s49 offen lds
v_exp_f32 v244, -v129
v_mfma_f32_16x16x32_bf16 v[136:139], v[92:95], v[32:35], v[136:139]
ds_read_b64_tr_b16 v[90:91], v232 offset:49664
v_exp_f32 v235, -v130
v_exp_f32 v233, -v131
v_mfma_f32_16x16x32_bf16 v[140:143], v[96:99], v[28:31], v[140:143]
ds_read_b64_tr_b16 v[92:93], v2 offset:49152
v_add_f32 v245, 1.0, v245
v_mfma_f32_16x16x32_bf16 v[144:147], v[96:99], v[32:35], v[144:147]
ds_read_b64_tr_b16 v[94:95], v2 offset:49664
v_add_f32 v244, 1.0, v244
s_waitcnt lgkmcnt(4)
v_mfma_f32_16x16x32_bf16 v[132:135], v[80:83], v[64:67], v[132:135]
ds_read_b64_tr_b16 v[96:97], v232 offset:53248
s_add_u32 m0, s48, 86016
s_add_u32 s49, s46, 3539584
buffer_load_dwordx4 v246, s[16:19], s49 offen lds
v_add_f32 v235, 1.0, v235
v_mfma_f32_16x16x32_bf16 v[136:139], v[80:83], v[68:71], v[136:139]
ds_read_b64_tr_b16 v[98:99], v232 offset:53760
v_add_f32 v233, 1.0, v233
s_setprio 1
v_mfma_f32_16x16x32_bf16 v[140:143], v[84:87], v[64:67], v[140:143]
ds_read_b64_tr_b16 v[80:81], v2 offset:53248
v_rcp_f32 v245, v245
v_rcp_f32 v244, v244
v_mfma_f32_16x16x32_bf16 v[144:147], v[84:87], v[68:71], v[144:147]
ds_read_b64_tr_b16 v[82:83], v2 offset:53760
v_rcp_f32 v235, v235
s_waitcnt lgkmcnt(4)
v_mfma_f32_16x16x32_bf16 v[132:135], v[88:91], v[180:183], v[132:135]
ds_read_b64_tr_b16 v[84:85], v232 offset:57344
s_add_u32 m0, s48, 126976
s_add_u32 s49, s46, 4129408
buffer_load_dwordx4 v246, s[16:19], s49 offen lds
v_rcp_f32 v233, v233
v_mfma_f32_16x16x32_bf16 v[136:139], v[88:91], v[184:187], v[136:139]
ds_read_b64_tr_b16 v[86:87], v232 offset:57856
v_mul_f32 v128, v128, v245
v_mfma_f32_16x16x32_bf16 v[140:143], v[92:95], v[180:183], v[140:143]
ds_read_b64_tr_b16 v[88:89], v2 offset:57344
v_mul_f32 v129, v129, v244
v_mfma_f32_16x16x32_bf16 v[144:147], v[92:95], v[184:187], v[144:147]
ds_read_b64_tr_b16 v[90:91], v2 offset:57856
v_mul_f32 v130, v130, v235
s_waitcnt lgkmcnt(4)
v_mfma_f32_16x16x32_bf16 v[132:135], v[96:99], v[188:191], v[132:135]
ds_read_b64_tr_b16 v[92:93], v232 offset:61440
v_mul_f32 v131, v131, v233
v_cvt_pk_bf16_f32 v120, v120, v121
v_mfma_f32_16x16x32_bf16 v[136:139], v[96:99], v[192:195], v[136:139]
ds_read_b64_tr_b16 v[94:95], v232 offset:61952
v_cvt_pk_bf16_f32 v121, v122, v123
v_mfma_f32_16x16x32_bf16 v[140:143], v[80:83], v[188:191], v[140:143]
ds_read_b64_tr_b16 v[96:97], v2 offset:61440
v_cvt_pk_bf16_f32 v122, v128, v129
v_mfma_f32_16x16x32_bf16 v[144:147], v[80:83], v[192:195], v[144:147]
ds_read_b64_tr_b16 v[98:99], v2 offset:61952
v_cvt_pk_bf16_f32 v123, v130, v131
s_setprio 0
s_waitcnt lgkmcnt(4)
v_mfma_f32_16x16x32_bf16 v[132:135], v[84:87], v[36:39], v[132:135]
ds_read_b64_tr_b16 v[80:81], v3 offset:0
v_mfma_f32_16x16x32_bf16 v[136:139], v[84:87], v[72:75], v[136:139]
ds_read_b64_tr_b16 v[82:83], v3 offset:512
v_mfma_f32_16x16x32_bf16 v[140:143], v[88:91], v[36:39], v[140:143]
ds_read_b64_tr_b16 v[84:85], v231 offset:0
v_add_u32 v255, 90112, v247
ds_write_b128 v255, v[116:119] offset:0
ds_write_b128 v255, v[120:123] offset:4096
v_mfma_f32_16x16x32_bf16 v[144:147], v[88:91], v[72:75], v[144:147]
ds_read_b64_tr_b16 v[86:87], v231 offset:512
s_waitcnt lgkmcnt(6)
v_mfma_f32_16x16x32_bf16 v[132:135], v[92:95], v[76:79], v[132:135]
ds_read_b64_tr_b16 v[88:89], v3 offset:4096
v_mfma_f32_16x16x32_bf16 v[136:139], v[92:95], v[196:199], v[136:139]
ds_read_b64_tr_b16 v[90:91], v3 offset:4608
v_mfma_f32_16x16x32_bf16 v[140:143], v[96:99], v[76:79], v[140:143]
ds_read_b64_tr_b16 v[92:93], v231 offset:4096
v_mfma_f32_16x16x32_bf16 v[144:147], v[96:99], v[196:199], v[144:147]
ds_read_b64_tr_b16 v[94:95], v231 offset:4608
s_waitcnt vmcnt(2)
s_waitcnt lgkmcnt(5)
s_barrier
s_setprio 3
v_mfma_f32_16x16x32_bf16 v[116:119], v[80:83], v[4:7], 0
ds_read_b64_tr_b16 v[96:97], v3 offset:8192
s_add_u32 m0, s48, 32768
s_add_u32 s49, s46, 4719232
buffer_load_dwordx4 v246, s[16:19], s49 offen lds
v_mfma_f32_16x16x32_bf16 v[120:123], v[80:83], v[8:11], 0
ds_read_b64_tr_b16 v[98:99], v3 offset:8704
s_waitcnt lgkmcnt(6)
v_mfma_f32_16x16x32_bf16 v[124:127], v[84:87], v[4:7], 0
ds_read_b64_tr_b16 v[80:81], v231 offset:8192
v_exp_f32 v245, -v132
v_mfma_f32_16x16x32_bf16 v[128:131], v[84:87], v[8:11], 0
ds_read_b64_tr_b16 v[82:83], v231 offset:8704
v_exp_f32 v244, -v133
s_waitcnt lgkmcnt(4)
v_mfma_f32_16x16x32_bf16 v[116:119], v[88:91], v[40:43], v[116:119]
ds_read_b64_tr_b16 v[84:85], v3 offset:12288
v_exp_f32 v235, -v134
v_exp_f32 v233, -v135
v_mfma_f32_16x16x32_bf16 v[120:123], v[88:91], v[44:47], v[120:123]
ds_read_b64_tr_b16 v[86:87], v3 offset:12800
v_add_f32 v245, 1.0, v245
v_mfma_f32_16x16x32_bf16 v[124:127], v[92:95], v[40:43], v[124:127]
ds_read_b64_tr_b16 v[88:89], v231 offset:12288
v_add_f32 v244, 1.0, v244
v_mfma_f32_16x16x32_bf16 v[128:131], v[92:95], v[44:47], v[128:131]
ds_read_b64_tr_b16 v[90:91], v231 offset:12800
v_add_f32 v235, 1.0, v235
s_waitcnt lgkmcnt(4)
v_mfma_f32_16x16x32_bf16 v[116:119], v[96:99], v[100:103], v[116:119]
ds_read_b64_tr_b16 v[92:93], v232 offset:0
s_add_u32 m0, s48, 40960
s_add_u32 s49, s47, 0
buffer_load_dwordx4 v234, s[20:23], s49 offen lds
v_add_f32 v233, 1.0, v233
v_mfma_f32_16x16x32_bf16 v[120:123], v[96:99], v[104:107], v[120:123]
ds_read_b64_tr_b16 v[94:95], v232 offset:512
v_rcp_f32 v245, v245
s_setprio 2
v_mfma_f32_16x16x32_bf16 v[124:127], v[80:83], v[100:103], v[124:127]
ds_read_b64_tr_b16 v[96:97], v2 offset:0
v_rcp_f32 v244, v244
v_rcp_f32 v235, v235
v_mfma_f32_16x16x32_bf16 v[128:131], v[80:83], v[104:107], v[128:131]
ds_read_b64_tr_b16 v[98:99], v2 offset:512
v_rcp_f32 v233, v233
s_waitcnt lgkmcnt(4)
v_mfma_f32_16x16x32_bf16 v[116:119], v[84:87], v[108:111], v[116:119]
ds_read_b64_tr_b16 v[80:81], v232 offset:4096
v_mul_f32 v132, v132, v245
v_mfma_f32_16x16x32_bf16 v[120:123], v[84:87], v[112:115], v[120:123]
ds_read_b64_tr_b16 v[82:83], v232 offset:4608
v_mul_f32 v133, v133, v244
v_mfma_f32_16x16x32_bf16 v[124:127], v[88:91], v[108:111], v[124:127]
ds_read_b64_tr_b16 v[84:85], v2 offset:4096
v_mul_f32 v134, v134, v235
v_mul_f32 v135, v135, v233
v_mfma_f32_16x16x32_bf16 v[128:131], v[88:91], v[112:115], v[128:131]
ds_read_b64_tr_b16 v[86:87], v2 offset:4608
v_exp_f32 v245, -v140
s_waitcnt lgkmcnt(4)
v_mfma_f32_16x16x32_bf16 v[116:119], v[92:95], v[12:15], v[116:119]
ds_read_b64_tr_b16 v[88:89], v232 offset:8192
s_add_u32 m0, s48, 49152
s_add_u32 s49, s47, 73728
buffer_load_dwordx4 v234, s[20:23], s49 offen lds
v_exp_f32 v244, -v141
v_mfma_f32_16x16x32_bf16 v[120:123], v[92:95], v[16:19], v[120:123]
ds_read_b64_tr_b16 v[90:91], v232 offset:8704
v_exp_f32 v235, -v142
s_setprio 1
v_mfma_f32_16x16x32_bf16 v[124:127], v[96:99], v[12:15], v[124:127]
ds_read_b64_tr_b16 v[92:93], v2 offset:8192
v_exp_f32 v233, -v143
v_mfma_f32_16x16x32_bf16 v[128:131], v[96:99], v[16:19], v[128:131]
ds_read_b64_tr_b16 v[94:95], v2 offset:8704
v_add_f32 v245, 1.0, v245
s_waitcnt lgkmcnt(4)
v_mfma_f32_16x16x32_bf16 v[116:119], v[80:83], v[48:51], v[116:119]
ds_read_b64_tr_b16 v[96:97], v232 offset:12288
v_add_f32 v244, 1.0, v244
v_add_f32 v235, 1.0, v235
v_mfma_f32_16x16x32_bf16 v[120:123], v[80:83], v[52:55], v[120:123]
ds_read_b64_tr_b16 v[98:99], v232 offset:12800
v_add_f32 v233, 1.0, v233
v_mfma_f32_16x16x32_bf16 v[124:127], v[84:87], v[48:51], v[124:127]
ds_read_b64_tr_b16 v[80:81], v2 offset:12288
v_rcp_f32 v245, v245
v_mfma_f32_16x16x32_bf16 v[128:131], v[84:87], v[52:55], v[128:131]
ds_read_b64_tr_b16 v[82:83], v2 offset:12800
v_rcp_f32 v244, v244
s_waitcnt lgkmcnt(4)
v_mfma_f32_16x16x32_bf16 v[116:119], v[88:91], v[148:151], v[116:119]
ds_read_b64_tr_b16 v[84:85], v232 offset:16384
s_add_u32 m0, s48, 57344
s_add_u32 s49, s47, 147456
buffer_load_dwordx4 v234, s[20:23], s49 offen lds
v_rcp_f32 v235, v235
v_mfma_f32_16x16x32_bf16 v[120:123], v[88:91], v[152:155], v[120:123]
ds_read_b64_tr_b16 v[86:87], v232 offset:16896
v_rcp_f32 v233, v233
v_mul_f32 v140, v140, v245
v_mfma_f32_16x16x32_bf16 v[124:127], v[92:95], v[148:151], v[124:127]
ds_read_b64_tr_b16 v[88:89], v2 offset:16384
v_mul_f32 v141, v141, v244
v_mfma_f32_16x16x32_bf16 v[128:131], v[92:95], v[152:155], v[128:131]
ds_read_b64_tr_b16 v[90:91], v2 offset:16896
v_mul_f32 v142, v142, v235
s_setprio 0
s_waitcnt lgkmcnt(4)
v_mfma_f32_16x16x32_bf16 v[116:119], v[96:99], v[156:159], v[116:119]
ds_read_b64_tr_b16 v[92:93], v232 offset:20480
v_mul_f32 v143, v143, v233
v_mfma_f32_16x16x32_bf16 v[120:123], v[96:99], v[160:163], v[120:123]
ds_read_b64_tr_b16 v[94:95], v232 offset:20992
v_cvt_pk_bf16_f32 v132, v132, v133
v_mfma_f32_16x16x32_bf16 v[124:127], v[80:83], v[156:159], v[124:127]
ds_read_b64_tr_b16 v[96:97], v2 offset:20480
v_cvt_pk_bf16_f32 v133, v134, v135
v_cvt_pk_bf16_f32 v134, v140, v141
v_mfma_f32_16x16x32_bf16 v[128:131], v[80:83], v[160:163], v[128:131]
ds_read_b64_tr_b16 v[98:99], v2 offset:20992
v_cvt_pk_bf16_f32 v135, v142, v143
s_waitcnt lgkmcnt(4)
v_mfma_f32_16x16x32_bf16 v[116:119], v[84:87], v[20:23], v[116:119]
ds_read_b64_tr_b16 v[80:81], v232 offset:24576
v_mfma_f32_16x16x32_bf16 v[120:123], v[84:87], v[24:27], v[120:123]
ds_read_b64_tr_b16 v[82:83], v232 offset:25088
v_exp_f32 v245, -v136
v_mfma_f32_16x16x32_bf16 v[124:127], v[88:91], v[20:23], v[124:127]
ds_read_b64_tr_b16 v[84:85], v2 offset:24576
v_exp_f32 v244, -v137
v_mfma_f32_16x16x32_bf16 v[128:131], v[88:91], v[24:27], v[128:131]
ds_read_b64_tr_b16 v[86:87], v2 offset:25088
v_exp_f32 v235, -v138
s_waitcnt vmcnt(2)
s_barrier
s_setprio 3
s_waitcnt lgkmcnt(4)
v_mfma_f32_16x16x32_bf16 v[116:119], v[92:95], v[56:59], v[116:119]
ds_read_b64_tr_b16 v[88:89], v3 offset:16384
s_add_u32 m0, s48, 0
s_add_u32 s49, s47, 221184
buffer_load_dwordx4 v234, s[20:23], s49 offen lds
v_exp_f32 v233, -v139
v_mfma_f32_16x16x32_bf16 v[120:123], v[92:95], v[60:63], v[120:123]
ds_read_b64_tr_b16 v[90:91], v3 offset:16896
v_add_f32 v245, 1.0, v245
v_add_f32 v244, 1.0, v244
v_mfma_f32_16x16x32_bf16 v[124:127], v[96:99], v[56:59], v[124:127]
ds_read_b64_tr_b16 v[92:93], v231 offset:16384
v_add_f32 v235, 1.0, v235
v_mfma_f32_16x16x32_bf16 v[128:131], v[96:99], v[60:63], v[128:131]
ds_read_b64_tr_b16 v[94:95], v231 offset:16896
v_add_f32 v233, 1.0, v233
s_waitcnt lgkmcnt(4)
v_mfma_f32_16x16x32_bf16 v[116:119], v[80:83], v[164:167], v[116:119]
ds_read_b64_tr_b16 v[96:97], v3 offset:20480
v_rcp_f32 v245, v245
v_rcp_f32 v244, v244
v_mfma_f32_16x16x32_bf16 v[120:123], v[80:83], v[168:171], v[120:123]
ds_read_b64_tr_b16 v[98:99], v3 offset:20992
v_add_u32 v255, 106496, v247
ds_read_b128 v[4:7], v255 offset:0
ds_read_b128 v[8:11], v255 offset:4096
v_mfma_f32_16x16x32_bf16 v[124:127], v[84:87], v[164:167], v[124:127]
ds_read_b64_tr_b16 v[80:81], v231 offset:20480
s_add_u32 m0, s48, 8192
s_add_u32 s49, s47, 294912
buffer_load_dwordx4 v234, s[20:23], s49 offen lds
v_rcp_f32 v235, v235
v_mfma_f32_16x16x32_bf16 v[128:131], v[84:87], v[168:171], v[128:131]
ds_read_b64_tr_b16 v[82:83], v231 offset:20992
v_rcp_f32 v233, v233
v_mul_f32 v136, v136, v245
s_waitcnt lgkmcnt(6)
v_mfma_f32_16x16x32_bf16 v[116:119], v[88:91], v[172:175], v[116:119]
ds_read_b64_tr_b16 v[84:85], v3 offset:57344
v_mul_f32 v137, v137, v244
v_mfma_f32_16x16x32_bf16 v[120:123], v[88:91], v[176:179], v[120:123]
ds_read_b64_tr_b16 v[86:87], v3 offset:57856
v_mul_f32 v138, v138, v235
s_setprio 2
v_mfma_f32_16x16x32_bf16 v[124:127], v[92:95], v[172:175], v[124:127]
ds_read_b64_tr_b16 v[88:89], v231 offset:57344
v_mul_f32 v139, v139, v233
v_exp_f32 v245, -v144
v_mfma_f32_16x16x32_bf16 v[128:131], v[92:95], v[176:179], v[128:131]
ds_read_b64_tr_b16 v[90:91], v231 offset:57856
v_add_u32 v255, 114688, v247
ds_read_b128 v[12:15], v255 offset:0
ds_read_b128 v[16:19], v255 offset:4096
s_waitcnt lgkmcnt(6)
v_mfma_f32_16x16x32_bf16 v[116:119], v[96:99], v[28:31], v[116:119]
ds_read_b64_tr_b16 v[92:93], v3 offset:61440
s_add_u32 m0, s48, 16384
s_add_u32 s49, s47, 128
buffer_load_dwordx4 v234, s[20:23], s49 offen lds
v_exp_f32 v244, -v145
v_mfma_f32_16x16x32_bf16 v[120:123], v[96:99], v[32:35], v[120:123]
ds_read_b64_tr_b16 v[94:95], v3 offset:61952
v_exp_f32 v235, -v146
v_exp_f32 v233, -v147
v_mfma_f32_16x16x32_bf16 v[124:127], v[80:83], v[28:31], v[124:127]
ds_read_b64_tr_b16 v[96:97], v231 offset:61440
v_add_f32 v245, 1.0, v245
v_mfma_f32_16x16x32_bf16 v[128:131], v[80:83], v[32:35], v[128:131]
ds_read_b64_tr_b16 v[98:99], v231 offset:61952
v_add_f32 v244, 1.0, v244
s_waitcnt lgkmcnt(6)
v_mfma_f32_16x16x32_bf16 v[116:119], v[84:87], v[64:67], v[116:119]
ds_read_b64_tr_b16 v[80:81], v232 offset:28672
v_add_f32 v235, 1.0, v235
v_mfma_f32_16x16x32_bf16 v[120:123], v[84:87], v[68:71], v[120:123]
ds_read_b64_tr_b16 v[82:83], v232 offset:29184
v_add_f32 v233, 1.0, v233
s_setprio 1
v_mfma_f32_16x16x32_bf16 v[124:127], v[88:91], v[64:67], v[124:127]
ds_read_b64_tr_b16 v[84:85], v2 offset:28672
s_add_u32 m0, s48, 69632
s_add_u32 s49, s47, 73856
buffer_load_dwordx4 v234, s[20:23], s49 offen lds
v_rcp_f32 v245, v245
v_rcp_f32 v244, v244
v_mfma_f32_16x16x32_bf16 v[128:131], v[88:91], v[68:71], v[128:131]
ds_read_b64_tr_b16 v[86:87], v2 offset:29184
v_rcp_f32 v235, v235
v_add_u32 v255, 90112, v247
ds_read_b128 v[20:23], v255 offset:0
ds_read_b128 v[24:27], v255 offset:4096
s_waitcnt lgkmcnt(6)
v_mfma_f32_16x16x32_bf16 v[116:119], v[92:95], v[180:183], v[116:119]
ds_read_b64_tr_b16 v[88:89], v232 offset:32768
v_rcp_f32 v233, v233
v_mfma_f32_16x16x32_bf16 v[120:123], v[92:95], v[184:187], v[120:123]
ds_read_b64_tr_b16 v[90:91], v232 offset:33280
v_mul_f32 v144, v144, v245
v_mfma_f32_16x16x32_bf16 v[124:127], v[96:99], v[180:183], v[124:127]
ds_read_b64_tr_b16 v[92:93], v2 offset:32768
v_mul_f32 v145, v145, v244
v_mfma_f32_16x16x32_bf16 v[128:131], v[96:99], v[184:187], v[128:131]
ds_read_b64_tr_b16 v[94:95], v2 offset:33280
v_mul_f32 v146, v146, v235
s_waitcnt lgkmcnt(6)
v_mfma_f32_16x16x32_bf16 v[116:119], v[80:83], v[188:191], v[116:119]
ds_read_b64_tr_b16 v[96:97], v232 offset:36864
s_add_u32 m0, s48, 77824
s_add_u32 s49, s47, 368640
buffer_load_dwordx4 v234, s[20:23], s49 offen lds
v_mul_f32 v147, v147, v233
v_cvt_pk_bf16_f32 v136, v136, v137
v_mfma_f32_16x16x32_bf16 v[120:123], v[80:83], v[192:195], v[120:123]
ds_read_b64_tr_b16 v[98:99], v232 offset:37376
v_cvt_pk_bf16_f32 v137, v138, v139
v_add_u32 v255, 98304, v247
ds_read_b128 v[28:31], v255 offset:0
ds_read_b128 v[32:35], v255 offset:4096
v_mfma_f32_16x16x32_bf16 v[124:127], v[84:87], v[188:191], v[124:127]
ds_read_b64_tr_b16 v[80:81], v2 offset:36864
v_cvt_pk_bf16_f32 v138, v144, v145
v_mfma_f32_16x16x32_bf16 v[128:131], v[84:87], v[192:195], v[128:131]
ds_read_b64_tr_b16 v[82:83], v2 offset:37376
v_cvt_pk_bf16_f32 v139, v146, v147
s_setprio 0
s_waitcnt lgkmcnt(6)
v_mfma_f32_16x16x32_bf16 v[116:119], v[88:91], v[36:39], v[116:119]
v_and_b32 v255, 1, v252
v_lshrrev_b32 v254, 1, v250
v_lshl_or_b32 v255, v255, 1, v254
v_lshlrev_b32 v255, 5, v255
v_lshl_add_u32 v254, v252, 2, v250
v_lshl_add_u32 v255, v254, 7, v255
v_lshl_add_u32 v255, v249, 3, v255
v_xor_b32 v232, 0, v255
v_add_u32 v3, 0x10000, v232
v_xor_b32 v2, 32, v255
v_add_u32 v243, 0x10000, v2
ds_read_b64_tr_b16 v[84:85], v232 offset:40960
v_mfma_f32_16x16x32_bf16 v[120:123], v[88:91], v[72:75], v[120:123]
ds_read_b64_tr_b16 v[86:87], v232 offset:43008
v_mfma_f32_16x16x32_bf16 v[124:127], v[92:95], v[36:39], v[124:127]
ds_read_b64_tr_b16 v[88:89], v2 offset:40960
v_add_u32 v255, 139264, v247
ds_write_b128 v255, v[132:135] offset:0
ds_write_b128 v255, v[136:139] offset:4096
v_mfma_f32_16x16x32_bf16 v[128:131], v[92:95], v[72:75], v[128:131]
ds_read_b64_tr_b16 v[90:91], v2 offset:43008
s_waitcnt lgkmcnt(6)
v_mfma_f32_16x16x32_bf16 v[116:119], v[96:99], v[76:79], v[116:119]
ds_read_b64_tr_b16 v[92:93], v232 offset:45056
v_mfma_f32_16x16x32_bf16 v[120:123], v[96:99], v[196:199], v[120:123]
ds_read_b64_tr_b16 v[94:95], v232 offset:47104
v_mfma_f32_16x16x32_bf16 v[124:127], v[80:83], v[76:79], v[124:127]
ds_read_b64_tr_b16 v[96:97], v2 offset:45056
v_mfma_f32_16x16x32_bf16 v[128:131], v[80:83], v[196:199], v[128:131]
ds_read_b64_tr_b16 v[98:99], v2 offset:47104
s_waitcnt vmcnt(2)
s_waitcnt lgkmcnt(5)
s_barrier
s_setprio 3
v_add_u32 v255, 139264, v247
ds_read_b128 v[36:39], v255 offset:0
ds_read_b128 v[40:43], v255 offset:4096
v_add_u32 v255, 147456, v247
ds_read_b128 v[44:47], v255 offset:0
ds_read_b128 v[48:51], v255 offset:4096
v_mfma_f32_16x16x32_bf16 v[52:55], v[84:87], v[200:203], 0
ds_read_b64_tr_b16 v[80:81], v232 offset:49152
s_add_u32 m0, s48, 24576
s_add_u32 s49, s47, 147584
buffer_load_dwordx4 v234, s[20:23], s49 offen lds
v_mfma_f32_16x16x32_bf16 v[56:59], v[84:87], v[204:207], 0
ds_read_b64_tr_b16 v[82:83], v232 offset:51200
v_exp_f32 v245, -v116
v_exp_f32 v244, -v117
s_waitcnt lgkmcnt(10)
v_mfma_f32_16x16x32_bf16 v[60:63], v[88:91], v[200:203], 0
ds_read_b64_tr_b16 v[84:85], v2 offset:49152
v_exp_f32 v235, -v118
v_exp_f32 v233, -v119
v_add_f32 v245, 1.0, v245
v_mfma_f32_16x16x32_bf16 v[64:67], v[88:91], v[204:207], 0
ds_read_b64_tr_b16 v[86:87], v2 offset:51200
v_add_f32 v244, 1.0, v244
v_add_f32 v235, 1.0, v235
s_waitcnt lgkmcnt(8)
v_mfma_f32_16x16x32_bf16 v[52:55], v[92:95], v[208:211], v[52:55]
ds_read_b64_tr_b16 v[88:89], v232 offset:53248
s_add_u32 m0, s48, 32768
s_add_u32 s49, s47, 221312
buffer_load_dwordx4 v234, s[20:23], s49 offen lds
v_add_f32 v233, 1.0, v233
v_rcp_f32 v245, v245
v_mfma_f32_16x16x32_bf16 v[56:59], v[92:95], v[212:215], v[56:59]
ds_read_b64_tr_b16 v[90:91], v232 offset:55296
v_rcp_f32 v244, v244
v_rcp_f32 v235, v235
v_rcp_f32 v233, v233
v_mfma_f32_16x16x32_bf16 v[60:63], v[96:99], v[208:211], v[60:63]
ds_read_b64_tr_b16 v[92:93], v2 offset:53248
v_mul_f32 v116, v116, v245
v_mul_f32 v117, v117, v244
v_mfma_f32_16x16x32_bf16 v[64:67], v[96:99], v[212:215], v[64:67]
ds_read_b64_tr_b16 v[94:95], v2 offset:55296
v_mul_f32 v118, v118, v235
v_mul_f32 v119, v119, v233
s_waitcnt lgkmcnt(4)
v_mfma_f32_16x16x32_bf16 v[52:55], v[80:83], v[216:219], v[52:55]
ds_read_b64_tr_b16 v[96:97], v232 offset:57344
s_add_u32 m0, s48, 81920
s_add_u32 s49, s47, 295040
buffer_load_dwordx4 v234, s[20:23], s49 offen lds
v_exp_f32 v245, -v124
v_exp_f32 v244, -v125
v_mfma_f32_16x16x32_bf16 v[56:59], v[80:83], v[220:223], v[56:59]
ds_read_b64_tr_b16 v[98:99], v232 offset:59392
v_exp_f32 v235, -v126
v_exp_f32 v233, -v127
v_add_f32 v245, 1.0, v245
s_setprio 2
v_mfma_f32_16x16x32_bf16 v[60:63], v[84:87], v[216:219], v[60:63]
ds_read_b64_tr_b16 v[80:81], v2 offset:57344
v_add_f32 v244, 1.0, v244
v_add_f32 v235, 1.0, v235
v_add_f32 v233, 1.0, v233
v_mfma_f32_16x16x32_bf16 v[64:67], v[84:87], v[220:223], v[64:67]
ds_read_b64_tr_b16 v[82:83], v2 offset:59392
v_rcp_f32 v245, v245
v_rcp_f32 v244, v244
s_waitcnt lgkmcnt(4)
v_mfma_f32_16x16x32_bf16 v[52:55], v[88:91], v[224:227], v[52:55]
ds_read_b64_tr_b16 v[84:85], v232 offset:61440
s_add_u32 m0, s48, 90112
s_add_u32 s49, s47, 368768
buffer_load_dwordx4 v234, s[20:23], s49 offen lds
v_rcp_f32 v235, v235
v_rcp_f32 v233, v233
v_mfma_f32_16x16x32_bf16 v[56:59], v[88:91], v[236:239], v[56:59]
ds_read_b64_tr_b16 v[86:87], v232 offset:63488
v_mul_f32 v124, v124, v245
v_mul_f32 v125, v125, v244
v_mul_f32 v126, v126, v235
v_mfma_f32_16x16x32_bf16 v[60:63], v[92:95], v[224:227], v[60:63]
ds_read_b64_tr_b16 v[88:89], v2 offset:61440
v_mul_f32 v127, v127, v233
v_cvt_pk_bf16_f32 v116, v116, v117
v_mfma_f32_16x16x32_bf16 v[64:67], v[92:95], v[236:239], v[64:67]
ds_read_b64_tr_b16 v[90:91], v2 offset:63488
v_cvt_pk_bf16_f32 v117, v118, v119
v_cvt_pk_bf16_f32 v118, v124, v125
s_waitcnt lgkmcnt(4)
v_mfma_f32_16x16x32_bf16 v[52:55], v[96:99], v[4:7], v[52:55]
ds_read_b64_tr_b16 v[92:93], v232 offset:0
s_add_u32 m0, s48, 98304
s_add_u32 s49, s47, 256
buffer_load_dwordx4 v234, s[20:23], s49 offen lds
v_cvt_pk_bf16_f32 v119, v126, v127
v_mfma_f32_16x16x32_bf16 v[56:59], v[96:99], v[8:11], v[56:59]
ds_read_b64_tr_b16 v[94:95], v232 offset:2048
v_exp_f32 v245, -v120
v_exp_f32 v244, -v121
v_exp_f32 v235, -v122
s_setprio 1
v_mfma_f32_16x16x32_bf16 v[60:63], v[80:83], v[4:7], v[60:63]
ds_read_b64_tr_b16 v[96:97], v2 offset:0
v_exp_f32 v233, -v123
v_add_f32 v245, 1.0, v245
v_add_f32 v244, 1.0, v244
v_mfma_f32_16x16x32_bf16 v[64:67], v[80:83], v[8:11], v[64:67]
ds_read_b64_tr_b16 v[98:99], v2 offset:2048
v_add_f32 v235, 1.0, v235
v_add_f32 v233, 1.0, v233
s_waitcnt lgkmcnt(4)
v_mfma_f32_16x16x32_bf16 v[52:55], v[84:87], v[12:15], v[52:55]
ds_read_b64_tr_b16 v[80:81], v232 offset:4096
s_add_u32 m0, s48, 106496
s_add_u32 s49, s47, 73984
buffer_load_dwordx4 v234, s[20:23], s49 offen lds
v_rcp_f32 v245, v245
v_rcp_f32 v244, v244
v_mfma_f32_16x16x32_bf16 v[56:59], v[84:87], v[16:19], v[56:59]
ds_read_b64_tr_b16 v[82:83], v232 offset:6144
v_rcp_f32 v235, v235
v_rcp_f32 v233, v233
v_mfma_f32_16x16x32_bf16 v[60:63], v[88:91], v[12:15], v[60:63]
ds_read_b64_tr_b16 v[84:85], v2 offset:4096
v_mul_f32 v120, v120, v245
v_mul_f32 v121, v121, v244
v_mul_f32 v122, v122, v235
v_mfma_f32_16x16x32_bf16 v[64:67], v[88:91], v[16:19], v[64:67]
ds_read_b64_tr_b16 v[86:87], v2 offset:6144
v_mul_f32 v123, v123, v233
v_exp_f32 v245, -v128
s_waitcnt lgkmcnt(4)
v_mfma_f32_16x16x32_bf16 v[52:55], v[92:95], v[20:23], v[52:55]
ds_read_b64_tr_b16 v[88:89], v232 offset:8192
s_add_u32 m0, s48, 114688
s_add_u32 s49, s47, 147712
buffer_load_dwordx4 v234, s[20:23], s49 offen lds
v_exp_f32 v244, -v129
v_exp_f32 v235, -v130
v_mfma_f32_16x16x32_bf16 v[56:59], v[92:95], v[24:27], v[56:59]
ds_read_b64_tr_b16 v[90:91], v232 offset:10240
v_exp_f32 v233, -v131
v_add_f32 v245, 1.0, v245
v_add_f32 v244, 1.0, v244
v_mfma_f32_16x16x32_bf16 v[60:63], v[96:99], v[20:23], v[60:63]
ds_read_b64_tr_b16 v[92:93], v2 offset:8192
v_add_f32 v235, 1.0, v235
v_add_f32 v233, 1.0, v233
v_rcp_f32 v245, v245
v_mfma_f32_16x16x32_bf16 v[64:67], v[96:99], v[24:27], v[64:67]
ds_read_b64_tr_b16 v[94:95], v2 offset:10240
v_rcp_f32 v244, v244
v_rcp_f32 v235, v235
s_setprio 0
s_waitcnt lgkmcnt(4)
v_mfma_f32_16x16x32_bf16 v[52:55], v[80:83], v[28:31], v[52:55]
ds_read_b64_tr_b16 v[96:97], v232 offset:12288
v_rcp_f32 v233, v233
v_mul_f32 v128, v128, v245
v_mfma_f32_16x16x32_bf16 v[56:59], v[80:83], v[32:35], v[56:59]
ds_read_b64_tr_b16 v[98:99], v232 offset:14336
v_mul_f32 v129, v129, v244
v_mul_f32 v130, v130, v235
v_mfma_f32_16x16x32_bf16 v[60:63], v[84:87], v[28:31], v[60:63]
ds_read_b64_tr_b16 v[80:81], v2 offset:12288
v_mul_f32 v131, v131, v233
v_cvt_pk_bf16_f32 v120, v120, v121
v_cvt_pk_bf16_f32 v121, v122, v123
v_mfma_f32_16x16x32_bf16 v[64:67], v[84:87], v[32:35], v[64:67]
ds_read_b64_tr_b16 v[82:83], v2 offset:14336
v_cvt_pk_bf16_f32 v122, v128, v129
v_cvt_pk_bf16_f32 v123, v130, v131
s_waitcnt lgkmcnt(4)
v_mfma_f32_16x16x32_bf16 v[52:55], v[88:91], v[36:39], v[52:55]
ds_read_b64_tr_b16 v[84:85], v232 offset:16384
v_add_u32 v255, 122880, v247
ds_write_b128 v255, v[116:119] offset:0
ds_write_b128 v255, v[120:123] offset:4096
v_mfma_f32_16x16x32_bf16 v[56:59], v[88:91], v[40:43], v[56:59]
ds_read_b64_tr_b16 v[86:87], v232 offset:18432
v_mfma_f32_16x16x32_bf16 v[60:63], v[92:95], v[36:39], v[60:63]
ds_read_b64_tr_b16 v[88:89], v2 offset:16384
v_mfma_f32_16x16x32_bf16 v[64:67], v[92:95], v[40:43], v[64:67]
ds_read_b64_tr_b16 v[90:91], v2 offset:18432
s_waitcnt vmcnt(5)
s_waitcnt lgkmcnt(3)
s_barrier
s_setprio 3
v_add_u32 v255, 122880, v247
ds_read_b128 v[68:71], v255 offset:0
ds_read_b128 v[72:75], v255 offset:4096
v_add_u32 v255, 131072, v247
ds_read_b128 v[76:79], v255 offset:0
ds_read_b128 v[100:103], v255 offset:4096
v_mfma_f32_16x16x32_bf16 v[52:55], v[96:99], v[44:47], v[52:55]
ds_read_b64_tr_b16 v[92:93], v3 offset:0
s_add_u32 m0, s48, 0
s_add_u32 s49, s47, 221440
buffer_load_dwordx4 v234, s[20:23], s49 offen lds
v_mfma_f32_16x16x32_bf16 v[56:59], v[96:99], v[48:51], v[56:59]
ds_read_b64_tr_b16 v[94:95], v3 offset:2048
v_mfma_f32_16x16x32_bf16 v[60:63], v[80:83], v[44:47], v[60:63]
ds_read_b64_tr_b16 v[96:97], v243 offset:0
v_mfma_f32_16x16x32_bf16 v[64:67], v[80:83], v[48:51], v[64:67]
ds_read_b64_tr_b16 v[98:99], v243 offset:2048
s_waitcnt lgkmcnt(8)
v_mfma_f32_16x16x32_bf16 v[104:107], v[84:87], v[200:203], 0
ds_read_b64_tr_b16 v[80:81], v3 offset:4096
v_mfma_f32_16x16x32_bf16 v[108:111], v[84:87], v[204:207], 0
ds_read_b64_tr_b16 v[82:83], v3 offset:6144
v_mfma_f32_16x16x32_bf16 v[112:115], v[88:91], v[200:203], 0
ds_read_b64_tr_b16 v[84:85], v243 offset:4096
s_add_u32 m0, s48, 8192
s_add_u32 s49, s47, 295168
buffer_load_dwordx4 v234, s[20:23], s49 offen lds
v_mfma_f32_16x16x32_bf16 v[116:119], v[88:91], v[204:207], 0
ds_read_b64_tr_b16 v[86:87], v243 offset:6144
s_waitcnt lgkmcnt(4)
v_mfma_f32_16x16x32_bf16 v[104:107], v[92:95], v[208:211], v[104:107]
ds_read_b64_tr_b16 v[88:89], v3 offset:8192
v_mfma_f32_16x16x32_bf16 v[108:111], v[92:95], v[212:215], v[108:111]
ds_read_b64_tr_b16 v[90:91], v3 offset:10240
s_setprio 2
v_mfma_f32_16x16x32_bf16 v[112:115], v[96:99], v[208:211], v[112:115]
ds_read_b64_tr_b16 v[92:93], v243 offset:8192
v_mfma_f32_16x16x32_bf16 v[116:119], v[96:99], v[212:215], v[116:119]
ds_read_b64_tr_b16 v[94:95], v243 offset:10240
s_waitcnt lgkmcnt(4)
v_mfma_f32_16x16x32_bf16 v[104:107], v[80:83], v[216:219], v[104:107]
ds_read_b64_tr_b16 v[96:97], v3 offset:12288
s_add_u32 m0, s48, 45056
s_add_u32 s49, s47, 368896
buffer_load_dwordx4 v234, s[20:23], s49 offen lds
v_mfma_f32_16x16x32_bf16 v[108:111], v[80:83], v[220:223], v[108:111]
ds_read_b64_tr_b16 v[98:99], v3 offset:14336
v_mfma_f32_16x16x32_bf16 v[112:115], v[84:87], v[216:219], v[112:115]
ds_read_b64_tr_b16 v[80:81], v243 offset:12288
v_mfma_f32_16x16x32_bf16 v[116:119], v[84:87], v[220:223], v[116:119]
ds_read_b64_tr_b16 v[82:83], v243 offset:14336
s_waitcnt lgkmcnt(4)
v_mfma_f32_16x16x32_bf16 v[104:107], v[88:91], v[224:227], v[104:107]
ds_read_b64_tr_b16 v[84:85], v232 offset:20480
v_mfma_f32_16x16x32_bf16 v[108:111], v[88:91], v[236:239], v[108:111]
ds_read_b64_tr_b16 v[86:87], v232 offset:22528
s_setprio 1
v_mfma_f32_16x16x32_bf16 v[112:115], v[92:95], v[224:227], v[112:115]
ds_read_b64_tr_b16 v[88:89], v2 offset:20480
s_add_u32 m0, s48, 53248
s_add_u32 s49, s47, 384
buffer_load_dwordx4 v234, s[20:23], s49 offen lds
v_mfma_f32_16x16x32_bf16 v[116:119], v[92:95], v[236:239], v[116:119]
ds_read_b64_tr_b16 v[90:91], v2 offset:22528
s_waitcnt lgkmcnt(4)
v_mfma_f32_16x16x32_bf16 v[52:55], v[96:99], v[68:71], v[52:55]
ds_read_b64_tr_b16 v[92:93], v232 offset:24576
v_mfma_f32_16x16x32_bf16 v[56:59], v[96:99], v[72:75], v[56:59]
ds_read_b64_tr_b16 v[94:95], v232 offset:26624
v_mfma_f32_16x16x32_bf16 v[60:63], v[80:83], v[68:71], v[60:63]
ds_read_b64_tr_b16 v[96:97], v2 offset:24576
v_mfma_f32_16x16x32_bf16 v[64:67], v[80:83], v[72:75], v[64:67]
ds_read_b64_tr_b16 v[98:99], v2 offset:26624
s_waitcnt lgkmcnt(4)
v_mfma_f32_16x16x32_bf16 v[52:55], v[84:87], v[76:79], v[52:55]
ds_read_b64_tr_b16 v[80:81], v232 offset:28672
s_add_u32 m0, s48, 61440
s_add_u32 s49, s47, 74112
buffer_load_dwordx4 v234, s[20:23], s49 offen lds
v_mfma_f32_16x16x32_bf16 v[56:59], v[84:87], v[100:103], v[56:59]
ds_read_b64_tr_b16 v[82:83], v232 offset:30720
v_mfma_f32_16x16x32_bf16 v[60:63], v[88:91], v[76:79], v[60:63]
ds_read_b64_tr_b16 v[84:85], v2 offset:28672
v_mfma_f32_16x16x32_bf16 v[64:67], v[88:91], v[100:103], v[64:67]
ds_read_b64_tr_b16 v[86:87], v2 offset:30720
s_setprio 0
s_waitcnt lgkmcnt(4)
v_mfma_f32_16x16x32_bf16 v[104:107], v[92:95], v[4:7], v[104:107]
ds_read_b64_tr_b16 v[88:89], v232 offset:32768
v_mfma_f32_16x16x32_bf16 v[108:111], v[92:95], v[8:11], v[108:111]
ds_read_b64_tr_b16 v[90:91], v232 offset:34816
v_mfma_f32_16x16x32_bf16 v[112:115], v[96:99], v[4:7], v[112:115]
ds_read_b64_tr_b16 v[92:93], v2 offset:32768
v_cvt_pk_bf16_f32 v52, v52, v53
v_cvt_pk_bf16_f32 v53, v54, v55
v_cvt_pk_bf16_f32 v54, v60, v61
v_cvt_pk_bf16_f32 v55, v62, v63
s_add_u32 s50, s55, 0
buffer_store_dwordx4 v[52:55], v248, s[24:27], s50 offen sc1
v_mfma_f32_16x16x32_bf16 v[116:119], v[96:99], v[8:11], v[116:119]
ds_read_b64_tr_b16 v[94:95], v2 offset:34816
s_waitcnt lgkmcnt(4)
v_mfma_f32_16x16x32_bf16 v[104:107], v[80:83], v[12:15], v[104:107]
ds_read_b64_tr_b16 v[96:97], v232 offset:36864
v_mfma_f32_16x16x32_bf16 v[108:111], v[80:83], v[16:19], v[108:111]
ds_read_b64_tr_b16 v[98:99], v232 offset:38912
v_mfma_f32_16x16x32_bf16 v[112:115], v[84:87], v[12:15], v[112:115]
ds_read_b64_tr_b16 v[80:81], v2 offset:36864
v_mfma_f32_16x16x32_bf16 v[116:119], v[84:87], v[16:19], v[116:119]
ds_read_b64_tr_b16 v[82:83], v2 offset:38912
s_waitcnt vmcnt(6)
s_barrier
s_setprio 3
s_waitcnt lgkmcnt(4)
v_mfma_f32_16x16x32_bf16 v[104:107], v[88:91], v[20:23], v[104:107]
ds_read_b64_tr_b16 v[84:85], v3 offset:16384
s_add_u32 m0, s48, 16384
s_add_u32 s49, s47, 147840
buffer_load_dwordx4 v234, s[20:23], s49 offen lds
v_mfma_f32_16x16x32_bf16 v[108:111], v[88:91], v[24:27], v[108:111]
ds_read_b64_tr_b16 v[86:87], v3 offset:18432
v_mfma_f32_16x16x32_bf16 v[112:115], v[92:95], v[20:23], v[112:115]
ds_read_b64_tr_b16 v[88:89], v243 offset:16384
v_cvt_pk_bf16_f32 v56, v56, v57
v_cvt_pk_bf16_f32 v57, v58, v59
v_cvt_pk_bf16_f32 v58, v64, v65
v_cvt_pk_bf16_f32 v59, v66, v67
s_add_u32 s50, s55, 12288
buffer_store_dwordx4 v[56:59], v248, s[24:27], s50 offen sc1
v_mfma_f32_16x16x32_bf16 v[116:119], v[92:95], v[24:27], v[116:119]
ds_read_b64_tr_b16 v[90:91], v243 offset:18432
s_waitcnt lgkmcnt(4)
v_mfma_f32_16x16x32_bf16 v[104:107], v[96:99], v[28:31], v[104:107]
ds_read_b64_tr_b16 v[92:93], v3 offset:20480
v_mfma_f32_16x16x32_bf16 v[108:111], v[96:99], v[32:35], v[108:111]
ds_read_b64_tr_b16 v[94:95], v3 offset:22528
v_mfma_f32_16x16x32_bf16 v[112:115], v[80:83], v[28:31], v[112:115]
ds_read_b64_tr_b16 v[96:97], v243 offset:20480
s_add_u32 m0, s48, 24576
s_add_u32 s49, s47, 221568
buffer_load_dwordx4 v234, s[20:23], s49 offen lds
v_mfma_f32_16x16x32_bf16 v[116:119], v[80:83], v[32:35], v[116:119]
ds_read_b64_tr_b16 v[98:99], v243 offset:22528
s_waitcnt lgkmcnt(4)
v_mfma_f32_16x16x32_bf16 v[104:107], v[84:87], v[36:39], v[104:107]
ds_read_b64_tr_b16 v[80:81], v3 offset:24576
v_mfma_f32_16x16x32_bf16 v[108:111], v[84:87], v[40:43], v[108:111]
ds_read_b64_tr_b16 v[82:83], v3 offset:26624
s_setprio 2
v_mfma_f32_16x16x32_bf16 v[112:115], v[88:91], v[36:39], v[112:115]
ds_read_b64_tr_b16 v[84:85], v243 offset:24576
v_mfma_f32_16x16x32_bf16 v[116:119], v[88:91], v[40:43], v[116:119]
ds_read_b64_tr_b16 v[86:87], v243 offset:26624
s_waitcnt lgkmcnt(4)
v_mfma_f32_16x16x32_bf16 v[104:107], v[92:95], v[44:47], v[104:107]
ds_read_b64_tr_b16 v[88:89], v3 offset:28672
s_add_u32 m0, s48, 65536
s_add_u32 s49, s47, 295296
buffer_load_dwordx4 v234, s[20:23], s49 offen lds
v_mfma_f32_16x16x32_bf16 v[108:111], v[92:95], v[48:51], v[108:111]
ds_read_b64_tr_b16 v[90:91], v3 offset:30720
v_mfma_f32_16x16x32_bf16 v[112:115], v[96:99], v[44:47], v[112:115]
ds_read_b64_tr_b16 v[92:93], v243 offset:28672
v_mfma_f32_16x16x32_bf16 v[116:119], v[96:99], v[48:51], v[116:119]
ds_read_b64_tr_b16 v[94:95], v243 offset:30720
s_waitcnt lgkmcnt(4)
v_mfma_f32_16x16x32_bf16 v[104:107], v[80:83], v[68:71], v[104:107]
ds_read_b64_tr_b16 v[96:97], v3 offset:32768
v_mfma_f32_16x16x32_bf16 v[108:111], v[80:83], v[72:75], v[108:111]
ds_read_b64_tr_b16 v[98:99], v3 offset:34816
s_setprio 1
v_mfma_f32_16x16x32_bf16 v[112:115], v[84:87], v[68:71], v[112:115]
ds_read_b64_tr_b16 v[80:81], v243 offset:32768
s_add_u32 m0, s48, 73728
s_add_u32 s49, s47, 369024
buffer_load_dwordx4 v234, s[20:23], s49 offen lds
v_mfma_f32_16x16x32_bf16 v[116:119], v[84:87], v[72:75], v[116:119]
ds_read_b64_tr_b16 v[82:83], v243 offset:34816
s_waitcnt lgkmcnt(4)
v_mfma_f32_16x16x32_bf16 v[104:107], v[88:91], v[76:79], v[104:107]
ds_read_b64_tr_b16 v[84:85], v3 offset:36864
v_mfma_f32_16x16x32_bf16 v[108:111], v[88:91], v[100:103], v[108:111]
ds_read_b64_tr_b16 v[86:87], v3 offset:38912
v_mfma_f32_16x16x32_bf16 v[112:115], v[92:95], v[76:79], v[112:115]
ds_read_b64_tr_b16 v[88:89], v243 offset:36864
v_mfma_f32_16x16x32_bf16 v[116:119], v[92:95], v[100:103], v[116:119]
ds_read_b64_tr_b16 v[90:91], v243 offset:38912
s_waitcnt lgkmcnt(4)
v_mfma_f32_16x16x32_bf16 v[52:55], v[96:99], v[200:203], 0
ds_read_b64_tr_b16 v[92:93], v3 offset:40960
s_add_u32 m0, s48, 122880
s_add_u32 s49, s47, 512
buffer_load_dwordx4 v234, s[20:23], s49 offen lds
v_mfma_f32_16x16x32_bf16 v[60:63], v[96:99], v[204:207], 0
ds_read_b64_tr_b16 v[94:95], v3 offset:43008
v_mfma_f32_16x16x32_bf16 v[120:123], v[80:83], v[200:203], 0
ds_read_b64_tr_b16 v[96:97], v243 offset:40960
v_cvt_pk_bf16_f32 v104, v104, v105
v_cvt_pk_bf16_f32 v105, v106, v107
v_cvt_pk_bf16_f32 v106, v112, v113
v_cvt_pk_bf16_f32 v107, v114, v115
s_add_u32 s50, s55, 196608
buffer_store_dwordx4 v[104:107], v248, s[24:27], s50 offen sc1
v_mfma_f32_16x16x32_bf16 v[124:127], v[80:83], v[204:207], 0
ds_read_b64_tr_b16 v[98:99], v243 offset:43008
s_setprio 0
s_waitcnt lgkmcnt(4)
v_mfma_f32_16x16x32_bf16 v[52:55], v[84:87], v[208:211], v[52:55]
ds_read_b64_tr_b16 v[80:81], v3 offset:45056
s_waitcnt vmcnt(5)
s_add_u32 s50, s56, 0
v_mov_b32 v244, s98
v_mov_b32 v245, s99
s_mov_b64 exec, 1
buffer_store_dwordx2 v[244:245], v248, s[24:27], s50 offen sc1
s_mov_b64 exec, -1
v_mfma_f32_16x16x32_bf16 v[60:63], v[84:87], v[212:215], v[60:63]
ds_read_b64_tr_b16 v[82:83], v3 offset:47104
v_mfma_f32_16x16x32_bf16 v[120:123], v[88:91], v[208:211], v[120:123]
ds_read_b64_tr_b16 v[84:85], v243 offset:45056
v_mfma_f32_16x16x32_bf16 v[124:127], v[88:91], v[212:215], v[124:127]
ds_read_b64_tr_b16 v[86:87], v243 offset:47104
s_waitcnt lgkmcnt(4)
v_mfma_f32_16x16x32_bf16 v[52:55], v[92:95], v[216:219], v[52:55]
ds_read_b64_tr_b16 v[88:89], v3 offset:49152
v_mfma_f32_16x16x32_bf16 v[60:63], v[92:95], v[220:223], v[60:63]
ds_read_b64_tr_b16 v[90:91], v3 offset:51200
v_mfma_f32_16x16x32_bf16 v[120:123], v[96:99], v[216:219], v[120:123]
ds_read_b64_tr_b16 v[92:93], v243 offset:49152
v_cvt_pk_bf16_f32 v108, v108, v109
v_cvt_pk_bf16_f32 v109, v110, v111
v_cvt_pk_bf16_f32 v110, v116, v117
v_cvt_pk_bf16_f32 v111, v118, v119
s_add_u32 s50, s55, 208896
buffer_store_dwordx4 v[108:111], v248, s[24:27], s50 offen sc1
v_mfma_f32_16x16x32_bf16 v[124:127], v[96:99], v[220:223], v[124:127]
ds_read_b64_tr_b16 v[94:95], v243 offset:51200
s_barrier
s_setprio 3
s_waitcnt lgkmcnt(4)
v_mfma_f32_16x16x32_bf16 v[52:55], v[80:83], v[224:227], v[52:55]
ds_read_b64_tr_b16 v[96:97], v3 offset:53248
s_add_u32 m0, s48, 32768
s_add_u32 s49, s47, 74240
buffer_load_dwordx4 v234, s[20:23], s49 offen lds
v_mfma_f32_16x16x32_bf16 v[60:63], v[80:83], v[236:239], v[60:63]
ds_read_b64_tr_b16 v[98:99], v3 offset:55296
v_mfma_f32_16x16x32_bf16 v[120:123], v[84:87], v[224:227], v[120:123]
ds_read_b64_tr_b16 v[80:81], v243 offset:53248
v_mfma_f32_16x16x32_bf16 v[124:127], v[84:87], v[236:239], v[124:127]
ds_read_b64_tr_b16 v[82:83], v243 offset:55296
s_waitcnt lgkmcnt(4)
v_mfma_f32_16x16x32_bf16 v[52:55], v[88:91], v[4:7], v[52:55]
ds_read_b64_tr_b16 v[84:85], v232 offset:0
v_mfma_f32_16x16x32_bf16 v[60:63], v[88:91], v[8:11], v[60:63]
ds_read_b64_tr_b16 v[86:87], v232 offset:2048
v_mfma_f32_16x16x32_bf16 v[120:123], v[92:95], v[4:7], v[120:123]
ds_read_b64_tr_b16 v[88:89], v2 offset:0
s_add_u32 m0, s48, 81920
s_add_u32 s49, s47, 147968
buffer_load_dwordx4 v234, s[20:23], s49 offen lds
v_mfma_f32_16x16x32_bf16 v[124:127], v[92:95], v[8:11], v[124:127]
ds_read_b64_tr_b16 v[90:91], v2 offset:2048
s_waitcnt lgkmcnt(4)
v_mfma_f32_16x16x32_bf16 v[52:55], v[96:99], v[12:15], v[52:55]
ds_read_b64_tr_b16 v[92:93], v232 offset:4096
v_mfma_f32_16x16x32_bf16 v[60:63], v[96:99], v[16:19], v[60:63]
ds_read_b64_tr_b16 v[94:95], v232 offset:6144
s_setprio 2
v_mfma_f32_16x16x32_bf16 v[120:123], v[80:83], v[12:15], v[120:123]
ds_read_b64_tr_b16 v[96:97], v2 offset:4096
v_mfma_f32_16x16x32_bf16 v[124:127], v[80:83], v[16:19], v[124:127]
ds_read_b64_tr_b16 v[98:99], v2 offset:6144
s_waitcnt lgkmcnt(4)
v_mfma_f32_16x16x32_bf16 v[52:55], v[84:87], v[20:23], v[52:55]
ds_read_b64_tr_b16 v[80:81], v232 offset:8192
s_add_u32 m0, s48, 90112
s_add_u32 s49, s47, 221696
buffer_load_dwordx4 v234, s[20:23], s49 offen lds
v_mfma_f32_16x16x32_bf16 v[60:63], v[84:87], v[24:27], v[60:63]
ds_read_b64_tr_b16 v[82:83], v232 offset:10240
v_mfma_f32_16x16x32_bf16 v[120:123], v[88:91], v[20:23], v[120:123]
ds_read_b64_tr_b16 v[84:85], v2 offset:8192
v_mfma_f32_16x16x32_bf16 v[124:127], v[88:91], v[24:27], v[124:127]
ds_read_b64_tr_b16 v[86:87], v2 offset:10240
s_waitcnt lgkmcnt(4)
v_mfma_f32_16x16x32_bf16 v[52:55], v[92:95], v[28:31], v[52:55]
ds_read_b64_tr_b16 v[88:89], v232 offset:40960
v_mfma_f32_16x16x32_bf16 v[60:63], v[92:95], v[32:35], v[60:63]
ds_read_b64_tr_b16 v[90:91], v232 offset:43008
s_setprio 1
v_mfma_f32_16x16x32_bf16 v[120:123], v[96:99], v[28:31], v[120:123]
ds_read_b64_tr_b16 v[92:93], v2 offset:40960
s_add_u32 m0, s48, 98304
s_add_u32 s49, s47, 295424
buffer_load_dwordx4 v234, s[20:23], s49 offen lds
v_mfma_f32_16x16x32_bf16 v[124:127], v[96:99], v[32:35], v[124:127]
ds_read_b64_tr_b16 v[94:95], v2 offset:43008
s_waitcnt lgkmcnt(4)
v_mfma_f32_16x16x32_bf16 v[52:55], v[80:83], v[36:39], v[52:55]
ds_read_b64_tr_b16 v[96:97], v232 offset:45056
v_mfma_f32_16x16x32_bf16 v[60:63], v[80:83], v[40:43], v[60:63]
ds_read_b64_tr_b16 v[98:99], v232 offset:47104
v_mfma_f32_16x16x32_bf16 v[120:123], v[84:87], v[36:39], v[120:123]
ds_read_b64_tr_b16 v[80:81], v2 offset:45056
v_mfma_f32_16x16x32_bf16 v[124:127], v[84:87], v[40:43], v[124:127]
ds_read_b64_tr_b16 v[82:83], v2 offset:47104
s_waitcnt lgkmcnt(4)
v_mfma_f32_16x16x32_bf16 v[52:55], v[88:91], v[44:47], v[52:55]
ds_read_b64_tr_b16 v[84:85], v232 offset:49152
s_add_u32 m0, s48, 106496
s_add_u32 s49, s47, 369152
buffer_load_dwordx4 v234, s[20:23], s49 offen lds
v_mfma_f32_16x16x32_bf16 v[60:63], v[88:91], v[48:51], v[60:63]
ds_read_b64_tr_b16 v[86:87], v232 offset:51200
s_waitcnt vmcnt(5)
s_add_u32 s50, s56, 32768
v_mov_b32 v244, s98
v_mov_b32 v245, s99
s_mov_b64 exec, 1
buffer_store_dwordx2 v[244:245], v248, s[24:27], s50 offen sc1
s_mov_b64 exec, -1
v_mfma_f32_16x16x32_bf16 v[120:123], v[92:95], v[44:47], v[120:123]
ds_read_b64_tr_b16 v[88:89], v2 offset:49152
v_mfma_f32_16x16x32_bf16 v[124:127], v[92:95], v[48:51], v[124:127]
ds_read_b64_tr_b16 v[90:91], v2 offset:51200
s_setprio 0
s_waitcnt lgkmcnt(4)
v_mfma_f32_16x16x32_bf16 v[52:55], v[96:99], v[68:71], v[52:55]
ds_read_b64_tr_b16 v[92:93], v232 offset:53248
v_mfma_f32_16x16x32_bf16 v[60:63], v[96:99], v[72:75], v[60:63]
ds_read_b64_tr_b16 v[94:95], v232 offset:55296
v_mfma_f32_16x16x32_bf16 v[120:123], v[80:83], v[68:71], v[120:123]
ds_read_b64_tr_b16 v[96:97], v2 offset:53248
v_mfma_f32_16x16x32_bf16 v[124:127], v[80:83], v[72:75], v[124:127]
ds_read_b64_tr_b16 v[98:99], v2 offset:55296
s_waitcnt lgkmcnt(4)
v_mfma_f32_16x16x32_bf16 v[52:55], v[84:87], v[76:79], v[52:55]
ds_read_b64_tr_b16 v[80:81], v232 offset:57344
v_mfma_f32_16x16x32_bf16 v[60:63], v[84:87], v[100:103], v[60:63]
ds_read_b64_tr_b16 v[82:83], v232 offset:59392
v_mfma_f32_16x16x32_bf16 v[120:123], v[88:91], v[76:79], v[120:123]
ds_read_b64_tr_b16 v[84:85], v2 offset:57344
v_mfma_f32_16x16x32_bf16 v[124:127], v[88:91], v[100:103], v[124:127]
ds_read_b64_tr_b16 v[86:87], v2 offset:59392
s_barrier
s_setprio 3
s_waitcnt lgkmcnt(4)
v_mfma_f32_16x16x32_bf16 v[56:59], v[92:95], v[200:203], 0
ds_read_b64_tr_b16 v[88:89], v232 offset:61440
s_add_u32 m0, s48, 4096
s_add_u32 s49, s47, 640
buffer_load_dwordx4 v234, s[20:23], s49 offen lds
v_mfma_f32_16x16x32_bf16 v[64:67], v[92:95], v[204:207], 0
ds_read_b64_tr_b16 v[90:91], v232 offset:63488
v_mfma_f32_16x16x32_bf16 v[104:107], v[96:99], v[200:203], 0
ds_read_b64_tr_b16 v[92:93], v2 offset:61440
v_cvt_pk_bf16_f32 v52, v52, v53
v_cvt_pk_bf16_f32 v53, v54, v55
v_cvt_pk_bf16_f32 v54, v120, v121
v_cvt_pk_bf16_f32 v55, v122, v123
s_add_u32 s50, s55, 393216
buffer_store_dwordx4 v[52:55], v248, s[24:27], s50 offen sc1
v_mfma_f32_16x16x32_bf16 v[108:111], v[96:99], v[204:207], 0
ds_read_b64_tr_b16 v[94:95], v2 offset:63488
s_waitcnt lgkmcnt(4)
v_mfma_f32_16x16x32_bf16 v[56:59], v[80:83], v[208:211], v[56:59]
ds_read_b64_tr_b16 v[96:97], v232 offset:12288
v_mfma_f32_16x16x32_bf16 v[64:67], v[80:83], v[212:215], v[64:67]
ds_read_b64_tr_b16 v[98:99], v232 offset:14336
v_mfma_f32_16x16x32_bf16 v[104:107], v[84:87], v[208:211], v[104:107]
ds_read_b64_tr_b16 v[80:81], v2 offset:12288
v_mfma_f32_16x16x32_bf16 v[108:111], v[84:87], v[212:215], v[108:111]
ds_read_b64_tr_b16 v[82:83], v2 offset:14336
s_waitcnt lgkmcnt(4)
v_mfma_f32_16x16x32_bf16 v[56:59], v[88:91], v[216:219], v[56:59]
ds_read_b64_tr_b16 v[84:85], v232 offset:16384
s_add_u32 m0, s48, 40960
s_add_u32 s49, s47, 74368
buffer_load_dwordx4 v234, s[20:23], s49 offen lds
v_mfma_f32_16x16x32_bf16 v[64:67], v[88:91], v[220:223], v[64:67]
ds_read_b64_tr_b16 v[86:87], v232 offset:18432
s_setprio 2
v_mfma_f32_16x16x32_bf16 v[104:107], v[92:95], v[216:219], v[104:107]
ds_read_b64_tr_b16 v[88:89], v2 offset:16384
v_cvt_pk_bf16_f32 v60, v60, v61
v_cvt_pk_bf16_f32 v61, v62, v63
v_cvt_pk_bf16_f32 v62, v124, v125
v_cvt_pk_bf16_f32 v63, v126, v127
s_add_u32 s50, s55, 405504
buffer_store_dwordx4 v[60:63], v248, s[24:27], s50 offen sc1
v_mfma_f32_16x16x32_bf16 v[108:111], v[92:95], v[220:223], v[108:111]
ds_read_b64_tr_b16 v[90:91], v2 offset:18432
s_waitcnt lgkmcnt(4)
v_mfma_f32_16x16x32_bf16 v[56:59], v[96:99], v[224:227], v[56:59]
ds_read_b64_tr_b16 v[92:93], v232 offset:20480
v_mfma_f32_16x16x32_bf16 v[64:67], v[96:99], v[236:239], v[64:67]
ds_read_b64_tr_b16 v[94:95], v232 offset:22528
v_mfma_f32_16x16x32_bf16 v[104:107], v[80:83], v[224:227], v[104:107]
ds_read_b64_tr_b16 v[96:97], v2 offset:20480
v_mfma_f32_16x16x32_bf16 v[108:111], v[80:83], v[236:239], v[108:111]
ds_read_b64_tr_b16 v[98:99], v2 offset:22528
s_waitcnt lgkmcnt(4)
v_mfma_f32_16x16x32_bf16 v[56:59], v[84:87], v[4:7], v[56:59]
ds_read_b64_tr_b16 v[80:81], v232 offset:24576
s_add_u32 m0, s48, 49152
s_add_u32 s49, s47, 148096
buffer_load_dwordx4 v234, s[20:23], s49 offen lds
v_mfma_f32_16x16x32_bf16 v[64:67], v[84:87], v[8:11], v[64:67]
ds_read_b64_tr_b16 v[82:83], v232 offset:26624
s_setprio 1
v_mfma_f32_16x16x32_bf16 v[104:107], v[88:91], v[4:7], v[104:107]
ds_read_b64_tr_b16 v[84:85], v2 offset:24576
v_mfma_f32_16x16x32_bf16 v[108:111], v[88:91], v[8:11], v[108:111]
ds_read_b64_tr_b16 v[86:87], v2 offset:26624
s_waitcnt lgkmcnt(4)
v_mfma_f32_16x16x32_bf16 v[56:59], v[92:95], v[12:15], v[56:59]
ds_read_b64_tr_b16 v[88:89], v232 offset:28672
v_mfma_f32_16x16x32_bf16 v[64:67], v[92:95], v[16:19], v[64:67]
ds_read_b64_tr_b16 v[90:91], v232 offset:30720
v_mfma_f32_16x16x32_bf16 v[104:107], v[96:99], v[12:15], v[104:107]
ds_read_b64_tr_b16 v[92:93], v2 offset:28672
v_mfma_f32_16x16x32_bf16 v[108:111], v[96:99], v[16:19], v[108:111]
ds_read_b64_tr_b16 v[94:95], v2 offset:30720
s_waitcnt lgkmcnt(4)
v_mfma_f32_16x16x32_bf16 v[56:59], v[80:83], v[20:23], v[56:59]
ds_read_b64_tr_b16 v[96:97], v3 offset:0
s_add_u32 m0, s48, 114688
s_add_u32 s49, s47, 221824
buffer_load_dwordx4 v234, s[20:23], s49 offen lds
v_mfma_f32_16x16x32_bf16 v[64:67], v[80:83], v[24:27], v[64:67]
ds_read_b64_tr_b16 v[98:99], v3 offset:2048
v_mfma_f32_16x16x32_bf16 v[104:107], v[84:87], v[20:23], v[104:107]
ds_read_b64_tr_b16 v[80:81], v243 offset:0
v_mfma_f32_16x16x32_bf16 v[108:111], v[84:87], v[24:27], v[108:111]
ds_read_b64_tr_b16 v[82:83], v243 offset:2048
s_setprio 0
s_waitcnt lgkmcnt(4)
v_mfma_f32_16x16x32_bf16 v[56:59], v[88:91], v[28:31], v[56:59]
ds_read_b64_tr_b16 v[84:85], v3 offset:4096
v_mfma_f32_16x16x32_bf16 v[64:67], v[88:91], v[32:35], v[64:67]
ds_read_b64_tr_b16 v[86:87], v3 offset:6144
v_mfma_f32_16x16x32_bf16 v[104:107], v[92:95], v[28:31], v[104:107]
ds_read_b64_tr_b16 v[88:89], v243 offset:4096
v_mfma_f32_16x16x32_bf16 v[108:111], v[92:95], v[32:35], v[108:111]
ds_read_b64_tr_b16 v[90:91], v243 offset:6144
s_waitcnt lgkmcnt(4)
v_mfma_f32_16x16x32_bf16 v[56:59], v[96:99], v[36:39], v[56:59]
ds_read_b64_tr_b16 v[92:93], v3 offset:8192
v_mfma_f32_16x16x32_bf16 v[64:67], v[96:99], v[40:43], v[64:67]
ds_read_b64_tr_b16 v[94:95], v3 offset:10240
v_mfma_f32_16x16x32_bf16 v[104:107], v[80:83], v[36:39], v[104:107]
ds_read_b64_tr_b16 v[96:97], v243 offset:8192
v_mfma_f32_16x16x32_bf16 v[108:111], v[80:83], v[40:43], v[108:111]
ds_read_b64_tr_b16 v[98:99], v243 offset:10240
s_waitcnt vmcnt(9)
s_barrier
s_setprio 3
s_mov_b32 s50, 46141440
v_min_u32 v255, 63, v1
v_lshlrev_b32 v255, 3, v255
buffer_load_dwordx2 v[244:245], v255, s[24:27], s50 offen sc1
s_waitcnt lgkmcnt(4)
v_mfma_f32_16x16x32_bf16 v[56:59], v[84:87], v[44:47], v[56:59]
ds_read_b64_tr_b16 v[80:81], v3 offset:12288
s_add_u32 m0, s48, 12288
s_add_u32 s49, s47, 295552
buffer_load_dwordx4 v234, s[20:23], s49 offen lds
v_mfma_f32_16x16x32_bf16 v[64:67], v[84:87], v[48:51], v[64:67]
ds_read_b64_tr_b16 v[82:83], v3 offset:14336
s_waitcnt vmcnt(4)
s_add_u32 s50, s56, 65536
v_mov_b32 v240, s98
v_mov_b32 v241, s99
s_mov_b64 exec, 1
buffer_store_dwordx2 v[240:241], v248, s[24:27], s50 offen sc1
s_mov_b64 exec, -1
v_mfma_f32_16x16x32_bf16 v[104:107], v[88:91], v[44:47], v[104:107]
ds_read_b64_tr_b16 v[84:85], v243 offset:12288
v_mfma_f32_16x16x32_bf16 v[108:111], v[88:91], v[48:51], v[108:111]
ds_read_b64_tr_b16 v[86:87], v243 offset:14336
s_waitcnt lgkmcnt(4)
v_mfma_f32_16x16x32_bf16 v[56:59], v[92:95], v[68:71], v[56:59]
ds_read_b64_tr_b16 v[88:89], v3 offset:57344
v_mfma_f32_16x16x32_bf16 v[64:67], v[92:95], v[72:75], v[64:67]
ds_read_b64_tr_b16 v[90:91], v3 offset:59392
v_mfma_f32_16x16x32_bf16 v[104:107], v[96:99], v[68:71], v[104:107]
ds_read_b64_tr_b16 v[92:93], v243 offset:57344
s_add_u32 m0, s48, 20480
s_add_u32 s49, s47, 369280
buffer_load_dwordx4 v234, s[20:23], s49 offen lds
v_mfma_f32_16x16x32_bf16 v[108:111], v[96:99], v[72:75], v[108:111]
ds_read_b64_tr_b16 v[94:95], v243 offset:59392
s_waitcnt lgkmcnt(4)
v_mfma_f32_16x16x32_bf16 v[56:59], v[80:83], v[76:79], v[56:59]
ds_read_b64_tr_b16 v[96:97], v3 offset:61440
v_mfma_f32_16x16x32_bf16 v[64:67], v[80:83], v[100:103], v[64:67]
ds_read_b64_tr_b16 v[98:99], v3 offset:63488
s_setprio 2
v_mfma_f32_16x16x32_bf16 v[104:107], v[84:87], v[76:79], v[104:107]
ds_read_b64_tr_b16 v[80:81], v243 offset:61440
v_mfma_f32_16x16x32_bf16 v[108:111], v[84:87], v[100:103], v[108:111]
ds_read_b64_tr_b16 v[82:83], v243 offset:63488
s_waitcnt lgkmcnt(4)
v_mfma_f32_16x16x32_bf16 v[52:55], v[88:91], v[200:203], 0
ds_read_b64_tr_b16 v[84:85], v232 offset:32768
s_add_u32 m0, s48, 28672
s_add_u32 s49, s47, 768
buffer_load_dwordx4 v234, s[20:23], s49 offen lds
v_mfma_f32_16x16x32_bf16 v[60:63], v[88:91], v[204:207], 0
ds_read_b64_tr_b16 v[86:87], v232 offset:34816
v_mfma_f32_16x16x32_bf16 v[112:115], v[92:95], v[200:203], 0
ds_read_b64_tr_b16 v[88:89], v2 offset:32768
v_cvt_pk_bf16_f32 v56, v56, v57
v_cvt_pk_bf16_f32 v57, v58, v59
v_cvt_pk_bf16_f32 v58, v104, v105
v_cvt_pk_bf16_f32 v59, v106, v107
s_add_u32 s50, s55, 589824
buffer_store_dwordx4 v[56:59], v248, s[24:27], s50 offen sc1
v_mfma_f32_16x16x32_bf16 v[116:119], v[92:95], v[204:207], 0
ds_read_b64_tr_b16 v[90:91], v2 offset:34816
s_waitcnt lgkmcnt(4)
v_mfma_f32_16x16x32_bf16 v[52:55], v[96:99], v[208:211], v[52:55]
ds_read_b64_tr_b16 v[92:93], v232 offset:36864
v_mfma_f32_16x16x32_bf16 v[60:63], v[96:99], v[212:215], v[60:63]
ds_read_b64_tr_b16 v[94:95], v232 offset:38912
s_setprio 1
v_mfma_f32_16x16x32_bf16 v[112:115], v[80:83], v[208:211], v[112:115]
ds_read_b64_tr_b16 v[96:97], v2 offset:36864
s_add_u32 m0, s48, 57344
s_add_u32 s49, s47, 74496
buffer_load_dwordx4 v234, s[20:23], s49 offen lds
v_mfma_f32_16x16x32_bf16 v[116:119], v[80:83], v[212:215], v[116:119]
ds_read_b64_tr_b16 v[98:99], v2 offset:38912
v_and_b32 v255, 1, v1
v_lshlrev_b32 v255, 4, v255
v_mov_b32 v254, 0x3f80
v_lshlrev_b32 v255, v255, v254
v_lshrrev_b32 v254, 1, v251
v_cmp_eq_u32 vcc, 0, v254
s_nop 1
v_cndmask_b32 v56, 0, v255, vcc
v_cmp_eq_u32 vcc, 1, v254
s_nop 1
v_cndmask_b32 v57, 0, v255, vcc
v_cmp_eq_u32 vcc, 2, v254
s_nop 1
v_cndmask_b32 v58, 0, v255, vcc
v_cmp_eq_u32 vcc, 3, v254
s_nop 1
v_cndmask_b32 v59, 0, v255, vcc
v_cmp_eq_u32 vcc, 4, v254
s_nop 1
v_cndmask_b32 v104, 0, v255, vcc
v_cmp_eq_u32 vcc, 5, v254
s_nop 1
v_cndmask_b32 v105, 0, v255, vcc
v_cmp_eq_u32 vcc, 6, v254
s_nop 1
v_cndmask_b32 v106, 0, v255, vcc
v_cmp_eq_u32 vcc, 7, v254
s_nop 1
v_cndmask_b32 v107, 0, v255, vcc
v_lshlrev_b32 v255, 4, v251
v_lshl_add_u32 v235, v252, 10, v255
v_and_b32 v255, 1, v252
v_lshrrev_b32 v254, 1, v252
v_lshl_add_u32 v254, v254, 4, v251
v_mul_u32_u24 v254, 1152, v254
v_lshl_add_u32 v233, v255, 5, v254
buffer_load_dwordx4 v[120:123], v233, s[8:11], s6 offen offset:0
buffer_load_dwordx4 v[124:127], v233, s[8:11], s6 offen offset:384
s_waitcnt lgkmcnt(4)
v_mfma_f32_16x16x32_bf16 v[52:55], v[84:87], v[216:219], v[52:55]
ds_read_b64_tr_b16 v[80:81], v3 offset:16384
v_mfma_f32_16x16x32_bf16 v[60:63], v[84:87], v[220:223], v[60:63]
ds_read_b64_tr_b16 v[82:83], v3 offset:18432
v_mfma_f32_16x16x32_bf16 v[112:115], v[88:91], v[216:219], v[112:115]
ds_read_b64_tr_b16 v[84:85], v243 offset:16384
v_cvt_pk_bf16_f32 v64, v64, v65
v_cvt_pk_bf16_f32 v65, v66, v67
v_cvt_pk_bf16_f32 v66, v108, v109
v_cvt_pk_bf16_f32 v67, v110, v111
s_add_u32 s50, s55, 602112
buffer_store_dwordx4 v[64:67], v248, s[24:27], s50 offen sc1
v_mfma_f32_16x16x32_bf16 v[116:119], v[88:91], v[220:223], v[116:119]
ds_read_b64_tr_b16 v[86:87], v243 offset:18432
s_waitcnt lgkmcnt(4)
v_mfma_f32_16x16x32_bf16 v[52:55], v[92:95], v[224:227], v[52:55]
ds_read_b64_tr_b16 v[88:89], v3 offset:20480
s_add_u32 m0, s48, 65536
s_add_u32 s49, s47, 148224
buffer_load_dwordx4 v234, s[20:23], s49 offen lds
v_mfma_f32_16x16x32_bf16 v[60:63], v[92:95], v[236:239], v[60:63]
ds_read_b64_tr_b16 v[90:91], v3 offset:22528
v_mfma_f32_16x16x32_bf16 v[112:115], v[96:99], v[224:227], v[112:115]
ds_read_b64_tr_b16 v[92:93], v243 offset:20480
v_mfma_f32_16x16x32_bf16 v[116:119], v[96:99], v[236:239], v[116:119]
ds_read_b64_tr_b16 v[94:95], v243 offset:22528
s_setprio 0
s_waitcnt lgkmcnt(4)
v_mfma_f32_16x16x32_bf16 v[52:55], v[80:83], v[4:7], v[52:55]
ds_read_b64_tr_b16 v[96:97], v3 offset:24576
v_mfma_f32_16x16x32_bf16 v[60:63], v[80:83], v[8:11], v[60:63]
ds_read_b64_tr_b16 v[98:99], v3 offset:26624
v_mfma_f32_16x16x32_bf16 v[112:115], v[84:87], v[4:7], v[112:115]
ds_read_b64_tr_b16 v[80:81], v243 offset:24576
v_mfma_f32_16x16x32_bf16 v[116:119], v[84:87], v[8:11], v[116:119]
ds_read_b64_tr_b16 v[82:83], v243 offset:26624
s_waitcnt lgkmcnt(4)
v_mfma_f32_16x16x32_bf16 v[52:55], v[88:91], v[12:15], v[52:55]
ds_read_b64_tr_b16 v[84:85], v3 offset:28672
v_mfma_f32_16x16x32_bf16 v[60:63], v[88:91], v[16:19], v[60:63]
ds_read_b64_tr_b16 v[86:87], v3 offset:30720
v_mfma_f32_16x16x32_bf16 v[112:115], v[92:95], v[12:15], v[112:115]
ds_read_b64_tr_b16 v[88:89], v243 offset:28672
v_mfma_f32_16x16x32_bf16 v[116:119], v[92:95], v[16:19], v[116:119]
ds_read_b64_tr_b16 v[90:91], v243 offset:30720
s_waitcnt vmcnt(12)
s_barrier
s_setprio 3
s_waitcnt vmcnt(10)
s_mov_b32 s52, 0
L_spf0_2:
v_cmp_ne_u64 vcc, s[98:99], v[244:245]
s_nop 1
s_cmp_eq_u64 vcc, 0
s_cbranch_scc1 L_spf0_2x
s_add_u32 s52, s52, 1
s_cmp_ge_u32 s52, 0x10000
s_cbranch_scc1 L_spf0_2x
s_sleep 2
s_mov_b32 s50, 46141440
v_min_u32 v255, 63, v1
v_lshlrev_b32 v255, 3, v255
buffer_load_dwordx2 v[244:245], v255, s[24:27], s50 offen sc1
s_waitcnt vmcnt(0)
s_branch L_spf0_2
L_spf0_2x:
s_waitcnt lgkmcnt(4)
v_mfma_f32_16x16x32_bf16 v[52:55], v[96:99], v[20:23], v[52:55]
ds_read_b64_tr_b16 v[92:93], v3 offset:32768
s_add_u32 m0, s48, 36864
s_add_u32 s49, s47, 221952
buffer_load_dwordx4 v234, s[20:23], s49 offen lds
v_mfma_f32_16x16x32_bf16 v[60:63], v[96:99], v[24:27], v[60:63]
ds_read_b64_tr_b16 v[94:95], v3 offset:34816
v_mfma_f32_16x16x32_bf16 v[112:115], v[80:83], v[20:23], v[112:115]
ds_read_b64_tr_b16 v[96:97], v243 offset:32768
s_add_u32 s50, s5, 0
v_min_u32 v255, 11, v1
v_lshlrev_b32 v255, 3, v255
buffer_load_dwordx2 v[244:245], v255, s[24:27], s50 offen sc1
v_mfma_f32_16x16x32_bf16 v[116:119], v[80:83], v[24:27], v[116:119]
ds_read_b64_tr_b16 v[98:99], v243 offset:34816
s_waitcnt lgkmcnt(4)
v_mfma_f32_16x16x32_bf16 v[52:55], v[84:87], v[28:31], v[52:55]
ds_read_b64_tr_b16 v[80:81], v3 offset:36864
v_mfma_f32_16x16x32_bf16 v[60:63], v[84:87], v[32:35], v[60:63]
ds_read_b64_tr_b16 v[82:83], v3 offset:38912
v_mfma_f32_16x16x32_bf16 v[112:115], v[88:91], v[28:31], v[112:115]
ds_read_b64_tr_b16 v[84:85], v243 offset:36864
v_mfma_f32_16x16x32_bf16 v[116:119], v[88:91], v[32:35], v[116:119]
ds_read_b64_tr_b16 v[86:87], v243 offset:38912
s_waitcnt lgkmcnt(4)
v_mfma_f32_16x16x32_bf16 v[52:55], v[92:95], v[36:39], v[52:55]
ds_read_b64_tr_b16 v[88:89], v3 offset:40960
s_add_u32 m0, s48, 73728
s_add_u32 s49, s47, 295680
buffer_load_dwordx4 v234, s[20:23], s49 offen lds
v_mfma_f32_16x16x32_bf16 v[60:63], v[92:95], v[40:43], v[60:63]
ds_read_b64_tr_b16 v[90:91], v3 offset:43008
s_setprio 2
v_mfma_f32_16x16x32_bf16 v[112:115], v[96:99], v[36:39], v[112:115]
ds_read_b64_tr_b16 v[92:93], v243 offset:40960
v_mfma_f32_16x16x32_bf16 v[116:119], v[96:99], v[40:43], v[116:119]
ds_read_b64_tr_b16 v[94:95], v243 offset:43008
s_waitcnt lgkmcnt(4)
v_mfma_f32_16x16x32_bf16 v[52:55], v[80:83], v[44:47], v[52:55]
ds_read_b64_tr_b16 v[96:97], v232 offset:0
s_waitcnt vmcnt(4)
s_add_u32 s50, s56, 98304
v_mov_b32 v240, s98
v_mov_b32 v241, s99
s_mov_b64 exec, 1
buffer_store_dwordx2 v[240:241], v248, s[24:27], s50 offen sc1
s_mov_b64 exec, -1
v_mfma_f32_16x16x32_bf16 v[60:63], v[80:83], v[48:51], v[60:63]
ds_read_b64_tr_b16 v[98:99], v232 offset:2048
v_mfma_f32_16x16x32_bf16 v[112:115], v[84:87], v[44:47], v[112:115]
ds_read_b64_tr_b16 v[80:81], v2 offset:0
v_mfma_f32_16x16x32_bf16 v[116:119], v[84:87], v[48:51], v[116:119]
ds_read_b64_tr_b16 v[82:83], v2 offset:2048
s_waitcnt lgkmcnt(4)
v_mfma_f32_16x16x32_bf16 v[52:55], v[88:91], v[68:71], v[52:55]
ds_read_b64_tr_b16 v[84:85], v232 offset:4096
s_add_u32 m0, s48, 81920
s_add_u32 s49, s47, 369408
buffer_load_dwordx4 v234, s[20:23], s49 offen lds
v_mfma_f32_16x16x32_bf16 v[60:63], v[88:91], v[72:75], v[60:63]
ds_read_b64_tr_b16 v[86:87], v232 offset:6144
s_setprio 1
v_mfma_f32_16x16x32_bf16 v[112:115], v[92:95], v[68:71], v[112:115]
ds_read_b64_tr_b16 v[88:89], v2 offset:4096
v_mfma_f32_16x16x32_bf16 v[116:119], v[92:95], v[72:75], v[116:119]
ds_read_b64_tr_b16 v[90:91], v2 offset:6144
s_waitcnt lgkmcnt(4)
v_mfma_f32_16x16x32_bf16 v[52:55], v[96:99], v[76:79], v[52:55]
ds_read_b64_tr_b16 v[92:93], v232 offset:8192
v_mfma_f32_16x16x32_bf16 v[60:63], v[96:99], v[100:103], v[60:63]
ds_read_b64_tr_b16 v[94:95], v232 offset:10240
v_mfma_f32_16x16x32_bf16 v[112:115], v[80:83], v[76:79], v[112:115]
ds_read_b64_tr_b16 v[96:97], v2 offset:8192
v_mfma_f32_16x16x32_bf16 v[116:119], v[80:83], v[100:103], v[116:119]
ds_read_b64_tr_b16 v[98:99], v2 offset:10240
s_waitcnt lgkmcnt(4)
v_mfma_f32_16x16x32_bf16 v[64:67], v[84:87], v[200:203], 0
ds_read_b64_tr_b16 v[80:81], v232 offset:40960
s_add_u32 m0, s48, 122880
s_add_u32 s49, s47, 896
buffer_load_dwordx4 v234, s[20:23], s49 offen lds
v_mfma_f32_16x16x32_bf16 v[108:111], v[84:87], v[204:207], 0
ds_read_b64_tr_b16 v[82:83], v232 offset:43008
v_mfma_f32_16x16x32_bf16 v[144:147], v[88:91], v[200:203], 0
ds_read_b64_tr_b16 v[84:85], v2 offset:40960
v_cvt_pk_bf16_f32 v52, v52, v53
v_cvt_pk_bf16_f32 v53, v54, v55
v_cvt_pk_bf16_f32 v54, v112, v113
v_cvt_pk_bf16_f32 v55, v114, v115
s_add_u32 s50, s55, 786432
buffer_store_dwordx4 v[52:55], v248, s[24:27], s50 offen sc1
v_mfma_f32_16x16x32_bf16 v[148:151], v[88:91], v[204:207], 0
ds_read_b64_tr_b16 v[86:87], v2 offset:43008
s_setprio 0
s_waitcnt lgkmcnt(4)
v_mfma_f32_16x16x32_bf16 v[64:67], v[92:95], v[208:211], v[64:67]
ds_read_b64_tr_b16 v[88:89], v232 offset:45056
v_mfma_f32_16x16x32_bf16 v[108:111], v[92:95], v[212:215], v[108:111]
ds_read_b64_tr_b16 v[90:91], v232 offset:47104
v_mfma_f32_16x16x32_bf16 v[144:147], v[96:99], v[208:211], v[144:147]
ds_read_b64_tr_b16 v[92:93], v2 offset:45056
v_mfma_f32_16x16x32_bf16 v[148:151], v[96:99], v[212:215], v[148:151]
ds_read_b64_tr_b16 v[94:95], v2 offset:47104
s_waitcnt lgkmcnt(4)
v_mfma_f32_16x16x32_bf16 v[64:67], v[80:83], v[216:219], v[64:67]
ds_read_b64_tr_b16 v[96:97], v232 offset:49152
v_mfma_f32_16x16x32_bf16 v[108:111], v[80:83], v[220:223], v[108:111]
ds_read_b64_tr_b16 v[98:99], v232 offset:51200
v_mfma_f32_16x16x32_bf16 v[144:147], v[84:87], v[216:219], v[144:147]
ds_read_b64_tr_b16 v[80:81], v2 offset:49152
v_cvt_pk_bf16_f32 v60, v60, v61
v_cvt_pk_bf16_f32 v61, v62, v63
v_cvt_pk_bf16_f32 v62, v116, v117
v_cvt_pk_bf16_f32 v63, v118, v119
s_add_u32 s50, s55, 798720
buffer_store_dwordx4 v[60:63], v248, s[24:27], s50 offen sc1
v_mfma_f32_16x16x32_bf16 v[148:151], v[84:87], v[220:223], v[148:151]
ds_read_b64_tr_b16 v[82:83], v2 offset:51200
s_barrier
s_setprio 3
s_waitcnt vmcnt(6)
s_mov_b32 s52, 0
L_spf0_3:
v_cmp_ne_u64 vcc, s[98:99], v[244:245]
s_nop 1
s_cmp_eq_u64 vcc, 0
s_cbranch_scc1 L_spf0_3x
s_add_u32 s52, s52, 1
s_cmp_ge_u32 s52, 0x10000
s_cbranch_scc1 L_spf0_3x
s_sleep 2
s_add_u32 s50, s5, 0
v_min_u32 v255, 11, v1
v_lshlrev_b32 v255, 3, v255
buffer_load_dwordx2 v[244:245], v255, s[24:27], s50 offen sc1
s_waitcnt vmcnt(0)
s_branch L_spf0_3
L_spf0_3x:
s_waitcnt lgkmcnt(4)
v_mfma_f32_16x16x32_bf16 v[64:67], v[88:91], v[224:227], v[64:67]
ds_read_b64_tr_b16 v[84:85], v3 offset:45056
s_add_u32 m0, s48, 0
s_add_u32 s49, s47, 74624
buffer_load_dwordx4 v234, s[20:23], s49 offen lds
v_mfma_f32_16x16x32_bf16 v[108:111], v[88:91], v[236:239], v[108:111]
ds_read_b64_tr_b16 v[86:87], v3 offset:47104
s_add_u32 s50, s4, 0
buffer_load_dwordx4 v[52:55], v235, s[24:27], s50 offen offset:0 sc1
v_mfma_f32_16x16x32_bf16 v[144:147], v[92:95], v[224:227], v[144:147]
ds_read_b64_tr_b16 v[88:89], v243 offset:45056
v_mfma_f32_16x16x32_bf16 v[148:151], v[92:95], v[236:239], v[148:151]
ds_read_b64_tr_b16 v[90:91], v243 offset:47104
s_waitcnt lgkmcnt(4)
v_mfma_f32_16x16x32_bf16 v[64:67], v[96:99], v[4:7], v[64:67]
ds_read_b64_tr_b16 v[92:93], v3 offset:49152
v_mfma_f32_16x16x32_bf16 v[108:111], v[96:99], v[8:11], v[108:111]
ds_read_b64_tr_b16 v[94:95], v3 offset:51200
v_mfma_f32_16x16x32_bf16 v[144:147], v[80:83], v[4:7], v[144:147]
ds_read_b64_tr_b16 v[96:97], v243 offset:49152
s_add_u32 m0, s48, 8192
s_add_u32 s49, s47, 148352
buffer_load_dwordx4 v234, s[20:23], s49 offen lds
v_mfma_f32_16x16x32_bf16 v[148:151], v[80:83], v[8:11], v[148:151]
ds_read_b64_tr_b16 v[98:99], v243 offset:51200
s_add_u32 s50, s4, 0
buffer_load_dwordx4 v[60:63], v235, s[24:27], s50 offen offset:256 sc1
s_waitcnt lgkmcnt(4)
v_mfma_f32_16x16x32_bf16 v[64:67], v[84:87], v[12:15], v[64:67]
ds_read_b64_tr_b16 v[80:81], v3 offset:53248
v_mfma_f32_16x16x32_bf16 v[108:111], v[84:87], v[16:19], v[108:111]
ds_read_b64_tr_b16 v[82:83], v3 offset:55296
s_setprio 2
v_mfma_f32_16x16x32_bf16 v[144:147], v[88:91], v[12:15], v[144:147]
ds_read_b64_tr_b16 v[84:85], v243 offset:53248
v_mfma_f32_16x16x32_bf16 v[148:151], v[88:91], v[16:19], v[148:151]
ds_read_b64_tr_b16 v[86:87], v243 offset:55296
s_waitcnt lgkmcnt(4)
v_mfma_f32_16x16x32_bf16 v[64:67], v[92:95], v[20:23], v[64:67]
ds_read_b64_tr_b16 v[88:89], v232 offset:12288
s_add_u32 m0, s48, 90112
s_add_u32 s49, s47, 222080
buffer_load_dwordx4 v234, s[20:23], s49 offen lds
v_mfma_f32_16x16x32_bf16 v[108:111], v[92:95], v[24:27], v[108:111]
ds_read_b64_tr_b16 v[90:91], v232 offset:14336
s_add_u32 s50, s4, 4096
buffer_load_dwordx4 v[112:115], v235, s[24:27], s50 offen offset:0 sc1
v_mfma_f32_16x16x32_bf16 v[144:147], v[96:99], v[20:23], v[144:147]
ds_read_b64_tr_b16 v[92:93], v2 offset:12288
v_mfma_f32_16x16x32_bf16 v[148:151], v[96:99], v[24:27], v[148:151]
ds_read_b64_tr_b16 v[94:95], v2 offset:14336
s_waitcnt lgkmcnt(4)
v_mfma_f32_16x16x32_bf16 v[64:67], v[80:83], v[28:31], v[64:67]
ds_read_b64_tr_b16 v[96:97], v232 offset:16384
v_mfma_f32_16x16x32_bf16 v[108:111], v[80:83], v[32:35], v[108:111]
ds_read_b64_tr_b16 v[98:99], v232 offset:18432
s_setprio 1
v_mfma_f32_16x16x32_bf16 v[144:147], v[84:87], v[28:31], v[144:147]
ds_read_b64_tr_b16 v[80:81], v2 offset:16384
s_add_u32 m0, s48, 98304
s_add_u32 s49, s47, 295808
buffer_load_dwordx4 v234, s[20:23], s49 offen lds
v_mfma_f32_16x16x32_bf16 v[148:151], v[84:87], v[32:35], v[148:151]
ds_read_b64_tr_b16 v[82:83], v2 offset:18432
s_add_u32 s50, s4, 4096
buffer_load_dwordx4 v[116:119], v235, s[24:27], s50 offen offset:256 sc1
s_waitcnt lgkmcnt(4)
v_mfma_f32_16x16x32_bf16 v[64:67], v[88:91], v[36:39], v[64:67]
ds_read_b64_tr_b16 v[84:85], v232 offset:20480
v_mfma_f32_16x16x32_bf16 v[108:111], v[88:91], v[40:43], v[108:111]
ds_read_b64_tr_b16 v[86:87], v232 offset:22528
v_mfma_f32_16x16x32_bf16 v[144:147], v[92:95], v[36:39], v[144:147]
ds_read_b64_tr_b16 v[88:89], v2 offset:20480
v_mfma_f32_16x16x32_bf16 v[148:151], v[92:95], v[40:43], v[148:151]
ds_read_b64_tr_b16 v[90:91], v2 offset:22528
s_waitcnt lgkmcnt(4)
v_mfma_f32_16x16x32_bf16 v[64:67], v[96:99], v[44:47], v[64:67]
ds_read_b64_tr_b16 v[92:93], v232 offset:24576
s_add_u32 m0, s48, 106496
s_add_u32 s49, s47, 369536
buffer_load_dwordx4 v234, s[20:23], s49 offen lds
s_add_u32 s50, s4, 8192
buffer_load_dwordx4 v[152:155], v235, s[24:27], s50 offen offset:0 sc1
v_mfma_f32_16x16x32_bf16 v[108:111], v[96:99], v[48:51], v[108:111]
ds_read_b64_tr_b16 v[94:95], v232 offset:26624
s_waitcnt vmcnt(10)
s_add_u32 s50, s56, 131072
v_mov_b32 v244, s98
v_mov_b32 v245, s99
s_mov_b64 exec, 1
buffer_store_dwordx2 v[244:245], v248, s[24:27], s50 offen sc1
s_mov_b64 exec, -1
v_mfma_f32_16x16x32_bf16 v[144:147], v[80:83], v[44:47], v[144:147]
ds_read_b64_tr_b16 v[96:97], v2 offset:24576
v_mfma_f32_16x16x32_bf16 v[148:151], v[80:83], v[48:51], v[148:151]
ds_read_b64_tr_b16 v[98:99], v2 offset:26624
s_setprio 0
s_waitcnt lgkmcnt(4)
v_mfma_f32_16x16x32_bf16 v[64:67], v[84:87], v[68:71], v[64:67]
ds_read_b64_tr_b16 v[80:81], v232 offset:28672
v_mfma_f32_16x16x32_bf16 v[108:111], v[84:87], v[72:75], v[108:111]
ds_read_b64_tr_b16 v[82:83], v232 offset:30720
v_mfma_f32_16x16x32_bf16 v[144:147], v[88:91], v[68:71], v[144:147]
ds_read_b64_tr_b16 v[84:85], v2 offset:28672
s_add_u32 s50, s4, 8192
buffer_load_dwordx4 v[156:159], v235, s[24:27], s50 offen offset:256 sc1
v_mfma_f32_16x16x32_bf16 v[148:151], v[88:91], v[72:75], v[148:151]
ds_read_b64_tr_b16 v[86:87], v2 offset:30720
s_waitcnt lgkmcnt(4)
v_mfma_f32_16x16x32_bf16 v[64:67], v[92:95], v[76:79], v[64:67]
ds_read_b64_tr_b16 v[88:89], v232 offset:53248
v_mfma_f32_16x16x32_bf16 v[108:111], v[92:95], v[100:103], v[108:111]
ds_read_b64_tr_b16 v[90:91], v232 offset:55296
v_mfma_f32_16x16x32_bf16 v[144:147], v[96:99], v[76:79], v[144:147]
ds_read_b64_tr_b16 v[92:93], v2 offset:53248
v_mfma_f32_16x16x32_bf16 v[148:151], v[96:99], v[100:103], v[148:151]
ds_read_b64_tr_b16 v[94:95], v2 offset:55296
s_barrier
s_setprio 3
s_waitcnt lgkmcnt(4)
v_mfma_f32_16x16x32_bf16 v[160:163], v[80:83], v[200:203], 0
ds_read_b64_tr_b16 v[96:97], v232 offset:57344
s_add_u32 m0, s48, 16384
s_add_u32 s49, s47, 1024
buffer_load_dwordx4 v234, s[20:23], s49 offen lds
v_mfma_f32_16x16x32_bf16 v[164:167], v[80:83], v[204:207], 0
ds_read_b64_tr_b16 v[98:99], v232 offset:59392
s_add_u32 s50, s4, 12288
buffer_load_dwordx4 v[176:179], v235, s[24:27], s50 offen offset:0 sc1
v_mfma_f32_16x16x32_bf16 v[168:171], v[84:87], v[200:203], 0
ds_read_b64_tr_b16 v[80:81], v2 offset:57344
v_mfma_f32_16x16x32_bf16 v[172:175], v[84:87], v[204:207], 0
ds_read_b64_tr_b16 v[82:83], v2 offset:59392
v_cvt_pk_bf16_f32 v64, v64, v65
v_cvt_pk_bf16_f32 v65, v66, v67
v_cvt_pk_bf16_f32 v66, v144, v145
v_cvt_pk_bf16_f32 v67, v146, v147
s_add_u32 s50, s55, 983040
buffer_store_dwordx4 v[64:67], v248, s[24:27], s50 offen sc1
s_waitcnt lgkmcnt(4)
v_mfma_f32_16x16x32_bf16 v[160:163], v[88:91], v[208:211], v[160:163]
ds_read_b64_tr_b16 v[84:85], v232 offset:61440
v_mfma_f32_16x16x32_bf16 v[164:167], v[88:91], v[212:215], v[164:167]
ds_read_b64_tr_b16 v[86:87], v232 offset:63488
v_mfma_f32_16x16x32_bf16 v[168:171], v[92:95], v[208:211], v[168:171]
ds_read_b64_tr_b16 v[88:89], v2 offset:61440
s_add_u32 s50, s4, 12288
buffer_load_dwordx4 v[64:67], v235, s[24:27], s50 offen offset:256 sc1
v_mfma_f32_16x16x32_bf16 v[172:175], v[92:95], v[212:215], v[172:175]
ds_read_b64_tr_b16 v[90:91], v2 offset:63488
s_waitcnt lgkmcnt(4)
v_mfma_f32_16x16x32_bf16 v[160:163], v[96:99], v[216:219], v[160:163]
ds_read_b64_tr_b16 v[92:93], v3 offset:0
s_add_u32 m0, s48, 24576
s_add_u32 s49, s47, 74752
buffer_load_dwordx4 v234, s[20:23], s49 offen lds
v_mfma_f32_16x16x32_bf16 v[164:167], v[96:99], v[220:223], v[164:167]
ds_read_b64_tr_b16 v[94:95], v3 offset:2048
s_setprio 2
v_mfma_f32_16x16x32_bf16 v[168:171], v[80:83], v[216:219], v[168:171]
ds_read_b64_tr_b16 v[96:97], v243 offset:0
v_mfma_f32_16x16x32_bf16 v[172:175], v[80:83], v[220:223], v[172:175]
ds_read_b64_tr_b16 v[98:99], v243 offset:2048
v_cvt_pk_bf16_f32 v108, v108, v109
v_cvt_pk_bf16_f32 v109, v110, v111
v_cvt_pk_bf16_f32 v110, v148, v149
v_cvt_pk_bf16_f32 v111, v150, v151
s_add_u32 s50, s55, 995328
buffer_store_dwordx4 v[108:111], v248, s[24:27], s50 offen sc1
s_waitcnt lgkmcnt(4)
v_mfma_f32_16x16x32_bf16 v[160:163], v[84:87], v[224:227], v[160:163]
ds_read_b64_tr_b16 v[80:81], v232 offset:32768
s_add_u32 s50, s4, 16384
buffer_load_dwordx4 v[108:111], v235, s[24:27], s50 offen offset:0 sc1
v_mfma_f32_16x16x32_bf16 v[164:167], v[84:87], v[236:239], v[164:167]
ds_read_b64_tr_b16 v[82:83], v232 offset:34816
v_mfma_f32_16x16x32_bf16 v[168:171], v[88:91], v[224:227], v[168:171]
ds_read_b64_tr_b16 v[84:85], v2 offset:32768
v_mfma_f32_16x16x32_bf16 v[172:175], v[88:91], v[236:239], v[172:175]
ds_read_b64_tr_b16 v[86:87], v2 offset:34816
s_waitcnt lgkmcnt(4)
v_mfma_f32_16x16x32_bf16 v[160:163], v[92:95], v[4:7], v[160:163]
ds_read_b64_tr_b16 v[88:89], v232 offset:36864
s_add_u32 m0, s48, 49152
s_add_u32 s49, s47, 148480
buffer_load_dwordx4 v234, s[20:23], s49 offen lds
v_mfma_f32_16x16x32_bf16 v[164:167], v[92:95], v[8:11], v[164:167]
ds_read_b64_tr_b16 v[90:91], v232 offset:38912
s_setprio 1
v_mfma_f32_16x16x32_bf16 v[168:171], v[96:99], v[4:7], v[168:171]
ds_read_b64_tr_b16 v[92:93], v2 offset:36864
s_add_u32 s50, s4, 16384
buffer_load_dwordx4 v[144:147], v235, s[24:27], s50 offen offset:256 sc1
v_mfma_f32_16x16x32_bf16 v[172:175], v[96:99], v[8:11], v[172:175]
ds_read_b64_tr_b16 v[94:95], v2 offset:38912
s_waitcnt lgkmcnt(4)
v_mfma_f32_16x16x32_bf16 v[160:163], v[80:83], v[12:15], v[160:163]
ds_read_b64_tr_b16 v[96:97], v3 offset:4096
s_waitcnt vmcnt(19)
v_mfma_f32_16x16x32_bf16 v[128:131], v[56:59], v[52:55], 0
v_mfma_f32_16x16x32_bf16 v[164:167], v[80:83], v[16:19], v[164:167]
ds_read_b64_tr_b16 v[98:99], v3 offset:6144
v_mfma_f32_16x16x32_bf16 v[168:171], v[84:87], v[12:15], v[168:171]
ds_read_b64_tr_b16 v[80:81], v243 offset:4096
s_waitcnt vmcnt(17)
v_mfma_f32_16x16x32_bf16 v[128:131], v[104:107], v[60:63], v[128:131]
v_mfma_f32_16x16x32_bf16 v[172:175], v[84:87], v[16:19], v[172:175]
ds_read_b64_tr_b16 v[82:83], v243 offset:6144
s_waitcnt lgkmcnt(4)
v_mfma_f32_16x16x32_bf16 v[160:163], v[88:91], v[20:23], v[160:163]
ds_read_b64_tr_b16 v[84:85], v3 offset:8192
s_add_u32 m0, s48, 114688
s_add_u32 s49, s47, 222208
buffer_load_dwordx4 v234, s[20:23], s49 offen lds
v_mfma_f32_16x16x32_bf16 v[164:167], v[88:91], v[24:27], v[164:167]
ds_read_b64_tr_b16 v[86:87], v3 offset:10240
s_add_u32 s50, s4, 20480
buffer_load_dwordx4 v[52:55], v235, s[24:27], s50 offen offset:0 sc1
v_mfma_f32_16x16x32_bf16 v[168:171], v[92:95], v[20:23], v[168:171]
ds_read_b64_tr_b16 v[88:89], v243 offset:8192
s_waitcnt vmcnt(17)
v_mfma_f32_16x16x32_bf16 v[128:131], v[56:59], v[112:115], v[128:131]
v_mfma_f32_16x16x32_bf16 v[172:175], v[92:95], v[24:27], v[172:175]
ds_read_b64_tr_b16 v[90:91], v243 offset:10240
s_setprio 0
s_waitcnt lgkmcnt(4)
v_mfma_f32_16x16x32_bf16 v[160:163], v[96:99], v[28:31], v[160:163]
ds_read_b64_tr_b16 v[92:93], v3 offset:12288
s_waitcnt vmcnt(15)
v_mfma_f32_16x16x32_bf16 v[128:131], v[104:107], v[116:119], v[128:131]
v_mfma_f32_16x16x32_bf16 v[164:167], v[96:99], v[32:35], v[164:167]
ds_read_b64_tr_b16 v[94:95], v3 offset:14336
v_mfma_f32_16x16x32_bf16 v[168:171], v[80:83], v[28:31], v[168:171]
ds_read_b64_tr_b16 v[96:97], v243 offset:12288
s_add_u32 s50, s4, 20480
buffer_load_dwordx4 v[60:63], v235, s[24:27], s50 offen offset:256 sc1
v_mfma_f32_16x16x32_bf16 v[172:175], v[80:83], v[32:35], v[172:175]
ds_read_b64_tr_b16 v[98:99], v243 offset:14336
s_waitcnt lgkmcnt(4)
v_mfma_f32_16x16x32_bf16 v[160:163], v[84:87], v[36:39], v[160:163]
ds_read_b64_tr_b16 v[80:81], v3 offset:16384
s_waitcnt vmcnt(14)
v_mfma_f32_16x16x32_bf16 v[128:131], v[56:59], v[152:155], v[128:131]
v_mfma_f32_16x16x32_bf16 v[164:167], v[84:87], v[40:43], v[164:167]
ds_read_b64_tr_b16 v[82:83], v3 offset:18432
v_mfma_f32_16x16x32_bf16 v[168:171], v[88:91], v[36:39], v[168:171]
ds_read_b64_tr_b16 v[84:85], v243 offset:16384
s_waitcnt vmcnt(12)
v_mfma_f32_16x16x32_bf16 v[128:131], v[104:107], v[156:159], v[128:131]
v_mfma_f32_16x16x32_bf16 v[172:175], v[88:91], v[40:43], v[172:175]
ds_read_b64_tr_b16 v[86:87], v243 offset:18432
s_barrier
s_setprio 1
s_waitcnt lgkmcnt(4)
v_mfma_f32_16x16x32_bf16 v[160:163], v[92:95], v[44:47], v[160:163]
ds_read_b64_tr_b16 v[88:89], v3 offset:20480
s_add_u32 m0, s48, 32768
s_add_u32 s49, s47, 295936
buffer_load_dwordx4 v234, s[20:23], s49 offen lds
v_mfma_f32_16x16x32_bf16 v[164:167], v[92:95], v[48:51], v[164:167]
ds_read_b64_tr_b16 v[90:91], v3 offset:22528
s_waitcnt vmcnt(7)
s_add_u32 s50, s56, 163840
v_mov_b32 v244, s98
v_mov_b32 v245, s99
s_mov_b64 exec, 1
buffer_store_dwordx2 v[244:245], v248, s[24:27], s50 offen sc1
s_mov_b64 exec, -1
v_mfma_f32_16x16x32_bf16 v[168:171], v[96:99], v[44:47], v[168:171]
ds_read_b64_tr_b16 v[92:93], v243 offset:20480
s_add_u32 s50, s7, 0
buffer_load_dwordx4 v[156:159], v248, s[24:27], s50 offen sc1
v_mfma_f32_16x16x32_bf16 v[172:175], v[96:99], v[48:51], v[172:175]
ds_read_b64_tr_b16 v[94:95], v243 offset:22528
s_waitcnt lgkmcnt(4)
v_mfma_f32_16x16x32_bf16 v[160:163], v[80:83], v[68:71], v[160:163]
ds_read_b64_tr_b16 v[96:97], v3 offset:57344
s_add_u32 m0, s48, 53248
s_add_u32 s49, s47, 369664
buffer_load_dwordx4 v234, s[20:23], s49 offen lds
v_mfma_f32_16x16x32_bf16 v[164:167], v[80:83], v[72:75], v[164:167]
ds_read_b64_tr_b16 v[98:99], v3 offset:59392
v_mfma_f32_16x16x32_bf16 v[168:171], v[84:87], v[68:71], v[168:171]
ds_read_b64_tr_b16 v[80:81], v243 offset:57344
v_mfma_f32_16x16x32_bf16 v[172:175], v[84:87], v[72:75], v[172:175]
ds_read_b64_tr_b16 v[82:83], v243 offset:59392
s_waitcnt lgkmcnt(4)
v_mfma_f32_16x16x32_bf16 v[160:163], v[88:91], v[76:79], v[160:163]
ds_read_b64_tr_b16 v[84:85], v3 offset:61440
s_add_u32 m0, s48, 61440
s_add_u32 s49, s7, 3072
buffer_load_dwordx4 v248, s[24:27], s49 offen sc1 lds
v_mfma_f32_16x16x32_bf16 v[164:167], v[88:91], v[100:103], v[164:167]
ds_read_b64_tr_b16 v[86:87], v3 offset:63488
s_add_u32 s50, s7, 9216
buffer_load_dwordx4 v[180:183], v248, s[24:27], s50 offen sc1
v_mfma_f32_16x16x32_bf16 v[168:171], v[92:95], v[76:79], v[168:171]
ds_read_b64_tr_b16 v[88:89], v243 offset:61440
v_mfma_f32_16x16x32_bf16 v[172:175], v[92:95], v[100:103], v[172:175]
ds_read_b64_tr_b16 v[90:91], v243 offset:63488
s_waitcnt lgkmcnt(4)
v_mfma_f32_16x16x32_bf16 v[112:115], v[96:99], v[200:203], 0
ds_read_b64_tr_b16 v[92:93], v232 offset:0
s_add_u32 m0, s48, 65536
s_add_u32 s49, s7, 12288
buffer_load_dwordx4 v248, s[24:27], s49 offen sc1 lds
v_mfma_f32_16x16x32_bf16 v[116:119], v[96:99], v[204:207], 0
ds_read_b64_tr_b16 v[94:95], v232 offset:2048
v_mfma_f32_16x16x32_bf16 v[148:151], v[80:83], v[200:203], 0
ds_read_b64_tr_b16 v[96:97], v2 offset:0
s_add_u32 s50, s7, 18432
buffer_load_dwordx4 v[184:187], v248, s[24:27], s50 offen sc1
v_mfma_f32_16x16x32_bf16 v[152:155], v[80:83], v[204:207], 0
ds_read_b64_tr_b16 v[98:99], v2 offset:2048
v_cvt_pk_bf16_f32 v160, v160, v161
v_cvt_pk_bf16_f32 v161, v162, v163
v_cvt_pk_bf16_f32 v162, v168, v169
v_cvt_pk_bf16_f32 v163, v170, v171
s_add_u32 s50, s55, 1179648
buffer_store_dwordx4 v[160:163], v248, s[24:27], s50 offen sc1
s_waitcnt lgkmcnt(4)
v_mfma_f32_16x16x32_bf16 v[112:115], v[84:87], v[208:211], v[112:115]
ds_read_b64_tr_b16 v[80:81], v232 offset:4096
s_add_u32 m0, s48, 69632
s_add_u32 s49, s7, 21504
buffer_load_dwordx4 v248, s[24:27], s49 offen sc1 lds
v_mfma_f32_16x16x32_bf16 v[116:119], v[84:87], v[212:215], v[116:119]
ds_read_b64_tr_b16 v[82:83], v232 offset:6144
v_mfma_f32_16x16x32_bf16 v[148:151], v[88:91], v[208:211], v[148:151]
ds_read_b64_tr_b16 v[84:85], v2 offset:4096
v_mfma_f32_16x16x32_bf16 v[132:135], v[56:59], v[176:179], 0
v_mfma_f32_16x16x32_bf16 v[152:155], v[88:91], v[212:215], v[152:155]
ds_read_b64_tr_b16 v[86:87], v2 offset:6144
s_waitcnt lgkmcnt(4)
v_mfma_f32_16x16x32_bf16 v[112:115], v[92:95], v[216:219], v[112:115]
ds_read_b64_tr_b16 v[88:89], v232 offset:8192
s_add_u32 m0, s48, 73728
s_add_u32 s49, s7, 30720
buffer_load_dwordx4 v248, s[24:27], s49 offen sc1 lds
v_mfma_f32_16x16x32_bf16 v[116:119], v[92:95], v[220:223], v[116:119]
ds_read_b64_tr_b16 v[90:91], v232 offset:10240
v_mfma_f32_16x16x32_bf16 v[132:135], v[104:107], v[64:67], v[132:135]
v_mfma_f32_16x16x32_bf16 v[148:151], v[96:99], v[216:219], v[148:151]
ds_read_b64_tr_b16 v[92:93], v2 offset:8192
s_add_u32 s50, s7, 27648
buffer_load_dwordx4 v[64:67], v248, s[24:27], s50 offen sc1
v_mfma_f32_16x16x32_bf16 v[152:155], v[96:99], v[220:223], v[152:155]
ds_read_b64_tr_b16 v[94:95], v2 offset:10240
v_cvt_pk_bf16_f32 v164, v164, v165
v_cvt_pk_bf16_f32 v165, v166, v167
v_cvt_pk_bf16_f32 v166, v172, v173
v_cvt_pk_bf16_f32 v167, v174, v175
s_add_u32 s50, s55, 1191936
buffer_store_dwordx4 v[164:167], v248, s[24:27], s50 offen sc1
s_waitcnt lgkmcnt(4)
v_mfma_f32_16x16x32_bf16 v[112:115], v[80:83], v[224:227], v[112:115]
ds_read_b64_tr_b16 v[96:97], v232 offset:40960
s_waitcnt vmcnt(18)
v_mfma_f32_16x16x32_bf16 v[132:135], v[56:59], v[108:111], v[132:135]
v_mfma_f32_16x16x32_bf16 v[116:119], v[80:83], v[236:239], v[116:119]
ds_read_b64_tr_b16 v[98:99], v232 offset:43008
v_mfma_f32_16x16x32_bf16 v[148:151], v[84:87], v[224:227], v[148:151]
ds_read_b64_tr_b16 v[80:81], v2 offset:40960
s_waitcnt vmcnt(16)
v_mfma_f32_16x16x32_bf16 v[132:135], v[104:107], v[144:147], v[132:135]
v_mfma_f32_16x16x32_bf16 v[152:155], v[84:87], v[236:239], v[152:155]
ds_read_b64_tr_b16 v[82:83], v2 offset:43008
s_waitcnt lgkmcnt(4)
v_mfma_f32_16x16x32_bf16 v[112:115], v[88:91], v[4:7], v[112:115]
ds_read_b64_tr_b16 v[84:85], v3 offset:24576
s_add_u32 s50, s7, 36864
buffer_load_dwordx4 v[108:111], v248, s[24:27], s50 offen sc1
v_mfma_f32_16x16x32_bf16 v[116:119], v[88:91], v[8:11], v[116:119]
ds_read_b64_tr_b16 v[86:87], v3 offset:26624
v_mfma_f32_16x16x32_bf16 v[148:151], v[92:95], v[4:7], v[148:151]
ds_read_b64_tr_b16 v[88:89], v243 offset:24576
s_waitcnt vmcnt(15)
v_mfma_f32_16x16x32_bf16 v[132:135], v[56:59], v[52:55], v[132:135]
v_mfma_f32_16x16x32_bf16 v[152:155], v[92:95], v[8:11], v[152:155]
ds_read_b64_tr_b16 v[90:91], v243 offset:26624
s_waitcnt lgkmcnt(4)
v_mfma_f32_16x16x32_bf16 v[112:115], v[96:99], v[12:15], v[112:115]
ds_read_b64_tr_b16 v[92:93], v3 offset:28672
s_waitcnt vmcnt(14)
v_mfma_f32_16x16x32_bf16 v[132:135], v[104:107], v[60:63], v[132:135]
v_mfma_f32_16x16x32_bf16 v[116:119], v[96:99], v[16:19], v[116:119]
ds_read_b64_tr_b16 v[94:95], v3 offset:30720
v_mfma_f32_16x16x32_bf16 v[148:151], v[80:83], v[12:15], v[148:151]
ds_read_b64_tr_b16 v[96:97], v243 offset:28672
v_mfma_f32_16x16x32_bf16 v[152:155], v[80:83], v[16:19], v[152:155]
ds_read_b64_tr_b16 v[98:99], v243 offset:30720
s_barrier
s_waitcnt lgkmcnt(4)
v_mfma_f32_16x16x32_bf16 v[112:115], v[84:87], v[20:23], v[112:115]
ds_read_b64_tr_b16 v[80:81], v3 offset:32768
s_add_u32 m0, s48, 0
s_add_u32 s49, s7, 39936
buffer_load_dwordx4 v248, s[24:27], s49 offen sc1 lds
v_mfma_f32_16x16x32_bf16 v[116:119], v[84:87], v[24:27], v[116:119]
ds_read_b64_tr_b16 v[82:83], v3 offset:34816
s_add_u32 s50, s7, 46080
buffer_load_dwordx4 v[164:167], v248, s[24:27], s50 offen sc1
v_mfma_f32_16x16x32_bf16 v[148:151], v[88:91], v[20:23], v[148:151]
ds_read_b64_tr_b16 v[84:85], v243 offset:32768
s_add_u32 s50, s5, 98304
v_min_u32 v255, 11, v1
v_lshlrev_b32 v255, 3, v255
buffer_load_dwordx2 v[244:245], v255, s[24:27], s50 offen sc1
v_mfma_f32_16x16x32_bf16 v[152:155], v[88:91], v[24:27], v[152:155]
ds_read_b64_tr_b16 v[86:87], v243 offset:34816
s_waitcnt lgkmcnt(4)
v_mfma_f32_16x16x32_bf16 v[112:115], v[92:95], v[28:31], v[112:115]
ds_read_b64_tr_b16 v[88:89], v3 offset:36864
s_add_u32 m0, s48, 4096
s_add_u32 s49, s7, 49152
buffer_load_dwordx4 v248, s[24:27], s49 offen sc1 lds
v_mfma_f32_16x16x32_bf16 v[116:119], v[92:95], v[32:35], v[116:119]
ds_read_b64_tr_b16 v[90:91], v3 offset:38912
v_mfma_f32_16x16x32_bf16 v[148:151], v[96:99], v[28:31], v[148:151]
ds_read_b64_tr_b16 v[92:93], v243 offset:36864
s_add_u32 s50, s7, 55296
buffer_load_dwordx4 v[168:171], v248, s[24:27], s50 offen sc1
v_mfma_f32_16x16x32_bf16 v[152:155], v[96:99], v[32:35], v[152:155]
ds_read_b64_tr_b16 v[94:95], v243 offset:38912
s_waitcnt lgkmcnt(4)
v_mfma_f32_16x16x32_bf16 v[112:115], v[80:83], v[36:39], v[112:115]
ds_read_b64_tr_b16 v[96:97], v3 offset:40960
s_add_u32 m0, s48, 8192
s_add_u32 s49, s7, 58368
buffer_load_dwordx4 v248, s[24:27], s49 offen sc1 lds
v_mfma_f32_16x16x32_bf16 v[116:119], v[80:83], v[40:43], v[116:119]
ds_read_b64_tr_b16 v[98:99], v3 offset:43008
v_mfma_f32_16x16x32_bf16 v[148:151], v[84:87], v[36:39], v[148:151]
ds_read_b64_tr_b16 v[80:81], v243 offset:40960
v_mfma_f32_16x16x32_bf16 v[152:155], v[84:87], v[40:43], v[152:155]
ds_read_b64_tr_b16 v[82:83], v243 offset:43008
s_waitcnt lgkmcnt(4)
v_mfma_f32_16x16x32_bf16 v[112:115], v[88:91], v[44:47], v[112:115]
ds_read_b64_tr_b16 v[84:85], v232 offset:12288
s_add_u32 m0, s48, 40960
s_add_u32 s49, s7, 67584
buffer_load_dwordx4 v248, s[24:27], s49 offen sc1 lds
v_mfma_f32_16x16x32_bf16 v[116:119], v[88:91], v[48:51], v[116:119]
ds_read_b64_tr_b16 v[86:87], v232 offset:14336
s_waitcnt vmcnt(8)
s_add_u32 s50, s56, 196608
v_mov_b32 v240, s98
v_mov_b32 v241, s99
s_mov_b64 exec, 1
buffer_store_dwordx2 v[240:241], v248, s[24:27], s50 offen sc1
s_mov_b64 exec, -1
v_mfma_f32_16x16x32_bf16 v[148:151], v[92:95], v[44:47], v[148:151]
ds_read_b64_tr_b16 v[88:89], v2 offset:12288
s_add_u32 s50, s7, 64512
buffer_load_dwordx4 v[172:175], v248, s[24:27], s50 offen sc1
v_mfma_f32_16x16x32_bf16 v[152:155], v[92:95], v[48:51], v[152:155]
ds_read_b64_tr_b16 v[90:91], v2 offset:14336
s_waitcnt lgkmcnt(4)
v_mfma_f32_16x16x32_bf16 v[112:115], v[96:99], v[68:71], v[112:115]
ds_read_b64_tr_b16 v[92:93], v232 offset:16384
s_add_u32 m0, s48, 77824
s_add_u32 s49, s7, 76800
buffer_load_dwordx4 v248, s[24:27], s49 offen sc1 lds
v_mfma_f32_16x16x32_bf16 v[116:119], v[96:99], v[72:75], v[116:119]
ds_read_b64_tr_b16 v[94:95], v232 offset:18432
v_mfma_f32_16x16x32_bf16 v[148:151], v[80:83], v[68:71], v[148:151]
ds_read_b64_tr_b16 v[96:97], v2 offset:16384
v_mfma_f32_16x16x32_bf16 v[152:155], v[80:83], v[72:75], v[152:155]
ds_read_b64_tr_b16 v[98:99], v2 offset:18432
s_waitcnt lgkmcnt(4)
v_mfma_f32_16x16x32_bf16 v[112:115], v[84:87], v[76:79], v[112:115]
ds_read_b64_tr_b16 v[80:81], v232 offset:20480
s_add_u32 m0, s48, 81920
s_add_u32 s49, s7, 86016
buffer_load_dwordx4 v248, s[24:27], s49 offen sc1 lds
v_mfma_f32_16x16x32_bf16 v[116:119], v[84:87], v[100:103], v[116:119]
ds_read_b64_tr_b16 v[82:83], v232 offset:22528
s_add_u32 s50, s7, 73728
buffer_load_dwordx4 v[176:179], v248, s[24:27], s50 offen sc1
v_mfma_f32_16x16x32_bf16 v[148:151], v[88:91], v[76:79], v[148:151]
ds_read_b64_tr_b16 v[84:85], v2 offset:20480
v_mfma_f32_16x16x32_bf16 v[152:155], v[88:91], v[100:103], v[152:155]
ds_read_b64_tr_b16 v[86:87], v2 offset:22528
s_waitcnt lgkmcnt(4)
v_mfma_f32_16x16x32_bf16 v[52:55], v[92:95], v[200:203], 0
ds_read_b64_tr_b16 v[88:89], v232 offset:24576
s_add_u32 m0, s48, 86016
s_add_u32 s49, s7, 95232
buffer_load_dwordx4 v248, s[24:27], s49 offen sc1 lds
v_mfma_f32_16x16x32_bf16 v[60:63], v[92:95], v[204:207], 0
ds_read_b64_tr_b16 v[90:91], v232 offset:26624
v_mfma_f32_16x16x32_bf16 v[144:147], v[96:99], v[200:203], 0
ds_read_b64_tr_b16 v[92:93], v2 offset:24576
v_cvt_pk_bf16_f32 v112, v112, v113
v_cvt_pk_bf16_f32 v113, v114, v115
v_cvt_pk_bf16_f32 v114, v148, v149
v_cvt_pk_bf16_f32 v115, v150, v151
s_add_u32 s50, s55, 1376256
buffer_store_dwordx4 v[112:115], v248, s[24:27], s50 offen sc1
v_mfma_f32_16x16x32_bf16 v[160:163], v[96:99], v[204:207], 0
ds_read_b64_tr_b16 v[94:95], v2 offset:26624
s_waitcnt lgkmcnt(4)
v_mfma_f32_16x16x32_bf16 v[52:55], v[80:83], v[208:211], v[52:55]
ds_read_b64_tr_b16 v[96:97], v232 offset:45056
s_add_u32 s50, s7, 82944
buffer_load_dwordx4 v[112:115], v248, s[24:27], s50 offen sc1
v_mfma_f32_16x16x32_bf16 v[60:63], v[80:83], v[212:215], v[60:63]
ds_read_b64_tr_b16 v[98:99], v232 offset:47104
v_mfma_f32_16x16x32_bf16 v[144:147], v[84:87], v[208:211], v[144:147]
ds_read_b64_tr_b16 v[80:81], v2 offset:45056
v_mfma_f32_16x16x32_bf16 v[160:163], v[84:87], v[212:215], v[160:163]
ds_read_b64_tr_b16 v[82:83], v2 offset:47104
s_waitcnt lgkmcnt(4)
v_mfma_f32_16x16x32_bf16 v[52:55], v[88:91], v[216:219], v[52:55]
ds_read_b64_tr_b16 v[84:85], v232 offset:49152
v_mfma_f32_16x16x32_bf16 v[60:63], v[88:91], v[220:223], v[60:63]
ds_read_b64_tr_b16 v[86:87], v232 offset:51200
v_mfma_f32_16x16x32_bf16 v[144:147], v[92:95], v[216:219], v[144:147]
ds_read_b64_tr_b16 v[88:89], v2 offset:49152
v_cvt_pk_bf16_f32 v116, v116, v117
v_cvt_pk_bf16_f32 v117, v118, v119
v_cvt_pk_bf16_f32 v118, v152, v153
v_cvt_pk_bf16_f32 v119, v154, v155
s_add_u32 s50, s55, 1388544
buffer_store_dwordx4 v[116:119], v248, s[24:27], s50 offen sc1
v_mfma_f32_16x16x32_bf16 v[160:163], v[92:95], v[220:223], v[160:163]
ds_read_b64_tr_b16 v[90:91], v2 offset:51200
s_barrier
s_waitcnt vmcnt(13)
s_mov_b32 s52, 0
L_spf0_4:
v_cmp_ne_u64 vcc, s[98:99], v[244:245]
s_nop 1
s_cmp_eq_u64 vcc, 0
s_cbranch_scc1 L_spf0_4x
s_add_u32 s52, s52, 1
s_cmp_ge_u32 s52, 0x10000
s_cbranch_scc1 L_spf0_4x
s_sleep 2
s_add_u32 s50, s5, 98304
v_min_u32 v255, 11, v1
v_lshlrev_b32 v255, 3, v255
buffer_load_dwordx2 v[244:245], v255, s[24:27], s50 offen sc1
s_waitcnt vmcnt(0)
s_branch L_spf0_4
L_spf0_4x:
s_waitcnt lgkmcnt(4)
v_mfma_f32_16x16x32_bf16 v[52:55], v[96:99], v[224:227], v[52:55]
ds_read_b64_tr_b16 v[92:93], v3 offset:45056
s_add_u32 m0, s48, 12288
s_add_u32 s49, s7, 104448
buffer_load_dwordx4 v248, s[24:27], s49 offen sc1 lds
v_mfma_f32_16x16x32_bf16 v[60:63], v[96:99], v[236:239], v[60:63]
ds_read_b64_tr_b16 v[94:95], v3 offset:47104
v_mfma_f32_16x16x32_bf16 v[144:147], v[80:83], v[224:227], v[144:147]
ds_read_b64_tr_b16 v[96:97], v243 offset:45056
v_mfma_f32_16x16x32_bf16 v[160:163], v[80:83], v[236:239], v[160:163]
ds_read_b64_tr_b16 v[98:99], v243 offset:47104
s_waitcnt lgkmcnt(4)
v_mfma_f32_16x16x32_bf16 v[52:55], v[84:87], v[4:7], v[52:55]
ds_read_b64_tr_b16 v[80:81], v3 offset:49152
s_add_u32 m0, s48, 16384
s_add_u32 s49, s7, 113664
buffer_load_dwordx4 v248, s[24:27], s49 offen sc1 lds
v_mfma_f32_16x16x32_bf16 v[60:63], v[84:87], v[8:11], v[60:63]
ds_read_b64_tr_b16 v[82:83], v3 offset:51200
s_add_u32 s50, s4, 589824
buffer_load_dwordx4 v[116:119], v235, s[24:27], s50 offen offset:0 sc1
v_mfma_f32_16x16x32_bf16 v[144:147], v[88:91], v[4:7], v[144:147]
ds_read_b64_tr_b16 v[84:85], v243 offset:49152
s_add_u32 s50, s4, 589824
buffer_load_dwordx4 v[148:151], v235, s[24:27], s50 offen offset:256 sc1
v_mfma_f32_16x16x32_bf16 v[160:163], v[88:91], v[8:11], v[160:163]
ds_read_b64_tr_b16 v[86:87], v243 offset:51200
s_waitcnt lgkmcnt(4)
v_mfma_f32_16x16x32_bf16 v[52:55], v[92:95], v[12:15], v[52:55]
ds_read_b64_tr_b16 v[88:89], v232 offset:28672
s_add_u32 m0, s48, 20480
s_add_u32 s49, s7, 122880
buffer_load_dwordx4 v248, s[24:27], s49 offen sc1 lds
v_mfma_f32_16x16x32_bf16 v[60:63], v[92:95], v[16:19], v[60:63]
ds_read_b64_tr_b16 v[90:91], v232 offset:30720
v_mfma_f32_16x16x32_bf16 v[144:147], v[96:99], v[12:15], v[144:147]
ds_read_b64_tr_b16 v[92:93], v2 offset:28672
s_add_u32 s50, s4, 593920
buffer_load_dwordx4 v[4:7], v235, s[24:27], s50 offen offset:0 sc1
v_mfma_f32_16x16x32_bf16 v[160:163], v[96:99], v[16:19], v[160:163]
ds_read_b64_tr_b16 v[94:95], v2 offset:30720
s_waitcnt lgkmcnt(4)
v_mfma_f32_16x16x32_bf16 v[52:55], v[80:83], v[20:23], v[52:55]
ds_read_b64_tr_b16 v[96:97], v232 offset:32768
s_add_u32 m0, s48, 24576
s_add_u32 s49, s7, 132096
buffer_load_dwordx4 v248, s[24:27], s49 offen sc1 lds
v_mfma_f32_16x16x32_bf16 v[60:63], v[80:83], v[24:27], v[60:63]
ds_read_b64_tr_b16 v[98:99], v232 offset:34816
s_add_u32 s50, s4, 593920
buffer_load_dwordx4 v[8:11], v235, s[24:27], s50 offen offset:256 sc1
v_mfma_f32_16x16x32_bf16 v[144:147], v[84:87], v[20:23], v[144:147]
ds_read_b64_tr_b16 v[80:81], v2 offset:32768
s_add_u32 s50, s4, 598016
buffer_load_dwordx4 v[12:15], v235, s[24:27], s50 offen offset:0 sc1
v_mfma_f32_16x16x32_bf16 v[160:163], v[84:87], v[24:27], v[160:163]
ds_read_b64_tr_b16 v[82:83], v2 offset:34816
s_waitcnt lgkmcnt(4)
v_mfma_f32_16x16x32_bf16 v[52:55], v[88:91], v[28:31], v[52:55]
ds_read_b64_tr_b16 v[84:85], v232 offset:36864
s_add_u32 m0, s48, 90112
s_add_u32 s49, s7, 141312
buffer_load_dwordx4 v248, s[24:27], s49 offen sc1 lds
v_mfma_f32_16x16x32_bf16 v[60:63], v[88:91], v[32:35], v[60:63]
ds_read_b64_tr_b16 v[86:87], v232 offset:38912
v_mfma_f32_16x16x32_bf16 v[144:147], v[92:95], v[28:31], v[144:147]
ds_read_b64_tr_b16 v[88:89], v2 offset:36864
s_add_u32 s50, s4, 598016
buffer_load_dwordx4 v[16:19], v235, s[24:27], s50 offen offset:256 sc1
v_mfma_f32_16x16x32_bf16 v[160:163], v[92:95], v[32:35], v[160:163]
ds_read_b64_tr_b16 v[90:91], v2 offset:38912
s_waitcnt lgkmcnt(4)
v_mfma_f32_16x16x32_bf16 v[52:55], v[96:99], v[36:39], v[52:55]
ds_read_b64_tr_b16 v[92:93], v232 offset:53248
s_add_u32 m0, s48, 94208
s_add_u32 s49, s7, 150528
buffer_load_dwordx4 v248, s[24:27], s49 offen sc1 lds
v_mfma_f32_16x16x32_bf16 v[60:63], v[96:99], v[40:43], v[60:63]
ds_read_b64_tr_b16 v[94:95], v232 offset:55296
s_add_u32 s50, s4, 602112
buffer_load_dwordx4 v[20:23], v235, s[24:27], s50 offen offset:0 sc1
v_mfma_f32_16x16x32_bf16 v[144:147], v[80:83], v[36:39], v[144:147]
ds_read_b64_tr_b16 v[96:97], v2 offset:53248
s_add_u32 s50, s4, 602112
buffer_load_dwordx4 v[24:27], v235, s[24:27], s50 offen offset:256 sc1
v_mfma_f32_16x16x32_bf16 v[160:163], v[80:83], v[40:43], v[160:163]
ds_read_b64_tr_b16 v[98:99], v2 offset:55296
s_waitcnt lgkmcnt(4)
v_mfma_f32_16x16x32_bf16 v[52:55], v[84:87], v[44:47], v[52:55]
ds_read_b64_tr_b16 v[80:81], v232 offset:57344
s_add_u32 m0, s48, 98304
s_add_u32 s49, s7, 159744
buffer_load_dwordx4 v248, s[24:27], s49 offen sc1 lds
s_add_u32 s50, s4, 606208
buffer_load_dwordx4 v[28:31], v235, s[24:27], s50 offen offset:0 sc1
v_mfma_f32_16x16x32_bf16 v[60:63], v[84:87], v[48:51], v[60:63]
ds_read_b64_tr_b16 v[82:83], v232 offset:59392
s_waitcnt vmcnt(16)
s_add_u32 s50, s56, 229376
v_mov_b32 v244, s98
v_mov_b32 v245, s99
s_mov_b64 exec, 1
buffer_store_dwordx2 v[244:245], v248, s[24:27], s50 offen sc1
s_mov_b64 exec, -1
v_mfma_f32_16x16x32_bf16 v[144:147], v[88:91], v[44:47], v[144:147]
ds_read_b64_tr_b16 v[84:85], v2 offset:57344
v_mfma_f32_16x16x32_bf16 v[160:163], v[88:91], v[48:51], v[160:163]
ds_read_b64_tr_b16 v[86:87], v2 offset:59392
s_waitcnt lgkmcnt(4)
v_mfma_f32_16x16x32_bf16 v[52:55], v[92:95], v[68:71], v[52:55]
s_add_u32 s50, s4, 606208
buffer_load_dwordx4 v[32:35], v235, s[24:27], s50 offen offset:256 sc1
v_mfma_f32_16x16x32_bf16 v[60:63], v[92:95], v[72:75], v[60:63]
v_mfma_f32_16x16x32_bf16 v[144:147], v[96:99], v[68:71], v[144:147]
s_add_u32 s50, s4, 610304
buffer_load_dwordx4 v[36:39], v235, s[24:27], s50 offen offset:0 sc1
v_mfma_f32_16x16x32_bf16 v[160:163], v[96:99], v[72:75], v[160:163]
s_waitcnt lgkmcnt(0)
v_mfma_f32_16x16x32_bf16 v[52:55], v[80:83], v[76:79], v[52:55]
s_add_u32 s50, s4, 610304
buffer_load_dwordx4 v[40:43], v235, s[24:27], s50 offen offset:256 sc1
v_mfma_f32_16x16x32_bf16 v[60:63], v[80:83], v[100:103], v[60:63]
v_mfma_f32_16x16x32_bf16 v[144:147], v[84:87], v[76:79], v[144:147]
v_mfma_f32_16x16x32_bf16 v[160:163], v[84:87], v[100:103], v[160:163]
s_nop 2
v_cvt_pk_bf16_f32 v52, v52, v53
v_cvt_pk_bf16_f32 v53, v54, v55
s_nop 1
v_cvt_pk_bf16_f32 v54, v144, v145
v_cvt_pk_bf16_f32 v55, v146, v147
s_add_u32 s50, s55, 1572864
buffer_store_dwordx4 v[52:55], v248, s[24:27], s50 offen sc1
v_cvt_pk_bf16_f32 v60, v60, v61
v_cvt_pk_bf16_f32 v61, v62, v63
v_cvt_pk_bf16_f32 v62, v160, v161
v_cvt_pk_bf16_f32 v63, v162, v163
s_add_u32 s50, s55, 1585152
buffer_store_dwordx4 v[60:63], v248, s[24:27], s50 offen sc1
s_waitcnt vmcnt(7)
s_barrier
s_setprio 3
v_add_u32 v245, 118784, v248
v_add_u32 v244, 0x10000, v247
s_add_u32 s50, s7, 92160
buffer_load_dwordx4 v[68:71], v248, s[24:27], s50 offen sc1
s_add_u32 s50, s7, 101376
buffer_load_dwordx4 v[72:75], v248, s[24:27], s50 offen sc1
s_add_u32 s50, s7, 110592
buffer_load_dwordx4 v[76:79], v248, s[24:27], s50 offen sc1
s_add_u32 s50, s7, 119808
buffer_load_dwordx4 v[80:83], v248, s[24:27], s50 offen sc1
s_add_u32 s50, s7, 129024
buffer_load_dwordx4 v[84:87], v248, s[24:27], s50 offen sc1
s_add_u32 s50, s7, 138240
buffer_load_dwordx4 v[88:91], v248, s[24:27], s50 offen sc1
s_add_u32 s50, s7, 147456
buffer_load_dwordx4 v[92:95], v248, s[24:27], s50 offen sc1
s_add_u32 s50, s7, 156672
buffer_load_dwordx4 v[96:99], v248, s[24:27], s50 offen sc1
v_mfma_f32_16x16x32_bf16 v[136:139], v[56:59], v[116:119], 0
v_mfma_f32_16x16x32_bf16 v[136:139], v[104:107], v[148:151], v[136:139]
v_mfma_f32_16x16x32_bf16 v[136:139], v[56:59], v[4:7], v[136:139]
v_mfma_f32_16x16x32_bf16 v[136:139], v[104:107], v[8:11], v[136:139]
v_mfma_f32_16x16x32_bf16 v[136:139], v[56:59], v[12:15], v[136:139]
v_mfma_f32_16x16x32_bf16 v[136:139], v[104:107], v[16:19], v[136:139]
v_mfma_f32_16x16x32_bf16 v[140:143], v[56:59], v[20:23], 0
v_mfma_f32_16x16x32_bf16 v[140:143], v[104:107], v[24:27], v[140:143]
s_waitcnt vmcnt(14)
v_mfma_f32_16x16x32_bf16 v[140:143], v[56:59], v[28:31], v[140:143]
s_waitcnt vmcnt(12)
v_mfma_f32_16x16x32_bf16 v[140:143], v[104:107], v[32:35], v[140:143]
s_waitcnt vmcnt(11)
v_mfma_f32_16x16x32_bf16 v[140:143], v[56:59], v[36:39], v[140:143]
s_waitcnt vmcnt(10)
v_mfma_f32_16x16x32_bf16 v[140:143], v[104:107], v[40:43], v[140:143]
s_waitcnt vmcnt(8)
s_add_u32 s50, s56, 262144
v_mov_b32 v240, s98
v_mov_b32 v241, s99
s_mov_b64 exec, 1
buffer_store_dwordx2 v[240:241], v248, s[24:27], s50 offen sc1
s_mov_b64 exec, -1
ds_read_b128 v[4:7], v247 offset:61440
ds_read_b128 v[8:11], v245 offset:0
ds_read_b128 v[12:15], v245 offset:1024
ds_read_b128 v[16:19], v244 offset:0
ds_read_b128 v[20:23], v245 offset:8192
ds_read_b128 v[24:27], v245 offset:9216
ds_read_b128 v[28:31], v244 offset:4096
ds_read_b128 v[32:35], v245 offset:16384
ds_read_b128 v[36:39], v245 offset:17408
ds_read_b128 v[40:43], v244 offset:8192
ds_read_b128 v[100:103], v245 offset:24576
ds_read_b128 v[116:119], v245 offset:25600
s_waitcnt lgkmcnt(9)
v_mfma_f32_16x16x32_bf16 v[44:47], v[156:159], v[8:11], 0
v_mfma_f32_16x16x32_bf16 v[48:51], v[156:159], v[12:15], 0
v_mfma_f32_16x16x32_bf16 v[52:55], v[4:7], v[8:11], 0
v_mfma_f32_16x16x32_bf16 v[60:63], v[4:7], v[12:15], 0
ds_read_b128 v[4:7], v247 offset:0
ds_read_b128 v[8:11], v245 offset:2048
ds_read_b128 v[12:15], v245 offset:3072
s_waitcnt lgkmcnt(9)
v_mfma_f32_16x16x32_bf16 v[44:47], v[180:183], v[20:23], v[44:47]
v_mfma_f32_16x16x32_bf16 v[48:51], v[180:183], v[24:27], v[48:51]
v_mfma_f32_16x16x32_bf16 v[52:55], v[16:19], v[20:23], v[52:55]
v_mfma_f32_16x16x32_bf16 v[60:63], v[16:19], v[24:27], v[60:63]
ds_read_b128 v[16:19], v247 offset:4096
ds_read_b128 v[20:23], v245 offset:10240
ds_read_b128 v[24:27], v245 offset:11264
s_waitcnt lgkmcnt(9)
v_mfma_f32_16x16x32_bf16 v[44:47], v[184:187], v[32:35], v[44:47]
v_mfma_f32_16x16x32_bf16 v[48:51], v[184:187], v[36:39], v[48:51]
v_mfma_f32_16x16x32_bf16 v[52:55], v[28:31], v[32:35], v[52:55]
v_mfma_f32_16x16x32_bf16 v[60:63], v[28:31], v[36:39], v[60:63]
ds_read_b128 v[28:31], v247 offset:8192
ds_read_b128 v[32:35], v245 offset:18432
ds_read_b128 v[36:39], v245 offset:19456
s_waitcnt lgkmcnt(9)
v_mfma_f32_16x16x32_bf16 v[44:47], v[64:67], v[100:103], v[44:47]
v_mfma_f32_16x16x32_bf16 v[48:51], v[64:67], v[116:119], v[48:51]
v_mfma_f32_16x16x32_bf16 v[52:55], v[40:43], v[100:103], v[52:55]
v_mfma_f32_16x16x32_bf16 v[60:63], v[40:43], v[116:119], v[60:63]
ds_read_b128 v[40:43], v247 offset:40960
ds_read_b128 v[64:67], v245 offset:26624
ds_read_b128 v[100:103], v245 offset:27648
s_waitcnt lgkmcnt(9)
v_mfma_f32_16x16x32_bf16 v[44:47], v[108:111], v[8:11], v[44:47]
v_mfma_f32_16x16x32_bf16 v[48:51], v[108:111], v[12:15], v[48:51]
v_mfma_f32_16x16x32_bf16 v[52:55], v[4:7], v[8:11], v[52:55]
v_mfma_f32_16x16x32_bf16 v[60:63], v[4:7], v[12:15], v[60:63]
s_waitcnt lgkmcnt(6)
v_mfma_f32_16x16x32_bf16 v[44:47], v[164:167], v[20:23], v[44:47]
v_mfma_f32_16x16x32_bf16 v[48:51], v[164:167], v[24:27], v[48:51]
v_mfma_f32_16x16x32_bf16 v[52:55], v[16:19], v[20:23], v[52:55]
v_mfma_f32_16x16x32_bf16 v[60:63], v[16:19], v[24:27], v[60:63]
s_waitcnt lgkmcnt(3)
v_mfma_f32_16x16x32_bf16 v[44:47], v[168:171], v[32:35], v[44:47]
v_mfma_f32_16x16x32_bf16 v[48:51], v[168:171], v[36:39], v[48:51]
v_mfma_f32_16x16x32_bf16 v[52:55], v[28:31], v[32:35], v[52:55]
v_mfma_f32_16x16x32_bf16 v[60:63], v[28:31], v[36:39], v[60:63]
s_waitcnt lgkmcnt(0)
v_mfma_f32_16x16x32_bf16 v[44:47], v[172:175], v[64:67], v[44:47]
v_mfma_f32_16x16x32_bf16 v[48:51], v[172:175], v[100:103], v[48:51]
v_mfma_f32_16x16x32_bf16 v[52:55], v[40:43], v[64:67], v[52:55]
v_mfma_f32_16x16x32_bf16 v[60:63], v[40:43], v[100:103], v[60:63]
v_exp_f32 v56, -v128
v_exp_f32 v57, -v129
v_exp_f32 v58, -v130
v_exp_f32 v59, -v131
v_exp_f32 v104, -v132
v_exp_f32 v105, -v133
v_exp_f32 v106, -v134
v_exp_f32 v107, -v135
v_mul_f32 v128, 0x3ef5fdf0, v128
v_mul_f32 v129, 0x3ef5fdf0, v129
v_mul_f32 v130, 0x3ef5fdf0, v130
v_mul_f32 v131, 0x3ef5fdf0, v131
v_mul_f32 v132, 0x3ef5fdf0, v132
v_mul_f32 v133, 0x3ef5fdf0, v133
v_mul_f32 v134, 0x3ef5fdf0, v134
v_mul_f32 v135, 0x3ef5fdf0, v135
v_add_f32 v56, 1.0, v56
v_add_f32 v57, 1.0, v57
v_add_f32 v58, 1.0, v58
v_add_f32 v59, 1.0, v59
v_add_f32 v104, 1.0, v104
v_add_f32 v105, 1.0, v105
v_add_f32 v106, 1.0, v106
v_add_f32 v107, 1.0, v107
v_rcp_f32 v56, v56
v_rcp_f32 v57, v57
v_rcp_f32 v58, v58
v_rcp_f32 v59, v59
v_rcp_f32 v104, v104
v_rcp_f32 v105, v105
v_rcp_f32 v106, v106
v_rcp_f32 v107, v107
v_mul_f32 v128, v128, v56
v_mul_f32 v129, v129, v57
v_mul_f32 v130, v130, v58
v_mul_f32 v131, v131, v59
v_mul_f32 v132, v132, v104
v_mul_f32 v133, v133, v105
v_mul_f32 v134, v134, v106
v_mul_f32 v135, v135, v107
v_exp_f32 v56, -v136
v_exp_f32 v57, -v137
v_exp_f32 v58, -v138
v_exp_f32 v59, -v139
v_exp_f32 v104, -v140
v_exp_f32 v105, -v141
v_exp_f32 v106, -v142
v_exp_f32 v107, -v143
v_mul_f32 v136, 0x3ef5fdf0, v136
v_mul_f32 v137, 0x3ef5fdf0, v137
v_mul_f32 v138, 0x3ef5fdf0, v138
v_mul_f32 v139, 0x3ef5fdf0, v139
v_mul_f32 v140, 0x3ef5fdf0, v140
v_mul_f32 v141, 0x3ef5fdf0, v141
v_mul_f32 v142, 0x3ef5fdf0, v142
v_mul_f32 v143, 0x3ef5fdf0, v143
v_add_f32 v56, 1.0, v56
v_add_f32 v57, 1.0, v57
v_add_f32 v58, 1.0, v58
v_add_f32 v59, 1.0, v59
v_add_f32 v104, 1.0, v104
v_add_f32 v105, 1.0, v105
v_add_f32 v106, 1.0, v106
v_add_f32 v107, 1.0, v107
v_rcp_f32 v56, v56
v_rcp_f32 v57, v57
v_rcp_f32 v58, v58
v_rcp_f32 v59, v59
v_rcp_f32 v104, v104
v_rcp_f32 v105, v105
v_rcp_f32 v106, v106
v_rcp_f32 v107, v107
v_mul_f32 v136, v136, v56
v_mul_f32 v137, v137, v57
v_mul_f32 v138, v138, v58
v_mul_f32 v139, v139, v59
v_mul_f32 v140, v140, v104
v_mul_f32 v141, v141, v105
v_mul_f32 v142, v142, v106
v_mul_f32 v143, v143, v107
s_barrier
v_lshlrev_b32 v255, 2, v1
v_add_u32 v255, 151552, v255
ds_read2st64_b32 v[4:5], v255 offset0:0 offset1:1
ds_read2st64_b32 v[6:7], v255 offset0:2 offset1:3
ds_read2st64_b32 v[8:9], v255 offset0:4 offset1:5
ds_read2st64_b32 v[10:11], v255 offset0:6 offset1:7
ds_read2st64_b32 v[12:13], v255 offset0:8 offset1:9
ds_read2st64_b32 v[14:15], v255 offset0:10 offset1:11
ds_read2st64_b32 v[16:17], v255 offset0:12 offset1:13
ds_read2st64_b32 v[18:19], v255 offset0:14 offset1:15
ds_read_b128 v[20:23], v244 offset:12288
ds_read_b128 v[24:27], v245 offset:4096
ds_read_b128 v[28:31], v245 offset:5120
ds_read_b128 v[32:35], v244 offset:16384
ds_read_b128 v[36:39], v245 offset:12288
ds_read_b128 v[40:43], v245 offset:13312
ds_read_b128 v[56:59], v244 offset:20480
ds_read_b128 v[64:67], v245 offset:20480
ds_read_b128 v[100:103], v245 offset:21504
ds_read_b128 v[104:107], v247 offset:12288
ds_read_b128 v[108:111], v245 offset:28672
ds_read_b128 v[116:119], v245 offset:29696
s_waitcnt lgkmcnt(9)
v_mfma_f32_16x16x32_bf16 v[44:47], v[176:179], v[24:27], v[44:47]
v_mfma_f32_16x16x32_bf16 v[48:51], v[176:179], v[28:31], v[48:51]
v_mfma_f32_16x16x32_bf16 v[52:55], v[20:23], v[24:27], v[52:55]
v_mfma_f32_16x16x32_bf16 v[60:63], v[20:23], v[28:31], v[60:63]
ds_read_b128 v[20:23], v247 offset:16384
ds_read_b128 v[24:27], v245 offset:6144
ds_read_b128 v[28:31], v245 offset:7168
s_waitcnt lgkmcnt(9)
v_mfma_f32_16x16x32_bf16 v[44:47], v[112:115], v[36:39], v[44:47]
v_mfma_f32_16x16x32_bf16 v[48:51], v[112:115], v[40:43], v[48:51]
v_mfma_f32_16x16x32_bf16 v[52:55], v[32:35], v[36:39], v[52:55]
v_mfma_f32_16x16x32_bf16 v[60:63], v[32:35], v[40:43], v[60:63]
ds_read_b128 v[32:35], v247 offset:20480
ds_read_b128 v[36:39], v245 offset:14336
ds_read_b128 v[40:43], v245 offset:15360
s_waitcnt lgkmcnt(9)
s_waitcnt vmcnt(8)
v_mfma_f32_16x16x32_bf16 v[44:47], v[68:71], v[64:67], v[44:47]
v_mfma_f32_16x16x32_bf16 v[48:51], v[68:71], v[100:103], v[48:51]
v_mfma_f32_16x16x32_bf16 v[52:55], v[56:59], v[64:67], v[52:55]
v_mfma_f32_16x16x32_bf16 v[60:63], v[56:59], v[100:103], v[60:63]
ds_read_b128 v[56:59], v247 offset:24576
ds_read_b128 v[64:67], v245 offset:22528
ds_read_b128 v[68:71], v245 offset:23552
s_mov_b32 s50, 0x05040100
s_mov_b32 s51, 0x07060302
v_perm_b32 v100, v5, v4, s50
v_perm_b32 v101, v7, v6, s50
v_perm_b32 v102, v9, v8, s50
v_perm_b32 v103, v11, v10, s50
v_perm_b32 v112, v5, v4, s51
v_perm_b32 v113, v7, v6, s51
v_perm_b32 v114, v9, v8, s51
v_perm_b32 v115, v11, v10, s51
v_perm_b32 v144, v13, v12, s50
v_perm_b32 v145, v15, v14, s50
v_perm_b32 v146, v17, v16, s50
v_perm_b32 v147, v19, v18, s50
v_perm_b32 v148, v13, v12, s51
v_perm_b32 v149, v15, v14, s51
v_perm_b32 v150, v17, v16, s51
v_perm_b32 v151, v19, v18, s51
s_waitcnt lgkmcnt(9)
s_waitcnt vmcnt(7)
v_mfma_f32_16x16x32_bf16 v[44:47], v[72:75], v[108:111], v[44:47]
v_mfma_f32_16x16x32_bf16 v[48:51], v[72:75], v[116:119], v[48:51]
v_mfma_f32_16x16x32_bf16 v[52:55], v[104:107], v[108:111], v[52:55]
v_mfma_f32_16x16x32_bf16 v[60:63], v[104:107], v[116:119], v[60:63]
ds_read_b128 v[72:75], v244 offset:24576
ds_read_b128 v[104:107], v245 offset:30720
ds_read_b128 v[108:111], v245 offset:31744
s_waitcnt lgkmcnt(9)
s_waitcnt vmcnt(6)
v_mfma_f32_16x16x32_bf16 v[44:47], v[76:79], v[24:27], v[44:47]
v_mfma_f32_16x16x32_bf16 v[48:51], v[76:79], v[28:31], v[48:51]
v_mfma_f32_16x16x32_bf16 v[52:55], v[20:23], v[24:27], v[52:55]
v_mfma_f32_16x16x32_bf16 v[60:63], v[20:23], v[28:31], v[60:63]
ds_read_b128 v[20:23], v244 offset:28672
s_waitcnt lgkmcnt(7)
s_waitcnt vmcnt(5)
v_mfma_f32_16x16x32_bf16 v[44:47], v[80:83], v[36:39], v[44:47]
v_mfma_f32_16x16x32_bf16 v[48:51], v[80:83], v[40:43], v[48:51]
v_mfma_f32_16x16x32_bf16 v[52:55], v[32:35], v[36:39], v[52:55]
v_mfma_f32_16x16x32_bf16 v[60:63], v[32:35], v[40:43], v[60:63]
ds_read_b128 v[24:27], v244 offset:32768
s_waitcnt lgkmcnt(5)
s_waitcnt vmcnt(4)
v_mfma_f32_16x16x32_bf16 v[44:47], v[84:87], v[64:67], v[44:47]
v_mfma_f32_16x16x32_bf16 v[48:51], v[84:87], v[68:71], v[48:51]
v_mfma_f32_16x16x32_bf16 v[52:55], v[56:59], v[64:67], v[52:55]
v_mfma_f32_16x16x32_bf16 v[60:63], v[56:59], v[68:71], v[60:63]
s_waitcnt lgkmcnt(2)
s_waitcnt vmcnt(3)
v_mfma_f32_16x16x32_bf16 v[44:47], v[88:91], v[104:107], v[44:47]
v_mfma_f32_16x16x32_bf16 v[48:51], v[88:91], v[108:111], v[48:51]
v_mfma_f32_16x16x32_bf16 v[52:55], v[72:75], v[104:107], v[52:55]
v_mfma_f32_16x16x32_bf16 v[60:63], v[72:75], v[108:111], v[60:63]
s_waitcnt lgkmcnt(1)
s_waitcnt vmcnt(2)
v_mfma_f32_16x16x32_bf16 v[44:47], v[92:95], v[100:103], v[44:47]
v_mfma_f32_16x16x32_bf16 v[48:51], v[92:95], v[112:115], v[48:51]
v_mfma_f32_16x16x32_bf16 v[52:55], v[20:23], v[100:103], v[52:55]
v_mfma_f32_16x16x32_bf16 v[60:63], v[20:23], v[112:115], v[60:63]
s_waitcnt lgkmcnt(0)
s_waitcnt vmcnt(1)
v_mfma_f32_16x16x32_bf16 v[44:47], v[96:99], v[144:147], v[44:47]
v_mfma_f32_16x16x32_bf16 v[48:51], v[96:99], v[148:151], v[48:51]
v_mfma_f32_16x16x32_bf16 v[52:55], v[24:27], v[144:147], v[52:55]
v_mfma_f32_16x16x32_bf16 v[60:63], v[24:27], v[148:151], v[60:63]
s_nop 4
v_mul_f32 v128, v128, v44
v_mul_f32 v129, v129, v45
v_mul_f32 v130, v130, v46
v_mul_f32 v131, v131, v47
v_mul_f32 v132, v132, v48
v_mul_f32 v133, v133, v49
v_mul_f32 v134, v134, v50
v_mul_f32 v135, v135, v51
v_lshlrev_b32 v44, 16, v120
v_and_b32 v45, s53, v120
v_lshlrev_b32 v46, 16, v121
v_and_b32 v47, s53, v121
v_lshlrev_b32 v48, 16, v122
v_and_b32 v49, s53, v122
v_lshlrev_b32 v50, 16, v123
v_and_b32 v51, s53, v123
v_permlane32_swap_b32 v128, v132
v_permlane32_swap_b32 v129, v133
v_permlane32_swap_b32 v130, v134
v_permlane32_swap_b32 v131, v135
v_add_f32 v128, v128, v44
v_add_f32 v129, v129, v45
v_add_f32 v130, v130, v46
v_add_f32 v131, v131, v47
v_add_f32 v132, v132, v48
v_add_f32 v133, v133, v49
v_add_f32 v134, v134, v50
v_add_f32 v135, v135, v51
v_cvt_pk_bf16_f32 v120, v128, v129
v_cvt_pk_bf16_f32 v121, v130, v131
v_cvt_pk_bf16_f32 v122, v132, v133
v_cvt_pk_bf16_f32 v123, v134, v135
buffer_store_dwordx4 v[120:123], v233, s[92:95], s6 offen offset:0
v_mul_f32 v136, v136, v52
v_mul_f32 v137, v137, v53
v_mul_f32 v138, v138, v54
v_mul_f32 v139, v139, v55
v_mul_f32 v140, v140, v60
v_mul_f32 v141, v141, v61
v_mul_f32 v142, v142, v62
v_mul_f32 v143, v143, v63
v_lshlrev_b32 v52, 16, v124
v_and_b32 v53, s53, v124
v_lshlrev_b32 v54, 16, v125
v_and_b32 v55, s53, v125
v_lshlrev_b32 v60, 16, v126
v_and_b32 v61, s53, v126
v_lshlrev_b32 v62, 16, v127
v_and_b32 v63, s53, v127
v_permlane32_swap_b32 v136, v140
v_permlane32_swap_b32 v137, v141
v_permlane32_swap_b32 v138, v142
v_permlane32_swap_b32 v139, v143
v_add_f32 v136, v136, v52
v_add_f32 v137, v137, v53
v_add_f32 v138, v138, v54
v_add_f32 v139, v139, v55
v_add_f32 v140, v140, v60
v_add_f32 v141, v141, v61
v_add_f32 v142, v142, v62
v_add_f32 v143, v143, v63
v_cvt_pk_bf16_f32 v124, v136, v137
v_cvt_pk_bf16_f32 v125, v138, v139
v_cvt_pk_bf16_f32 v126, v140, v141
v_cvt_pk_bf16_f32 v127, v142, v143
buffer_store_dwordx4 v[124:127], v233, s[92:95], s6 offen offset:384
s_endpgm
L_ffn_c1:
s_setprio 2
s_waitcnt vmcnt(17)
v_dot2_f32_bf16 v76, v4, s54, 0
v_dot2_f32_bf16 v78, v4, v4, 0
v_dot2_f32_bf16 v76, v5, s54, v76
v_dot2_f32_bf16 v78, v5, v5, v78
v_dot2_f32_bf16 v76, v6, s54, v76
v_dot2_f32_bf16 v78, v6, v6, v78
v_dot2_f32_bf16 v76, v7, s54, v76
v_dot2_f32_bf16 v78, v7, v7, v78
s_waitcnt vmcnt(16)
v_dot2_f32_bf16 v77, v40, s54, 0
v_dot2_f32_bf16 v79, v40, v40, 0
v_dot2_f32_bf16 v77, v41, s54, v77
v_dot2_f32_bf16 v79, v41, v41, v79
v_dot2_f32_bf16 v77, v42, s54, v77
v_dot2_f32_bf16 v79, v42, v42, v79
v_dot2_f32_bf16 v77, v43, s54, v77
v_dot2_f32_bf16 v79, v43, v43, v79
s_waitcnt vmcnt(15)
v_dot2_f32_bf16 v76, v8, s54, v76
v_dot2_f32_bf16 v78, v8, v8, v78
v_dot2_f32_bf16 v76, v9, s54, v76
v_dot2_f32_bf16 v78, v9, v9, v78
v_dot2_f32_bf16 v76, v10, s54, v76
v_dot2_f32_bf16 v78, v10, v10, v78
v_dot2_f32_bf16 v76, v11, s54, v76
v_dot2_f32_bf16 v78, v11, v11, v78
s_waitcnt vmcnt(14)
v_dot2_f32_bf16 v77, v44, s54, v77
v_dot2_f32_bf16 v79, v44, v44, v79
v_dot2_f32_bf16 v77, v45, s54, v77
v_dot2_f32_bf16 v79, v45, v45, v79
v_dot2_f32_bf16 v77, v46, s54, v77
v_dot2_f32_bf16 v79, v46, v46, v79
v_dot2_f32_bf16 v77, v47, s54, v77
v_dot2_f32_bf16 v79, v47, v47, v79
s_waitcnt vmcnt(13)
v_dot2_f32_bf16 v76, v12, s54, v76
v_dot2_f32_bf16 v78, v12, v12, v78
v_dot2_f32_bf16 v76, v13, s54, v76
v_dot2_f32_bf16 v78, v13, v13, v78
v_dot2_f32_bf16 v76, v14, s54, v76
v_dot2_f32_bf16 v78, v14, v14, v78
v_dot2_f32_bf16 v76, v15, s54, v76
v_dot2_f32_bf16 v78, v15, v15, v78
s_waitcnt vmcnt(12)
v_dot2_f32_bf16 v77, v48, s54, v77
v_dot2_f32_bf16 v79, v48, v48, v79
v_dot2_f32_bf16 v77, v49, s54, v77
v_dot2_f32_bf16 v79, v49, v49, v79
v_dot2_f32_bf16 v77, v50, s54, v77
v_dot2_f32_bf16 v79, v50, v50, v79
v_dot2_f32_bf16 v77, v51, s54, v77
v_dot2_f32_bf16 v79, v51, v51, v79
s_waitcnt vmcnt(11)
v_dot2_f32_bf16 v76, v16, s54, v76
v_dot2_f32_bf16 v78, v16, v16, v78
v_dot2_f32_bf16 v76, v17, s54, v76
v_dot2_f32_bf16 v78, v17, v17, v78
v_dot2_f32_bf16 v76, v18, s54, v76
v_dot2_f32_bf16 v78, v18, v18, v78
v_dot2_f32_bf16 v76, v19, s54, v76
v_dot2_f32_bf16 v78, v19, v19, v78
s_waitcnt vmcnt(10)
v_dot2_f32_bf16 v77, v52, s54, v77
v_dot2_f32_bf16 v79, v52, v52, v79
v_dot2_f32_bf16 v77, v53, s54, v77
v_dot2_f32_bf16 v79, v53, v53, v79
v_dot2_f32_bf16 v77, v54, s54, v77
v_dot2_f32_bf16 v79, v54, v54, v79
v_dot2_f32_bf16 v77, v55, s54, v77
v_dot2_f32_bf16 v79, v55, v55, v79
s_waitcnt vmcnt(9)
v_dot2_f32_bf16 v76, v20, s54, v76
v_dot2_f32_bf16 v78, v20, v20, v78
v_dot2_f32_bf16 v76, v21, s54, v76
v_dot2_f32_bf16 v78, v21, v21, v78
v_dot2_f32_bf16 v76, v22, s54, v76
v_dot2_f32_bf16 v78, v22, v22, v78
v_dot2_f32_bf16 v76, v23, s54, v76
v_dot2_f32_bf16 v78, v23, v23, v78
s_waitcnt vmcnt(8)
v_dot2_f32_bf16 v77, v56, s54, v77
v_dot2_f32_bf16 v79, v56, v56, v79
v_dot2_f32_bf16 v77, v57, s54, v77
v_dot2_f32_bf16 v79, v57, v57, v79
v_dot2_f32_bf16 v77, v58, s54, v77
v_dot2_f32_bf16 v79, v58, v58, v79
v_dot2_f32_bf16 v77, v59, s54, v77
v_dot2_f32_bf16 v79, v59, v59, v79
s_waitcnt vmcnt(7)
v_dot2_f32_bf16 v76, v24, s54, v76
v_dot2_f32_bf16 v78, v24, v24, v78
v_dot2_f32_bf16 v76, v25, s54, v76
v_dot2_f32_bf16 v78, v25, v25, v78
v_dot2_f32_bf16 v76, v26, s54, v76
v_dot2_f32_bf16 v78, v26, v26, v78
v_dot2_f32_bf16 v76, v27, s54, v76
v_dot2_f32_bf16 v78, v27, v27, v78
s_waitcnt vmcnt(6)
v_dot2_f32_bf16 v77, v60, s54, v77
v_dot2_f32_bf16 v79, v60, v60, v79
v_dot2_f32_bf16 v77, v61, s54, v77
v_dot2_f32_bf16 v79, v61, v61, v79
v_dot2_f32_bf16 v77, v62, s54, v77
v_dot2_f32_bf16 v79, v62, v62, v79
v_dot2_f32_bf16 v77, v63, s54, v77
v_dot2_f32_bf16 v79, v63, v63, v79
s_waitcnt vmcnt(5)
v_dot2_f32_bf16 v76, v28, s54, v76
v_dot2_f32_bf16 v78, v28, v28, v78
v_dot2_f32_bf16 v76, v29, s54, v76
v_dot2_f32_bf16 v78, v29, v29, v78
v_dot2_f32_bf16 v76, v30, s54, v76
v_dot2_f32_bf16 v78, v30, v30, v78
v_dot2_f32_bf16 v76, v31, s54, v76
v_dot2_f32_bf16 v78, v31, v31, v78
s_waitcnt vmcnt(4)
v_dot2_f32_bf16 v77, v64, s54, v77
v_dot2_f32_bf16 v79, v64, v64, v79
v_dot2_f32_bf16 v77, v65, s54, v77
v_dot2_f32_bf16 v79, v65, v65, v79
v_dot2_f32_bf16 v77, v66, s54, v77
v_dot2_f32_bf16 v79, v66, v66, v79
v_dot2_f32_bf16 v77, v67, s54, v77
v_dot2_f32_bf16 v79, v67, v67, v79
s_waitcnt vmcnt(3)
v_dot2_f32_bf16 v76, v32, s54, v76
v_dot2_f32_bf16 v78, v32, v32, v78
v_dot2_f32_bf16 v76, v33, s54, v76
v_dot2_f32_bf16 v78, v33, v33, v78
v_dot2_f32_bf16 v76, v34, s54, v76
v_dot2_f32_bf16 v78, v34, v34, v78
v_dot2_f32_bf16 v76, v35, s54, v76
v_dot2_f32_bf16 v78, v35, v35, v78
s_waitcnt vmcnt(2)
v_dot2_f32_bf16 v77, v68, s54, v77
v_dot2_f32_bf16 v79, v68, v68, v79
v_dot2_f32_bf16 v77, v69, s54, v77
v_dot2_f32_bf16 v79, v69, v69, v79
v_dot2_f32_bf16 v77, v70, s54, v77
v_dot2_f32_bf16 v79, v70, v70, v79
v_dot2_f32_bf16 v77, v71, s54, v77
v_dot2_f32_bf16 v79, v71, v71, v79
s_waitcnt vmcnt(1)
v_dot2_f32_bf16 v76, v36, s54, v76
v_dot2_f32_bf16 v78, v36, v36, v78
v_dot2_f32_bf16 v76, v37, s54, v76
v_dot2_f32_bf16 v78, v37, v37, v78
v_dot2_f32_bf16 v76, v38, s54, v76
v_dot2_f32_bf16 v78, v38, v38, v78
v_dot2_f32_bf16 v76, v39, s54, v76
v_dot2_f32_bf16 v78, v39, v39, v78
s_waitcnt vmcnt(0)
v_dot2_f32_bf16 v77, v72, s54, v77
v_dot2_f32_bf16 v79, v72, v72, v79
v_dot2_f32_bf16 v77, v73, s54, v77
v_dot2_f32_bf16 v79, v73, v73, v79
v_dot2_f32_bf16 v77, v74, s54, v77
v_dot2_f32_bf16 v79, v74, v74, v79
v_dot2_f32_bf16 v77, v75, s54, v77
v_dot2_f32_bf16 v79, v75, v75, v79
v_add_f32_dpp v76, v76, v76 quad_perm:[1,0,3,2] row_mask:0xf bank_mask:0xf
s_nop 0
v_add_f32_dpp v77, v77, v77 quad_perm:[1,0,3,2] row_mask:0xf bank_mask:0xf
v_add_f32_dpp v78, v78, v78 quad_perm:[1,0,3,2] row_mask:0xf bank_mask:0xf
v_add_f32_dpp v79, v79, v79 quad_perm:[1,0,3,2] row_mask:0xf bank_mask:0xf
v_add_f32_dpp v76, v76, v76 quad_perm:[2,3,0,1] row_mask:0xf bank_mask:0xf
v_add_f32_dpp v77, v77, v77 quad_perm:[2,3,0,1] row_mask:0xf bank_mask:0xf
v_add_f32_dpp v78, v78, v78 quad_perm:[2,3,0,1] row_mask:0xf bank_mask:0xf
v_add_f32_dpp v79, v79, v79 quad_perm:[2,3,0,1] row_mask:0xf bank_mask:0xf
v_add_f32_dpp v76, v76, v76 row_half_mirror row_mask:0xf bank_mask:0xf
v_add_f32_dpp v77, v77, v77 row_half_mirror row_mask:0xf bank_mask:0xf
v_add_f32_dpp v78, v78, v78 row_half_mirror row_mask:0xf bank_mask:0xf
v_add_f32_dpp v79, v79, v79 row_half_mirror row_mask:0xf bank_mask:0xf
v_mul_f32 v76, 0xbae38e39, v76
v_mul_f32 v77, 0xbae38e39, v77
v_mul_f32 v78, 0x3ae38e39, v78
v_mul_f32 v79, 0x3ae38e39, v79
v_fma_f32 v78, -v76, v76, v78
v_fma_f32 v79, -v77, v77, v79
v_max_f32 v78, 0, v78
v_max_f32 v79, 0, v79
v_add_f32 v78, 0x3727c5ac, v78
v_add_f32 v79, 0x3727c5ac, v79
v_rsq_f32 v78, v78
v_rsq_f32 v79, v79
v_mul_f32 v78, 1069066811, v78
v_mul_f32 v79, 1069066811, v79
v_mul_f32 v76, v76, v78
v_mul_f32 v77, v77, v79
v_lshlrev_b32 v245, 16, v4
v_and_b32 v244, s53, v4
v_lshlrev_b32 v243, 16, v5
v_and_b32 v242, s53, v5
v_lshlrev_b32 v241, 16, v6
v_and_b32 v240, s53, v6
v_lshlrev_b32 v239, 16, v7
v_and_b32 v238, s53, v7
v_fma_f32 v245, v245, v78, v76
v_fma_f32 v244, v244, v78, v76
v_fma_f32 v243, v243, v78, v76
v_fma_f32 v242, v242, v78, v76
v_fma_f32 v241, v241, v78, v76
v_fma_f32 v240, v240, v78, v76
v_fma_f32 v239, v239, v78, v76
v_fma_f32 v238, v238, v78, v76
v_cvt_pk_bf16_f32 v4, v245, v244
v_cvt_pk_bf16_f32 v5, v243, v242
v_cvt_pk_bf16_f32 v6, v241, v240
v_cvt_pk_bf16_f32 v7, v239, v238
ds_write_b128 v237, v[4:7] offset:0
v_lshlrev_b32 v245, 16, v40
v_and_b32 v244, s53, v40
v_lshlrev_b32 v243, 16, v41
v_and_b32 v242, s53, v41
v_lshlrev_b32 v241, 16, v42
v_and_b32 v240, s53, v42
v_lshlrev_b32 v239, 16, v43
v_and_b32 v238, s53, v43
v_fma_f32 v245, v245, v79, v77
v_fma_f32 v244, v244, v79, v77
v_fma_f32 v243, v243, v79, v77
v_fma_f32 v242, v242, v79, v77
v_fma_f32 v241, v241, v79, v77
v_fma_f32 v240, v240, v79, v77
v_fma_f32 v239, v239, v79, v77
v_fma_f32 v238, v238, v79, v77
v_cvt_pk_bf16_f32 v40, v245, v244
v_cvt_pk_bf16_f32 v41, v243, v242
v_cvt_pk_bf16_f32 v42, v241, v240
v_cvt_pk_bf16_f32 v43, v239, v238
ds_write_b128 v237, v[40:43] offset:128
v_lshlrev_b32 v245, 16, v8
v_and_b32 v244, s53, v8
v_lshlrev_b32 v243, 16, v9
v_and_b32 v242, s53, v9
v_lshlrev_b32 v241, 16, v10
v_and_b32 v240, s53, v10
v_lshlrev_b32 v239, 16, v11
v_and_b32 v238, s53, v11
v_fma_f32 v245, v245, v78, v76
v_fma_f32 v244, v244, v78, v76
v_fma_f32 v243, v243, v78, v76
v_fma_f32 v242, v242, v78, v76
v_fma_f32 v241, v241, v78, v76
v_fma_f32 v240, v240, v78, v76
v_fma_f32 v239, v239, v78, v76
v_fma_f32 v238, v238, v78, v76
v_cvt_pk_bf16_f32 v8, v245, v244
v_cvt_pk_bf16_f32 v9, v243, v242
v_cvt_pk_bf16_f32 v10, v241, v240
v_cvt_pk_bf16_f32 v11, v239, v238
ds_write_b128 v237, v[8:11] offset:16384
v_lshlrev_b32 v245, 16, v44
v_and_b32 v244, s53, v44
v_lshlrev_b32 v243, 16, v45
v_and_b32 v242, s53, v45
v_lshlrev_b32 v241, 16, v46
v_and_b32 v240, s53, v46
v_lshlrev_b32 v239, 16, v47
v_and_b32 v238, s53, v47
v_fma_f32 v245, v245, v79, v77
v_fma_f32 v244, v244, v79, v77
v_fma_f32 v243, v243, v79, v77
v_fma_f32 v242, v242, v79, v77
v_fma_f32 v241, v241, v79, v77
v_fma_f32 v240, v240, v79, v77
v_fma_f32 v239, v239, v79, v77
v_fma_f32 v238, v238, v79, v77
v_cvt_pk_bf16_f32 v44, v245, v244
v_cvt_pk_bf16_f32 v45, v243, v242
v_cvt_pk_bf16_f32 v46, v241, v240
v_cvt_pk_bf16_f32 v47, v239, v238
ds_write_b128 v237, v[44:47] offset:16512
v_and_b32 v255, 1, v252
v_lshrrev_b32 v254, 1, v250
v_lshl_or_b32 v255, v255, 1, v254
v_lshlrev_b32 v255, 5, v255
v_lshl_add_u32 v254, v252, 3, v250
v_lshl_add_u32 v255, v254, 7, v255
v_lshl_add_u32 v255, v249, 3, v255
v_xor_b32 v233, 64, v255
v_add_u32 v232, 0x10000, v233
v_xor_b32 v3, 96, v255
v_add_u32 v2, 0x10000, v3
s_waitcnt lgkmcnt(0)
s_barrier
s_setprio 1
ds_read_b128 v[4:7], v236 offset:0
ds_read_b128 v[8:11], v236 offset:1024
ds_read_b64_tr_b16 v[80:81], v233 offset:0
ds_read_b64_tr_b16 v[82:83], v233 offset:512
ds_read_b64_tr_b16 v[84:85], v3 offset:0
ds_read_b64_tr_b16 v[86:87], v3 offset:512
ds_read_b64_tr_b16 v[88:89], v233 offset:4096
ds_read_b64_tr_b16 v[90:91], v233 offset:4608
ds_read_b64_tr_b16 v[92:93], v3 offset:4096
ds_read_b64_tr_b16 v[94:95], v3 offset:4608
ds_read_b128 v[40:43], v235 offset:8192
ds_read_b128 v[44:47], v235 offset:9216
ds_read_b128 v[100:103], v236 offset:16384
ds_read_b128 v[104:107], v236 offset:17408
ds_read_b128 v[108:111], v235 offset:24576
ds_read_b128 v[112:115], v235 offset:25600
s_waitcnt lgkmcnt(14)
s_waitcnt lgkmcnt(10)
v_mfma_f32_16x16x32_bf16 v[116:119], v[80:83], v[4:7], 0
ds_read_b64_tr_b16 v[96:97], v233 offset:8192
v_lshlrev_b32 v245, 16, v12
v_and_b32 v244, s53, v12
v_lshlrev_b32 v243, 16, v13
v_and_b32 v242, s53, v13
v_mfma_f32_16x16x32_bf16 v[120:123], v[80:83], v[8:11], 0
ds_read_b64_tr_b16 v[98:99], v233 offset:8704
v_lshlrev_b32 v241, 16, v14
v_and_b32 v240, s53, v14
v_lshlrev_b32 v239, 16, v15
v_and_b32 v238, s53, v15
v_mfma_f32_16x16x32_bf16 v[124:127], v[84:87], v[4:7], 0
ds_read_b64_tr_b16 v[80:81], v3 offset:8192
s_add_u32 m0, s48, 36864
s_add_u32 s49, s46, 1474560
buffer_load_dwordx4 v246, s[16:19], s49 offen lds
v_fma_f32 v245, v245, v78, v76
v_fma_f32 v244, v244, v78, v76
v_fma_f32 v243, v243, v78, v76
v_mfma_f32_16x16x32_bf16 v[128:131], v[84:87], v[8:11], 0
ds_read_b64_tr_b16 v[82:83], v3 offset:8704
v_fma_f32 v242, v242, v78, v76
v_fma_f32 v241, v241, v78, v76
v_fma_f32 v240, v240, v78, v76
v_fma_f32 v239, v239, v78, v76
s_waitcnt lgkmcnt(8)
v_mfma_f32_16x16x32_bf16 v[116:119], v[88:91], v[40:43], v[116:119]
ds_read_b64_tr_b16 v[84:85], v233 offset:12288
s_add_u32 m0, s48, 45056
s_add_u32 s49, s46, 2064384
buffer_load_dwordx4 v246, s[16:19], s49 offen lds
v_fma_f32 v238, v238, v78, v76
v_cvt_pk_bf16_f32 v12, v245, v244
v_cvt_pk_bf16_f32 v13, v243, v242
v_mfma_f32_16x16x32_bf16 v[120:123], v[88:91], v[44:47], v[120:123]
ds_read_b64_tr_b16 v[86:87], v233 offset:12800
v_cvt_pk_bf16_f32 v14, v241, v240
v_cvt_pk_bf16_f32 v15, v239, v238
ds_write_b128 v237, v[12:15] offset:32768
v_lshlrev_b32 v245, 16, v48
v_mfma_f32_16x16x32_bf16 v[124:127], v[92:95], v[40:43], v[124:127]
ds_read_b64_tr_b16 v[88:89], v3 offset:12288
s_add_u32 m0, s48, 53248
s_add_u32 s49, s46, 1474688
buffer_load_dwordx4 v246, s[16:19], s49 offen lds
v_and_b32 v244, s53, v48
v_lshlrev_b32 v243, 16, v49
v_and_b32 v242, s53, v49
v_mfma_f32_16x16x32_bf16 v[128:131], v[92:95], v[44:47], v[128:131]
ds_read_b64_tr_b16 v[90:91], v3 offset:12800
v_lshlrev_b32 v241, 16, v50
v_and_b32 v240, s53, v50
v_lshlrev_b32 v239, 16, v51
v_and_b32 v238, s53, v51
s_waitcnt lgkmcnt(11)
s_waitcnt lgkmcnt(5)
v_mfma_f32_16x16x32_bf16 v[116:119], v[96:99], v[100:103], v[116:119]
ds_read_b64_tr_b16 v[92:93], v233 offset:16384
s_add_u32 m0, s48, 61440
s_add_u32 s49, s46, 2064512
buffer_load_dwordx4 v246, s[16:19], s49 offen lds
v_fma_f32 v245, v245, v79, v77
v_fma_f32 v244, v244, v79, v77
v_fma_f32 v243, v243, v79, v77
v_mfma_f32_16x16x32_bf16 v[120:123], v[96:99], v[104:107], v[120:123]
ds_read_b64_tr_b16 v[94:95], v233 offset:16896
v_fma_f32 v242, v242, v79, v77
v_fma_f32 v241, v241, v79, v77
v_fma_f32 v240, v240, v79, v77
v_fma_f32 v239, v239, v79, v77
v_mfma_f32_16x16x32_bf16 v[124:127], v[80:83], v[100:103], v[124:127]
ds_read_b64_tr_b16 v[96:97], v3 offset:16384
s_add_u32 m0, s48, 69632
s_add_u32 s49, s46, 2654208
buffer_load_dwordx4 v246, s[16:19], s49 offen lds
v_fma_f32 v238, v238, v79, v77
v_cvt_pk_bf16_f32 v48, v245, v244
v_cvt_pk_bf16_f32 v49, v243, v242
v_mfma_f32_16x16x32_bf16 v[128:131], v[80:83], v[104:107], v[128:131]
ds_read_b64_tr_b16 v[98:99], v3 offset:16896
v_cvt_pk_bf16_f32 v50, v241, v240
v_cvt_pk_bf16_f32 v51, v239, v238
ds_write_b128 v237, v[48:51] offset:32896
v_lshlrev_b32 v245, 16, v16
s_waitcnt lgkmcnt(5)
v_mfma_f32_16x16x32_bf16 v[116:119], v[84:87], v[108:111], v[116:119]
ds_read_b64_tr_b16 v[80:81], v233 offset:20480
s_add_u32 m0, s48, 77824
s_add_u32 s49, s46, 3244032
buffer_load_dwordx4 v246, s[16:19], s49 offen lds
v_and_b32 v244, s53, v16
v_lshlrev_b32 v243, 16, v17
v_and_b32 v242, s53, v17
v_mfma_f32_16x16x32_bf16 v[120:123], v[84:87], v[112:115], v[120:123]
ds_read_b64_tr_b16 v[82:83], v233 offset:20992
v_lshlrev_b32 v241, 16, v18
v_and_b32 v240, s53, v18
v_lshlrev_b32 v239, 16, v19
v_and_b32 v238, s53, v19
v_mfma_f32_16x16x32_bf16 v[124:127], v[88:91], v[108:111], v[124:127]
ds_read_b64_tr_b16 v[84:85], v3 offset:20480
s_add_u32 m0, s48, 86016
s_add_u32 s49, s46, 2654336
buffer_load_dwordx4 v246, s[16:19], s49 offen lds
v_fma_f32 v245, v245, v78, v76
v_fma_f32 v244, v244, v78, v76
v_fma_f32 v243, v243, v78, v76
v_mfma_f32_16x16x32_bf16 v[128:131], v[88:91], v[112:115], v[128:131]
ds_read_b64_tr_b16 v[86:87], v3 offset:20992
v_fma_f32 v242, v242, v78, v76
v_fma_f32 v241, v241, v78, v76
v_fma_f32 v240, v240, v78, v76
v_fma_f32 v239, v239, v78, v76
s_waitcnt lgkmcnt(5)
v_mfma_f32_16x16x32_bf16 v[132:135], v[92:95], v[4:7], 0
ds_read_b64_tr_b16 v[88:89], v233 offset:24576
v_fma_f32 v238, v238, v78, v76
v_cvt_pk_bf16_f32 v16, v245, v244
v_cvt_pk_bf16_f32 v17, v243, v242
v_cvt_pk_bf16_f32 v18, v241, v240
v_mfma_f32_16x16x32_bf16 v[136:139], v[92:95], v[8:11], 0
ds_read_b64_tr_b16 v[90:91], v233 offset:25088
v_cvt_pk_bf16_f32 v19, v239, v238
ds_write_b128 v237, v[16:19] offset:49152
v_lshlrev_b32 v245, 16, v52
v_mfma_f32_16x16x32_bf16 v[140:143], v[96:99], v[4:7], 0
ds_read_b64_tr_b16 v[92:93], v3 offset:24576
v_and_b32 v244, s53, v52
v_lshlrev_b32 v243, 16, v53
v_and_b32 v242, s53, v53
v_lshlrev_b32 v241, 16, v54
v_mfma_f32_16x16x32_bf16 v[144:147], v[96:99], v[8:11], 0
ds_read_b64_tr_b16 v[94:95], v3 offset:25088
v_and_b32 v240, s53, v54
v_lshlrev_b32 v239, 16, v55
v_and_b32 v238, s53, v55
s_waitcnt lgkmcnt(5)
v_mfma_f32_16x16x32_bf16 v[132:135], v[80:83], v[40:43], v[132:135]
ds_read_b64_tr_b16 v[96:97], v233 offset:28672
v_fma_f32 v245, v245, v79, v77
v_fma_f32 v244, v244, v79, v77
v_fma_f32 v243, v243, v79, v77
v_fma_f32 v242, v242, v79, v77
v_mfma_f32_16x16x32_bf16 v[136:139], v[80:83], v[44:47], v[136:139]
ds_read_b64_tr_b16 v[98:99], v233 offset:29184
v_fma_f32 v241, v241, v79, v77
v_fma_f32 v240, v240, v79, v77
v_fma_f32 v239, v239, v79, v77
v_mfma_f32_16x16x32_bf16 v[140:143], v[84:87], v[40:43], v[140:143]
ds_read_b64_tr_b16 v[80:81], v3 offset:28672
v_fma_f32 v238, v238, v79, v77
v_cvt_pk_bf16_f32 v52, v245, v244
v_cvt_pk_bf16_f32 v53, v243, v242
v_cvt_pk_bf16_f32 v54, v241, v240
v_mfma_f32_16x16x32_bf16 v[144:147], v[84:87], v[44:47], v[144:147]
ds_read_b64_tr_b16 v[82:83], v3 offset:29184
v_cvt_pk_bf16_f32 v55, v239, v238
ds_write_b128 v237, v[52:55] offset:49280
s_waitcnt lgkmcnt(5)
v_mfma_f32_16x16x32_bf16 v[132:135], v[88:91], v[100:103], v[132:135]
ds_read_b64_tr_b16 v[84:85], v233 offset:32768
v_mfma_f32_16x16x32_bf16 v[136:139], v[88:91], v[104:107], v[136:139]
ds_read_b64_tr_b16 v[86:87], v233 offset:33280
v_mfma_f32_16x16x32_bf16 v[140:143], v[92:95], v[100:103], v[140:143]
ds_read_b64_tr_b16 v[88:89], v3 offset:32768
v_mfma_f32_16x16x32_bf16 v[144:147], v[92:95], v[104:107], v[144:147]
ds_read_b64_tr_b16 v[90:91], v3 offset:33280
s_lshl_b32 s50, s42, 4
s_add_u32 s50, s50, 0
v_add_u32 v253, s50, v1
v_lshrrev_b32 v255, 2, v253
v_mul_u32_u24 v254, 9216, v255
v_lshl_add_u32 v254, v249, 7, v254
s_mul_i32 s50, s40, 331776
s_add_u32 s50, s50, s46
s_add_u32 s50, s50, 256
v_cmp_gt_u32 vcc, 144, v253
s_nop 0
s_and_b64 vcc, vcc, 0xffff
v_mov_b32 v253, 1879048192
v_cndmask_b32 v254, v253, v254, vcc
buffer_load_dword v231, v254, s[16:19], s50 offen
s_waitcnt vmcnt(4)
s_waitcnt lgkmcnt(4)
s_barrier
s_setprio 3
ds_read_b128 v[12:15], v236 offset:32768
ds_read_b128 v[16:19], v236 offset:33792
ds_read_b128 v[48:51], v235 offset:40960
ds_read_b128 v[52:55], v235 offset:41984
ds_read_b128 v[148:151], v236 offset:49152
ds_read_b128 v[152:155], v236 offset:50176
ds_read_b128 v[156:159], v235 offset:57344
ds_read_b128 v[160:163], v235 offset:58368
v_mfma_f32_16x16x32_bf16 v[132:135], v[96:99], v[108:111], v[132:135]
ds_read_b64_tr_b16 v[92:93], v233 offset:36864
v_lshlrev_b32 v245, 16, v20
v_and_b32 v244, s53, v20
v_lshlrev_b32 v243, 16, v21
v_and_b32 v242, s53, v21
v_mfma_f32_16x16x32_bf16 v[136:139], v[96:99], v[112:115], v[136:139]
ds_read_b64_tr_b16 v[94:95], v233 offset:37376
v_lshlrev_b32 v241, 16, v22
v_and_b32 v240, s53, v22
v_lshlrev_b32 v239, 16, v23
v_and_b32 v238, s53, v23
v_mfma_f32_16x16x32_bf16 v[140:143], v[80:83], v[108:111], v[140:143]
ds_read_b64_tr_b16 v[96:97], v3 offset:36864
s_add_u32 m0, s48, 4096
s_add_u32 s49, s46, 3244160
buffer_load_dwordx4 v246, s[16:19], s49 offen lds
v_fma_f32 v245, v245, v78, v76
v_fma_f32 v244, v244, v78, v76
v_fma_f32 v243, v243, v78, v76
v_mfma_f32_16x16x32_bf16 v[144:147], v[80:83], v[112:115], v[144:147]
ds_read_b64_tr_b16 v[98:99], v3 offset:37376
v_fma_f32 v242, v242, v78, v76
v_fma_f32 v241, v241, v78, v76
v_fma_f32 v240, v240, v78, v76
v_fma_f32 v239, v239, v78, v76
s_waitcnt lgkmcnt(10)
v_mfma_f32_16x16x32_bf16 v[116:119], v[84:87], v[12:15], v[116:119]
ds_read_b64_tr_b16 v[80:81], v233 offset:40960
v_fma_f32 v238, v238, v78, v76
v_cvt_pk_bf16_f32 v20, v245, v244
v_cvt_pk_bf16_f32 v21, v243, v242
v_cvt_pk_bf16_f32 v22, v241, v240
v_mfma_f32_16x16x32_bf16 v[120:123], v[84:87], v[16:19], v[120:123]
ds_read_b64_tr_b16 v[82:83], v233 offset:41472
v_cvt_pk_bf16_f32 v23, v239, v238
ds_write_b128 v237, v[20:23] offset:0
v_lshlrev_b32 v245, 16, v56
v_mfma_f32_16x16x32_bf16 v[124:127], v[88:91], v[12:15], v[124:127]
ds_read_b64_tr_b16 v[84:85], v3 offset:40960
v_and_b32 v244, s53, v56
v_lshlrev_b32 v243, 16, v57
v_and_b32 v242, s53, v57
v_lshlrev_b32 v241, 16, v58
v_mfma_f32_16x16x32_bf16 v[128:131], v[88:91], v[16:19], v[128:131]
ds_read_b64_tr_b16 v[86:87], v3 offset:41472
v_and_b32 v240, s53, v58
v_lshlrev_b32 v239, 16, v59
v_and_b32 v238, s53, v59
s_setprio 2
s_waitcnt lgkmcnt(13)
s_waitcnt lgkmcnt(5)
v_mfma_f32_16x16x32_bf16 v[116:119], v[92:95], v[48:51], v[116:119]
ds_read_b64_tr_b16 v[88:89], v233 offset:45056
v_fma_f32 v245, v245, v79, v77
v_fma_f32 v244, v244, v79, v77
v_fma_f32 v243, v243, v79, v77
v_fma_f32 v242, v242, v79, v77
v_mfma_f32_16x16x32_bf16 v[120:123], v[92:95], v[52:55], v[120:123]
ds_read_b64_tr_b16 v[90:91], v233 offset:45568
v_fma_f32 v241, v241, v79, v77
v_fma_f32 v240, v240, v79, v77
v_fma_f32 v239, v239, v79, v77
v_mfma_f32_16x16x32_bf16 v[124:127], v[96:99], v[48:51], v[124:127]
ds_read_b64_tr_b16 v[92:93], v3 offset:45056
s_add_u32 m0, s48, 12288
s_add_u32 s49, s46, 3833856
buffer_load_dwordx4 v246, s[16:19], s49 offen lds
v_fma_f32 v238, v238, v79, v77
v_cvt_pk_bf16_f32 v56, v245, v244
v_cvt_pk_bf16_f32 v57, v243, v242
v_mfma_f32_16x16x32_bf16 v[128:131], v[96:99], v[52:55], v[128:131]
ds_read_b64_tr_b16 v[94:95], v3 offset:45568
v_cvt_pk_bf16_f32 v58, v241, v240
v_cvt_pk_bf16_f32 v59, v239, v238
ds_write_b128 v237, v[56:59] offset:128
v_lshlrev_b32 v245, 16, v24
s_waitcnt lgkmcnt(5)
v_mfma_f32_16x16x32_bf16 v[116:119], v[80:83], v[148:151], v[116:119]
ds_read_b64_tr_b16 v[96:97], v233 offset:49152
v_and_b32 v244, s53, v24
v_lshlrev_b32 v243, 16, v25
v_and_b32 v242, s53, v25
v_lshlrev_b32 v241, 16, v26
v_mfma_f32_16x16x32_bf16 v[120:123], v[80:83], v[152:155], v[120:123]
ds_read_b64_tr_b16 v[98:99], v233 offset:49664
v_and_b32 v240, s53, v26
v_lshlrev_b32 v239, 16, v27
v_and_b32 v238, s53, v27
s_setprio 1
v_mfma_f32_16x16x32_bf16 v[124:127], v[84:87], v[148:151], v[124:127]
ds_read_b64_tr_b16 v[80:81], v3 offset:49152
v_fma_f32 v245, v245, v78, v76
v_fma_f32 v244, v244, v78, v76
v_fma_f32 v243, v243, v78, v76
v_fma_f32 v242, v242, v78, v76
v_mfma_f32_16x16x32_bf16 v[128:131], v[84:87], v[152:155], v[128:131]
ds_read_b64_tr_b16 v[82:83], v3 offset:49664
v_fma_f32 v241, v241, v78, v76
v_fma_f32 v240, v240, v78, v76
v_fma_f32 v239, v239, v78, v76
s_waitcnt lgkmcnt(5)
v_mfma_f32_16x16x32_bf16 v[116:119], v[88:91], v[156:159], v[116:119]
ds_read_b64_tr_b16 v[84:85], v233 offset:53248
v_fma_f32 v238, v238, v78, v76
v_cvt_pk_bf16_f32 v24, v245, v244
v_cvt_pk_bf16_f32 v25, v243, v242
v_cvt_pk_bf16_f32 v26, v241, v240
v_mfma_f32_16x16x32_bf16 v[120:123], v[88:91], v[160:163], v[120:123]
ds_read_b64_tr_b16 v[86:87], v233 offset:53760
v_cvt_pk_bf16_f32 v27, v239, v238
ds_write_b128 v237, v[24:27] offset:16384
v_lshlrev_b32 v245, 16, v60
v_mfma_f32_16x16x32_bf16 v[124:127], v[92:95], v[156:159], v[124:127]
ds_read_b64_tr_b16 v[88:89], v3 offset:53248
s_add_u32 m0, s48, 20480
s_add_u32 s49, s46, 4423680
buffer_load_dwordx4 v246, s[16:19], s49 offen lds
v_and_b32 v244, s53, v60
v_lshlrev_b32 v243, 16, v61
v_and_b32 v242, s53, v61
v_mfma_f32_16x16x32_bf16 v[128:131], v[92:95], v[160:163], v[128:131]
ds_read_b64_tr_b16 v[90:91], v3 offset:53760
v_lshlrev_b32 v241, 16, v62
v_and_b32 v240, s53, v62
v_lshlrev_b32 v239, 16, v63
v_and_b32 v238, s53, v63
s_waitcnt lgkmcnt(5)
v_mfma_f32_16x16x32_bf16 v[132:135], v[96:99], v[12:15], v[132:135]
ds_read_b64_tr_b16 v[92:93], v233 offset:57344
v_fma_f32 v245, v245, v79, v77
v_fma_f32 v244, v244, v79, v77
v_fma_f32 v243, v243, v79, v77
v_fma_f32 v242, v242, v79, v77
v_mfma_f32_16x16x32_bf16 v[136:139], v[96:99], v[16:19], v[136:139]
ds_read_b64_tr_b16 v[94:95], v233 offset:57856
v_fma_f32 v241, v241, v79, v77
v_fma_f32 v240, v240, v79, v77
v_fma_f32 v239, v239, v79, v77
s_setprio 0
v_mfma_f32_16x16x32_bf16 v[140:143], v[80:83], v[12:15], v[140:143]
ds_read_b64_tr_b16 v[96:97], v3 offset:57344
v_fma_f32 v238, v238, v79, v77
v_cvt_pk_bf16_f32 v60, v245, v244
v_cvt_pk_bf16_f32 v61, v243, v242
v_cvt_pk_bf16_f32 v62, v241, v240
v_mfma_f32_16x16x32_bf16 v[144:147], v[80:83], v[16:19], v[144:147]
ds_read_b64_tr_b16 v[98:99], v3 offset:57856
v_cvt_pk_bf16_f32 v63, v239, v238
ds_write_b128 v237, v[60:63] offset:16512
s_waitcnt lgkmcnt(5)
v_mfma_f32_16x16x32_bf16 v[132:135], v[84:87], v[48:51], v[132:135]
ds_read_b64_tr_b16 v[80:81], v233 offset:61440
v_mfma_f32_16x16x32_bf16 v[136:139], v[84:87], v[52:55], v[136:139]
ds_read_b64_tr_b16 v[82:83], v233 offset:61952
v_mfma_f32_16x16x32_bf16 v[140:143], v[88:91], v[48:51], v[140:143]
ds_read_b64_tr_b16 v[84:85], v3 offset:61440
v_mfma_f32_16x16x32_bf16 v[144:147], v[88:91], v[52:55], v[144:147]
ds_read_b64_tr_b16 v[86:87], v3 offset:61952
s_waitcnt vmcnt(4)
s_waitcnt lgkmcnt(4)
s_barrier
s_setprio 3
ds_read_b128 v[20:23], v236 offset:0
ds_read_b128 v[24:27], v236 offset:1024
ds_read_b128 v[56:59], v235 offset:8192
ds_read_b128 v[60:63], v235 offset:9216
ds_read_b128 v[164:167], v236 offset:16384
ds_read_b128 v[168:171], v236 offset:17408
ds_read_b128 v[172:175], v235 offset:24576
ds_read_b128 v[176:179], v235 offset:25600
v_mfma_f32_16x16x32_bf16 v[132:135], v[92:95], v[148:151], v[132:135]
ds_read_b64_tr_b16 v[88:89], v232 offset:0
v_lshlrev_b32 v245, 16, v28
v_and_b32 v244, s53, v28
v_lshlrev_b32 v243, 16, v29
v_and_b32 v242, s53, v29
v_mfma_f32_16x16x32_bf16 v[136:139], v[92:95], v[152:155], v[136:139]
ds_read_b64_tr_b16 v[90:91], v232 offset:512
v_lshlrev_b32 v241, 16, v30
v_and_b32 v240, s53, v30
v_lshlrev_b32 v239, 16, v31
v_and_b32 v238, s53, v31
v_mfma_f32_16x16x32_bf16 v[140:143], v[96:99], v[148:151], v[140:143]
ds_read_b64_tr_b16 v[92:93], v2 offset:0
s_add_u32 m0, s48, 28672
s_add_u32 s49, s46, 4718592
buffer_load_dwordx4 v246, s[16:19], s49 offen lds
v_fma_f32 v245, v245, v78, v76
v_fma_f32 v244, v244, v78, v76
v_fma_f32 v243, v243, v78, v76
v_mfma_f32_16x16x32_bf16 v[144:147], v[96:99], v[152:155], v[144:147]
ds_read_b64_tr_b16 v[94:95], v2 offset:512
v_fma_f32 v242, v242, v78, v76
v_fma_f32 v241, v241, v78, v76
v_fma_f32 v240, v240, v78, v76
v_fma_f32 v239, v239, v78, v76
s_waitcnt lgkmcnt(12)
v_mfma_f32_16x16x32_bf16 v[132:135], v[80:83], v[156:159], v[132:135]
ds_read_b64_tr_b16 v[96:97], v232 offset:4096
v_fma_f32 v238, v238, v78, v76
v_cvt_pk_bf16_f32 v28, v245, v244
v_cvt_pk_bf16_f32 v29, v243, v242
v_cvt_pk_bf16_f32 v30, v241, v240
v_mfma_f32_16x16x32_bf16 v[136:139], v[80:83], v[160:163], v[136:139]
ds_read_b64_tr_b16 v[98:99], v232 offset:4608
v_cvt_pk_bf16_f32 v31, v239, v238
ds_write_b128 v237, v[28:31] offset:32768
v_lshlrev_b32 v245, 16, v64
v_mfma_f32_16x16x32_bf16 v[140:143], v[84:87], v[156:159], v[140:143]
ds_read_b64_tr_b16 v[80:81], v2 offset:4096
v_and_b32 v244, s53, v64
v_lshlrev_b32 v243, 16, v65
v_and_b32 v242, s53, v65
v_lshlrev_b32 v241, 16, v66
v_mfma_f32_16x16x32_bf16 v[144:147], v[84:87], v[160:163], v[144:147]
ds_read_b64_tr_b16 v[82:83], v2 offset:4608
v_and_b32 v240, s53, v66
v_lshlrev_b32 v239, 16, v67
v_and_b32 v238, s53, v67
s_setprio 2
s_waitcnt lgkmcnt(15)
s_waitcnt lgkmcnt(5)
v_mfma_f32_16x16x32_bf16 v[116:119], v[88:91], v[20:23], v[116:119]
ds_read_b64_tr_b16 v[84:85], v232 offset:8192
s_add_u32 m0, s48, 36864
s_add_u32 s49, s46, 3833984
buffer_load_dwordx4 v246, s[16:19], s49 offen lds
v_fma_f32 v245, v245, v79, v77
v_fma_f32 v244, v244, v79, v77
v_fma_f32 v243, v243, v79, v77
v_mfma_f32_16x16x32_bf16 v[120:123], v[88:91], v[24:27], v[120:123]
ds_read_b64_tr_b16 v[86:87], v232 offset:8704
v_fma_f32 v242, v242, v79, v77
v_fma_f32 v241, v241, v79, v77
v_fma_f32 v240, v240, v79, v77
v_fma_f32 v239, v239, v79, v77
v_mfma_f32_16x16x32_bf16 v[124:127], v[92:95], v[20:23], v[124:127]
ds_read_b64_tr_b16 v[88:89], v2 offset:8192
v_fma_f32 v238, v238, v79, v77
v_cvt_pk_bf16_f32 v64, v245, v244
v_cvt_pk_bf16_f32 v65, v243, v242
v_cvt_pk_bf16_f32 v66, v241, v240
v_mfma_f32_16x16x32_bf16 v[128:131], v[92:95], v[24:27], v[128:131]
ds_read_b64_tr_b16 v[90:91], v2 offset:8704
v_cvt_pk_bf16_f32 v67, v239, v238
ds_write_b128 v237, v[64:67] offset:32896
v_lshlrev_b32 v245, 16, v32
s_waitcnt lgkmcnt(5)
v_mfma_f32_16x16x32_bf16 v[116:119], v[96:99], v[56:59], v[116:119]
ds_read_b64_tr_b16 v[92:93], v232 offset:12288
v_and_b32 v244, s53, v32
v_lshlrev_b32 v243, 16, v33
v_and_b32 v242, s53, v33
v_lshlrev_b32 v241, 16, v34
v_mfma_f32_16x16x32_bf16 v[120:123], v[96:99], v[60:63], v[120:123]
ds_read_b64_tr_b16 v[94:95], v232 offset:12800
v_and_b32 v240, s53, v34
v_lshlrev_b32 v239, 16, v35
v_and_b32 v238, s53, v35
s_setprio 1
v_mfma_f32_16x16x32_bf16 v[124:127], v[80:83], v[56:59], v[124:127]
ds_read_b64_tr_b16 v[96:97], v2 offset:12288
s_add_u32 m0, s48, 45056
s_add_u32 s49, s46, 4423808
buffer_load_dwordx4 v246, s[16:19], s49 offen lds
v_fma_f32 v245, v245, v78, v76
v_fma_f32 v244, v244, v78, v76
v_fma_f32 v243, v243, v78, v76
v_mfma_f32_16x16x32_bf16 v[128:131], v[80:83], v[60:63], v[128:131]
ds_read_b64_tr_b16 v[98:99], v2 offset:12800
v_fma_f32 v242, v242, v78, v76
v_fma_f32 v241, v241, v78, v76
v_fma_f32 v240, v240, v78, v76
v_fma_f32 v239, v239, v78, v76
s_waitcnt lgkmcnt(5)
v_mfma_f32_16x16x32_bf16 v[116:119], v[84:87], v[164:167], v[116:119]
ds_read_b64_tr_b16 v[80:81], v232 offset:16384
v_fma_f32 v238, v238, v78, v76
v_cvt_pk_bf16_f32 v32, v245, v244
v_cvt_pk_bf16_f32 v33, v243, v242
v_cvt_pk_bf16_f32 v34, v241, v240
v_mfma_f32_16x16x32_bf16 v[120:123], v[84:87], v[168:171], v[120:123]
ds_read_b64_tr_b16 v[82:83], v232 offset:16896
v_cvt_pk_bf16_f32 v35, v239, v238
ds_write_b128 v237, v[32:35] offset:49152
v_lshlrev_b32 v245, 16, v68
v_mfma_f32_16x16x32_bf16 v[124:127], v[88:91], v[164:167], v[124:127]
ds_read_b64_tr_b16 v[84:85], v2 offset:16384
v_and_b32 v244, s53, v68
v_lshlrev_b32 v243, 16, v69
v_and_b32 v242, s53, v69
v_lshlrev_b32 v241, 16, v70
v_mfma_f32_16x16x32_bf16 v[128:131], v[88:91], v[168:171], v[128:131]
ds_read_b64_tr_b16 v[86:87], v2 offset:16896
v_and_b32 v240, s53, v70
v_lshlrev_b32 v239, 16, v71
v_and_b32 v238, s53, v71
s_waitcnt lgkmcnt(5)
v_mfma_f32_16x16x32_bf16 v[116:119], v[92:95], v[172:175], v[116:119]
ds_read_b64_tr_b16 v[88:89], v232 offset:20480
s_add_u32 m0, s48, 53248
s_add_u32 s49, s46, 5013632
buffer_load_dwordx4 v246, s[16:19], s49 offen lds
v_fma_f32 v245, v245, v79, v77
v_fma_f32 v244, v244, v79, v77
v_fma_f32 v243, v243, v79, v77
v_mfma_f32_16x16x32_bf16 v[120:123], v[92:95], v[176:179], v[120:123]
ds_read_b64_tr_b16 v[90:91], v232 offset:20992
v_fma_f32 v242, v242, v79, v77
v_fma_f32 v241, v241, v79, v77
v_fma_f32 v240, v240, v79, v77
v_fma_f32 v239, v239, v79, v77
s_setprio 0
v_mfma_f32_16x16x32_bf16 v[124:127], v[96:99], v[172:175], v[124:127]
ds_read_b64_tr_b16 v[92:93], v2 offset:20480
v_fma_f32 v238, v238, v79, v77
v_cvt_pk_bf16_f32 v68, v245, v244
v_cvt_pk_bf16_f32 v69, v243, v242
v_cvt_pk_bf16_f32 v70, v241, v240
v_mfma_f32_16x16x32_bf16 v[128:131], v[96:99], v[176:179], v[128:131]
ds_read_b64_tr_b16 v[94:95], v2 offset:20992
v_cvt_pk_bf16_f32 v71, v239, v238
ds_write_b128 v237, v[68:71] offset:49280
s_waitcnt lgkmcnt(5)
v_mfma_f32_16x16x32_bf16 v[132:135], v[80:83], v[20:23], v[132:135]
ds_read_b64_tr_b16 v[96:97], v233 offset:0
v_mfma_f32_16x16x32_bf16 v[136:139], v[80:83], v[24:27], v[136:139]
ds_read_b64_tr_b16 v[98:99], v233 offset:512
v_mfma_f32_16x16x32_bf16 v[140:143], v[84:87], v[20:23], v[140:143]
ds_read_b64_tr_b16 v[80:81], v3 offset:0
v_mfma_f32_16x16x32_bf16 v[144:147], v[84:87], v[24:27], v[144:147]
ds_read_b64_tr_b16 v[82:83], v3 offset:512
s_lshl_b32 s50, s42, 4
s_add_u32 s50, s50, 128
v_add_u32 v253, s50, v1
v_lshrrev_b32 v255, 2, v253
v_mul_u32_u24 v254, 9216, v255
v_lshl_add_u32 v254, v249, 7, v254
s_mul_i32 s50, s40, 331776
s_add_u32 s50, s50, s46
s_add_u32 s50, s50, 256
v_cmp_gt_u32 vcc, 144, v253
s_nop 0
s_and_b64 vcc, vcc, 0xffff
v_mov_b32 v253, 1879048192
v_cndmask_b32 v254, v253, v254, vcc
buffer_load_dword v231, v254, s[16:19], s50 offen
s_waitcnt vmcnt(4)
s_waitcnt lgkmcnt(4)
s_barrier
s_setprio 3
ds_read_b128 v[28:31], v236 offset:32768
ds_read_b128 v[32:35], v236 offset:33792
ds_read_b128 v[64:67], v235 offset:40960
ds_read_b128 v[68:71], v235 offset:41984
ds_read_b128 v[180:183], v236 offset:49152
ds_read_b128 v[184:187], v236 offset:50176
ds_read_b128 v[188:191], v235 offset:57344
ds_read_b128 v[192:195], v235 offset:58368
v_mfma_f32_16x16x32_bf16 v[132:135], v[88:91], v[56:59], v[132:135]
ds_read_b64_tr_b16 v[84:85], v233 offset:4096
v_lshlrev_b32 v245, 16, v36
v_and_b32 v244, s53, v36
v_mfma_f32_16x16x32_bf16 v[136:139], v[88:91], v[60:63], v[136:139]
ds_read_b64_tr_b16 v[86:87], v233 offset:4608
v_lshlrev_b32 v243, 16, v37
v_and_b32 v242, s53, v37
v_mfma_f32_16x16x32_bf16 v[140:143], v[92:95], v[56:59], v[140:143]
ds_read_b64_tr_b16 v[88:89], v3 offset:4096
s_add_u32 m0, s48, 61440
s_add_u32 s49, s46, 295168
buffer_load_dwordx4 v246, s[16:19], s49 offen lds
v_lshlrev_b32 v241, 16, v38
v_and_b32 v240, s53, v38
v_mfma_f32_16x16x32_bf16 v[144:147], v[92:95], v[60:63], v[144:147]
ds_read_b64_tr_b16 v[90:91], v3 offset:4608
v_lshlrev_b32 v239, 16, v39
v_and_b32 v238, s53, v39
s_waitcnt lgkmcnt(12)
v_mfma_f32_16x16x32_bf16 v[132:135], v[96:99], v[164:167], v[132:135]
ds_read_b64_tr_b16 v[92:93], v233 offset:8192
v_fma_f32 v245, v245, v78, v76
v_fma_f32 v244, v244, v78, v76
v_mfma_f32_16x16x32_bf16 v[136:139], v[96:99], v[168:171], v[136:139]
ds_read_b64_tr_b16 v[94:95], v233 offset:8704
v_fma_f32 v243, v243, v78, v76
v_mfma_f32_16x16x32_bf16 v[140:143], v[80:83], v[164:167], v[140:143]
ds_read_b64_tr_b16 v[96:97], v3 offset:8192
s_add_u32 m0, s48, 69632
s_add_u32 s49, s46, 884992
buffer_load_dwordx4 v246, s[16:19], s49 offen lds
v_fma_f32 v242, v242, v78, v76
v_fma_f32 v241, v241, v78, v76
v_mfma_f32_16x16x32_bf16 v[144:147], v[80:83], v[168:171], v[144:147]
ds_read_b64_tr_b16 v[98:99], v3 offset:8704
v_fma_f32 v240, v240, v78, v76
v_fma_f32 v239, v239, v78, v76
s_setprio 2
s_waitcnt lgkmcnt(4)
v_mfma_f32_16x16x32_bf16 v[132:135], v[84:87], v[172:175], v[132:135]
ds_read_b64_tr_b16 v[80:81], v233 offset:12288
v_fma_f32 v238, v238, v78, v76
v_cvt_pk_bf16_f32 v36, v245, v244
v_mfma_f32_16x16x32_bf16 v[136:139], v[84:87], v[176:179], v[136:139]
ds_read_b64_tr_b16 v[82:83], v233 offset:12800
v_cvt_pk_bf16_f32 v37, v243, v242
v_mfma_f32_16x16x32_bf16 v[140:143], v[88:91], v[172:175], v[140:143]
ds_read_b64_tr_b16 v[84:85], v3 offset:12288
s_add_u32 m0, s48, 77824
s_add_u32 s49, s46, 1474816
buffer_load_dwordx4 v246, s[16:19], s49 offen lds
v_cvt_pk_bf16_f32 v38, v241, v240
v_cvt_pk_bf16_f32 v39, v239, v238
v_mfma_f32_16x16x32_bf16 v[144:147], v[88:91], v[176:179], v[144:147]
ds_read_b64_tr_b16 v[86:87], v3 offset:12800
ds_write_b128 v237, v[36:39] offset:0
v_lshlrev_b32 v245, 16, v72
s_waitcnt lgkmcnt(5)
v_mfma_f32_16x16x32_bf16 v[116:119], v[92:95], v[28:31], v[116:119]
ds_read_b64_tr_b16 v[88:89], v233 offset:16384
v_and_b32 v244, s53, v72
v_lshlrev_b32 v243, 16, v73
v_mfma_f32_16x16x32_bf16 v[120:123], v[92:95], v[32:35], v[120:123]
ds_read_b64_tr_b16 v[90:91], v233 offset:16896
v_and_b32 v242, s53, v73
s_setprio 1
v_mfma_f32_16x16x32_bf16 v[124:127], v[96:99], v[28:31], v[124:127]
ds_read_b64_tr_b16 v[92:93], v3 offset:16384
s_add_u32 m0, s48, 106496
s_add_u32 s49, s46, 2064640
buffer_load_dwordx4 v246, s[16:19], s49 offen lds
v_lshlrev_b32 v241, 16, v74
v_and_b32 v240, s53, v74
v_mfma_f32_16x16x32_bf16 v[128:131], v[96:99], v[32:35], v[128:131]
ds_read_b64_tr_b16 v[94:95], v3 offset:16896
v_lshlrev_b32 v239, 16, v75
v_and_b32 v238, s53, v75
s_waitcnt lgkmcnt(5)
v_mfma_f32_16x16x32_bf16 v[116:119], v[80:83], v[64:67], v[116:119]
ds_read_b64_tr_b16 v[96:97], v233 offset:20480
v_fma_f32 v245, v245, v79, v77
v_fma_f32 v244, v244, v79, v77
v_mfma_f32_16x16x32_bf16 v[120:123], v[80:83], v[68:71], v[120:123]
ds_read_b64_tr_b16 v[98:99], v233 offset:20992
v_fma_f32 v243, v243, v79, v77
v_fma_f32 v242, v242, v79, v77
v_mfma_f32_16x16x32_bf16 v[124:127], v[84:87], v[64:67], v[124:127]
ds_read_b64_tr_b16 v[80:81], v3 offset:20480
s_add_u32 m0, s48, 114688
s_add_u32 s49, s46, 2654464
buffer_load_dwordx4 v246, s[16:19], s49 offen lds
v_fma_f32 v241, v241, v79, v77
v_mfma_f32_16x16x32_bf16 v[128:131], v[84:87], v[68:71], v[128:131]
ds_read_b64_tr_b16 v[82:83], v3 offset:20992
v_fma_f32 v240, v240, v79, v77
v_fma_f32 v239, v239, v79, v77
s_waitcnt lgkmcnt(4)
v_mfma_f32_16x16x32_bf16 v[116:119], v[88:91], v[180:183], v[116:119]
ds_read_b64_tr_b16 v[84:85], v233 offset:24576
v_fma_f32 v238, v238, v79, v77
v_cvt_pk_bf16_f32 v72, v245, v244
v_mfma_f32_16x16x32_bf16 v[120:123], v[88:91], v[184:187], v[120:123]
ds_read_b64_tr_b16 v[86:87], v233 offset:25088
v_cvt_pk_bf16_f32 v73, v243, v242
v_cvt_pk_bf16_f32 v74, v241, v240
s_setprio 0
v_mfma_f32_16x16x32_bf16 v[124:127], v[92:95], v[180:183], v[124:127]
ds_read_b64_tr_b16 v[88:89], v3 offset:24576
v_cvt_pk_bf16_f32 v75, v239, v238
ds_write_b128 v237, v[72:75] offset:128
v_mfma_f32_16x16x32_bf16 v[128:131], v[92:95], v[184:187], v[128:131]
ds_read_b64_tr_b16 v[90:91], v3 offset:25088
s_waitcnt lgkmcnt(5)
v_mfma_f32_16x16x32_bf16 v[116:119], v[96:99], v[188:191], v[116:119]
ds_read_b64_tr_b16 v[92:93], v233 offset:28672
v_mfma_f32_16x16x32_bf16 v[120:123], v[96:99], v[192:195], v[120:123]
ds_read_b64_tr_b16 v[94:95], v233 offset:29184
v_mfma_f32_16x16x32_bf16 v[124:127], v[80:83], v[188:191], v[124:127]
ds_read_b64_tr_b16 v[96:97], v3 offset:28672
v_mfma_f32_16x16x32_bf16 v[128:131], v[80:83], v[192:195], v[128:131]
ds_read_b64_tr_b16 v[98:99], v3 offset:29184
s_waitcnt vmcnt(4)
s_waitcnt lgkmcnt(5)
s_barrier
s_setprio 3
ds_read_b128 v[36:39], v236 offset:0
ds_read_b128 v[72:75], v236 offset:1024
ds_read_b128 v[76:79], v235 offset:8192
ds_read_b128 v[196:199], v235 offset:9216
v_mfma_f32_16x16x32_bf16 v[132:135], v[84:87], v[28:31], v[132:135]
ds_read_b64_tr_b16 v[80:81], v233 offset:32768
v_mfma_f32_16x16x32_bf16 v[136:139], v[84:87], v[32:35], v[136:139]
ds_read_b64_tr_b16 v[82:83], v233 offset:33280
s_waitcnt lgkmcnt(10)
v_mfma_f32_16x16x32_bf16 v[140:143], v[88:91], v[28:31], v[140:143]
ds_read_b64_tr_b16 v[84:85], v3 offset:32768
s_add_u32 m0, s48, 0
s_add_u32 s49, s46, 3244288
buffer_load_dwordx4 v246, s[16:19], s49 offen lds
v_mfma_f32_16x16x32_bf16 v[144:147], v[88:91], v[32:35], v[144:147]
ds_read_b64_tr_b16 v[86:87], v3 offset:33280
s_waitcnt lgkmcnt(6)
v_mfma_f32_16x16x32_bf16 v[116:119], v[92:95], v[36:39], v[116:119]
ds_read_b64_tr_b16 v[88:89], v233 offset:36864
v_mfma_f32_16x16x32_bf16 v[120:123], v[92:95], v[72:75], v[120:123]
ds_read_b64_tr_b16 v[90:91], v233 offset:37376
v_mfma_f32_16x16x32_bf16 v[124:127], v[96:99], v[36:39], v[124:127]
ds_read_b64_tr_b16 v[92:93], v3 offset:36864
v_mfma_f32_16x16x32_bf16 v[128:131], v[96:99], v[72:75], v[128:131]
ds_read_b64_tr_b16 v[94:95], v3 offset:37376
s_setprio 2
s_waitcnt lgkmcnt(8)
s_waitcnt lgkmcnt(4)
v_mfma_f32_16x16x32_bf16 v[116:119], v[80:83], v[76:79], v[116:119]
ds_read_b64_tr_b16 v[96:97], v233 offset:40960
s_add_u32 m0, s48, 8192
s_add_u32 s49, s46, 3834112
buffer_load_dwordx4 v246, s[16:19], s49 offen lds
v_mfma_f32_16x16x32_bf16 v[120:123], v[80:83], v[196:199], v[120:123]
ds_read_b64_tr_b16 v[98:99], v233 offset:41472
v_mfma_f32_16x16x32_bf16 v[124:127], v[84:87], v[76:79], v[124:127]
ds_read_b64_tr_b16 v[80:81], v3 offset:40960
v_mfma_f32_16x16x32_bf16 v[128:131], v[84:87], v[196:199], v[128:131]
ds_read_b64_tr_b16 v[82:83], v3 offset:41472
s_waitcnt lgkmcnt(4)
v_mfma_f32_16x16x32_bf16 v[132:135], v[88:91], v[64:67], v[132:135]
ds_read_b64_tr_b16 v[84:85], v233 offset:45056
v_mfma_f32_16x16x32_bf16 v[136:139], v[88:91], v[68:71], v[136:139]
ds_read_b64_tr_b16 v[86:87], v233 offset:45568
v_mfma_f32_16x16x32_bf16 v[140:143], v[92:95], v[64:67], v[140:143]
ds_read_b64_tr_b16 v[88:89], v3 offset:45056
s_add_u32 m0, s48, 16384
s_add_u32 s49, s46, 4423936
buffer_load_dwordx4 v246, s[16:19], s49 offen lds
v_mfma_f32_16x16x32_bf16 v[144:147], v[92:95], v[68:71], v[144:147]
ds_read_b64_tr_b16 v[90:91], v3 offset:45568
s_setprio 1
s_waitcnt lgkmcnt(4)
v_mfma_f32_16x16x32_bf16 v[132:135], v[96:99], v[180:183], v[132:135]
ds_read_b64_tr_b16 v[92:93], v233 offset:49152
v_exp_f32 v235, -v116
v_exp_f32 v245, -v117
v_mfma_f32_16x16x32_bf16 v[136:139], v[96:99], v[184:187], v[136:139]
ds_read_b64_tr_b16 v[94:95], v233 offset:49664
v_exp_f32 v244, -v118
v_exp_f32 v230, -v119
v_mfma_f32_16x16x32_bf16 v[140:143], v[80:83], v[180:183], v[140:143]
ds_read_b64_tr_b16 v[96:97], v3 offset:49152
v_add_f32 v235, 1.0, v235
v_add_f32 v245, 1.0, v245
v_mfma_f32_16x16x32_bf16 v[144:147], v[80:83], v[184:187], v[144:147]
ds_read_b64_tr_b16 v[98:99], v3 offset:49664
v_add_f32 v244, 1.0, v244
v_add_f32 v230, 1.0, v230
s_waitcnt lgkmcnt(4)
v_mfma_f32_16x16x32_bf16 v[132:135], v[84:87], v[188:191], v[132:135]
ds_read_b64_tr_b16 v[80:81], v233 offset:53248
s_add_u32 m0, s48, 86016
s_add_u32 s49, s46, 5013760
buffer_load_dwordx4 v246, s[16:19], s49 offen lds
v_rcp_f32 v235, v235
v_rcp_f32 v245, v245
v_mfma_f32_16x16x32_bf16 v[136:139], v[84:87], v[192:195], v[136:139]
ds_read_b64_tr_b16 v[82:83], v233 offset:53760
v_rcp_f32 v244, v244
v_rcp_f32 v230, v230
v_mul_f32 v116, v116, v235
v_mfma_f32_16x16x32_bf16 v[140:143], v[88:91], v[188:191], v[140:143]
ds_read_b64_tr_b16 v[84:85], v3 offset:53248
v_mul_f32 v117, v117, v245
v_mul_f32 v118, v118, v244
v_mfma_f32_16x16x32_bf16 v[144:147], v[88:91], v[192:195], v[144:147]
ds_read_b64_tr_b16 v[86:87], v3 offset:53760
v_mul_f32 v119, v119, v230
v_exp_f32 v235, -v124
s_setprio 0
s_waitcnt lgkmcnt(4)
v_mfma_f32_16x16x32_bf16 v[132:135], v[92:95], v[36:39], v[132:135]
ds_read_b64_tr_b16 v[88:89], v233 offset:57344
v_exp_f32 v245, -v125
v_exp_f32 v244, -v126
v_exp_f32 v230, -v127
v_mfma_f32_16x16x32_bf16 v[136:139], v[92:95], v[72:75], v[136:139]
ds_read_b64_tr_b16 v[90:91], v233 offset:57856
v_add_f32 v235, 1.0, v235
v_add_f32 v245, 1.0, v245
v_mfma_f32_16x16x32_bf16 v[140:143], v[96:99], v[36:39], v[140:143]
ds_read_b64_tr_b16 v[92:93], v3 offset:57344
v_add_f32 v244, 1.0, v244
v_add_f32 v230, 1.0, v230
v_mfma_f32_16x16x32_bf16 v[144:147], v[96:99], v[72:75], v[144:147]
ds_read_b64_tr_b16 v[94:95], v3 offset:57856
v_rcp_f32 v235, v235
v_rcp_f32 v245, v245
s_waitcnt lgkmcnt(4)
v_mfma_f32_16x16x32_bf16 v[132:135], v[80:83], v[76:79], v[132:135]
ds_read_b64_tr_b16 v[96:97], v233 offset:61440
v_rcp_f32 v244, v244
v_rcp_f32 v230, v230
v_mul_f32 v124, v124, v235
v_mfma_f32_16x16x32_bf16 v[136:139], v[80:83], v[196:199], v[136:139]
ds_read_b64_tr_b16 v[98:99], v233 offset:61952
v_mul_f32 v125, v125, v245
v_mul_f32 v126, v126, v244
v_mfma_f32_16x16x32_bf16 v[140:143], v[84:87], v[76:79], v[140:143]
ds_read_b64_tr_b16 v[80:81], v3 offset:61440
v_mul_f32 v127, v127, v230
v_cvt_pk_bf16_f32 v116, v116, v117
v_mfma_f32_16x16x32_bf16 v[144:147], v[84:87], v[196:199], v[144:147]
ds_read_b64_tr_b16 v[82:83], v3 offset:61952
v_cvt_pk_bf16_f32 v117, v118, v119
v_cvt_pk_bf16_f32 v118, v124, v125
s_waitcnt vmcnt(4)
s_barrier
s_setprio 3
v_mov_b32 v255, 0
buffer_load_dwordx2 v[228:229], v255, s[36:39], 0 offen sc1
s_waitcnt lgkmcnt(4)
v_mfma_f32_16x16x32_bf16 v[200:203], v[88:91], v[4:7], 0
ds_read_b64_tr_b16 v[84:85], v232 offset:0
v_cvt_pk_bf16_f32 v119, v126, v127
v_mfma_f32_16x16x32_bf16 v[204:207], v[88:91], v[8:11], 0
ds_read_b64_tr_b16 v[86:87], v232 offset:512
v_exp_f32 v235, -v120
v_exp_f32 v245, -v121
v_mfma_f32_16x16x32_bf16 v[208:211], v[92:95], v[4:7], 0
ds_read_b64_tr_b16 v[88:89], v2 offset:0
s_add_u32 m0, s48, 28672
s_add_u32 s49, s46, 295296
buffer_load_dwordx4 v246, s[16:19], s49 offen lds
v_exp_f32 v244, -v122
v_mfma_f32_16x16x32_bf16 v[212:215], v[92:95], v[8:11], 0
ds_read_b64_tr_b16 v[90:91], v2 offset:512
v_exp_f32 v230, -v123
v_add_f32 v235, 1.0, v235
s_waitcnt lgkmcnt(4)
v_mfma_f32_16x16x32_bf16 v[200:203], v[96:99], v[40:43], v[200:203]
ds_read_b64_tr_b16 v[92:93], v232 offset:4096
v_add_f32 v245, 1.0, v245
v_add_f32 v244, 1.0, v244
v_mfma_f32_16x16x32_bf16 v[204:207], v[96:99], v[44:47], v[204:207]
ds_read_b64_tr_b16 v[94:95], v232 offset:4608
v_add_f32 v230, 1.0, v230
v_rcp_f32 v235, v235
v_mfma_f32_16x16x32_bf16 v[208:211], v[80:83], v[40:43], v[208:211]
ds_read_b64_tr_b16 v[96:97], v2 offset:4096
s_add_u32 m0, s48, 36864
s_add_u32 s49, s46, 885120
buffer_load_dwordx4 v246, s[16:19], s49 offen lds
v_rcp_f32 v245, v245
v_mfma_f32_16x16x32_bf16 v[212:215], v[80:83], v[44:47], v[212:215]
ds_read_b64_tr_b16 v[98:99], v2 offset:4608
v_rcp_f32 v244, v244
v_rcp_f32 v230, v230
s_waitcnt lgkmcnt(4)
v_mfma_f32_16x16x32_bf16 v[200:203], v[84:87], v[100:103], v[200:203]
ds_read_b64_tr_b16 v[80:81], v232 offset:8192
v_mul_f32 v120, v120, v235
v_mul_f32 v121, v121, v245
v_mfma_f32_16x16x32_bf16 v[204:207], v[84:87], v[104:107], v[204:207]
ds_read_b64_tr_b16 v[82:83], v232 offset:8704
v_mul_f32 v122, v122, v244
v_mul_f32 v123, v123, v230
s_setprio 2
v_mfma_f32_16x16x32_bf16 v[208:211], v[88:91], v[100:103], v[208:211]
ds_read_b64_tr_b16 v[84:85], v2 offset:8192
s_add_u32 m0, s48, 45056
s_add_u32 s49, s46, 1474944
buffer_load_dwordx4 v246, s[16:19], s49 offen lds
v_exp_f32 v235, -v128
v_mfma_f32_16x16x32_bf16 v[212:215], v[88:91], v[104:107], v[212:215]
ds_read_b64_tr_b16 v[86:87], v2 offset:8704
v_exp_f32 v245, -v129
v_exp_f32 v244, -v130
s_waitcnt lgkmcnt(4)
v_mfma_f32_16x16x32_bf16 v[200:203], v[92:95], v[108:111], v[200:203]
ds_read_b64_tr_b16 v[88:89], v232 offset:12288
v_exp_f32 v230, -v131
v_add_f32 v235, 1.0, v235
v_mfma_f32_16x16x32_bf16 v[204:207], v[92:95], v[112:115], v[204:207]
ds_read_b64_tr_b16 v[90:91], v232 offset:12800
v_add_f32 v245, 1.0, v245
v_add_f32 v244, 1.0, v244
v_mfma_f32_16x16x32_bf16 v[208:211], v[96:99], v[108:111], v[208:211]
ds_read_b64_tr_b16 v[92:93], v2 offset:12288
s_add_u32 m0, s48, 53248
s_add_u32 s49, s46, 2064768
buffer_load_dwordx4 v246, s[16:19], s49 offen lds
v_add_f32 v230, 1.0, v230
v_mfma_f32_16x16x32_bf16 v[212:215], v[96:99], v[112:115], v[212:215]
ds_read_b64_tr_b16 v[94:95], v2 offset:12800
v_rcp_f32 v235, v235
v_rcp_f32 v245, v245
s_waitcnt lgkmcnt(4)
v_mfma_f32_16x16x32_bf16 v[200:203], v[80:83], v[12:15], v[200:203]
ds_read_b64_tr_b16 v[96:97], v232 offset:16384
v_rcp_f32 v244, v244
v_rcp_f32 v230, v230
v_mfma_f32_16x16x32_bf16 v[204:207], v[80:83], v[16:19], v[204:207]
ds_read_b64_tr_b16 v[98:99], v232 offset:16896
v_mul_f32 v128, v128, v235
v_mul_f32 v129, v129, v245
s_setprio 1
v_mfma_f32_16x16x32_bf16 v[208:211], v[84:87], v[12:15], v[208:211]
ds_read_b64_tr_b16 v[80:81], v2 offset:16384
s_add_u32 m0, s48, 94208
s_add_u32 s49, s46, 2654592
buffer_load_dwordx4 v246, s[16:19], s49 offen lds
v_mul_f32 v130, v130, v244
v_mfma_f32_16x16x32_bf16 v[212:215], v[84:87], v[16:19], v[212:215]
ds_read_b64_tr_b16 v[82:83], v2 offset:16896
v_mul_f32 v131, v131, v230
v_cvt_pk_bf16_f32 v120, v120, v121
s_waitcnt lgkmcnt(4)
v_mfma_f32_16x16x32_bf16 v[200:203], v[88:91], v[48:51], v[200:203]
ds_read_b64_tr_b16 v[84:85], v232 offset:40960
v_cvt_pk_bf16_f32 v121, v122, v123
v_cvt_pk_bf16_f32 v122, v128, v129
v_mfma_f32_16x16x32_bf16 v[204:207], v[88:91], v[52:55], v[204:207]
ds_read_b64_tr_b16 v[86:87], v232 offset:41472
v_cvt_pk_bf16_f32 v123, v130, v131
v_mfma_f32_16x16x32_bf16 v[208:211], v[92:95], v[48:51], v[208:211]
ds_read_b64_tr_b16 v[88:89], v2 offset:40960
s_add_u32 m0, s48, 102400
s_add_u32 s49, s46, 3244416
buffer_load_dwordx4 v246, s[16:19], s49 offen lds
v_mfma_f32_16x16x32_bf16 v[212:215], v[92:95], v[52:55], v[212:215]
ds_read_b64_tr_b16 v[90:91], v2 offset:41472
v_add_u32 v255, 147456, v247
ds_write_b128 v255, v[116:119] offset:0
ds_write_b128 v255, v[120:123] offset:4096
s_waitcnt lgkmcnt(6)
v_mfma_f32_16x16x32_bf16 v[200:203], v[96:99], v[148:151], v[200:203]
ds_read_b64_tr_b16 v[92:93], v232 offset:45056
v_mfma_f32_16x16x32_bf16 v[204:207], v[96:99], v[152:155], v[204:207]
ds_read_b64_tr_b16 v[94:95], v232 offset:45568
v_mfma_f32_16x16x32_bf16 v[208:211], v[80:83], v[148:151], v[208:211]
ds_read_b64_tr_b16 v[96:97], v2 offset:45056
v_exp_f32 v235, -v132
v_exp_f32 v230, -v133
v_mfma_f32_16x16x32_bf16 v[212:215], v[80:83], v[152:155], v[212:215]
ds_read_b64_tr_b16 v[98:99], v2 offset:45568
v_exp_f32 v245, -v134
v_exp_f32 v244, -v135
s_setprio 0
s_waitcnt lgkmcnt(6)
v_mfma_f32_16x16x32_bf16 v[200:203], v[84:87], v[156:159], v[200:203]
ds_read_b64_tr_b16 v[80:81], v232 offset:49152
v_add_f32 v235, 1.0, v235
v_add_f32 v230, 1.0, v230
v_mfma_f32_16x16x32_bf16 v[204:207], v[84:87], v[160:163], v[204:207]
ds_read_b64_tr_b16 v[82:83], v232 offset:49664
v_add_f32 v245, 1.0, v245
v_mfma_f32_16x16x32_bf16 v[208:211], v[88:91], v[156:159], v[208:211]
ds_read_b64_tr_b16 v[84:85], v2 offset:49152
v_add_f32 v244, 1.0, v244
v_rcp_f32 v235, v235
v_mfma_f32_16x16x32_bf16 v[212:215], v[88:91], v[160:163], v[212:215]
ds_read_b64_tr_b16 v[86:87], v2 offset:49664
v_rcp_f32 v230, v230
v_rcp_f32 v245, v245
s_waitcnt lgkmcnt(4)
v_mfma_f32_16x16x32_bf16 v[200:203], v[92:95], v[20:23], v[200:203]
ds_read_b64_tr_b16 v[88:89], v232 offset:53248
v_rcp_f32 v244, v244
v_mul_f32 v132, v132, v235
v_mfma_f32_16x16x32_bf16 v[204:207], v[92:95], v[24:27], v[204:207]
ds_read_b64_tr_b16 v[90:91], v232 offset:53760
v_mul_f32 v133, v133, v230
v_mfma_f32_16x16x32_bf16 v[208:211], v[96:99], v[20:23], v[208:211]
ds_read_b64_tr_b16 v[92:93], v2 offset:53248
v_mul_f32 v134, v134, v245
v_mul_f32 v135, v135, v244
v_mfma_f32_16x16x32_bf16 v[212:215], v[96:99], v[24:27], v[212:215]
ds_read_b64_tr_b16 v[94:95], v2 offset:53760
v_exp_f32 v235, -v140
s_lshl_b32 s50, s42, 4
s_add_u32 s50, s50, 64
v_add_u32 v253, s50, v1
v_mul_u32_u24 v255, 2731, v253
v_lshrrev_b32 v255, 16, v255
v_mul_u32_u24 v254, 1152, v253
v_mul_u32_u24 v255, 27520, v255
v_sub_u32 v254, v254, v255
s_mul_i32 s50, s40, 27648
s_add_u32 s50, s50, s47
v_cmp_gt_u32 vcc, 216, v253
s_nop 0
s_and_b64 vcc, vcc, 0xffff
v_mov_b32 v253, 1879048192
v_cndmask_b32 v254, v253, v254, vcc
buffer_load_dword v231, v254, s[20:23], s50 offen
s_waitcnt vmcnt(6)
s_barrier
s_setprio 3
s_waitcnt lgkmcnt(4)
v_mfma_f32_16x16x32_bf16 v[200:203], v[80:83], v[56:59], v[200:203]
ds_read_b64_tr_b16 v[96:97], v233 offset:0
v_exp_f32 v230, -v141
v_exp_f32 v245, -v142
v_mfma_f32_16x16x32_bf16 v[204:207], v[80:83], v[60:63], v[204:207]
ds_read_b64_tr_b16 v[98:99], v233 offset:512
v_exp_f32 v244, -v143
v_add_f32 v235, 1.0, v235
v_mfma_f32_16x16x32_bf16 v[208:211], v[84:87], v[56:59], v[208:211]
ds_read_b64_tr_b16 v[80:81], v3 offset:0
s_add_u32 m0, s48, 61440
s_add_u32 s49, s46, 3834240
buffer_load_dwordx4 v246, s[16:19], s49 offen lds
v_add_f32 v230, 1.0, v230
v_add_f32 v245, 1.0, v245
v_mfma_f32_16x16x32_bf16 v[212:215], v[84:87], v[60:63], v[212:215]
ds_read_b64_tr_b16 v[82:83], v3 offset:512
v_add_f32 v244, 1.0, v244
v_rcp_f32 v235, v235
s_waitcnt lgkmcnt(4)
v_mfma_f32_16x16x32_bf16 v[200:203], v[88:91], v[164:167], v[200:203]
ds_read_b64_tr_b16 v[84:85], v233 offset:4096
v_rcp_f32 v230, v230
v_rcp_f32 v245, v245
v_mfma_f32_16x16x32_bf16 v[204:207], v[88:91], v[168:171], v[204:207]
ds_read_b64_tr_b16 v[86:87], v233 offset:4608
v_rcp_f32 v244, v244
v_mfma_f32_16x16x32_bf16 v[208:211], v[92:95], v[164:167], v[208:211]
ds_read_b64_tr_b16 v[88:89], v3 offset:4096
v_mul_f32 v140, v140, v235
v_mul_f32 v141, v141, v230
v_mfma_f32_16x16x32_bf16 v[212:215], v[92:95], v[168:171], v[212:215]
ds_read_b64_tr_b16 v[90:91], v3 offset:4608
v_mul_f32 v142, v142, v245
v_mul_f32 v143, v143, v244
s_waitcnt lgkmcnt(4)
v_mfma_f32_16x16x32_bf16 v[200:203], v[96:99], v[172:175], v[200:203]
ds_read_b64_tr_b16 v[92:93], v233 offset:8192
v_cvt_pk_bf16_f32 v132, v132, v133
v_cvt_pk_bf16_f32 v133, v134, v135
v_mfma_f32_16x16x32_bf16 v[204:207], v[96:99], v[176:179], v[204:207]
ds_read_b64_tr_b16 v[94:95], v233 offset:8704
v_cvt_pk_bf16_f32 v134, v140, v141
s_setprio 2
v_mfma_f32_16x16x32_bf16 v[208:211], v[80:83], v[172:175], v[208:211]
ds_read_b64_tr_b16 v[96:97], v3 offset:8192
v_cvt_pk_bf16_f32 v135, v142, v143
v_mfma_f32_16x16x32_bf16 v[212:215], v[80:83], v[176:179], v[212:215]
ds_read_b64_tr_b16 v[98:99], v3 offset:8704
v_exp_f32 v235, -v136
v_exp_f32 v230, -v137
s_waitcnt lgkmcnt(4)
v_mfma_f32_16x16x32_bf16 v[200:203], v[84:87], v[28:31], v[200:203]
ds_read_b64_tr_b16 v[80:81], v233 offset:12288
s_add_u32 m0, s48, 69632
s_add_u32 s49, s46, 4424064
buffer_load_dwordx4 v246, s[16:19], s49 offen lds
v_exp_f32 v245, -v138
v_mfma_f32_16x16x32_bf16 v[204:207], v[84:87], v[32:35], v[204:207]
ds_read_b64_tr_b16 v[82:83], v233 offset:12800
v_exp_f32 v244, -v139
v_add_f32 v235, 1.0, v235
v_mfma_f32_16x16x32_bf16 v[208:211], v[88:91], v[28:31], v[208:211]
ds_read_b64_tr_b16 v[84:85], v3 offset:12288
v_add_f32 v230, 1.0, v230
v_add_f32 v245, 1.0, v245
v_mfma_f32_16x16x32_bf16 v[212:215], v[88:91], v[32:35], v[212:215]
ds_read_b64_tr_b16 v[86:87], v3 offset:12800
v_add_f32 v244, 1.0, v244
v_rcp_f32 v235, v235
s_waitcnt lgkmcnt(4)
v_mfma_f32_16x16x32_bf16 v[200:203], v[92:95], v[64:67], v[200:203]
ds_read_b64_tr_b16 v[88:89], v233 offset:16384
v_rcp_f32 v230, v230
v_rcp_f32 v245, v245
v_mfma_f32_16x16x32_bf16 v[204:207], v[92:95], v[68:71], v[204:207]
ds_read_b64_tr_b16 v[90:91], v233 offset:16896
v_rcp_f32 v244, v244
s_setprio 1
v_mfma_f32_16x16x32_bf16 v[208:211], v[96:99], v[64:67], v[208:211]
ds_read_b64_tr_b16 v[92:93], v3 offset:16384
v_mul_f32 v136, v136, v235
v_mul_f32 v137, v137, v230
v_mfma_f32_16x16x32_bf16 v[212:215], v[96:99], v[68:71], v[212:215]
ds_read_b64_tr_b16 v[94:95], v3 offset:16896
v_mul_f32 v138, v138, v245
v_mul_f32 v139, v139, v244
s_waitcnt lgkmcnt(4)
v_mfma_f32_16x16x32_bf16 v[200:203], v[80:83], v[180:183], v[200:203]
ds_read_b64_tr_b16 v[96:97], v233 offset:20480
v_exp_f32 v235, -v144
v_exp_f32 v230, -v145
v_mfma_f32_16x16x32_bf16 v[204:207], v[80:83], v[184:187], v[204:207]
ds_read_b64_tr_b16 v[98:99], v233 offset:20992
v_exp_f32 v245, -v146
v_exp_f32 v244, -v147
v_mfma_f32_16x16x32_bf16 v[208:211], v[84:87], v[180:183], v[208:211]
ds_read_b64_tr_b16 v[80:81], v3 offset:20480
s_add_u32 m0, s48, 77824
s_add_u32 s49, s46, 5013888
buffer_load_dwordx4 v246, s[16:19], s49 offen lds
v_add_f32 v235, 1.0, v235
v_mfma_f32_16x16x32_bf16 v[212:215], v[84:87], v[184:187], v[212:215]
ds_read_b64_tr_b16 v[82:83], v3 offset:20992
v_add_f32 v230, 1.0, v230
v_add_f32 v245, 1.0, v245
s_waitcnt lgkmcnt(4)
v_mfma_f32_16x16x32_bf16 v[200:203], v[88:91], v[188:191], v[200:203]
ds_read_b64_tr_b16 v[84:85], v232 offset:20480
v_add_f32 v244, 1.0, v244
v_rcp_f32 v235, v235
v_mfma_f32_16x16x32_bf16 v[204:207], v[88:91], v[192:195], v[204:207]
ds_read_b64_tr_b16 v[86:87], v232 offset:20992
v_rcp_f32 v230, v230
v_rcp_f32 v245, v245
v_mfma_f32_16x16x32_bf16 v[208:211], v[92:95], v[188:191], v[208:211]
ds_read_b64_tr_b16 v[88:89], v2 offset:20480
v_rcp_f32 v244, v244
v_mul_f32 v144, v144, v235
v_mfma_f32_16x16x32_bf16 v[212:215], v[92:95], v[192:195], v[212:215]
ds_read_b64_tr_b16 v[90:91], v2 offset:20992
v_mul_f32 v145, v145, v230
s_setprio 0
s_waitcnt lgkmcnt(4)
v_mfma_f32_16x16x32_bf16 v[200:203], v[96:99], v[36:39], v[200:203]
ds_read_b64_tr_b16 v[92:93], v233 offset:24576
v_mul_f32 v146, v146, v245
v_mul_f32 v147, v147, v244
v_mfma_f32_16x16x32_bf16 v[204:207], v[96:99], v[72:75], v[204:207]
ds_read_b64_tr_b16 v[94:95], v233 offset:25088
v_cvt_pk_bf16_f32 v136, v136, v137
v_cvt_pk_bf16_f32 v137, v138, v139
v_mfma_f32_16x16x32_bf16 v[208:211], v[80:83], v[36:39], v[208:211]
ds_read_b64_tr_b16 v[96:97], v3 offset:24576
v_cvt_pk_bf16_f32 v138, v144, v145
v_cvt_pk_bf16_f32 v139, v146, v147
v_mfma_f32_16x16x32_bf16 v[212:215], v[80:83], v[72:75], v[212:215]
ds_read_b64_tr_b16 v[98:99], v3 offset:25088
s_waitcnt lgkmcnt(4)
v_mfma_f32_16x16x32_bf16 v[200:203], v[84:87], v[76:79], v[200:203]
ds_read_b64_tr_b16 v[80:81], v233 offset:28672
v_add_u32 v255, 131072, v247
ds_write_b128 v255, v[132:135] offset:0
ds_write_b128 v255, v[136:139] offset:4096
v_mfma_f32_16x16x32_bf16 v[204:207], v[84:87], v[196:199], v[204:207]
ds_read_b64_tr_b16 v[82:83], v233 offset:29184
v_mfma_f32_16x16x32_bf16 v[208:211], v[88:91], v[76:79], v[208:211]
ds_read_b64_tr_b16 v[84:85], v3 offset:28672
v_mfma_f32_16x16x32_bf16 v[212:215], v[88:91], v[196:199], v[212:215]
ds_read_b64_tr_b16 v[86:87], v3 offset:29184
s_waitcnt vmcnt(5)
s_waitcnt lgkmcnt(3)
s_barrier
s_setprio 3
s_mov_b32 s52, 0
L_spf1_1:
v_cmp_eq_u32 vcc, 0, v228
s_nop 1
s_cmp_eq_u64 vcc, 0
s_cbranch_scc1 L_spf1_1x
s_add_u32 s52, s52, 1
s_cmp_ge_u32 s52, 0x10000
s_cbranch_scc1 L_spf1_1x
s_sleep 2
v_mov_b32 v255, 0
buffer_load_dwordx2 v[228:229], v255, s[36:39], 0 offen sc1
s_waitcnt vmcnt(0)
s_branch L_spf1_1
L_spf1_1x:
v_readfirstlane_b32 s98, v228
v_readfirstlane_b32 s99, v229
v_mfma_f32_16x16x32_bf16 v[116:119], v[92:95], v[4:7], 0
ds_read_b64_tr_b16 v[88:89], v233 offset:32768
v_mfma_f32_16x16x32_bf16 v[120:123], v[92:95], v[8:11], 0
ds_read_b64_tr_b16 v[90:91], v233 offset:33280
v_mfma_f32_16x16x32_bf16 v[124:127], v[96:99], v[4:7], 0
ds_read_b64_tr_b16 v[92:93], v3 offset:32768
s_add_u32 m0, s48, 0
s_add_u32 s49, s46, 295424
buffer_load_dwordx4 v246, s[16:19], s49 offen lds
v_exp_f32 v235, -v200
v_mfma_f32_16x16x32_bf16 v[128:131], v[96:99], v[8:11], 0
ds_read_b64_tr_b16 v[94:95], v3 offset:33280
v_exp_f32 v245, -v201
s_waitcnt lgkmcnt(4)
v_mfma_f32_16x16x32_bf16 v[116:119], v[80:83], v[40:43], v[116:119]
ds_read_b64_tr_b16 v[96:97], v233 offset:36864
v_exp_f32 v244, -v202
v_exp_f32 v230, -v203
v_mfma_f32_16x16x32_bf16 v[120:123], v[80:83], v[44:47], v[120:123]
ds_read_b64_tr_b16 v[98:99], v233 offset:37376
v_add_f32 v235, 1.0, v235
v_mfma_f32_16x16x32_bf16 v[124:127], v[84:87], v[40:43], v[124:127]
ds_read_b64_tr_b16 v[80:81], v3 offset:36864
v_add_f32 v245, 1.0, v245
v_mfma_f32_16x16x32_bf16 v[128:131], v[84:87], v[44:47], v[128:131]
ds_read_b64_tr_b16 v[82:83], v3 offset:37376
v_add_f32 v244, 1.0, v244
s_waitcnt lgkmcnt(4)
v_mfma_f32_16x16x32_bf16 v[116:119], v[88:91], v[100:103], v[116:119]
ds_read_b64_tr_b16 v[84:85], v233 offset:40960
v_add_f32 v230, 1.0, v230
v_mfma_f32_16x16x32_bf16 v[120:123], v[88:91], v[104:107], v[120:123]
ds_read_b64_tr_b16 v[86:87], v233 offset:41472
v_rcp_f32 v235, v235
s_setprio 2
v_mfma_f32_16x16x32_bf16 v[124:127], v[92:95], v[100:103], v[124:127]
ds_read_b64_tr_b16 v[88:89], v3 offset:40960
s_add_u32 m0, s48, 8192
s_add_u32 s49, s46, 885248
buffer_load_dwordx4 v246, s[16:19], s49 offen lds
v_rcp_f32 v245, v245
v_mfma_f32_16x16x32_bf16 v[128:131], v[92:95], v[104:107], v[128:131]
ds_read_b64_tr_b16 v[90:91], v3 offset:41472
v_rcp_f32 v244, v244
v_rcp_f32 v230, v230
s_waitcnt lgkmcnt(4)
v_mfma_f32_16x16x32_bf16 v[116:119], v[96:99], v[108:111], v[116:119]
ds_read_b64_tr_b16 v[92:93], v233 offset:45056
v_mul_f32 v200, v200, v235
v_mfma_f32_16x16x32_bf16 v[120:123], v[96:99], v[112:115], v[120:123]
ds_read_b64_tr_b16 v[94:95], v233 offset:45568
v_mul_f32 v201, v201, v245
v_mfma_f32_16x16x32_bf16 v[124:127], v[80:83], v[108:111], v[124:127]
ds_read_b64_tr_b16 v[96:97], v3 offset:45056
v_mul_f32 v202, v202, v244
v_mul_f32 v203, v203, v230
v_mfma_f32_16x16x32_bf16 v[128:131], v[80:83], v[112:115], v[128:131]
ds_read_b64_tr_b16 v[98:99], v3 offset:45568
v_exp_f32 v235, -v208
s_waitcnt lgkmcnt(4)
v_mfma_f32_16x16x32_bf16 v[116:119], v[84:87], v[12:15], v[116:119]
ds_read_b64_tr_b16 v[80:81], v233 offset:49152
v_exp_f32 v245, -v209
v_mfma_f32_16x16x32_bf16 v[120:123], v[84:87], v[16:19], v[120:123]
ds_read_b64_tr_b16 v[82:83], v233 offset:49664
v_exp_f32 v244, -v210
s_setprio 1
v_mfma_f32_16x16x32_bf16 v[124:127], v[88:91], v[12:15], v[124:127]
ds_read_b64_tr_b16 v[84:85], v3 offset:49152
s_add_u32 m0, s48, 16384
s_add_u32 s49, s46, 1475072
buffer_load_dwordx4 v246, s[16:19], s49 offen lds
v_exp_f32 v230, -v211
v_mfma_f32_16x16x32_bf16 v[128:131], v[88:91], v[16:19], v[128:131]
ds_read_b64_tr_b16 v[86:87], v3 offset:49664
v_add_f32 v235, 1.0, v235
s_waitcnt lgkmcnt(4)
v_mfma_f32_16x16x32_bf16 v[116:119], v[92:95], v[48:51], v[116:119]
ds_read_b64_tr_b16 v[88:89], v233 offset:53248
v_add_f32 v245, 1.0, v245
v_add_f32 v244, 1.0, v244
v_mfma_f32_16x16x32_bf16 v[120:123], v[92:95], v[52:55], v[120:123]
ds_read_b64_tr_b16 v[90:91], v233 offset:53760
v_add_f32 v230, 1.0, v230
v_mfma_f32_16x16x32_bf16 v[124:127], v[96:99], v[48:51], v[124:127]
ds_read_b64_tr_b16 v[92:93], v3 offset:53248
v_rcp_f32 v235, v235
v_mfma_f32_16x16x32_bf16 v[128:131], v[96:99], v[52:55], v[128:131]
ds_read_b64_tr_b16 v[94:95], v3 offset:53760
v_rcp_f32 v245, v245
s_waitcnt lgkmcnt(4)
v_mfma_f32_16x16x32_bf16 v[116:119], v[80:83], v[148:151], v[116:119]
ds_read_b64_tr_b16 v[96:97], v232 offset:24576
v_rcp_f32 v244, v244
v_rcp_f32 v230, v230
v_mfma_f32_16x16x32_bf16 v[120:123], v[80:83], v[152:155], v[120:123]
ds_read_b64_tr_b16 v[98:99], v232 offset:25088
v_mul_f32 v208, v208, v235
v_mfma_f32_16x16x32_bf16 v[124:127], v[84:87], v[148:151], v[124:127]
ds_read_b64_tr_b16 v[80:81], v2 offset:24576
s_add_u32 m0, s48, 86016
s_add_u32 s49, s46, 2064896
buffer_load_dwordx4 v246, s[16:19], s49 offen lds
v_mul_f32 v209, v209, v245
v_mfma_f32_16x16x32_bf16 v[128:131], v[84:87], v[152:155], v[128:131]
ds_read_b64_tr_b16 v[82:83], v2 offset:25088
v_mul_f32 v210, v210, v244
s_setprio 0
s_waitcnt lgkmcnt(4)
v_mfma_f32_16x16x32_bf16 v[116:119], v[88:91], v[156:159], v[116:119]
ds_read_b64_tr_b16 v[84:85], v232 offset:28672
v_mul_f32 v211, v211, v230
v_mfma_f32_16x16x32_bf16 v[120:123], v[88:91], v[160:163], v[120:123]
ds_read_b64_tr_b16 v[86:87], v232 offset:29184
v_cvt_pk_bf16_f32 v200, v200, v201
v_mfma_f32_16x16x32_bf16 v[124:127], v[92:95], v[156:159], v[124:127]
ds_read_b64_tr_b16 v[88:89], v2 offset:28672
v_cvt_pk_bf16_f32 v201, v202, v203
v_cvt_pk_bf16_f32 v202, v208, v209
v_mfma_f32_16x16x32_bf16 v[128:131], v[92:95], v[160:163], v[128:131]
ds_read_b64_tr_b16 v[90:91], v2 offset:29184
v_cvt_pk_bf16_f32 v203, v210, v211
s_waitcnt lgkmcnt(4)
v_mfma_f32_16x16x32_bf16 v[116:119], v[96:99], v[20:23], v[116:119]
ds_read_b64_tr_b16 v[92:93], v232 offset:32768
v_mfma_f32_16x16x32_bf16 v[120:123], v[96:99], v[24:27], v[120:123]
ds_read_b64_tr_b16 v[94:95], v232 offset:33280
v_exp_f32 v235, -v204
v_mfma_f32_16x16x32_bf16 v[124:127], v[80:83], v[20:23], v[124:127]
ds_read_b64_tr_b16 v[96:97], v2 offset:32768
v_exp_f32 v245, -v205
v_mfma_f32_16x16x32_bf16 v[128:131], v[80:83], v[24:27], v[128:131]
ds_read_b64_tr_b16 v[98:99], v2 offset:33280
v_exp_f32 v244, -v206
s_lshl_b32 s50, s42, 4
s_add_u32 s50, s50, 192
v_add_u32 v253, s50, v1
v_mul_u32_u24 v255, 2731, v253
v_lshrrev_b32 v255, 16, v255
v_mul_u32_u24 v254, 1152, v253
v_mul_u32_u24 v255, 27520, v255
v_sub_u32 v254, v254, v255
s_mul_i32 s50, s40, 27648
s_add_u32 s50, s50, s47
v_cmp_gt_u32 vcc, 216, v253
s_nop 0
s_and_b64 vcc, vcc, 0xffff
v_mov_b32 v253, 1879048192
v_cndmask_b32 v254, v253, v254, vcc
buffer_load_dword v231, v254, s[20:23], s50 offen
s_waitcnt vmcnt(4)
s_barrier
s_setprio 3
s_waitcnt lgkmcnt(4)
v_mfma_f32_16x16x32_bf16 v[116:119], v[84:87], v[56:59], v[116:119]
ds_read_b64_tr_b16 v[80:81], v232 offset:36864
v_exp_f32 v230, -v207
v_add_f32 v235, 1.0, v235
v_mfma_f32_16x16x32_bf16 v[120:123], v[84:87], v[60:63], v[120:123]
ds_read_b64_tr_b16 v[82:83], v232 offset:37376
v_add_f32 v245, 1.0, v245
v_mfma_f32_16x16x32_bf16 v[124:127], v[88:91], v[56:59], v[124:127]
ds_read_b64_tr_b16 v[84:85], v2 offset:36864
s_add_u32 m0, s48, 28672
s_add_u32 s49, s46, 2654720
buffer_load_dwordx4 v246, s[16:19], s49 offen lds
v_add_f32 v244, 1.0, v244
v_mfma_f32_16x16x32_bf16 v[128:131], v[88:91], v[60:63], v[128:131]
ds_read_b64_tr_b16 v[86:87], v2 offset:37376
v_add_f32 v230, 1.0, v230
s_waitcnt lgkmcnt(4)
v_mfma_f32_16x16x32_bf16 v[116:119], v[92:95], v[164:167], v[116:119]
ds_read_b64_tr_b16 v[88:89], v233 offset:57344
v_rcp_f32 v235, v235
v_mfma_f32_16x16x32_bf16 v[120:123], v[92:95], v[168:171], v[120:123]
ds_read_b64_tr_b16 v[90:91], v233 offset:57856
v_rcp_f32 v245, v245
v_mfma_f32_16x16x32_bf16 v[124:127], v[96:99], v[164:167], v[124:127]
ds_read_b64_tr_b16 v[92:93], v3 offset:57344
v_rcp_f32 v244, v244
v_rcp_f32 v230, v230
v_mfma_f32_16x16x32_bf16 v[128:131], v[96:99], v[168:171], v[128:131]
ds_read_b64_tr_b16 v[94:95], v3 offset:57856
v_mul_f32 v204, v204, v235
s_waitcnt lgkmcnt(4)
v_mfma_f32_16x16x32_bf16 v[116:119], v[80:83], v[172:175], v[116:119]
ds_read_b64_tr_b16 v[96:97], v233 offset:61440
v_mul_f32 v205, v205, v245
v_mfma_f32_16x16x32_bf16 v[120:123], v[80:83], v[176:179], v[120:123]
ds_read_b64_tr_b16 v[98:99], v233 offset:61952
v_mul_f32 v206, v206, v244
s_setprio 2
v_mfma_f32_16x16x32_bf16 v[124:127], v[84:87], v[172:175], v[124:127]
ds_read_b64_tr_b16 v[80:81], v3 offset:61440
s_add_u32 m0, s48, 36864
s_add_u32 s49, s46, 3244544
buffer_load_dwordx4 v246, s[16:19], s49 offen lds
v_mul_f32 v207, v207, v230
v_mfma_f32_16x16x32_bf16 v[128:131], v[84:87], v[176:179], v[128:131]
ds_read_b64_tr_b16 v[82:83], v3 offset:61952
v_exp_f32 v235, -v212
s_waitcnt lgkmcnt(4)
v_mfma_f32_16x16x32_bf16 v[116:119], v[88:91], v[28:31], v[116:119]
ds_read_b64_tr_b16 v[84:85], v232 offset:0
v_exp_f32 v245, -v213
v_exp_f32 v244, -v214
v_mfma_f32_16x16x32_bf16 v[120:123], v[88:91], v[32:35], v[120:123]
ds_read_b64_tr_b16 v[86:87], v232 offset:512
v_exp_f32 v230, -v215
v_mfma_f32_16x16x32_bf16 v[124:127], v[92:95], v[28:31], v[124:127]
ds_read_b64_tr_b16 v[88:89], v2 offset:0
v_add_f32 v235, 1.0, v235
v_mfma_f32_16x16x32_bf16 v[128:131], v[92:95], v[32:35], v[128:131]
ds_read_b64_tr_b16 v[90:91], v2 offset:512
v_add_f32 v245, 1.0, v245
s_waitcnt lgkmcnt(4)
v_mfma_f32_16x16x32_bf16 v[116:119], v[96:99], v[64:67], v[116:119]
ds_read_b64_tr_b16 v[92:93], v232 offset:4096
v_add_f32 v244, 1.0, v244
v_mfma_f32_16x16x32_bf16 v[120:123], v[96:99], v[68:71], v[120:123]
ds_read_b64_tr_b16 v[94:95], v232 offset:4608
v_add_f32 v230, 1.0, v230
s_setprio 1
v_mfma_f32_16x16x32_bf16 v[124:127], v[80:83], v[64:67], v[124:127]
ds_read_b64_tr_b16 v[96:97], v2 offset:4096
s_add_u32 m0, s48, 45056
s_add_u32 s49, s46, 3834368
buffer_load_dwordx4 v246, s[16:19], s49 offen lds
v_rcp_f32 v235, v235
v_mfma_f32_16x16x32_bf16 v[128:131], v[80:83], v[68:71], v[128:131]
ds_read_b64_tr_b16 v[98:99], v2 offset:4608
v_rcp_f32 v245, v245
v_rcp_f32 v244, v244
s_waitcnt lgkmcnt(4)
v_mfma_f32_16x16x32_bf16 v[116:119], v[84:87], v[180:183], v[116:119]
ds_read_b64_tr_b16 v[80:81], v232 offset:8192
v_rcp_f32 v230, v230
v_mfma_f32_16x16x32_bf16 v[120:123], v[84:87], v[184:187], v[120:123]
ds_read_b64_tr_b16 v[82:83], v232 offset:8704
v_mul_f32 v212, v212, v235
v_mfma_f32_16x16x32_bf16 v[124:127], v[88:91], v[180:183], v[124:127]
ds_read_b64_tr_b16 v[84:85], v2 offset:8192
v_mul_f32 v213, v213, v245
v_mfma_f32_16x16x32_bf16 v[128:131], v[88:91], v[184:187], v[128:131]
ds_read_b64_tr_b16 v[86:87], v2 offset:8704
v_mul_f32 v214, v214, v244
s_waitcnt lgkmcnt(4)
v_mfma_f32_16x16x32_bf16 v[116:119], v[92:95], v[188:191], v[116:119]
ds_read_b64_tr_b16 v[88:89], v232 offset:12288
v_mul_f32 v215, v215, v230
v_cvt_pk_bf16_f32 v204, v204, v205
v_mfma_f32_16x16x32_bf16 v[120:123], v[92:95], v[192:195], v[120:123]
ds_read_b64_tr_b16 v[90:91], v232 offset:12800
v_cvt_pk_bf16_f32 v205, v206, v207
v_mfma_f32_16x16x32_bf16 v[124:127], v[96:99], v[188:191], v[124:127]
ds_read_b64_tr_b16 v[92:93], v2 offset:12288
s_add_u32 m0, s48, 53248
s_add_u32 s49, s46, 4424192
buffer_load_dwordx4 v246, s[16:19], s49 offen lds
v_cvt_pk_bf16_f32 v206, v212, v213
v_mfma_f32_16x16x32_bf16 v[128:131], v[96:99], v[192:195], v[128:131]
ds_read_b64_tr_b16 v[94:95], v2 offset:12800
v_cvt_pk_bf16_f32 v207, v214, v215
s_setprio 0
s_waitcnt lgkmcnt(4)
v_mfma_f32_16x16x32_bf16 v[116:119], v[80:83], v[36:39], v[116:119]
ds_read_b64_tr_b16 v[96:97], v232 offset:16384
v_mfma_f32_16x16x32_bf16 v[120:123], v[80:83], v[72:75], v[120:123]
ds_read_b64_tr_b16 v[98:99], v232 offset:16896
v_mfma_f32_16x16x32_bf16 v[124:127], v[84:87], v[36:39], v[124:127]
ds_read_b64_tr_b16 v[80:81], v2 offset:16384
v_add_u32 v255, 114688, v247
ds_write_b128 v255, v[200:203] offset:0
ds_write_b128 v255, v[204:207] offset:4096
v_mfma_f32_16x16x32_bf16 v[128:131], v[84:87], v[72:75], v[128:131]
ds_read_b64_tr_b16 v[82:83], v2 offset:16896
s_waitcnt lgkmcnt(6)
v_mfma_f32_16x16x32_bf16 v[116:119], v[88:91], v[76:79], v[116:119]
ds_read_b64_tr_b16 v[84:85], v233 offset:0
v_mfma_f32_16x16x32_bf16 v[120:123], v[88:91], v[196:199], v[120:123]
ds_read_b64_tr_b16 v[86:87], v233 offset:512
v_mfma_f32_16x16x32_bf16 v[124:127], v[92:95], v[76:79], v[124:127]
ds_read_b64_tr_b16 v[88:89], v3 offset:0
v_mfma_f32_16x16x32_bf16 v[128:131], v[92:95], v[196:199], v[128:131]
ds_read_b64_tr_b16 v[90:91], v3 offset:512
s_waitcnt vmcnt(4)
s_waitcnt vmcnt(3)
s_waitcnt lgkmcnt(5)
s_barrier
s_setprio 3
v_mfma_f32_16x16x32_bf16 v[132:135], v[96:99], v[4:7], 0
ds_read_b64_tr_b16 v[92:93], v233 offset:4096
v_mfma_f32_16x16x32_bf16 v[136:139], v[96:99], v[8:11], 0
ds_read_b64_tr_b16 v[94:95], v233 offset:4608
s_waitcnt lgkmcnt(6)
v_mfma_f32_16x16x32_bf16 v[140:143], v[80:83], v[4:7], 0
ds_read_b64_tr_b16 v[96:97], v3 offset:4096
s_add_u32 m0, s48, 61440
s_add_u32 s49, s46, 5014016
buffer_load_dwordx4 v246, s[16:19], s49 offen lds
v_exp_f32 v235, -v116
v_mfma_f32_16x16x32_bf16 v[144:147], v[80:83], v[8:11], 0
ds_read_b64_tr_b16 v[98:99], v3 offset:4608
v_exp_f32 v245, -v117
s_waitcnt lgkmcnt(4)
v_mfma_f32_16x16x32_bf16 v[132:135], v[84:87], v[40:43], v[132:135]
ds_read_b64_tr_b16 v[80:81], v233 offset:8192
v_exp_f32 v244, -v118
v_exp_f32 v243, -v119
v_mfma_f32_16x16x32_bf16 v[136:139], v[84:87], v[44:47], v[136:139]
ds_read_b64_tr_b16 v[82:83], v233 offset:8704
v_add_f32 v235, 1.0, v235
v_add_u32 v255, 139264, v247
ds_read_b128 v[200:203], v255 offset:0
ds_read_b128 v[204:207], v255 offset:4096
v_mfma_f32_16x16x32_bf16 v[140:143], v[88:91], v[40:43], v[140:143]
ds_read_b64_tr_b16 v[84:85], v3 offset:8192
v_add_f32 v245, 1.0, v245
v_mfma_f32_16x16x32_bf16 v[144:147], v[88:91], v[44:47], v[144:147]
ds_read_b64_tr_b16 v[86:87], v3 offset:8704
v_add_f32 v244, 1.0, v244
s_waitcnt lgkmcnt(6)
v_mfma_f32_16x16x32_bf16 v[132:135], v[92:95], v[100:103], v[132:135]
ds_read_b64_tr_b16 v[88:89], v233 offset:12288
v_add_f32 v243, 1.0, v243
v_mfma_f32_16x16x32_bf16 v[136:139], v[92:95], v[104:107], v[136:139]
ds_read_b64_tr_b16 v[90:91], v233 offset:12800
v_rcp_f32 v235, v235
s_setprio 2
v_mfma_f32_16x16x32_bf16 v[140:143], v[96:99], v[100:103], v[140:143]
ds_read_b64_tr_b16 v[92:93], v3 offset:12288
v_rcp_f32 v245, v245
v_rcp_f32 v244, v244
v_mfma_f32_16x16x32_bf16 v[144:147], v[96:99], v[104:107], v[144:147]
ds_read_b64_tr_b16 v[94:95], v3 offset:12800
v_rcp_f32 v243, v243
v_add_u32 v255, 147456, v247
ds_read_b128 v[208:211], v255 offset:0
ds_read_b128 v[212:215], v255 offset:4096
s_waitcnt lgkmcnt(6)
v_mfma_f32_16x16x32_bf16 v[132:135], v[80:83], v[108:111], v[132:135]
ds_read_b64_tr_b16 v[96:97], v233 offset:16384
s_add_u32 m0, s48, 69632
s_add_u32 s49, s46, 295552
buffer_load_dwordx4 v246, s[16:19], s49 offen lds
v_mul_f32 v116, v116, v235
v_mfma_f32_16x16x32_bf16 v[136:139], v[80:83], v[112:115], v[136:139]
ds_read_b64_tr_b16 v[98:99], v233 offset:16896
v_mul_f32 v117, v117, v245
v_mfma_f32_16x16x32_bf16 v[140:143], v[84:87], v[108:111], v[140:143]
ds_read_b64_tr_b16 v[80:81], v3 offset:16384
v_mul_f32 v118, v118, v244
v_mul_f32 v119, v119, v243
v_mfma_f32_16x16x32_bf16 v[144:147], v[84:87], v[112:115], v[144:147]
ds_read_b64_tr_b16 v[82:83], v3 offset:16896
v_exp_f32 v235, -v124
s_waitcnt lgkmcnt(6)
v_mfma_f32_16x16x32_bf16 v[132:135], v[88:91], v[12:15], v[132:135]
ds_read_b64_tr_b16 v[84:85], v233 offset:20480
v_exp_f32 v245, -v125
v_mfma_f32_16x16x32_bf16 v[136:139], v[88:91], v[16:19], v[136:139]
ds_read_b64_tr_b16 v[86:87], v233 offset:20992
v_exp_f32 v244, -v126
s_setprio 1
v_mfma_f32_16x16x32_bf16 v[140:143], v[92:95], v[12:15], v[140:143]
ds_read_b64_tr_b16 v[88:89], v3 offset:20480
v_exp_f32 v243, -v127
v_add_f32 v235, 1.0, v235
v_mfma_f32_16x16x32_bf16 v[144:147], v[92:95], v[16:19], v[144:147]
ds_read_b64_tr_b16 v[90:91], v3 offset:20992
v_add_u32 v255, 122880, v247
ds_read_b128 v[216:219], v255 offset:0
ds_read_b128 v[220:223], v255 offset:4096
s_waitcnt lgkmcnt(6)
v_mfma_f32_16x16x32_bf16 v[132:135], v[96:99], v[48:51], v[132:135]
ds_read_b64_tr_b16 v[92:93], v232 offset:20480
v_add_f32 v245, 1.0, v245
v_add_f32 v244, 1.0, v244
v_mfma_f32_16x16x32_bf16 v[136:139], v[96:99], v[52:55], v[136:139]
ds_read_b64_tr_b16 v[94:95], v232 offset:20992
v_add_f32 v243, 1.0, v243
v_mfma_f32_16x16x32_bf16 v[140:143], v[80:83], v[48:51], v[140:143]
ds_read_b64_tr_b16 v[96:97], v2 offset:20480
s_add_u32 m0, s48, 77824
s_add_u32 s49, s46, 885376
buffer_load_dwordx4 v246, s[16:19], s49 offen lds
v_rcp_f32 v235, v235
v_mfma_f32_16x16x32_bf16 v[144:147], v[80:83], v[52:55], v[144:147]
ds_read_b64_tr_b16 v[98:99], v2 offset:20992
v_rcp_f32 v245, v245
s_waitcnt lgkmcnt(6)
v_mfma_f32_16x16x32_bf16 v[132:135], v[84:87], v[148:151], v[132:135]
ds_read_b64_tr_b16 v[80:81], v233 offset:24576
v_rcp_f32 v244, v244
v_rcp_f32 v243, v243
v_mfma_f32_16x16x32_bf16 v[136:139], v[84:87], v[152:155], v[136:139]
ds_read_b64_tr_b16 v[82:83], v233 offset:25088
v_mul_f32 v124, v124, v235
v_add_u32 v255, 131072, v247
ds_read_b128 v[224:227], v255 offset:0
ds_read_b128 v[228:231], v255 offset:4096
v_mfma_f32_16x16x32_bf16 v[140:143], v[88:91], v[148:151], v[140:143]
ds_read_b64_tr_b16 v[84:85], v3 offset:24576
v_mul_f32 v125, v125, v245
v_mfma_f32_16x16x32_bf16 v[144:147], v[88:91], v[152:155], v[144:147]
ds_read_b64_tr_b16 v[86:87], v3 offset:25088
v_mul_f32 v126, v126, v244
s_setprio 0
s_waitcnt lgkmcnt(6)
v_mfma_f32_16x16x32_bf16 v[132:135], v[92:95], v[156:159], v[132:135]
ds_read_b64_tr_b16 v[88:89], v233 offset:28672
v_mul_f32 v127, v127, v243
v_mfma_f32_16x16x32_bf16 v[136:139], v[92:95], v[160:163], v[136:139]
ds_read_b64_tr_b16 v[90:91], v233 offset:29184
v_cvt_pk_bf16_f32 v116, v116, v117
v_mfma_f32_16x16x32_bf16 v[140:143], v[96:99], v[156:159], v[140:143]
ds_read_b64_tr_b16 v[92:93], v3 offset:28672
v_cvt_pk_bf16_f32 v117, v118, v119
v_cvt_pk_bf16_f32 v118, v124, v125
v_mfma_f32_16x16x32_bf16 v[144:147], v[96:99], v[160:163], v[144:147]
ds_read_b64_tr_b16 v[94:95], v3 offset:29184
v_cvt_pk_bf16_f32 v119, v126, v127
s_waitcnt lgkmcnt(4)
v_mfma_f32_16x16x32_bf16 v[132:135], v[80:83], v[20:23], v[132:135]
ds_read_b64_tr_b16 v[96:97], v233 offset:32768
v_mfma_f32_16x16x32_bf16 v[136:139], v[80:83], v[24:27], v[136:139]
ds_read_b64_tr_b16 v[98:99], v233 offset:33280
v_exp_f32 v235, -v120
v_mfma_f32_16x16x32_bf16 v[140:143], v[84:87], v[20:23], v[140:143]
ds_read_b64_tr_b16 v[80:81], v3 offset:32768
v_exp_f32 v245, -v121
v_mfma_f32_16x16x32_bf16 v[144:147], v[84:87], v[24:27], v[144:147]
ds_read_b64_tr_b16 v[82:83], v3 offset:33280
v_exp_f32 v244, -v122
s_waitcnt vmcnt(1)
s_barrier
s_setprio 3
s_waitcnt lgkmcnt(4)
v_mfma_f32_16x16x32_bf16 v[132:135], v[88:91], v[56:59], v[132:135]
ds_read_b64_tr_b16 v[84:85], v233 offset:36864
v_exp_f32 v243, -v123
v_add_f32 v235, 1.0, v235
v_mfma_f32_16x16x32_bf16 v[136:139], v[88:91], v[60:63], v[136:139]
ds_read_b64_tr_b16 v[86:87], v233 offset:37376
v_add_f32 v245, 1.0, v245
v_mfma_f32_16x16x32_bf16 v[140:143], v[92:95], v[56:59], v[140:143]
ds_read_b64_tr_b16 v[88:89], v3 offset:36864
s_add_u32 m0, s48, 4096
s_add_u32 s49, s46, 1475200
buffer_load_dwordx4 v246, s[16:19], s49 offen lds
v_add_f32 v244, 1.0, v244
v_mfma_f32_16x16x32_bf16 v[144:147], v[92:95], v[60:63], v[144:147]
ds_read_b64_tr_b16 v[90:91], v3 offset:37376
v_add_f32 v243, 1.0, v243
s_waitcnt lgkmcnt(4)
v_mfma_f32_16x16x32_bf16 v[132:135], v[96:99], v[164:167], v[132:135]
ds_read_b64_tr_b16 v[92:93], v233 offset:40960
v_rcp_f32 v235, v235
v_mfma_f32_16x16x32_bf16 v[136:139], v[96:99], v[168:171], v[136:139]
ds_read_b64_tr_b16 v[94:95], v233 offset:41472
v_rcp_f32 v245, v245
v_mfma_f32_16x16x32_bf16 v[140:143], v[80:83], v[164:167], v[140:143]
ds_read_b64_tr_b16 v[96:97], v3 offset:40960
v_rcp_f32 v244, v244
v_rcp_f32 v243, v243
v_mfma_f32_16x16x32_bf16 v[144:147], v[80:83], v[168:171], v[144:147]
ds_read_b64_tr_b16 v[98:99], v3 offset:41472
v_mul_f32 v120, v120, v235
s_waitcnt lgkmcnt(4)
v_mfma_f32_16x16x32_bf16 v[132:135], v[84:87], v[172:175], v[132:135]
ds_read_b64_tr_b16 v[80:81], v233 offset:45056
s_add_u32 m0, s48, 12288
s_add_u32 s49, s46, 2065024
buffer_load_dwordx4 v246, s[16:19], s49 offen lds
v_mul_f32 v121, v121, v245
v_mfma_f32_16x16x32_bf16 v[136:139], v[84:87], v[176:179], v[136:139]
ds_read_b64_tr_b16 v[82:83], v233 offset:45568
v_mul_f32 v122, v122, v244
s_setprio 2
v_mfma_f32_16x16x32_bf16 v[140:143], v[88:91], v[172:175], v[140:143]
ds_read_b64_tr_b16 v[84:85], v3 offset:45056
v_mul_f32 v123, v123, v243
v_mfma_f32_16x16x32_bf16 v[144:147], v[88:91], v[176:179], v[144:147]
ds_read_b64_tr_b16 v[86:87], v3 offset:45568
v_exp_f32 v235, -v128
s_waitcnt lgkmcnt(4)
v_mfma_f32_16x16x32_bf16 v[132:135], v[92:95], v[28:31], v[132:135]
ds_read_b64_tr_b16 v[88:89], v233 offset:49152
v_exp_f32 v245, -v129
v_exp_f32 v244, -v130
v_mfma_f32_16x16x32_bf16 v[136:139], v[92:95], v[32:35], v[136:139]
ds_read_b64_tr_b16 v[90:91], v233 offset:49664
v_exp_f32 v243, -v131
v_mfma_f32_16x16x32_bf16 v[140:143], v[96:99], v[28:31], v[140:143]
ds_read_b64_tr_b16 v[92:93], v3 offset:49152
s_add_u32 m0, s48, 20480
s_add_u32 s49, s46, 2654848
buffer_load_dwordx4 v246, s[16:19], s49 offen lds
v_add_f32 v235, 1.0, v235
v_mfma_f32_16x16x32_bf16 v[144:147], v[96:99], v[32:35], v[144:147]
ds_read_b64_tr_b16 v[94:95], v3 offset:49664
v_add_f32 v245, 1.0, v245
s_waitcnt lgkmcnt(4)
v_mfma_f32_16x16x32_bf16 v[132:135], v[80:83], v[64:67], v[132:135]
ds_read_b64_tr_b16 v[96:97], v233 offset:53248
v_add_f32 v244, 1.0, v244
v_mfma_f32_16x16x32_bf16 v[136:139], v[80:83], v[68:71], v[136:139]
ds_read_b64_tr_b16 v[98:99], v233 offset:53760
v_add_f32 v243, 1.0, v243
s_setprio 1
v_mfma_f32_16x16x32_bf16 v[140:143], v[84:87], v[64:67], v[140:143]
ds_read_b64_tr_b16 v[80:81], v3 offset:53248
v_rcp_f32 v235, v235
v_rcp_f32 v245, v245
v_mfma_f32_16x16x32_bf16 v[144:147], v[84:87], v[68:71], v[144:147]
ds_read_b64_tr_b16 v[82:83], v3 offset:53760
v_rcp_f32 v244, v244
s_waitcnt lgkmcnt(4)
v_mfma_f32_16x16x32_bf16 v[132:135], v[88:91], v[180:183], v[132:135]
ds_read_b64_tr_b16 v[84:85], v233 offset:57344
s_add_u32 m0, s48, 81920
s_add_u32 s49, s46, 3244672
buffer_load_dwordx4 v246, s[16:19], s49 offen lds
v_rcp_f32 v243, v243
v_mfma_f32_16x16x32_bf16 v[136:139], v[88:91], v[184:187], v[136:139]
ds_read_b64_tr_b16 v[86:87], v233 offset:57856
v_mul_f32 v128, v128, v235
v_mfma_f32_16x16x32_bf16 v[140:143], v[92:95], v[180:183], v[140:143]
ds_read_b64_tr_b16 v[88:89], v3 offset:57344
v_mul_f32 v129, v129, v245
v_mfma_f32_16x16x32_bf16 v[144:147], v[92:95], v[184:187], v[144:147]
ds_read_b64_tr_b16 v[90:91], v3 offset:57856
v_mul_f32 v130, v130, v244
s_waitcnt lgkmcnt(4)
v_mfma_f32_16x16x32_bf16 v[132:135], v[96:99], v[188:191], v[132:135]
ds_read_b64_tr_b16 v[92:93], v233 offset:61440
v_mul_f32 v131, v131, v243
v_cvt_pk_bf16_f32 v120, v120, v121
v_mfma_f32_16x16x32_bf16 v[136:139], v[96:99], v[192:195], v[136:139]
ds_read_b64_tr_b16 v[94:95], v233 offset:61952
v_cvt_pk_bf16_f32 v121, v122, v123
v_mfma_f32_16x16x32_bf16 v[140:143], v[80:83], v[188:191], v[140:143]
ds_read_b64_tr_b16 v[96:97], v3 offset:61440
s_add_u32 m0, s48, 122880
s_add_u32 s49, s46, 3834496
buffer_load_dwordx4 v246, s[16:19], s49 offen lds
v_cvt_pk_bf16_f32 v122, v128, v129
v_mfma_f32_16x16x32_bf16 v[144:147], v[80:83], v[192:195], v[144:147]
ds_read_b64_tr_b16 v[98:99], v3 offset:61952
v_cvt_pk_bf16_f32 v123, v130, v131
s_setprio 0
s_waitcnt lgkmcnt(4)
v_mfma_f32_16x16x32_bf16 v[132:135], v[84:87], v[36:39], v[132:135]
ds_read_b64_tr_b16 v[80:81], v232 offset:0
v_mfma_f32_16x16x32_bf16 v[136:139], v[84:87], v[72:75], v[136:139]
ds_read_b64_tr_b16 v[82:83], v232 offset:512
v_mfma_f32_16x16x32_bf16 v[140:143], v[88:91], v[36:39], v[140:143]
ds_read_b64_tr_b16 v[84:85], v2 offset:0
v_add_u32 v255, 98304, v247
ds_write_b128 v255, v[116:119] offset:0
ds_write_b128 v255, v[120:123] offset:4096
v_mfma_f32_16x16x32_bf16 v[144:147], v[88:91], v[72:75], v[144:147]
ds_read_b64_tr_b16 v[86:87], v2 offset:512
s_waitcnt lgkmcnt(6)
v_mfma_f32_16x16x32_bf16 v[132:135], v[92:95], v[76:79], v[132:135]
ds_read_b64_tr_b16 v[88:89], v232 offset:4096
v_mfma_f32_16x16x32_bf16 v[136:139], v[92:95], v[196:199], v[136:139]
ds_read_b64_tr_b16 v[90:91], v232 offset:4608
v_mfma_f32_16x16x32_bf16 v[140:143], v[96:99], v[76:79], v[140:143]
ds_read_b64_tr_b16 v[92:93], v2 offset:4096
v_mfma_f32_16x16x32_bf16 v[144:147], v[96:99], v[196:199], v[144:147]
ds_read_b64_tr_b16 v[94:95], v2 offset:4608
s_waitcnt vmcnt(2)
s_waitcnt lgkmcnt(5)
s_barrier
s_setprio 3
v_mfma_f32_16x16x32_bf16 v[116:119], v[80:83], v[4:7], 0
ds_read_b64_tr_b16 v[96:97], v232 offset:8192
v_mfma_f32_16x16x32_bf16 v[120:123], v[80:83], v[8:11], 0
ds_read_b64_tr_b16 v[98:99], v232 offset:8704
s_waitcnt lgkmcnt(6)
v_mfma_f32_16x16x32_bf16 v[124:127], v[84:87], v[4:7], 0
ds_read_b64_tr_b16 v[80:81], v2 offset:8192
s_add_u32 m0, s48, 28672
s_add_u32 s49, s46, 4424320
buffer_load_dwordx4 v246, s[16:19], s49 offen lds
v_exp_f32 v235, -v132
v_mfma_f32_16x16x32_bf16 v[128:131], v[84:87], v[8:11], 0
ds_read_b64_tr_b16 v[82:83], v2 offset:8704
v_exp_f32 v245, -v133
s_waitcnt lgkmcnt(4)
v_mfma_f32_16x16x32_bf16 v[116:119], v[88:91], v[40:43], v[116:119]
ds_read_b64_tr_b16 v[84:85], v232 offset:12288
v_exp_f32 v244, -v134
v_exp_f32 v243, -v135
v_mfma_f32_16x16x32_bf16 v[120:123], v[88:91], v[44:47], v[120:123]
ds_read_b64_tr_b16 v[86:87], v232 offset:12800
v_add_f32 v235, 1.0, v235
v_mfma_f32_16x16x32_bf16 v[124:127], v[92:95], v[40:43], v[124:127]
ds_read_b64_tr_b16 v[88:89], v2 offset:12288
v_add_f32 v245, 1.0, v245
v_mfma_f32_16x16x32_bf16 v[128:131], v[92:95], v[44:47], v[128:131]
ds_read_b64_tr_b16 v[90:91], v2 offset:12800
v_add_f32 v244, 1.0, v244
s_waitcnt lgkmcnt(4)
v_mfma_f32_16x16x32_bf16 v[116:119], v[96:99], v[100:103], v[116:119]
ds_read_b64_tr_b16 v[92:93], v233 offset:0
s_add_u32 m0, s48, 36864
s_add_u32 s49, s46, 5014144
buffer_load_dwordx4 v246, s[16:19], s49 offen lds
v_add_f32 v243, 1.0, v243
v_mfma_f32_16x16x32_bf16 v[120:123], v[96:99], v[104:107], v[120:123]
ds_read_b64_tr_b16 v[94:95], v233 offset:512
v_rcp_f32 v235, v235
s_setprio 2
v_mfma_f32_16x16x32_bf16 v[124:127], v[80:83], v[100:103], v[124:127]
ds_read_b64_tr_b16 v[96:97], v3 offset:0
v_rcp_f32 v245, v245
v_rcp_f32 v244, v244
v_mfma_f32_16x16x32_bf16 v[128:131], v[80:83], v[104:107], v[128:131]
ds_read_b64_tr_b16 v[98:99], v3 offset:512
v_rcp_f32 v243, v243
s_waitcnt lgkmcnt(4)
v_mfma_f32_16x16x32_bf16 v[116:119], v[84:87], v[108:111], v[116:119]
ds_read_b64_tr_b16 v[80:81], v233 offset:4096
v_mul_f32 v132, v132, v235
v_mfma_f32_16x16x32_bf16 v[120:123], v[84:87], v[112:115], v[120:123]
ds_read_b64_tr_b16 v[82:83], v233 offset:4608
v_mul_f32 v133, v133, v245
v_mfma_f32_16x16x32_bf16 v[124:127], v[88:91], v[108:111], v[124:127]
ds_read_b64_tr_b16 v[84:85], v3 offset:4096
s_add_u32 m0, s48, 45056
s_add_u32 s49, s47, 36864
buffer_load_dwordx4 v234, s[20:23], s49 offen lds
v_mul_f32 v134, v134, v244
v_mfma_f32_16x16x32_bf16 v[128:131], v[88:91], v[112:115], v[128:131]
ds_read_b64_tr_b16 v[86:87], v3 offset:4608
v_mul_f32 v135, v135, v243
v_exp_f32 v235, -v140
s_waitcnt lgkmcnt(4)
v_mfma_f32_16x16x32_bf16 v[116:119], v[92:95], v[12:15], v[116:119]
ds_read_b64_tr_b16 v[88:89], v233 offset:8192
v_exp_f32 v245, -v141
v_mfma_f32_16x16x32_bf16 v[120:123], v[92:95], v[16:19], v[120:123]
ds_read_b64_tr_b16 v[90:91], v233 offset:8704
v_exp_f32 v244, -v142
s_setprio 1
v_mfma_f32_16x16x32_bf16 v[124:127], v[96:99], v[12:15], v[124:127]
ds_read_b64_tr_b16 v[92:93], v3 offset:8192
v_exp_f32 v243, -v143
v_mfma_f32_16x16x32_bf16 v[128:131], v[96:99], v[16:19], v[128:131]
ds_read_b64_tr_b16 v[94:95], v3 offset:8704
v_add_f32 v235, 1.0, v235
s_waitcnt lgkmcnt(4)
v_mfma_f32_16x16x32_bf16 v[116:119], v[80:83], v[48:51], v[116:119]
ds_read_b64_tr_b16 v[96:97], v233 offset:12288
s_add_u32 m0, s48, 53248
s_add_u32 s49, s47, 110592
buffer_load_dwordx4 v234, s[20:23], s49 offen lds
v_add_f32 v245, 1.0, v245
v_mfma_f32_16x16x32_bf16 v[120:123], v[80:83], v[52:55], v[120:123]
ds_read_b64_tr_b16 v[98:99], v233 offset:12800
v_add_f32 v244, 1.0, v244
v_add_f32 v243, 1.0, v243
v_mfma_f32_16x16x32_bf16 v[124:127], v[84:87], v[48:51], v[124:127]
ds_read_b64_tr_b16 v[80:81], v3 offset:12288
v_rcp_f32 v235, v235
v_mfma_f32_16x16x32_bf16 v[128:131], v[84:87], v[52:55], v[128:131]
ds_read_b64_tr_b16 v[82:83], v3 offset:12800
v_rcp_f32 v245, v245
s_waitcnt lgkmcnt(4)
v_mfma_f32_16x16x32_bf16 v[116:119], v[88:91], v[148:151], v[116:119]
ds_read_b64_tr_b16 v[84:85], v233 offset:16384
v_rcp_f32 v244, v244
v_rcp_f32 v243, v243
v_mfma_f32_16x16x32_bf16 v[120:123], v[88:91], v[152:155], v[120:123]
ds_read_b64_tr_b16 v[86:87], v233 offset:16896
v_mul_f32 v140, v140, v235
v_mfma_f32_16x16x32_bf16 v[124:127], v[92:95], v[148:151], v[124:127]
ds_read_b64_tr_b16 v[88:89], v3 offset:16384
s_add_u32 m0, s48, 61440
s_add_u32 s49, s47, 184320
buffer_load_dwordx4 v234, s[20:23], s49 offen lds
v_mul_f32 v141, v141, v245
v_mfma_f32_16x16x32_bf16 v[128:131], v[92:95], v[152:155], v[128:131]
ds_read_b64_tr_b16 v[90:91], v3 offset:16896
v_mul_f32 v142, v142, v244
s_setprio 0
s_waitcnt lgkmcnt(4)
v_mfma_f32_16x16x32_bf16 v[116:119], v[96:99], v[156:159], v[116:119]
ds_read_b64_tr_b16 v[92:93], v233 offset:20480
v_mul_f32 v143, v143, v243
v_mfma_f32_16x16x32_bf16 v[120:123], v[96:99], v[160:163], v[120:123]
ds_read_b64_tr_b16 v[94:95], v233 offset:20992
v_cvt_pk_bf16_f32 v132, v132, v133
v_mfma_f32_16x16x32_bf16 v[124:127], v[80:83], v[156:159], v[124:127]
ds_read_b64_tr_b16 v[96:97], v3 offset:20480
v_cvt_pk_bf16_f32 v133, v134, v135
v_cvt_pk_bf16_f32 v134, v140, v141
v_mfma_f32_16x16x32_bf16 v[128:131], v[80:83], v[160:163], v[128:131]
ds_read_b64_tr_b16 v[98:99], v3 offset:20992
v_cvt_pk_bf16_f32 v135, v142, v143
s_waitcnt lgkmcnt(4)
v_mfma_f32_16x16x32_bf16 v[116:119], v[84:87], v[20:23], v[116:119]
ds_read_b64_tr_b16 v[80:81], v233 offset:24576
v_mfma_f32_16x16x32_bf16 v[120:123], v[84:87], v[24:27], v[120:123]
ds_read_b64_tr_b16 v[82:83], v233 offset:25088
v_exp_f32 v235, -v136
v_mfma_f32_16x16x32_bf16 v[124:127], v[88:91], v[20:23], v[124:127]
ds_read_b64_tr_b16 v[84:85], v3 offset:24576
v_exp_f32 v245, -v137
v_mfma_f32_16x16x32_bf16 v[128:131], v[88:91], v[24:27], v[128:131]
ds_read_b64_tr_b16 v[86:87], v3 offset:25088
v_exp_f32 v244, -v138
s_waitcnt vmcnt(2)
s_barrier
s_setprio 3
s_waitcnt lgkmcnt(4)
v_mfma_f32_16x16x32_bf16 v[116:119], v[92:95], v[56:59], v[116:119]
ds_read_b64_tr_b16 v[88:89], v232 offset:16384
v_exp_f32 v243, -v139
v_add_f32 v235, 1.0, v235
v_mfma_f32_16x16x32_bf16 v[120:123], v[92:95], v[60:63], v[120:123]
ds_read_b64_tr_b16 v[90:91], v232 offset:16896
v_add_f32 v245, 1.0, v245
v_mfma_f32_16x16x32_bf16 v[124:127], v[96:99], v[56:59], v[124:127]
ds_read_b64_tr_b16 v[92:93], v2 offset:16384
s_add_u32 m0, s48, 4096
s_add_u32 s49, s47, 258048
buffer_load_dwordx4 v234, s[20:23], s49 offen lds
v_add_f32 v244, 1.0, v244
v_mfma_f32_16x16x32_bf16 v[128:131], v[96:99], v[60:63], v[128:131]
ds_read_b64_tr_b16 v[94:95], v2 offset:16896
v_add_f32 v243, 1.0, v243
s_waitcnt lgkmcnt(4)
v_mfma_f32_16x16x32_bf16 v[116:119], v[80:83], v[164:167], v[116:119]
ds_read_b64_tr_b16 v[96:97], v232 offset:20480
v_rcp_f32 v235, v235
v_rcp_f32 v245, v245
v_mfma_f32_16x16x32_bf16 v[120:123], v[80:83], v[168:171], v[120:123]
ds_read_b64_tr_b16 v[98:99], v232 offset:20992
v_add_u32 v255, 106496, v247
ds_read_b128 v[4:7], v255 offset:0
ds_read_b128 v[8:11], v255 offset:4096
v_mfma_f32_16x16x32_bf16 v[124:127], v[84:87], v[164:167], v[124:127]
ds_read_b64_tr_b16 v[80:81], v2 offset:20480
v_rcp_f32 v244, v244
v_rcp_f32 v243, v243
v_mfma_f32_16x16x32_bf16 v[128:131], v[84:87], v[168:171], v[128:131]
ds_read_b64_tr_b16 v[82:83], v2 offset:20992
v_mul_f32 v136, v136, v235
s_waitcnt lgkmcnt(6)
v_mfma_f32_16x16x32_bf16 v[116:119], v[88:91], v[172:175], v[116:119]
ds_read_b64_tr_b16 v[84:85], v232 offset:57344
v_mul_f32 v137, v137, v245
v_mfma_f32_16x16x32_bf16 v[120:123], v[88:91], v[176:179], v[120:123]
ds_read_b64_tr_b16 v[86:87], v232 offset:57856
v_mul_f32 v138, v138, v244
s_setprio 2
v_mfma_f32_16x16x32_bf16 v[124:127], v[92:95], v[172:175], v[124:127]
ds_read_b64_tr_b16 v[88:89], v2 offset:57344
s_add_u32 m0, s48, 12288
s_add_u32 s49, s47, 331776
buffer_load_dwordx4 v234, s[20:23], s49 offen lds
v_mul_f32 v139, v139, v243
v_mfma_f32_16x16x32_bf16 v[128:131], v[92:95], v[176:179], v[128:131]
ds_read_b64_tr_b16 v[90:91], v2 offset:57856
v_exp_f32 v235, -v144
v_add_u32 v255, 114688, v247
ds_read_b128 v[12:15], v255 offset:0
ds_read_b128 v[16:19], v255 offset:4096
s_waitcnt lgkmcnt(6)
v_mfma_f32_16x16x32_bf16 v[116:119], v[96:99], v[28:31], v[116:119]
ds_read_b64_tr_b16 v[92:93], v232 offset:61440
v_exp_f32 v245, -v145
v_exp_f32 v244, -v146
v_mfma_f32_16x16x32_bf16 v[120:123], v[96:99], v[32:35], v[120:123]
ds_read_b64_tr_b16 v[94:95], v232 offset:61952
v_exp_f32 v243, -v147
v_mfma_f32_16x16x32_bf16 v[124:127], v[80:83], v[28:31], v[124:127]
ds_read_b64_tr_b16 v[96:97], v2 offset:61440
v_add_f32 v235, 1.0, v235
v_mfma_f32_16x16x32_bf16 v[128:131], v[80:83], v[32:35], v[128:131]
ds_read_b64_tr_b16 v[98:99], v2 offset:61952
v_add_f32 v245, 1.0, v245
s_waitcnt lgkmcnt(6)
v_mfma_f32_16x16x32_bf16 v[116:119], v[84:87], v[64:67], v[116:119]
ds_read_b64_tr_b16 v[80:81], v233 offset:28672
v_add_f32 v244, 1.0, v244
v_mfma_f32_16x16x32_bf16 v[120:123], v[84:87], v[68:71], v[120:123]
ds_read_b64_tr_b16 v[82:83], v233 offset:29184
v_add_f32 v243, 1.0, v243
s_setprio 1
v_mfma_f32_16x16x32_bf16 v[124:127], v[88:91], v[64:67], v[124:127]
ds_read_b64_tr_b16 v[84:85], v3 offset:28672
s_add_u32 m0, s48, 65536
s_add_u32 s49, s47, 36992
buffer_load_dwordx4 v234, s[20:23], s49 offen lds
v_rcp_f32 v235, v235
v_rcp_f32 v245, v245
v_mfma_f32_16x16x32_bf16 v[128:131], v[88:91], v[68:71], v[128:131]
ds_read_b64_tr_b16 v[86:87], v3 offset:29184
v_rcp_f32 v244, v244
v_add_u32 v255, 90112, v247
ds_read_b128 v[20:23], v255 offset:0
ds_read_b128 v[24:27], v255 offset:4096
s_waitcnt lgkmcnt(6)
v_mfma_f32_16x16x32_bf16 v[116:119], v[92:95], v[180:183], v[116:119]
ds_read_b64_tr_b16 v[88:89], v233 offset:32768
v_rcp_f32 v243, v243
v_mfma_f32_16x16x32_bf16 v[120:123], v[92:95], v[184:187], v[120:123]
ds_read_b64_tr_b16 v[90:91], v233 offset:33280
v_mul_f32 v144, v144, v235
v_mfma_f32_16x16x32_bf16 v[124:127], v[96:99], v[180:183], v[124:127]
ds_read_b64_tr_b16 v[92:93], v3 offset:32768
v_mul_f32 v145, v145, v245
v_mfma_f32_16x16x32_bf16 v[128:131], v[96:99], v[184:187], v[128:131]
ds_read_b64_tr_b16 v[94:95], v3 offset:33280
v_mul_f32 v146, v146, v244
s_waitcnt lgkmcnt(6)
v_mfma_f32_16x16x32_bf16 v[116:119], v[80:83], v[188:191], v[116:119]
ds_read_b64_tr_b16 v[96:97], v233 offset:36864
v_mul_f32 v147, v147, v243
v_cvt_pk_bf16_f32 v136, v136, v137
v_mfma_f32_16x16x32_bf16 v[120:123], v[80:83], v[192:195], v[120:123]
ds_read_b64_tr_b16 v[98:99], v233 offset:37376
v_cvt_pk_bf16_f32 v137, v138, v139
v_add_u32 v255, 98304, v247
ds_read_b128 v[28:31], v255 offset:0
ds_read_b128 v[32:35], v255 offset:4096
v_mfma_f32_16x16x32_bf16 v[124:127], v[84:87], v[188:191], v[124:127]
ds_read_b64_tr_b16 v[80:81], v3 offset:36864
s_add_u32 m0, s48, 73728
s_add_u32 s49, s47, 110720
buffer_load_dwordx4 v234, s[20:23], s49 offen lds
v_cvt_pk_bf16_f32 v138, v144, v145
v_mfma_f32_16x16x32_bf16 v[128:131], v[84:87], v[192:195], v[128:131]
ds_read_b64_tr_b16 v[82:83], v3 offset:37376
v_cvt_pk_bf16_f32 v139, v146, v147
s_setprio 0
s_waitcnt lgkmcnt(6)
v_mfma_f32_16x16x32_bf16 v[116:119], v[88:91], v[36:39], v[116:119]
v_and_b32 v255, 1, v252
v_lshrrev_b32 v254, 1, v250
v_lshl_or_b32 v255, v255, 1, v254
v_lshlrev_b32 v255, 5, v255
v_lshl_add_u32 v254, v252, 2, v250
v_lshl_add_u32 v255, v254, 7, v255
v_lshl_add_u32 v255, v249, 3, v255
v_xor_b32 v233, 64, v255
v_add_u32 v232, 0x10000, v233
v_xor_b32 v3, 96, v255
v_add_u32 v2, 0x10000, v3
ds_read_b64_tr_b16 v[84:85], v233 offset:40960
v_mfma_f32_16x16x32_bf16 v[120:123], v[88:91], v[72:75], v[120:123]
ds_read_b64_tr_b16 v[86:87], v233 offset:43008
v_mfma_f32_16x16x32_bf16 v[124:127], v[92:95], v[36:39], v[124:127]
ds_read_b64_tr_b16 v[88:89], v3 offset:40960
v_add_u32 v255, 147456, v247
ds_write_b128 v255, v[132:135] offset:0
ds_write_b128 v255, v[136:139] offset:4096
v_mfma_f32_16x16x32_bf16 v[128:131], v[92:95], v[72:75], v[128:131]
ds_read_b64_tr_b16 v[90:91], v3 offset:43008
s_waitcnt lgkmcnt(6)
v_mfma_f32_16x16x32_bf16 v[116:119], v[96:99], v[76:79], v[116:119]
ds_read_b64_tr_b16 v[92:93], v233 offset:45056
v_mfma_f32_16x16x32_bf16 v[120:123], v[96:99], v[196:199], v[120:123]
ds_read_b64_tr_b16 v[94:95], v233 offset:47104
v_mfma_f32_16x16x32_bf16 v[124:127], v[80:83], v[76:79], v[124:127]
ds_read_b64_tr_b16 v[96:97], v3 offset:45056
v_mfma_f32_16x16x32_bf16 v[128:131], v[80:83], v[196:199], v[128:131]
ds_read_b64_tr_b16 v[98:99], v3 offset:47104
s_waitcnt vmcnt(2)
s_waitcnt lgkmcnt(5)
s_barrier
s_setprio 3
v_add_u32 v255, 139264, v247
ds_read_b128 v[36:39], v255 offset:0
ds_read_b128 v[40:43], v255 offset:4096
v_add_u32 v255, 147456, v247
ds_read_b128 v[44:47], v255 offset:0
ds_read_b128 v[48:51], v255 offset:4096
v_mfma_f32_16x16x32_bf16 v[52:55], v[84:87], v[200:203], 0
ds_read_b64_tr_b16 v[80:81], v233 offset:49152
v_mfma_f32_16x16x32_bf16 v[56:59], v[84:87], v[204:207], 0
ds_read_b64_tr_b16 v[82:83], v233 offset:51200
v_exp_f32 v235, -v116
v_exp_f32 v245, -v117
s_waitcnt lgkmcnt(10)
v_mfma_f32_16x16x32_bf16 v[60:63], v[88:91], v[200:203], 0
ds_read_b64_tr_b16 v[84:85], v3 offset:49152
s_add_u32 m0, s48, 20480
s_add_u32 s49, s47, 405504
buffer_load_dwordx4 v234, s[20:23], s49 offen lds
v_exp_f32 v244, -v118
v_exp_f32 v243, -v119
v_mfma_f32_16x16x32_bf16 v[64:67], v[88:91], v[204:207], 0
ds_read_b64_tr_b16 v[86:87], v3 offset:51200
v_add_f32 v235, 1.0, v235
v_add_f32 v245, 1.0, v245
v_add_f32 v244, 1.0, v244
s_waitcnt lgkmcnt(8)
v_mfma_f32_16x16x32_bf16 v[52:55], v[92:95], v[208:211], v[52:55]
ds_read_b64_tr_b16 v[88:89], v233 offset:53248
v_add_f32 v243, 1.0, v243
v_rcp_f32 v235, v235
v_rcp_f32 v245, v245
v_mfma_f32_16x16x32_bf16 v[56:59], v[92:95], v[212:215], v[56:59]
ds_read_b64_tr_b16 v[90:91], v233 offset:55296
v_rcp_f32 v244, v244
v_rcp_f32 v243, v243
v_mfma_f32_16x16x32_bf16 v[60:63], v[96:99], v[208:211], v[60:63]
ds_read_b64_tr_b16 v[92:93], v3 offset:53248
s_add_u32 m0, s48, 28672
s_add_u32 s49, s47, 184448
buffer_load_dwordx4 v234, s[20:23], s49 offen lds
v_mul_f32 v116, v116, v235
v_mul_f32 v117, v117, v245
v_mfma_f32_16x16x32_bf16 v[64:67], v[96:99], v[212:215], v[64:67]
ds_read_b64_tr_b16 v[94:95], v3 offset:55296
v_mul_f32 v118, v118, v244
v_mul_f32 v119, v119, v243
s_waitcnt lgkmcnt(4)
v_mfma_f32_16x16x32_bf16 v[52:55], v[80:83], v[216:219], v[52:55]
ds_read_b64_tr_b16 v[96:97], v233 offset:57344
v_exp_f32 v235, -v124
v_exp_f32 v245, -v125
v_exp_f32 v244, -v126
v_mfma_f32_16x16x32_bf16 v[56:59], v[80:83], v[220:223], v[56:59]
ds_read_b64_tr_b16 v[98:99], v233 offset:59392
v_exp_f32 v243, -v127
v_add_f32 v235, 1.0, v235
s_setprio 2
v_mfma_f32_16x16x32_bf16 v[60:63], v[84:87], v[216:219], v[60:63]
ds_read_b64_tr_b16 v[80:81], v3 offset:57344
s_add_u32 m0, s48, 36864
s_add_u32 s49, s47, 258176
buffer_load_dwordx4 v234, s[20:23], s49 offen lds
v_add_f32 v245, 1.0, v245
v_add_f32 v244, 1.0, v244
v_mfma_f32_16x16x32_bf16 v[64:67], v[84:87], v[220:223], v[64:67]
ds_read_b64_tr_b16 v[82:83], v3 offset:59392
v_add_f32 v243, 1.0, v243
v_rcp_f32 v235, v235
v_rcp_f32 v245, v245
s_waitcnt lgkmcnt(4)
v_mfma_f32_16x16x32_bf16 v[52:55], v[88:91], v[224:227], v[52:55]
ds_read_b64_tr_b16 v[84:85], v233 offset:61440
v_rcp_f32 v244, v244
v_rcp_f32 v243, v243
v_mul_f32 v124, v124, v235
v_mfma_f32_16x16x32_bf16 v[56:59], v[88:91], v[228:231], v[56:59]
ds_read_b64_tr_b16 v[86:87], v233 offset:63488
v_mul_f32 v125, v125, v245
v_mul_f32 v126, v126, v244
v_mfma_f32_16x16x32_bf16 v[60:63], v[92:95], v[224:227], v[60:63]
ds_read_b64_tr_b16 v[88:89], v3 offset:61440
s_add_u32 m0, s48, 86016
s_add_u32 s49, s47, 331904
buffer_load_dwordx4 v234, s[20:23], s49 offen lds
v_mul_f32 v127, v127, v243
v_cvt_pk_bf16_f32 v116, v116, v117
v_mfma_f32_16x16x32_bf16 v[64:67], v[92:95], v[228:231], v[64:67]
ds_read_b64_tr_b16 v[90:91], v3 offset:63488
v_cvt_pk_bf16_f32 v117, v118, v119
v_cvt_pk_bf16_f32 v118, v124, v125
s_waitcnt lgkmcnt(4)
v_mfma_f32_16x16x32_bf16 v[52:55], v[96:99], v[4:7], v[52:55]
ds_read_b64_tr_b16 v[92:93], v233 offset:0
v_cvt_pk_bf16_f32 v119, v126, v127
v_exp_f32 v235, -v120
v_mfma_f32_16x16x32_bf16 v[56:59], v[96:99], v[8:11], v[56:59]
ds_read_b64_tr_b16 v[94:95], v233 offset:2048
v_exp_f32 v245, -v121
v_exp_f32 v244, -v122
s_setprio 1
v_mfma_f32_16x16x32_bf16 v[60:63], v[80:83], v[4:7], v[60:63]
ds_read_b64_tr_b16 v[96:97], v3 offset:0
s_add_u32 m0, s48, 94208
s_add_u32 s49, s47, 405632
buffer_load_dwordx4 v234, s[20:23], s49 offen lds
v_exp_f32 v243, -v123
v_add_f32 v235, 1.0, v235
v_mfma_f32_16x16x32_bf16 v[64:67], v[80:83], v[8:11], v[64:67]
ds_read_b64_tr_b16 v[98:99], v3 offset:2048
v_add_f32 v245, 1.0, v245
v_add_f32 v244, 1.0, v244
v_add_f32 v243, 1.0, v243
s_waitcnt lgkmcnt(4)
v_mfma_f32_16x16x32_bf16 v[52:55], v[84:87], v[12:15], v[52:55]
ds_read_b64_tr_b16 v[80:81], v233 offset:4096
v_rcp_f32 v235, v235
v_rcp_f32 v245, v245
v_mfma_f32_16x16x32_bf16 v[56:59], v[84:87], v[16:19], v[56:59]
ds_read_b64_tr_b16 v[82:83], v233 offset:6144
v_rcp_f32 v244, v244
v_rcp_f32 v243, v243
v_mfma_f32_16x16x32_bf16 v[60:63], v[88:91], v[12:15], v[60:63]
ds_read_b64_tr_b16 v[84:85], v3 offset:4096
s_add_u32 m0, s48, 102400
s_add_u32 s49, s47, 37120
buffer_load_dwordx4 v234, s[20:23], s49 offen lds
v_mul_f32 v120, v120, v235
v_mul_f32 v121, v121, v245
v_mfma_f32_16x16x32_bf16 v[64:67], v[88:91], v[16:19], v[64:67]
ds_read_b64_tr_b16 v[86:87], v3 offset:6144
v_mul_f32 v122, v122, v244
v_mul_f32 v123, v123, v243
v_exp_f32 v235, -v128
s_waitcnt lgkmcnt(4)
v_mfma_f32_16x16x32_bf16 v[52:55], v[92:95], v[20:23], v[52:55]
ds_read_b64_tr_b16 v[88:89], v233 offset:8192
v_exp_f32 v245, -v129
v_exp_f32 v244, -v130
v_exp_f32 v243, -v131
v_mfma_f32_16x16x32_bf16 v[56:59], v[92:95], v[24:27], v[56:59]
ds_read_b64_tr_b16 v[90:91], v233 offset:10240
v_add_f32 v235, 1.0, v235
v_add_f32 v245, 1.0, v245
v_mfma_f32_16x16x32_bf16 v[60:63], v[96:99], v[20:23], v[60:63]
ds_read_b64_tr_b16 v[92:93], v3 offset:8192
s_add_u32 m0, s48, 110592
s_add_u32 s49, s47, 110848
buffer_load_dwordx4 v234, s[20:23], s49 offen lds
v_add_f32 v244, 1.0, v244
v_add_f32 v243, 1.0, v243
v_mfma_f32_16x16x32_bf16 v[64:67], v[96:99], v[24:27], v[64:67]
ds_read_b64_tr_b16 v[94:95], v3 offset:10240
v_rcp_f32 v235, v235
v_rcp_f32 v245, v245
v_rcp_f32 v244, v244
s_setprio 0
s_waitcnt lgkmcnt(4)
v_mfma_f32_16x16x32_bf16 v[52:55], v[80:83], v[28:31], v[52:55]
ds_read_b64_tr_b16 v[96:97], v233 offset:12288
v_rcp_f32 v243, v243
v_mul_f32 v128, v128, v235
v_mfma_f32_16x16x32_bf16 v[56:59], v[80:83], v[32:35], v[56:59]
ds_read_b64_tr_b16 v[98:99], v233 offset:14336
v_mul_f32 v129, v129, v245
v_mul_f32 v130, v130, v244
v_mfma_f32_16x16x32_bf16 v[60:63], v[84:87], v[28:31], v[60:63]
ds_read_b64_tr_b16 v[80:81], v3 offset:12288
v_mul_f32 v131, v131, v243
v_cvt_pk_bf16_f32 v120, v120, v121
v_cvt_pk_bf16_f32 v121, v122, v123
v_mfma_f32_16x16x32_bf16 v[64:67], v[84:87], v[32:35], v[64:67]
ds_read_b64_tr_b16 v[82:83], v3 offset:14336
v_cvt_pk_bf16_f32 v122, v128, v129
v_cvt_pk_bf16_f32 v123, v130, v131
s_waitcnt lgkmcnt(4)
v_mfma_f32_16x16x32_bf16 v[52:55], v[88:91], v[36:39], v[52:55]
ds_read_b64_tr_b16 v[84:85], v233 offset:16384
v_add_u32 v255, 131072, v247
ds_write_b128 v255, v[116:119] offset:0
ds_write_b128 v255, v[120:123] offset:4096
v_mfma_f32_16x16x32_bf16 v[56:59], v[88:91], v[40:43], v[56:59]
ds_read_b64_tr_b16 v[86:87], v233 offset:18432
v_mfma_f32_16x16x32_bf16 v[60:63], v[92:95], v[36:39], v[60:63]
ds_read_b64_tr_b16 v[88:89], v3 offset:16384
v_mfma_f32_16x16x32_bf16 v[64:67], v[92:95], v[40:43], v[64:67]
ds_read_b64_tr_b16 v[90:91], v3 offset:18432
s_waitcnt vmcnt(4)
s_waitcnt lgkmcnt(3)
s_barrier
s_setprio 3
v_add_u32 v255, 122880, v247
ds_read_b128 v[68:71], v255 offset:0
ds_read_b128 v[72:75], v255 offset:4096
v_add_u32 v255, 131072, v247
ds_read_b128 v[76:79], v255 offset:0
ds_read_b128 v[100:103], v255 offset:4096
v_mfma_f32_16x16x32_bf16 v[52:55], v[96:99], v[44:47], v[52:55]
ds_read_b64_tr_b16 v[92:93], v232 offset:0
v_mfma_f32_16x16x32_bf16 v[56:59], v[96:99], v[48:51], v[56:59]
ds_read_b64_tr_b16 v[94:95], v232 offset:2048
v_mfma_f32_16x16x32_bf16 v[60:63], v[80:83], v[44:47], v[60:63]
ds_read_b64_tr_b16 v[96:97], v2 offset:0
s_add_u32 m0, s48, 118784
s_add_u32 s49, s47, 184576
buffer_load_dwordx4 v234, s[20:23], s49 offen lds
v_mfma_f32_16x16x32_bf16 v[64:67], v[80:83], v[48:51], v[64:67]
ds_read_b64_tr_b16 v[98:99], v2 offset:2048
s_waitcnt lgkmcnt(8)
v_mfma_f32_16x16x32_bf16 v[104:107], v[84:87], v[200:203], 0
ds_read_b64_tr_b16 v[80:81], v232 offset:4096
v_mfma_f32_16x16x32_bf16 v[108:111], v[84:87], v[204:207], 0
ds_read_b64_tr_b16 v[82:83], v232 offset:6144
v_mfma_f32_16x16x32_bf16 v[112:115], v[88:91], v[200:203], 0
ds_read_b64_tr_b16 v[84:85], v2 offset:4096
v_mfma_f32_16x16x32_bf16 v[116:119], v[88:91], v[204:207], 0
ds_read_b64_tr_b16 v[86:87], v2 offset:6144
s_waitcnt lgkmcnt(4)
v_mfma_f32_16x16x32_bf16 v[104:107], v[92:95], v[208:211], v[104:107]
ds_read_b64_tr_b16 v[88:89], v232 offset:8192
s_add_u32 m0, s48, 4096
s_add_u32 s49, s47, 258304
buffer_load_dwordx4 v234, s[20:23], s49 offen lds
v_mfma_f32_16x16x32_bf16 v[108:111], v[92:95], v[212:215], v[108:111]
ds_read_b64_tr_b16 v[90:91], v232 offset:10240
s_setprio 2
v_mfma_f32_16x16x32_bf16 v[112:115], v[96:99], v[208:211], v[112:115]
ds_read_b64_tr_b16 v[92:93], v2 offset:8192
v_mfma_f32_16x16x32_bf16 v[116:119], v[96:99], v[212:215], v[116:119]
ds_read_b64_tr_b16 v[94:95], v2 offset:10240
s_waitcnt lgkmcnt(4)
v_mfma_f32_16x16x32_bf16 v[104:107], v[80:83], v[216:219], v[104:107]
ds_read_b64_tr_b16 v[96:97], v232 offset:12288
v_mfma_f32_16x16x32_bf16 v[108:111], v[80:83], v[220:223], v[108:111]
ds_read_b64_tr_b16 v[98:99], v232 offset:14336
v_mfma_f32_16x16x32_bf16 v[112:115], v[84:87], v[216:219], v[112:115]
ds_read_b64_tr_b16 v[80:81], v2 offset:12288
s_add_u32 m0, s48, 40960
s_add_u32 s49, s47, 332032
buffer_load_dwordx4 v234, s[20:23], s49 offen lds
v_mfma_f32_16x16x32_bf16 v[116:119], v[84:87], v[220:223], v[116:119]
ds_read_b64_tr_b16 v[82:83], v2 offset:14336
s_waitcnt lgkmcnt(4)
v_mfma_f32_16x16x32_bf16 v[104:107], v[88:91], v[224:227], v[104:107]
ds_read_b64_tr_b16 v[84:85], v233 offset:20480
v_mfma_f32_16x16x32_bf16 v[108:111], v[88:91], v[228:231], v[108:111]
ds_read_b64_tr_b16 v[86:87], v233 offset:22528
s_setprio 1
v_mfma_f32_16x16x32_bf16 v[112:115], v[92:95], v[224:227], v[112:115]
ds_read_b64_tr_b16 v[88:89], v3 offset:20480
v_mfma_f32_16x16x32_bf16 v[116:119], v[92:95], v[228:231], v[116:119]
ds_read_b64_tr_b16 v[90:91], v3 offset:22528
s_waitcnt lgkmcnt(4)
v_mfma_f32_16x16x32_bf16 v[52:55], v[96:99], v[68:71], v[52:55]
ds_read_b64_tr_b16 v[92:93], v233 offset:24576
s_add_u32 m0, s48, 49152
s_add_u32 s49, s47, 405760
buffer_load_dwordx4 v234, s[20:23], s49 offen lds
v_mfma_f32_16x16x32_bf16 v[56:59], v[96:99], v[72:75], v[56:59]
ds_read_b64_tr_b16 v[94:95], v233 offset:26624
v_mfma_f32_16x16x32_bf16 v[60:63], v[80:83], v[68:71], v[60:63]
ds_read_b64_tr_b16 v[96:97], v3 offset:24576
v_mfma_f32_16x16x32_bf16 v[64:67], v[80:83], v[72:75], v[64:67]
ds_read_b64_tr_b16 v[98:99], v3 offset:26624
s_waitcnt lgkmcnt(4)
v_mfma_f32_16x16x32_bf16 v[52:55], v[84:87], v[76:79], v[52:55]
ds_read_b64_tr_b16 v[80:81], v233 offset:28672
v_mfma_f32_16x16x32_bf16 v[56:59], v[84:87], v[100:103], v[56:59]
ds_read_b64_tr_b16 v[82:83], v233 offset:30720
v_mfma_f32_16x16x32_bf16 v[60:63], v[88:91], v[76:79], v[60:63]
ds_read_b64_tr_b16 v[84:85], v3 offset:28672
s_add_u32 m0, s48, 57344
s_add_u32 s49, s47, 37248
buffer_load_dwordx4 v234, s[20:23], s49 offen lds
v_mfma_f32_16x16x32_bf16 v[64:67], v[88:91], v[100:103], v[64:67]
ds_read_b64_tr_b16 v[86:87], v3 offset:30720
s_setprio 0
s_waitcnt lgkmcnt(4)
v_mfma_f32_16x16x32_bf16 v[104:107], v[92:95], v[4:7], v[104:107]
ds_read_b64_tr_b16 v[88:89], v233 offset:32768
v_mfma_f32_16x16x32_bf16 v[108:111], v[92:95], v[8:11], v[108:111]
ds_read_b64_tr_b16 v[90:91], v233 offset:34816
v_mfma_f32_16x16x32_bf16 v[112:115], v[96:99], v[4:7], v[112:115]
ds_read_b64_tr_b16 v[92:93], v3 offset:32768
v_mfma_f32_16x16x32_bf16 v[116:119], v[96:99], v[8:11], v[116:119]
ds_read_b64_tr_b16 v[94:95], v3 offset:34816
s_waitcnt lgkmcnt(4)
v_mfma_f32_16x16x32_bf16 v[104:107], v[80:83], v[12:15], v[104:107]
ds_read_b64_tr_b16 v[96:97], v233 offset:36864
v_mfma_f32_16x16x32_bf16 v[108:111], v[80:83], v[16:19], v[108:111]
ds_read_b64_tr_b16 v[98:99], v233 offset:38912
v_mfma_f32_16x16x32_bf16 v[112:115], v[84:87], v[12:15], v[112:115]
ds_read_b64_tr_b16 v[80:81], v3 offset:36864
v_cvt_pk_bf16_f32 v52, v52, v53
v_cvt_pk_bf16_f32 v53, v54, v55
v_cvt_pk_bf16_f32 v54, v60, v61
v_cvt_pk_bf16_f32 v55, v62, v63
s_add_u32 s50, s55, 0
buffer_store_dwordx4 v[52:55], v248, s[24:27], s50 offen sc1
v_mfma_f32_16x16x32_bf16 v[116:119], v[84:87], v[16:19], v[116:119]
ds_read_b64_tr_b16 v[82:83], v3 offset:38912
s_waitcnt vmcnt(6)
s_barrier
s_setprio 3
s_waitcnt lgkmcnt(4)
v_mfma_f32_16x16x32_bf16 v[104:107], v[88:91], v[20:23], v[104:107]
ds_read_b64_tr_b16 v[84:85], v232 offset:16384
v_mfma_f32_16x16x32_bf16 v[108:111], v[88:91], v[24:27], v[108:111]
ds_read_b64_tr_b16 v[86:87], v232 offset:18432
v_mfma_f32_16x16x32_bf16 v[112:115], v[92:95], v[20:23], v[112:115]
ds_read_b64_tr_b16 v[88:89], v2 offset:16384
s_add_u32 m0, s48, 12288
s_add_u32 s49, s47, 110976
buffer_load_dwordx4 v234, s[20:23], s49 offen lds
v_mfma_f32_16x16x32_bf16 v[116:119], v[92:95], v[24:27], v[116:119]
ds_read_b64_tr_b16 v[90:91], v2 offset:18432
s_waitcnt lgkmcnt(4)
v_mfma_f32_16x16x32_bf16 v[104:107], v[96:99], v[28:31], v[104:107]
ds_read_b64_tr_b16 v[92:93], v232 offset:20480
v_mfma_f32_16x16x32_bf16 v[108:111], v[96:99], v[32:35], v[108:111]
ds_read_b64_tr_b16 v[94:95], v232 offset:22528
v_mfma_f32_16x16x32_bf16 v[112:115], v[80:83], v[28:31], v[112:115]
ds_read_b64_tr_b16 v[96:97], v2 offset:20480
s_add_u32 m0, s48, 20480
s_add_u32 s49, s47, 184704
buffer_load_dwordx4 v234, s[20:23], s49 offen lds
v_mfma_f32_16x16x32_bf16 v[116:119], v[80:83], v[32:35], v[116:119]
ds_read_b64_tr_b16 v[98:99], v2 offset:22528
v_cvt_pk_bf16_f32 v56, v56, v57
v_cvt_pk_bf16_f32 v57, v58, v59
v_cvt_pk_bf16_f32 v58, v64, v65
v_cvt_pk_bf16_f32 v59, v66, v67
s_add_u32 s50, s55, 12288
buffer_store_dwordx4 v[56:59], v248, s[24:27], s50 offen sc1
s_waitcnt lgkmcnt(4)
v_mfma_f32_16x16x32_bf16 v[104:107], v[84:87], v[36:39], v[104:107]
ds_read_b64_tr_b16 v[80:81], v232 offset:24576
v_mfma_f32_16x16x32_bf16 v[108:111], v[84:87], v[40:43], v[108:111]
ds_read_b64_tr_b16 v[82:83], v232 offset:26624
s_setprio 2
v_mfma_f32_16x16x32_bf16 v[112:115], v[88:91], v[36:39], v[112:115]
ds_read_b64_tr_b16 v[84:85], v2 offset:24576
s_add_u32 m0, s48, 28672
s_add_u32 s49, s47, 258432
buffer_load_dwordx4 v234, s[20:23], s49 offen lds
v_mfma_f32_16x16x32_bf16 v[116:119], v[88:91], v[40:43], v[116:119]
ds_read_b64_tr_b16 v[86:87], v2 offset:26624
s_waitcnt lgkmcnt(4)
v_mfma_f32_16x16x32_bf16 v[104:107], v[92:95], v[44:47], v[104:107]
ds_read_b64_tr_b16 v[88:89], v232 offset:28672
v_mfma_f32_16x16x32_bf16 v[108:111], v[92:95], v[48:51], v[108:111]
ds_read_b64_tr_b16 v[90:91], v232 offset:30720
v_mfma_f32_16x16x32_bf16 v[112:115], v[96:99], v[44:47], v[112:115]
ds_read_b64_tr_b16 v[92:93], v2 offset:28672
s_add_u32 m0, s48, 69632
s_add_u32 s49, s47, 332160
buffer_load_dwordx4 v234, s[20:23], s49 offen lds
v_mfma_f32_16x16x32_bf16 v[116:119], v[96:99], v[48:51], v[116:119]
ds_read_b64_tr_b16 v[94:95], v2 offset:30720
s_waitcnt lgkmcnt(4)
v_mfma_f32_16x16x32_bf16 v[104:107], v[80:83], v[68:71], v[104:107]
ds_read_b64_tr_b16 v[96:97], v232 offset:32768
v_mfma_f32_16x16x32_bf16 v[108:111], v[80:83], v[72:75], v[108:111]
ds_read_b64_tr_b16 v[98:99], v232 offset:34816
s_setprio 1
v_mfma_f32_16x16x32_bf16 v[112:115], v[84:87], v[68:71], v[112:115]
ds_read_b64_tr_b16 v[80:81], v2 offset:32768
s_add_u32 m0, s48, 77824
s_add_u32 s49, s47, 405888
buffer_load_dwordx4 v234, s[20:23], s49 offen lds
v_mfma_f32_16x16x32_bf16 v[116:119], v[84:87], v[72:75], v[116:119]
ds_read_b64_tr_b16 v[82:83], v2 offset:34816
s_waitcnt lgkmcnt(4)
v_mfma_f32_16x16x32_bf16 v[104:107], v[88:91], v[76:79], v[104:107]
ds_read_b64_tr_b16 v[84:85], v232 offset:36864
v_mfma_f32_16x16x32_bf16 v[108:111], v[88:91], v[100:103], v[108:111]
ds_read_b64_tr_b16 v[86:87], v232 offset:38912
v_mfma_f32_16x16x32_bf16 v[112:115], v[92:95], v[76:79], v[112:115]
ds_read_b64_tr_b16 v[88:89], v2 offset:36864
s_add_u32 m0, s48, 126976
s_add_u32 s49, s47, 37376
buffer_load_dwordx4 v234, s[20:23], s49 offen lds
v_mfma_f32_16x16x32_bf16 v[116:119], v[92:95], v[100:103], v[116:119]
ds_read_b64_tr_b16 v[90:91], v2 offset:38912
s_waitcnt lgkmcnt(4)
v_mfma_f32_16x16x32_bf16 v[52:55], v[96:99], v[200:203], 0
ds_read_b64_tr_b16 v[92:93], v232 offset:40960
v_mfma_f32_16x16x32_bf16 v[60:63], v[96:99], v[204:207], 0
ds_read_b64_tr_b16 v[94:95], v232 offset:43008
v_mfma_f32_16x16x32_bf16 v[120:123], v[80:83], v[200:203], 0
ds_read_b64_tr_b16 v[96:97], v2 offset:40960
v_mfma_f32_16x16x32_bf16 v[124:127], v[80:83], v[204:207], 0
ds_read_b64_tr_b16 v[98:99], v2 offset:43008
s_setprio 0
s_waitcnt lgkmcnt(4)
v_mfma_f32_16x16x32_bf16 v[52:55], v[84:87], v[208:211], v[52:55]
ds_read_b64_tr_b16 v[80:81], v232 offset:45056
s_waitcnt vmcnt(4)
s_add_u32 s50, s56, 0
v_mov_b32 v244, s98
v_mov_b32 v245, s99
s_mov_b64 exec, 1
buffer_store_dwordx2 v[244:245], v248, s[24:27], s50 offen sc1
s_mov_b64 exec, -1
v_mfma_f32_16x16x32_bf16 v[60:63], v[84:87], v[212:215], v[60:63]
ds_read_b64_tr_b16 v[82:83], v232 offset:47104
v_mfma_f32_16x16x32_bf16 v[120:123], v[88:91], v[208:211], v[120:123]
ds_read_b64_tr_b16 v[84:85], v2 offset:45056
v_cvt_pk_bf16_f32 v104, v104, v105
v_cvt_pk_bf16_f32 v105, v106, v107
v_cvt_pk_bf16_f32 v106, v112, v113
v_cvt_pk_bf16_f32 v107, v114, v115
s_add_u32 s50, s55, 196608
buffer_store_dwordx4 v[104:107], v248, s[24:27], s50 offen sc1
v_mfma_f32_16x16x32_bf16 v[124:127], v[88:91], v[212:215], v[124:127]
ds_read_b64_tr_b16 v[86:87], v2 offset:47104
s_waitcnt lgkmcnt(4)
v_mfma_f32_16x16x32_bf16 v[52:55], v[92:95], v[216:219], v[52:55]
ds_read_b64_tr_b16 v[88:89], v232 offset:49152
v_mfma_f32_16x16x32_bf16 v[60:63], v[92:95], v[220:223], v[60:63]
ds_read_b64_tr_b16 v[90:91], v232 offset:51200
v_mfma_f32_16x16x32_bf16 v[120:123], v[96:99], v[216:219], v[120:123]
ds_read_b64_tr_b16 v[92:93], v2 offset:49152
v_mfma_f32_16x16x32_bf16 v[124:127], v[96:99], v[220:223], v[124:127]
ds_read_b64_tr_b16 v[94:95], v2 offset:51200
s_barrier
s_setprio 3
s_waitcnt lgkmcnt(4)
v_mfma_f32_16x16x32_bf16 v[52:55], v[80:83], v[224:227], v[52:55]
ds_read_b64_tr_b16 v[96:97], v232 offset:53248
v_mfma_f32_16x16x32_bf16 v[60:63], v[80:83], v[228:231], v[60:63]
ds_read_b64_tr_b16 v[98:99], v232 offset:55296
v_mfma_f32_16x16x32_bf16 v[120:123], v[84:87], v[224:227], v[120:123]
ds_read_b64_tr_b16 v[80:81], v2 offset:53248
s_add_u32 m0, s48, 36864
s_add_u32 s49, s47, 111104
buffer_load_dwordx4 v234, s[20:23], s49 offen lds
v_mfma_f32_16x16x32_bf16 v[124:127], v[84:87], v[228:231], v[124:127]
ds_read_b64_tr_b16 v[82:83], v2 offset:55296
v_cvt_pk_bf16_f32 v108, v108, v109
v_cvt_pk_bf16_f32 v109, v110, v111
v_cvt_pk_bf16_f32 v110, v116, v117
v_cvt_pk_bf16_f32 v111, v118, v119
s_add_u32 s50, s55, 208896
buffer_store_dwordx4 v[108:111], v248, s[24:27], s50 offen sc1
s_waitcnt lgkmcnt(4)
v_mfma_f32_16x16x32_bf16 v[52:55], v[88:91], v[4:7], v[52:55]
ds_read_b64_tr_b16 v[84:85], v233 offset:0
v_mfma_f32_16x16x32_bf16 v[60:63], v[88:91], v[8:11], v[60:63]
ds_read_b64_tr_b16 v[86:87], v233 offset:2048
v_mfma_f32_16x16x32_bf16 v[120:123], v[92:95], v[4:7], v[120:123]
ds_read_b64_tr_b16 v[88:89], v3 offset:0
v_mfma_f32_16x16x32_bf16 v[124:127], v[92:95], v[8:11], v[124:127]
ds_read_b64_tr_b16 v[90:91], v3 offset:2048
s_waitcnt lgkmcnt(4)
v_mfma_f32_16x16x32_bf16 v[52:55], v[96:99], v[12:15], v[52:55]
ds_read_b64_tr_b16 v[92:93], v233 offset:4096
v_mfma_f32_16x16x32_bf16 v[60:63], v[96:99], v[16:19], v[60:63]
ds_read_b64_tr_b16 v[94:95], v233 offset:6144
s_setprio 2
v_mfma_f32_16x16x32_bf16 v[120:123], v[80:83], v[12:15], v[120:123]
ds_read_b64_tr_b16 v[96:97], v3 offset:4096
s_add_u32 m0, s48, 86016
s_add_u32 s49, s47, 184832
buffer_load_dwordx4 v234, s[20:23], s49 offen lds
v_mfma_f32_16x16x32_bf16 v[124:127], v[80:83], v[16:19], v[124:127]
ds_read_b64_tr_b16 v[98:99], v3 offset:6144
s_waitcnt lgkmcnt(4)
v_mfma_f32_16x16x32_bf16 v[52:55], v[84:87], v[20:23], v[52:55]
ds_read_b64_tr_b16 v[80:81], v233 offset:8192
v_mfma_f32_16x16x32_bf16 v[60:63], v[84:87], v[24:27], v[60:63]
ds_read_b64_tr_b16 v[82:83], v233 offset:10240
v_mfma_f32_16x16x32_bf16 v[120:123], v[88:91], v[20:23], v[120:123]
ds_read_b64_tr_b16 v[84:85], v3 offset:8192
v_mfma_f32_16x16x32_bf16 v[124:127], v[88:91], v[24:27], v[124:127]
ds_read_b64_tr_b16 v[86:87], v3 offset:10240
s_waitcnt lgkmcnt(4)
v_mfma_f32_16x16x32_bf16 v[52:55], v[92:95], v[28:31], v[52:55]
ds_read_b64_tr_b16 v[88:89], v233 offset:40960
v_mfma_f32_16x16x32_bf16 v[60:63], v[92:95], v[32:35], v[60:63]
ds_read_b64_tr_b16 v[90:91], v233 offset:43008
s_setprio 1
v_mfma_f32_16x16x32_bf16 v[120:123], v[96:99], v[28:31], v[120:123]
ds_read_b64_tr_b16 v[92:93], v3 offset:40960
s_add_u32 m0, s48, 94208
s_add_u32 s49, s47, 258560
buffer_load_dwordx4 v234, s[20:23], s49 offen lds
v_mfma_f32_16x16x32_bf16 v[124:127], v[96:99], v[32:35], v[124:127]
ds_read_b64_tr_b16 v[94:95], v3 offset:43008
s_waitcnt lgkmcnt(4)
v_mfma_f32_16x16x32_bf16 v[52:55], v[80:83], v[36:39], v[52:55]
ds_read_b64_tr_b16 v[96:97], v233 offset:45056
v_mfma_f32_16x16x32_bf16 v[60:63], v[80:83], v[40:43], v[60:63]
ds_read_b64_tr_b16 v[98:99], v233 offset:47104
v_mfma_f32_16x16x32_bf16 v[120:123], v[84:87], v[36:39], v[120:123]
ds_read_b64_tr_b16 v[80:81], v3 offset:45056
v_mfma_f32_16x16x32_bf16 v[124:127], v[84:87], v[40:43], v[124:127]
ds_read_b64_tr_b16 v[82:83], v3 offset:47104
s_waitcnt lgkmcnt(4)
v_mfma_f32_16x16x32_bf16 v[52:55], v[88:91], v[44:47], v[52:55]
ds_read_b64_tr_b16 v[84:85], v233 offset:49152
s_waitcnt vmcnt(2)
s_add_u32 s50, s56, 32768
v_mov_b32 v244, s98
v_mov_b32 v245, s99
s_mov_b64 exec, 1
buffer_store_dwordx2 v[244:245], v248, s[24:27], s50 offen sc1
s_mov_b64 exec, -1
v_mfma_f32_16x16x32_bf16 v[60:63], v[88:91], v[48:51], v[60:63]
ds_read_b64_tr_b16 v[86:87], v233 offset:51200
v_mfma_f32_16x16x32_bf16 v[120:123], v[92:95], v[44:47], v[120:123]
ds_read_b64_tr_b16 v[88:89], v3 offset:49152
s_add_u32 m0, s48, 102400
s_add_u32 s49, s47, 332288
buffer_load_dwordx4 v234, s[20:23], s49 offen lds
v_mfma_f32_16x16x32_bf16 v[124:127], v[92:95], v[48:51], v[124:127]
ds_read_b64_tr_b16 v[90:91], v3 offset:51200
s_setprio 0
s_waitcnt lgkmcnt(4)
v_mfma_f32_16x16x32_bf16 v[52:55], v[96:99], v[68:71], v[52:55]
ds_read_b64_tr_b16 v[92:93], v233 offset:53248
v_mfma_f32_16x16x32_bf16 v[60:63], v[96:99], v[72:75], v[60:63]
ds_read_b64_tr_b16 v[94:95], v233 offset:55296
v_mfma_f32_16x16x32_bf16 v[120:123], v[80:83], v[68:71], v[120:123]
ds_read_b64_tr_b16 v[96:97], v3 offset:53248
v_mfma_f32_16x16x32_bf16 v[124:127], v[80:83], v[72:75], v[124:127]
ds_read_b64_tr_b16 v[98:99], v3 offset:55296
s_waitcnt lgkmcnt(4)
v_mfma_f32_16x16x32_bf16 v[52:55], v[84:87], v[76:79], v[52:55]
ds_read_b64_tr_b16 v[80:81], v233 offset:57344
v_mfma_f32_16x16x32_bf16 v[60:63], v[84:87], v[100:103], v[60:63]
ds_read_b64_tr_b16 v[82:83], v233 offset:59392
v_mfma_f32_16x16x32_bf16 v[120:123], v[88:91], v[76:79], v[120:123]
ds_read_b64_tr_b16 v[84:85], v3 offset:57344
v_mfma_f32_16x16x32_bf16 v[124:127], v[88:91], v[100:103], v[124:127]
ds_read_b64_tr_b16 v[86:87], v3 offset:59392
s_barrier
s_setprio 3
s_waitcnt lgkmcnt(4)
v_mfma_f32_16x16x32_bf16 v[56:59], v[92:95], v[200:203], 0
ds_read_b64_tr_b16 v[88:89], v233 offset:61440
v_mfma_f32_16x16x32_bf16 v[64:67], v[92:95], v[204:207], 0
ds_read_b64_tr_b16 v[90:91], v233 offset:63488
v_mfma_f32_16x16x32_bf16 v[104:107], v[96:99], v[200:203], 0
ds_read_b64_tr_b16 v[92:93], v3 offset:61440
s_add_u32 m0, s48, 0
s_add_u32 s49, s47, 406016
buffer_load_dwordx4 v234, s[20:23], s49 offen lds
v_mfma_f32_16x16x32_bf16 v[108:111], v[96:99], v[204:207], 0
ds_read_b64_tr_b16 v[94:95], v3 offset:63488
s_waitcnt lgkmcnt(4)
v_mfma_f32_16x16x32_bf16 v[56:59], v[80:83], v[208:211], v[56:59]
ds_read_b64_tr_b16 v[96:97], v233 offset:12288
v_mfma_f32_16x16x32_bf16 v[64:67], v[80:83], v[212:215], v[64:67]
ds_read_b64_tr_b16 v[98:99], v233 offset:14336
v_mfma_f32_16x16x32_bf16 v[104:107], v[84:87], v[208:211], v[104:107]
ds_read_b64_tr_b16 v[80:81], v3 offset:12288
v_cvt_pk_bf16_f32 v52, v52, v53
v_cvt_pk_bf16_f32 v53, v54, v55
v_cvt_pk_bf16_f32 v54, v120, v121
v_cvt_pk_bf16_f32 v55, v122, v123
s_add_u32 s50, s55, 393216
buffer_store_dwordx4 v[52:55], v248, s[24:27], s50 offen sc1
v_mfma_f32_16x16x32_bf16 v[108:111], v[84:87], v[212:215], v[108:111]
ds_read_b64_tr_b16 v[82:83], v3 offset:14336
s_waitcnt lgkmcnt(4)
v_mfma_f32_16x16x32_bf16 v[56:59], v[88:91], v[216:219], v[56:59]
ds_read_b64_tr_b16 v[84:85], v233 offset:16384
s_add_u32 m0, s48, 8192
s_add_u32 s49, s47, 37504
buffer_load_dwordx4 v234, s[20:23], s49 offen lds
v_mfma_f32_16x16x32_bf16 v[64:67], v[88:91], v[220:223], v[64:67]
ds_read_b64_tr_b16 v[86:87], v233 offset:18432
s_setprio 2
v_mfma_f32_16x16x32_bf16 v[104:107], v[92:95], v[216:219], v[104:107]
ds_read_b64_tr_b16 v[88:89], v3 offset:16384
v_mfma_f32_16x16x32_bf16 v[108:111], v[92:95], v[220:223], v[108:111]
ds_read_b64_tr_b16 v[90:91], v3 offset:18432
s_waitcnt lgkmcnt(4)
v_mfma_f32_16x16x32_bf16 v[56:59], v[96:99], v[224:227], v[56:59]
ds_read_b64_tr_b16 v[92:93], v233 offset:20480
v_mfma_f32_16x16x32_bf16 v[64:67], v[96:99], v[228:231], v[64:67]
ds_read_b64_tr_b16 v[94:95], v233 offset:22528
v_mfma_f32_16x16x32_bf16 v[104:107], v[80:83], v[224:227], v[104:107]
ds_read_b64_tr_b16 v[96:97], v3 offset:20480
s_add_u32 m0, s48, 45056
s_add_u32 s49, s47, 111232
buffer_load_dwordx4 v234, s[20:23], s49 offen lds
v_mfma_f32_16x16x32_bf16 v[108:111], v[80:83], v[228:231], v[108:111]
ds_read_b64_tr_b16 v[98:99], v3 offset:22528
v_cvt_pk_bf16_f32 v60, v60, v61
v_cvt_pk_bf16_f32 v61, v62, v63
v_cvt_pk_bf16_f32 v62, v124, v125
v_cvt_pk_bf16_f32 v63, v126, v127
s_add_u32 s50, s55, 405504
buffer_store_dwordx4 v[60:63], v248, s[24:27], s50 offen sc1
s_waitcnt lgkmcnt(4)
v_mfma_f32_16x16x32_bf16 v[56:59], v[84:87], v[4:7], v[56:59]
ds_read_b64_tr_b16 v[80:81], v233 offset:24576
v_mfma_f32_16x16x32_bf16 v[64:67], v[84:87], v[8:11], v[64:67]
ds_read_b64_tr_b16 v[82:83], v233 offset:26624
s_setprio 1
v_mfma_f32_16x16x32_bf16 v[104:107], v[88:91], v[4:7], v[104:107]
ds_read_b64_tr_b16 v[84:85], v3 offset:24576
v_mfma_f32_16x16x32_bf16 v[108:111], v[88:91], v[8:11], v[108:111]
ds_read_b64_tr_b16 v[86:87], v3 offset:26624
s_waitcnt lgkmcnt(4)
v_mfma_f32_16x16x32_bf16 v[56:59], v[92:95], v[12:15], v[56:59]
ds_read_b64_tr_b16 v[88:89], v233 offset:28672
s_add_u32 m0, s48, 110592
s_add_u32 s49, s47, 184960
buffer_load_dwordx4 v234, s[20:23], s49 offen lds
v_mfma_f32_16x16x32_bf16 v[64:67], v[92:95], v[16:19], v[64:67]
ds_read_b64_tr_b16 v[90:91], v233 offset:30720
v_mfma_f32_16x16x32_bf16 v[104:107], v[96:99], v[12:15], v[104:107]
ds_read_b64_tr_b16 v[92:93], v3 offset:28672
v_mfma_f32_16x16x32_bf16 v[108:111], v[96:99], v[16:19], v[108:111]
ds_read_b64_tr_b16 v[94:95], v3 offset:30720
s_waitcnt lgkmcnt(4)
v_mfma_f32_16x16x32_bf16 v[56:59], v[80:83], v[20:23], v[56:59]
ds_read_b64_tr_b16 v[96:97], v232 offset:0
v_mfma_f32_16x16x32_bf16 v[64:67], v[80:83], v[24:27], v[64:67]
ds_read_b64_tr_b16 v[98:99], v232 offset:2048
v_mfma_f32_16x16x32_bf16 v[104:107], v[84:87], v[20:23], v[104:107]
ds_read_b64_tr_b16 v[80:81], v2 offset:0
s_add_u32 m0, s48, 118784
s_add_u32 s49, s47, 258688
buffer_load_dwordx4 v234, s[20:23], s49 offen lds
v_mfma_f32_16x16x32_bf16 v[108:111], v[84:87], v[24:27], v[108:111]
ds_read_b64_tr_b16 v[82:83], v2 offset:2048
s_setprio 0
s_waitcnt lgkmcnt(4)
v_mfma_f32_16x16x32_bf16 v[56:59], v[88:91], v[28:31], v[56:59]
ds_read_b64_tr_b16 v[84:85], v232 offset:4096
v_mfma_f32_16x16x32_bf16 v[64:67], v[88:91], v[32:35], v[64:67]
ds_read_b64_tr_b16 v[86:87], v232 offset:6144
v_mfma_f32_16x16x32_bf16 v[104:107], v[92:95], v[28:31], v[104:107]
ds_read_b64_tr_b16 v[88:89], v2 offset:4096
v_mfma_f32_16x16x32_bf16 v[108:111], v[92:95], v[32:35], v[108:111]
ds_read_b64_tr_b16 v[90:91], v2 offset:6144
s_waitcnt lgkmcnt(4)
v_mfma_f32_16x16x32_bf16 v[56:59], v[96:99], v[36:39], v[56:59]
ds_read_b64_tr_b16 v[92:93], v232 offset:8192
v_mfma_f32_16x16x32_bf16 v[64:67], v[96:99], v[40:43], v[64:67]
ds_read_b64_tr_b16 v[94:95], v232 offset:10240
v_mfma_f32_16x16x32_bf16 v[104:107], v[80:83], v[36:39], v[104:107]
ds_read_b64_tr_b16 v[96:97], v2 offset:8192
v_mfma_f32_16x16x32_bf16 v[108:111], v[80:83], v[40:43], v[108:111]
ds_read_b64_tr_b16 v[98:99], v2 offset:10240
s_waitcnt vmcnt(9)
s_barrier
s_setprio 3
s_mov_b32 s50, 46141440
v_min_u32 v255, 63, v1
v_lshlrev_b32 v255, 3, v255
buffer_load_dwordx2 v[244:245], v255, s[24:27], s50 offen sc1
s_waitcnt lgkmcnt(4)
v_mfma_f32_16x16x32_bf16 v[56:59], v[84:87], v[44:47], v[56:59]
ds_read_b64_tr_b16 v[80:81], v232 offset:12288
s_waitcnt vmcnt(3)
s_add_u32 s50, s56, 65536
v_mov_b32 v242, s98
v_mov_b32 v243, s99
s_mov_b64 exec, 1
buffer_store_dwordx2 v[242:243], v248, s[24:27], s50 offen sc1
s_mov_b64 exec, -1
v_mfma_f32_16x16x32_bf16 v[64:67], v[84:87], v[48:51], v[64:67]
ds_read_b64_tr_b16 v[82:83], v232 offset:14336
v_mfma_f32_16x16x32_bf16 v[104:107], v[88:91], v[44:47], v[104:107]
ds_read_b64_tr_b16 v[84:85], v2 offset:12288
s_add_u32 m0, s48, 16384
s_add_u32 s49, s47, 332416
buffer_load_dwordx4 v234, s[20:23], s49 offen lds
v_mfma_f32_16x16x32_bf16 v[108:111], v[88:91], v[48:51], v[108:111]
ds_read_b64_tr_b16 v[86:87], v2 offset:14336
s_waitcnt lgkmcnt(4)
v_mfma_f32_16x16x32_bf16 v[56:59], v[92:95], v[68:71], v[56:59]
ds_read_b64_tr_b16 v[88:89], v232 offset:57344
v_mfma_f32_16x16x32_bf16 v[64:67], v[92:95], v[72:75], v[64:67]
ds_read_b64_tr_b16 v[90:91], v232 offset:59392
v_mfma_f32_16x16x32_bf16 v[104:107], v[96:99], v[68:71], v[104:107]
ds_read_b64_tr_b16 v[92:93], v2 offset:57344
v_mfma_f32_16x16x32_bf16 v[108:111], v[96:99], v[72:75], v[108:111]
ds_read_b64_tr_b16 v[94:95], v2 offset:59392
s_waitcnt lgkmcnt(4)
v_mfma_f32_16x16x32_bf16 v[56:59], v[80:83], v[76:79], v[56:59]
ds_read_b64_tr_b16 v[96:97], v232 offset:61440
v_mfma_f32_16x16x32_bf16 v[64:67], v[80:83], v[100:103], v[64:67]
ds_read_b64_tr_b16 v[98:99], v232 offset:63488
s_setprio 2
v_mfma_f32_16x16x32_bf16 v[104:107], v[84:87], v[76:79], v[104:107]
ds_read_b64_tr_b16 v[80:81], v2 offset:61440
s_add_u32 m0, s48, 24576
s_add_u32 s49, s47, 406144
buffer_load_dwordx4 v234, s[20:23], s49 offen lds
v_mfma_f32_16x16x32_bf16 v[108:111], v[84:87], v[100:103], v[108:111]
ds_read_b64_tr_b16 v[82:83], v2 offset:63488
s_waitcnt lgkmcnt(4)
v_mfma_f32_16x16x32_bf16 v[52:55], v[88:91], v[200:203], 0
ds_read_b64_tr_b16 v[84:85], v233 offset:32768
v_mfma_f32_16x16x32_bf16 v[60:63], v[88:91], v[204:207], 0
ds_read_b64_tr_b16 v[86:87], v233 offset:34816
v_mfma_f32_16x16x32_bf16 v[112:115], v[92:95], v[200:203], 0
ds_read_b64_tr_b16 v[88:89], v3 offset:32768
v_mfma_f32_16x16x32_bf16 v[116:119], v[92:95], v[204:207], 0
ds_read_b64_tr_b16 v[90:91], v3 offset:34816
s_waitcnt lgkmcnt(4)
v_mfma_f32_16x16x32_bf16 v[52:55], v[96:99], v[208:211], v[52:55]
ds_read_b64_tr_b16 v[92:93], v233 offset:36864
v_mfma_f32_16x16x32_bf16 v[60:63], v[96:99], v[212:215], v[60:63]
ds_read_b64_tr_b16 v[94:95], v233 offset:38912
s_setprio 1
v_mfma_f32_16x16x32_bf16 v[112:115], v[80:83], v[208:211], v[112:115]
ds_read_b64_tr_b16 v[96:97], v3 offset:36864
s_add_u32 m0, s48, 53248
s_add_u32 s49, s47, 37632
buffer_load_dwordx4 v234, s[20:23], s49 offen lds
v_and_b32 v255, 1, v1
v_lshlrev_b32 v255, 4, v255
v_mov_b32 v254, 0x3f80
v_lshlrev_b32 v255, v255, v254
v_lshrrev_b32 v254, 1, v251
v_cmp_eq_u32 vcc, 0, v254
s_nop 1
v_cndmask_b32 v120, 0, v255, vcc
v_cmp_eq_u32 vcc, 1, v254
s_nop 1
v_cndmask_b32 v121, 0, v255, vcc
v_cmp_eq_u32 vcc, 2, v254
s_nop 1
v_cndmask_b32 v122, 0, v255, vcc
v_cmp_eq_u32 vcc, 3, v254
s_nop 1
v_cndmask_b32 v123, 0, v255, vcc
v_cmp_eq_u32 vcc, 4, v254
s_nop 1
v_cndmask_b32 v124, 0, v255, vcc
v_cmp_eq_u32 vcc, 5, v254
s_nop 1
v_cndmask_b32 v125, 0, v255, vcc
v_cmp_eq_u32 vcc, 6, v254
s_nop 1
v_cndmask_b32 v126, 0, v255, vcc
v_cmp_eq_u32 vcc, 7, v254
s_nop 1
v_cndmask_b32 v127, 0, v255, vcc
v_lshlrev_b32 v255, 4, v251
v_lshl_add_u32 v235, v252, 10, v255
v_and_b32 v255, 1, v252
v_lshrrev_b32 v254, 1, v252
v_lshl_add_u32 v254, v254, 4, v251
v_mul_u32_u24 v254, 1152, v254
v_lshl_add_u32 v243, v255, 5, v254
buffer_load_dwordx4 v[128:131], v243, s[8:11], s6 offen offset:0
v_mfma_f32_16x16x32_bf16 v[116:119], v[80:83], v[212:215], v[116:119]
ds_read_b64_tr_b16 v[98:99], v3 offset:38912
v_cvt_pk_bf16_f32 v56, v56, v57
v_cvt_pk_bf16_f32 v57, v58, v59
v_cvt_pk_bf16_f32 v58, v104, v105
v_cvt_pk_bf16_f32 v59, v106, v107
s_add_u32 s50, s55, 589824
buffer_store_dwordx4 v[56:59], v248, s[24:27], s50 offen sc1
s_waitcnt lgkmcnt(4)
v_mfma_f32_16x16x32_bf16 v[52:55], v[84:87], v[216:219], v[52:55]
ds_read_b64_tr_b16 v[80:81], v232 offset:16384
v_mfma_f32_16x16x32_bf16 v[60:63], v[84:87], v[220:223], v[60:63]
ds_read_b64_tr_b16 v[82:83], v232 offset:18432
v_mfma_f32_16x16x32_bf16 v[112:115], v[88:91], v[216:219], v[112:115]
ds_read_b64_tr_b16 v[84:85], v2 offset:16384
v_mfma_f32_16x16x32_bf16 v[116:119], v[88:91], v[220:223], v[116:119]
ds_read_b64_tr_b16 v[86:87], v2 offset:18432
s_waitcnt lgkmcnt(4)
v_mfma_f32_16x16x32_bf16 v[52:55], v[92:95], v[224:227], v[52:55]
ds_read_b64_tr_b16 v[88:89], v232 offset:20480
v_mfma_f32_16x16x32_bf16 v[60:63], v[92:95], v[228:231], v[60:63]
ds_read_b64_tr_b16 v[90:91], v232 offset:22528
v_mfma_f32_16x16x32_bf16 v[112:115], v[96:99], v[224:227], v[112:115]
ds_read_b64_tr_b16 v[92:93], v2 offset:20480
s_add_u32 m0, s48, 61440
s_add_u32 s49, s47, 111360
buffer_load_dwordx4 v234, s[20:23], s49 offen lds
v_mfma_f32_16x16x32_bf16 v[116:119], v[96:99], v[228:231], v[116:119]
ds_read_b64_tr_b16 v[94:95], v2 offset:22528
v_cvt_pk_bf16_f32 v64, v64, v65
v_cvt_pk_bf16_f32 v65, v66, v67
v_cvt_pk_bf16_f32 v66, v108, v109
v_cvt_pk_bf16_f32 v67, v110, v111
s_add_u32 s50, s55, 602112
buffer_store_dwordx4 v[64:67], v248, s[24:27], s50 offen sc1
s_setprio 0
s_waitcnt lgkmcnt(4)
v_mfma_f32_16x16x32_bf16 v[52:55], v[80:83], v[4:7], v[52:55]
ds_read_b64_tr_b16 v[96:97], v232 offset:24576
v_mfma_f32_16x16x32_bf16 v[60:63], v[80:83], v[8:11], v[60:63]
ds_read_b64_tr_b16 v[98:99], v232 offset:26624
v_mfma_f32_16x16x32_bf16 v[112:115], v[84:87], v[4:7], v[112:115]
ds_read_b64_tr_b16 v[80:81], v2 offset:24576
v_mfma_f32_16x16x32_bf16 v[116:119], v[84:87], v[8:11], v[116:119]
ds_read_b64_tr_b16 v[82:83], v2 offset:26624
s_waitcnt lgkmcnt(4)
v_mfma_f32_16x16x32_bf16 v[52:55], v[88:91], v[12:15], v[52:55]
ds_read_b64_tr_b16 v[84:85], v232 offset:28672
v_mfma_f32_16x16x32_bf16 v[60:63], v[88:91], v[16:19], v[60:63]
ds_read_b64_tr_b16 v[86:87], v232 offset:30720
v_mfma_f32_16x16x32_bf16 v[112:115], v[92:95], v[12:15], v[112:115]
ds_read_b64_tr_b16 v[88:89], v2 offset:28672
v_mfma_f32_16x16x32_bf16 v[116:119], v[92:95], v[16:19], v[116:119]
ds_read_b64_tr_b16 v[90:91], v2 offset:30720
s_barrier
s_setprio 3
s_waitcnt vmcnt(8)
s_mov_b32 s52, 0
L_spf1_2:
v_cmp_ne_u64 vcc, s[98:99], v[244:245]
s_nop 1
s_cmp_eq_u64 vcc, 0
s_cbranch_scc1 L_spf1_2x
s_add_u32 s52, s52, 1
s_cmp_ge_u32 s52, 0x10000
s_cbranch_scc1 L_spf1_2x
s_sleep 2
s_mov_b32 s50, 46141440
v_min_u32 v255, 63, v1
v_lshlrev_b32 v255, 3, v255
buffer_load_dwordx2 v[244:245], v255, s[24:27], s50 offen sc1
s_waitcnt vmcnt(0)
s_branch L_spf1_2
L_spf1_2x:
s_waitcnt lgkmcnt(4)
v_mfma_f32_16x16x32_bf16 v[52:55], v[96:99], v[20:23], v[52:55]
ds_read_b64_tr_b16 v[92:93], v232 offset:32768
s_add_u32 s50, s7, 0
buffer_load_dwordx4 v[140:143], v248, s[24:27], s50 offen sc1
v_mfma_f32_16x16x32_bf16 v[60:63], v[96:99], v[24:27], v[60:63]
ds_read_b64_tr_b16 v[94:95], v232 offset:34816
v_mfma_f32_16x16x32_bf16 v[112:115], v[80:83], v[20:23], v[112:115]
ds_read_b64_tr_b16 v[96:97], v2 offset:32768
s_add_u32 m0, s48, 32768
s_add_u32 s49, s47, 185088
buffer_load_dwordx4 v234, s[20:23], s49 offen lds
v_mfma_f32_16x16x32_bf16 v[116:119], v[80:83], v[24:27], v[116:119]
ds_read_b64_tr_b16 v[98:99], v2 offset:34816
s_waitcnt lgkmcnt(4)
v_mfma_f32_16x16x32_bf16 v[52:55], v[84:87], v[28:31], v[52:55]
ds_read_b64_tr_b16 v[80:81], v232 offset:36864
v_mfma_f32_16x16x32_bf16 v[60:63], v[84:87], v[32:35], v[60:63]
ds_read_b64_tr_b16 v[82:83], v232 offset:38912
v_mfma_f32_16x16x32_bf16 v[112:115], v[88:91], v[28:31], v[112:115]
ds_read_b64_tr_b16 v[84:85], v2 offset:36864
v_mfma_f32_16x16x32_bf16 v[116:119], v[88:91], v[32:35], v[116:119]
ds_read_b64_tr_b16 v[86:87], v2 offset:38912
s_waitcnt lgkmcnt(4)
v_mfma_f32_16x16x32_bf16 v[52:55], v[92:95], v[36:39], v[52:55]
ds_read_b64_tr_b16 v[88:89], v232 offset:40960
s_add_u32 m0, s48, 69632
s_add_u32 s49, s47, 258816
buffer_load_dwordx4 v234, s[20:23], s49 offen lds
v_mfma_f32_16x16x32_bf16 v[60:63], v[92:95], v[40:43], v[60:63]
ds_read_b64_tr_b16 v[90:91], v232 offset:43008
s_setprio 2
v_mfma_f32_16x16x32_bf16 v[112:115], v[96:99], v[36:39], v[112:115]
ds_read_b64_tr_b16 v[92:93], v2 offset:40960
v_mfma_f32_16x16x32_bf16 v[116:119], v[96:99], v[40:43], v[116:119]
ds_read_b64_tr_b16 v[94:95], v2 offset:43008
s_waitcnt lgkmcnt(4)
v_mfma_f32_16x16x32_bf16 v[52:55], v[80:83], v[44:47], v[52:55]
ds_read_b64_tr_b16 v[96:97], v233 offset:0
s_add_u32 s50, s7, 9216
buffer_load_dwordx4 v[144:147], v248, s[24:27], s50 offen sc1
v_mfma_f32_16x16x32_bf16 v[60:63], v[80:83], v[48:51], v[60:63]
ds_read_b64_tr_b16 v[98:99], v233 offset:2048
s_waitcnt vmcnt(4)
s_add_u32 s50, s56, 98304
v_mov_b32 v244, s98
v_mov_b32 v245, s99
s_mov_b64 exec, 1
buffer_store_dwordx2 v[244:245], v248, s[24:27], s50 offen sc1
s_mov_b64 exec, -1
v_mfma_f32_16x16x32_bf16 v[112:115], v[84:87], v[44:47], v[112:115]
ds_read_b64_tr_b16 v[80:81], v3 offset:0
s_add_u32 m0, s48, 77824
s_add_u32 s49, s47, 332544
buffer_load_dwordx4 v234, s[20:23], s49 offen lds
v_mfma_f32_16x16x32_bf16 v[116:119], v[84:87], v[48:51], v[116:119]
ds_read_b64_tr_b16 v[82:83], v3 offset:2048
s_waitcnt lgkmcnt(4)
v_mfma_f32_16x16x32_bf16 v[52:55], v[88:91], v[68:71], v[52:55]
ds_read_b64_tr_b16 v[84:85], v233 offset:4096
v_mfma_f32_16x16x32_bf16 v[60:63], v[88:91], v[72:75], v[60:63]
ds_read_b64_tr_b16 v[86:87], v233 offset:6144
s_setprio 1
v_mfma_f32_16x16x32_bf16 v[112:115], v[92:95], v[68:71], v[112:115]
ds_read_b64_tr_b16 v[88:89], v3 offset:4096
v_mfma_f32_16x16x32_bf16 v[116:119], v[92:95], v[72:75], v[116:119]
ds_read_b64_tr_b16 v[90:91], v3 offset:6144
s_waitcnt lgkmcnt(4)
v_mfma_f32_16x16x32_bf16 v[52:55], v[96:99], v[76:79], v[52:55]
ds_read_b64_tr_b16 v[92:93], v233 offset:8192
s_add_u32 m0, s48, 86016
s_add_u32 s49, s47, 406272
buffer_load_dwordx4 v234, s[20:23], s49 offen lds
v_mfma_f32_16x16x32_bf16 v[60:63], v[96:99], v[100:103], v[60:63]
ds_read_b64_tr_b16 v[94:95], v233 offset:10240
v_mfma_f32_16x16x32_bf16 v[112:115], v[80:83], v[76:79], v[112:115]
ds_read_b64_tr_b16 v[96:97], v3 offset:8192
v_mfma_f32_16x16x32_bf16 v[116:119], v[80:83], v[100:103], v[116:119]
ds_read_b64_tr_b16 v[98:99], v3 offset:10240
s_waitcnt lgkmcnt(4)
v_mfma_f32_16x16x32_bf16 v[56:59], v[84:87], v[200:203], 0
ds_read_b64_tr_b16 v[80:81], v233 offset:40960
s_add_u32 s50, s7, 18432
buffer_load_dwordx4 v[148:151], v248, s[24:27], s50 offen sc1
v_mfma_f32_16x16x32_bf16 v[64:67], v[84:87], v[204:207], 0
ds_read_b64_tr_b16 v[82:83], v233 offset:43008
v_mfma_f32_16x16x32_bf16 v[104:107], v[88:91], v[200:203], 0
ds_read_b64_tr_b16 v[84:85], v3 offset:40960
s_add_u32 m0, s48, 126976
s_add_u32 s49, s47, 37760
buffer_load_dwordx4 v234, s[20:23], s49 offen lds
v_mfma_f32_16x16x32_bf16 v[108:111], v[88:91], v[204:207], 0
ds_read_b64_tr_b16 v[86:87], v3 offset:43008
s_setprio 0
s_waitcnt lgkmcnt(4)
v_mfma_f32_16x16x32_bf16 v[56:59], v[92:95], v[208:211], v[56:59]
ds_read_b64_tr_b16 v[88:89], v233 offset:45056
v_mfma_f32_16x16x32_bf16 v[64:67], v[92:95], v[212:215], v[64:67]
ds_read_b64_tr_b16 v[90:91], v233 offset:47104
v_mfma_f32_16x16x32_bf16 v[104:107], v[96:99], v[208:211], v[104:107]
ds_read_b64_tr_b16 v[92:93], v3 offset:45056
v_cvt_pk_bf16_f32 v52, v52, v53
v_cvt_pk_bf16_f32 v53, v54, v55
v_cvt_pk_bf16_f32 v54, v112, v113
v_cvt_pk_bf16_f32 v55, v114, v115
s_add_u32 s50, s55, 786432
buffer_store_dwordx4 v[52:55], v248, s[24:27], s50 offen sc1
v_mfma_f32_16x16x32_bf16 v[108:111], v[96:99], v[212:215], v[108:111]
ds_read_b64_tr_b16 v[94:95], v3 offset:47104
s_waitcnt lgkmcnt(4)
v_mfma_f32_16x16x32_bf16 v[56:59], v[80:83], v[216:219], v[56:59]
ds_read_b64_tr_b16 v[96:97], v233 offset:49152
v_mfma_f32_16x16x32_bf16 v[64:67], v[80:83], v[220:223], v[64:67]
ds_read_b64_tr_b16 v[98:99], v233 offset:51200
v_mfma_f32_16x16x32_bf16 v[104:107], v[84:87], v[216:219], v[104:107]
ds_read_b64_tr_b16 v[80:81], v3 offset:49152
v_mfma_f32_16x16x32_bf16 v[108:111], v[84:87], v[220:223], v[108:111]
ds_read_b64_tr_b16 v[82:83], v3 offset:51200
s_barrier
s_setprio 3
s_waitcnt lgkmcnt(4)
v_mfma_f32_16x16x32_bf16 v[56:59], v[88:91], v[224:227], v[56:59]
ds_read_b64_tr_b16 v[84:85], v232 offset:45056
s_add_u32 s50, s7, 27648
buffer_load_dwordx4 v[52:55], v248, s[24:27], s50 offen sc1
v_mfma_f32_16x16x32_bf16 v[64:67], v[88:91], v[228:231], v[64:67]
ds_read_b64_tr_b16 v[86:87], v232 offset:47104
v_mfma_f32_16x16x32_bf16 v[104:107], v[92:95], v[224:227], v[104:107]
ds_read_b64_tr_b16 v[88:89], v2 offset:45056
s_add_u32 m0, s48, 4096
s_add_u32 s49, s47, 111488
buffer_load_dwordx4 v234, s[20:23], s49 offen lds
v_mfma_f32_16x16x32_bf16 v[108:111], v[92:95], v[228:231], v[108:111]
ds_read_b64_tr_b16 v[90:91], v2 offset:47104
v_cvt_pk_bf16_f32 v60, v60, v61
v_cvt_pk_bf16_f32 v61, v62, v63
v_cvt_pk_bf16_f32 v62, v116, v117
v_cvt_pk_bf16_f32 v63, v118, v119
s_add_u32 s50, s55, 798720
buffer_store_dwordx4 v[60:63], v248, s[24:27], s50 offen sc1
s_waitcnt lgkmcnt(4)
v_mfma_f32_16x16x32_bf16 v[56:59], v[96:99], v[4:7], v[56:59]
ds_read_b64_tr_b16 v[92:93], v232 offset:49152
v_mfma_f32_16x16x32_bf16 v[64:67], v[96:99], v[8:11], v[64:67]
ds_read_b64_tr_b16 v[94:95], v232 offset:51200
v_mfma_f32_16x16x32_bf16 v[104:107], v[80:83], v[4:7], v[104:107]
ds_read_b64_tr_b16 v[96:97], v2 offset:49152
v_mfma_f32_16x16x32_bf16 v[108:111], v[80:83], v[8:11], v[108:111]
ds_read_b64_tr_b16 v[98:99], v2 offset:51200
s_waitcnt lgkmcnt(4)
v_mfma_f32_16x16x32_bf16 v[56:59], v[84:87], v[12:15], v[56:59]
ds_read_b64_tr_b16 v[80:81], v232 offset:53248
v_mfma_f32_16x16x32_bf16 v[64:67], v[84:87], v[16:19], v[64:67]
ds_read_b64_tr_b16 v[82:83], v232 offset:55296
s_setprio 2
v_mfma_f32_16x16x32_bf16 v[104:107], v[88:91], v[12:15], v[104:107]
ds_read_b64_tr_b16 v[84:85], v2 offset:53248
s_add_u32 m0, s48, 40960
s_add_u32 s49, s47, 185216
buffer_load_dwordx4 v234, s[20:23], s49 offen lds
v_mfma_f32_16x16x32_bf16 v[108:111], v[88:91], v[16:19], v[108:111]
ds_read_b64_tr_b16 v[86:87], v2 offset:55296
s_waitcnt lgkmcnt(4)
v_mfma_f32_16x16x32_bf16 v[56:59], v[92:95], v[20:23], v[56:59]
ds_read_b64_tr_b16 v[88:89], v233 offset:12288
s_add_u32 s50, s7, 36864
buffer_load_dwordx4 v[60:63], v248, s[24:27], s50 offen sc1
v_mfma_f32_16x16x32_bf16 v[64:67], v[92:95], v[24:27], v[64:67]
ds_read_b64_tr_b16 v[90:91], v233 offset:14336
v_mfma_f32_16x16x32_bf16 v[104:107], v[96:99], v[20:23], v[104:107]
ds_read_b64_tr_b16 v[92:93], v3 offset:12288
v_mfma_f32_16x16x32_bf16 v[108:111], v[96:99], v[24:27], v[108:111]
ds_read_b64_tr_b16 v[94:95], v3 offset:14336
s_waitcnt lgkmcnt(4)
v_mfma_f32_16x16x32_bf16 v[56:59], v[80:83], v[28:31], v[56:59]
ds_read_b64_tr_b16 v[96:97], v233 offset:16384
v_mfma_f32_16x16x32_bf16 v[64:67], v[80:83], v[32:35], v[64:67]
ds_read_b64_tr_b16 v[98:99], v233 offset:18432
s_setprio 1
v_mfma_f32_16x16x32_bf16 v[104:107], v[84:87], v[28:31], v[104:107]
ds_read_b64_tr_b16 v[80:81], v3 offset:16384
s_add_u32 m0, s48, 94208
s_add_u32 s49, s47, 258944
buffer_load_dwordx4 v234, s[20:23], s49 offen lds
v_mfma_f32_16x16x32_bf16 v[108:111], v[84:87], v[32:35], v[108:111]
ds_read_b64_tr_b16 v[82:83], v3 offset:18432
s_waitcnt lgkmcnt(4)
v_mfma_f32_16x16x32_bf16 v[56:59], v[88:91], v[36:39], v[56:59]
ds_read_b64_tr_b16 v[84:85], v233 offset:20480
v_mfma_f32_16x16x32_bf16 v[64:67], v[88:91], v[40:43], v[64:67]
ds_read_b64_tr_b16 v[86:87], v233 offset:22528
v_mfma_f32_16x16x32_bf16 v[104:107], v[92:95], v[36:39], v[104:107]
ds_read_b64_tr_b16 v[88:89], v3 offset:20480
v_mfma_f32_16x16x32_bf16 v[108:111], v[92:95], v[40:43], v[108:111]
ds_read_b64_tr_b16 v[90:91], v3 offset:22528
s_waitcnt lgkmcnt(4)
v_mfma_f32_16x16x32_bf16 v[56:59], v[96:99], v[44:47], v[56:59]
ds_read_b64_tr_b16 v[92:93], v233 offset:24576
s_add_u32 s50, s7, 46080
buffer_load_dwordx4 v[112:115], v248, s[24:27], s50 offen sc1
v_mfma_f32_16x16x32_bf16 v[64:67], v[96:99], v[48:51], v[64:67]
ds_read_b64_tr_b16 v[94:95], v233 offset:26624
s_waitcnt vmcnt(4)
s_add_u32 s50, s56, 131072
v_mov_b32 v244, s98
v_mov_b32 v245, s99
s_mov_b64 exec, 1
buffer_store_dwordx2 v[244:245], v248, s[24:27], s50 offen sc1
s_mov_b64 exec, -1
v_mfma_f32_16x16x32_bf16 v[104:107], v[80:83], v[44:47], v[104:107]
ds_read_b64_tr_b16 v[96:97], v3 offset:24576
s_add_u32 m0, s48, 102400
s_add_u32 s49, s47, 332672
buffer_load_dwordx4 v234, s[20:23], s49 offen lds
v_mfma_f32_16x16x32_bf16 v[108:111], v[80:83], v[48:51], v[108:111]
ds_read_b64_tr_b16 v[98:99], v3 offset:26624
s_setprio 0
s_waitcnt lgkmcnt(4)
v_mfma_f32_16x16x32_bf16 v[56:59], v[84:87], v[68:71], v[56:59]
ds_read_b64_tr_b16 v[80:81], v233 offset:28672
v_mfma_f32_16x16x32_bf16 v[64:67], v[84:87], v[72:75], v[64:67]
ds_read_b64_tr_b16 v[82:83], v233 offset:30720
v_mfma_f32_16x16x32_bf16 v[104:107], v[88:91], v[68:71], v[104:107]
ds_read_b64_tr_b16 v[84:85], v3 offset:28672
v_mfma_f32_16x16x32_bf16 v[108:111], v[88:91], v[72:75], v[108:111]
ds_read_b64_tr_b16 v[86:87], v3 offset:30720
s_waitcnt lgkmcnt(4)
v_mfma_f32_16x16x32_bf16 v[56:59], v[92:95], v[76:79], v[56:59]
ds_read_b64_tr_b16 v[88:89], v233 offset:53248
v_mfma_f32_16x16x32_bf16 v[64:67], v[92:95], v[100:103], v[64:67]
ds_read_b64_tr_b16 v[90:91], v233 offset:55296
v_mfma_f32_16x16x32_bf16 v[104:107], v[96:99], v[76:79], v[104:107]
ds_read_b64_tr_b16 v[92:93], v3 offset:53248
v_mfma_f32_16x16x32_bf16 v[108:111], v[96:99], v[100:103], v[108:111]
ds_read_b64_tr_b16 v[94:95], v3 offset:55296
s_barrier
s_setprio 3
s_waitcnt lgkmcnt(4)
v_mfma_f32_16x16x32_bf16 v[116:119], v[80:83], v[200:203], 0
ds_read_b64_tr_b16 v[96:97], v233 offset:57344
s_add_u32 s50, s7, 55296
buffer_load_dwordx4 v[164:167], v248, s[24:27], s50 offen sc1
v_mfma_f32_16x16x32_bf16 v[152:155], v[80:83], v[204:207], 0
ds_read_b64_tr_b16 v[98:99], v233 offset:59392
v_mfma_f32_16x16x32_bf16 v[156:159], v[84:87], v[200:203], 0
ds_read_b64_tr_b16 v[80:81], v3 offset:57344
s_add_u32 m0, s48, 12288
s_add_u32 s49, s47, 406400
buffer_load_dwordx4 v234, s[20:23], s49 offen lds
v_mfma_f32_16x16x32_bf16 v[160:163], v[84:87], v[204:207], 0
ds_read_b64_tr_b16 v[82:83], v3 offset:59392
s_waitcnt lgkmcnt(4)
v_mfma_f32_16x16x32_bf16 v[116:119], v[88:91], v[208:211], v[116:119]
ds_read_b64_tr_b16 v[84:85], v233 offset:61440
v_mfma_f32_16x16x32_bf16 v[152:155], v[88:91], v[212:215], v[152:155]
ds_read_b64_tr_b16 v[86:87], v233 offset:63488
v_mfma_f32_16x16x32_bf16 v[156:159], v[92:95], v[208:211], v[156:159]
ds_read_b64_tr_b16 v[88:89], v3 offset:61440
v_cvt_pk_bf16_f32 v56, v56, v57
v_cvt_pk_bf16_f32 v57, v58, v59
v_cvt_pk_bf16_f32 v58, v104, v105
v_cvt_pk_bf16_f32 v59, v106, v107
s_add_u32 s50, s55, 983040
buffer_store_dwordx4 v[56:59], v248, s[24:27], s50 offen sc1
v_mfma_f32_16x16x32_bf16 v[160:163], v[92:95], v[212:215], v[160:163]
ds_read_b64_tr_b16 v[90:91], v3 offset:63488
s_waitcnt lgkmcnt(4)
v_mfma_f32_16x16x32_bf16 v[116:119], v[96:99], v[216:219], v[116:119]
ds_read_b64_tr_b16 v[92:93], v232 offset:0
v_mfma_f32_16x16x32_bf16 v[152:155], v[96:99], v[220:223], v[152:155]
ds_read_b64_tr_b16 v[94:95], v232 offset:2048
s_setprio 2
v_mfma_f32_16x16x32_bf16 v[156:159], v[80:83], v[216:219], v[156:159]
ds_read_b64_tr_b16 v[96:97], v2 offset:0
s_add_u32 m0, s48, 20480
s_add_u32 s49, s47, 37888
buffer_load_dwordx4 v234, s[20:23], s49 offen lds
v_mfma_f32_16x16x32_bf16 v[160:163], v[80:83], v[220:223], v[160:163]
ds_read_b64_tr_b16 v[98:99], v2 offset:2048
s_waitcnt lgkmcnt(4)
v_mfma_f32_16x16x32_bf16 v[116:119], v[84:87], v[224:227], v[116:119]
ds_read_b64_tr_b16 v[80:81], v233 offset:32768
s_add_u32 s50, s7, 64512
buffer_load_dwordx4 v[56:59], v248, s[24:27], s50 offen sc1
v_mfma_f32_16x16x32_bf16 v[152:155], v[84:87], v[228:231], v[152:155]
ds_read_b64_tr_b16 v[82:83], v233 offset:34816
v_mfma_f32_16x16x32_bf16 v[156:159], v[88:91], v[224:227], v[156:159]
ds_read_b64_tr_b16 v[84:85], v3 offset:32768
v_cvt_pk_bf16_f32 v64, v64, v65
v_cvt_pk_bf16_f32 v65, v66, v67
v_cvt_pk_bf16_f32 v66, v108, v109
v_cvt_pk_bf16_f32 v67, v110, v111
s_add_u32 s50, s55, 995328
buffer_store_dwordx4 v[64:67], v248, s[24:27], s50 offen sc1
v_mfma_f32_16x16x32_bf16 v[160:163], v[88:91], v[228:231], v[160:163]
ds_read_b64_tr_b16 v[86:87], v3 offset:34816
s_waitcnt lgkmcnt(4)
v_mfma_f32_16x16x32_bf16 v[116:119], v[92:95], v[4:7], v[116:119]
ds_read_b64_tr_b16 v[88:89], v233 offset:36864
v_mfma_f32_16x16x32_bf16 v[152:155], v[92:95], v[8:11], v[152:155]
ds_read_b64_tr_b16 v[90:91], v233 offset:38912
s_setprio 1
v_mfma_f32_16x16x32_bf16 v[156:159], v[96:99], v[4:7], v[156:159]
ds_read_b64_tr_b16 v[92:93], v3 offset:36864
s_add_u32 m0, s48, 45056
s_add_u32 s49, s47, 111616
buffer_load_dwordx4 v234, s[20:23], s49 offen lds
v_mfma_f32_16x16x32_bf16 v[160:163], v[96:99], v[8:11], v[160:163]
ds_read_b64_tr_b16 v[94:95], v3 offset:38912
s_waitcnt lgkmcnt(4)
v_mfma_f32_16x16x32_bf16 v[116:119], v[80:83], v[12:15], v[116:119]
ds_read_b64_tr_b16 v[96:97], v232 offset:4096
v_mfma_f32_16x16x32_bf16 v[152:155], v[80:83], v[16:19], v[152:155]
ds_read_b64_tr_b16 v[98:99], v232 offset:6144
v_mfma_f32_16x16x32_bf16 v[156:159], v[84:87], v[12:15], v[156:159]
ds_read_b64_tr_b16 v[80:81], v2 offset:4096
v_mfma_f32_16x16x32_bf16 v[160:163], v[84:87], v[16:19], v[160:163]
ds_read_b64_tr_b16 v[82:83], v2 offset:6144
s_waitcnt lgkmcnt(4)
v_mfma_f32_16x16x32_bf16 v[116:119], v[88:91], v[20:23], v[116:119]
ds_read_b64_tr_b16 v[84:85], v232 offset:8192
s_add_u32 s50, s7, 73728
buffer_load_dwordx4 v[64:67], v248, s[24:27], s50 offen sc1
v_mfma_f32_16x16x32_bf16 v[152:155], v[88:91], v[24:27], v[152:155]
ds_read_b64_tr_b16 v[86:87], v232 offset:10240
v_mfma_f32_16x16x32_bf16 v[156:159], v[92:95], v[20:23], v[156:159]
ds_read_b64_tr_b16 v[88:89], v2 offset:8192
s_add_u32 m0, s48, 110592
s_add_u32 s49, s47, 185344
buffer_load_dwordx4 v234, s[20:23], s49 offen lds
v_mfma_f32_16x16x32_bf16 v[160:163], v[92:95], v[24:27], v[160:163]
ds_read_b64_tr_b16 v[90:91], v2 offset:10240
s_setprio 0
s_waitcnt lgkmcnt(4)
v_mfma_f32_16x16x32_bf16 v[116:119], v[96:99], v[28:31], v[116:119]
ds_read_b64_tr_b16 v[92:93], v232 offset:12288
v_mfma_f32_16x16x32_bf16 v[152:155], v[96:99], v[32:35], v[152:155]
ds_read_b64_tr_b16 v[94:95], v232 offset:14336
v_mfma_f32_16x16x32_bf16 v[156:159], v[80:83], v[28:31], v[156:159]
ds_read_b64_tr_b16 v[96:97], v2 offset:12288
v_mfma_f32_16x16x32_bf16 v[160:163], v[80:83], v[32:35], v[160:163]
ds_read_b64_tr_b16 v[98:99], v2 offset:14336
s_waitcnt lgkmcnt(4)
v_mfma_f32_16x16x32_bf16 v[116:119], v[84:87], v[36:39], v[116:119]
ds_read_b64_tr_b16 v[80:81], v232 offset:16384
v_mfma_f32_16x16x32_bf16 v[152:155], v[84:87], v[40:43], v[152:155]
ds_read_b64_tr_b16 v[82:83], v232 offset:18432
v_mfma_f32_16x16x32_bf16 v[156:159], v[88:91], v[36:39], v[156:159]
ds_read_b64_tr_b16 v[84:85], v2 offset:16384
v_mfma_f32_16x16x32_bf16 v[160:163], v[88:91], v[40:43], v[160:163]
ds_read_b64_tr_b16 v[86:87], v2 offset:18432
s_waitcnt vmcnt(12)
s_barrier
s_waitcnt lgkmcnt(4)
v_mfma_f32_16x16x32_bf16 v[116:119], v[92:95], v[44:47], v[116:119]
ds_read_b64_tr_b16 v[88:89], v232 offset:20480
s_add_u32 s50, s7, 82944
buffer_load_dwordx4 v[176:179], v248, s[24:27], s50 offen sc1
v_mfma_f32_16x16x32_bf16 v[152:155], v[92:95], v[48:51], v[152:155]
ds_read_b64_tr_b16 v[90:91], v232 offset:22528
s_waitcnt vmcnt(4)
s_add_u32 s50, s56, 163840
v_mov_b32 v244, s98
v_mov_b32 v245, s99
s_mov_b64 exec, 1
buffer_store_dwordx2 v[244:245], v248, s[24:27], s50 offen sc1
s_mov_b64 exec, -1
v_mfma_f32_16x16x32_bf16 v[156:159], v[96:99], v[44:47], v[156:159]
ds_read_b64_tr_b16 v[92:93], v2 offset:20480
s_add_u32 m0, s48, 28672
s_add_u32 s49, s47, 259072
buffer_load_dwordx4 v234, s[20:23], s49 offen lds
v_mfma_f32_16x16x32_bf16 v[160:163], v[96:99], v[48:51], v[160:163]
ds_read_b64_tr_b16 v[94:95], v2 offset:22528
s_waitcnt lgkmcnt(4)
v_mfma_f32_16x16x32_bf16 v[116:119], v[80:83], v[68:71], v[116:119]
ds_read_b64_tr_b16 v[96:97], v232 offset:57344
v_mfma_f32_16x16x32_bf16 v[152:155], v[80:83], v[72:75], v[152:155]
ds_read_b64_tr_b16 v[98:99], v232 offset:59392
v_mfma_f32_16x16x32_bf16 v[156:159], v[84:87], v[68:71], v[156:159]
ds_read_b64_tr_b16 v[80:81], v2 offset:57344
v_mfma_f32_16x16x32_bf16 v[160:163], v[84:87], v[72:75], v[160:163]
ds_read_b64_tr_b16 v[82:83], v2 offset:59392
s_waitcnt lgkmcnt(4)
v_mfma_f32_16x16x32_bf16 v[116:119], v[88:91], v[76:79], v[116:119]
ds_read_b64_tr_b16 v[84:85], v232 offset:61440
v_mfma_f32_16x16x32_bf16 v[152:155], v[88:91], v[100:103], v[152:155]
ds_read_b64_tr_b16 v[86:87], v232 offset:63488
v_mfma_f32_16x16x32_bf16 v[156:159], v[92:95], v[76:79], v[156:159]
ds_read_b64_tr_b16 v[88:89], v2 offset:61440
v_mfma_f32_16x16x32_bf16 v[160:163], v[92:95], v[100:103], v[160:163]
ds_read_b64_tr_b16 v[90:91], v2 offset:63488
s_waitcnt lgkmcnt(4)
v_mfma_f32_16x16x32_bf16 v[104:107], v[96:99], v[200:203], 0
ds_read_b64_tr_b16 v[92:93], v233 offset:0
s_add_u32 m0, s48, 36864
s_add_u32 s49, s47, 332800
buffer_load_dwordx4 v234, s[20:23], s49 offen lds
v_mfma_f32_16x16x32_bf16 v[108:111], v[96:99], v[204:207], 0
ds_read_b64_tr_b16 v[94:95], v233 offset:2048
s_add_u32 s50, s7, 92160
buffer_load_dwordx4 v[180:183], v248, s[24:27], s50 offen sc1
v_mfma_f32_16x16x32_bf16 v[168:171], v[80:83], v[200:203], 0
ds_read_b64_tr_b16 v[96:97], v3 offset:0
v_mfma_f32_16x16x32_bf16 v[172:175], v[80:83], v[204:207], 0
ds_read_b64_tr_b16 v[98:99], v3 offset:2048
s_waitcnt lgkmcnt(4)
v_mfma_f32_16x16x32_bf16 v[104:107], v[84:87], v[208:211], v[104:107]
ds_read_b64_tr_b16 v[80:81], v233 offset:4096
v_mfma_f32_16x16x32_bf16 v[108:111], v[84:87], v[212:215], v[108:111]
ds_read_b64_tr_b16 v[82:83], v233 offset:6144
v_mfma_f32_16x16x32_bf16 v[168:171], v[88:91], v[208:211], v[168:171]
ds_read_b64_tr_b16 v[84:85], v3 offset:4096
v_cvt_pk_bf16_f32 v116, v116, v117
v_cvt_pk_bf16_f32 v117, v118, v119
v_cvt_pk_bf16_f32 v118, v156, v157
v_cvt_pk_bf16_f32 v119, v158, v159
s_add_u32 s50, s55, 1179648
buffer_store_dwordx4 v[116:119], v248, s[24:27], s50 offen sc1
v_mfma_f32_16x16x32_bf16 v[172:175], v[88:91], v[212:215], v[172:175]
ds_read_b64_tr_b16 v[86:87], v3 offset:6144
s_waitcnt lgkmcnt(4)
v_mfma_f32_16x16x32_bf16 v[104:107], v[92:95], v[216:219], v[104:107]
ds_read_b64_tr_b16 v[88:89], v233 offset:8192
v_mfma_f32_16x16x32_bf16 v[108:111], v[92:95], v[220:223], v[108:111]
ds_read_b64_tr_b16 v[90:91], v233 offset:10240
v_mfma_f32_16x16x32_bf16 v[168:171], v[96:99], v[216:219], v[168:171]
ds_read_b64_tr_b16 v[92:93], v3 offset:8192
s_add_u32 m0, s48, 57344
s_add_u32 s49, s47, 406528
buffer_load_dwordx4 v234, s[20:23], s49 offen lds
v_mfma_f32_16x16x32_bf16 v[172:175], v[96:99], v[220:223], v[172:175]
ds_read_b64_tr_b16 v[94:95], v3 offset:10240
s_waitcnt lgkmcnt(4)
v_mfma_f32_16x16x32_bf16 v[104:107], v[80:83], v[224:227], v[104:107]
ds_read_b64_tr_b16 v[96:97], v233 offset:40960
s_add_u32 s50, s7, 101376
buffer_load_dwordx4 v[116:119], v248, s[24:27], s50 offen sc1
v_mfma_f32_16x16x32_bf16 v[108:111], v[80:83], v[228:231], v[108:111]
ds_read_b64_tr_b16 v[98:99], v233 offset:43008
v_mfma_f32_16x16x32_bf16 v[168:171], v[84:87], v[224:227], v[168:171]
ds_read_b64_tr_b16 v[80:81], v3 offset:40960
v_cvt_pk_bf16_f32 v152, v152, v153
v_cvt_pk_bf16_f32 v153, v154, v155
v_cvt_pk_bf16_f32 v154, v160, v161
v_cvt_pk_bf16_f32 v155, v162, v163
s_add_u32 s50, s55, 1191936
buffer_store_dwordx4 v[152:155], v248, s[24:27], s50 offen sc1
v_mfma_f32_16x16x32_bf16 v[172:175], v[84:87], v[228:231], v[172:175]
ds_read_b64_tr_b16 v[82:83], v3 offset:43008
s_waitcnt lgkmcnt(4)
v_mfma_f32_16x16x32_bf16 v[104:107], v[88:91], v[4:7], v[104:107]
ds_read_b64_tr_b16 v[84:85], v232 offset:24576
v_mfma_f32_16x16x32_bf16 v[108:111], v[88:91], v[8:11], v[108:111]
ds_read_b64_tr_b16 v[86:87], v232 offset:26624
v_mfma_f32_16x16x32_bf16 v[168:171], v[92:95], v[4:7], v[168:171]
ds_read_b64_tr_b16 v[88:89], v2 offset:24576
v_mfma_f32_16x16x32_bf16 v[172:175], v[92:95], v[8:11], v[172:175]
ds_read_b64_tr_b16 v[90:91], v2 offset:26624
s_waitcnt lgkmcnt(4)
v_mfma_f32_16x16x32_bf16 v[104:107], v[96:99], v[12:15], v[104:107]
ds_read_b64_tr_b16 v[92:93], v232 offset:28672
v_mfma_f32_16x16x32_bf16 v[108:111], v[96:99], v[16:19], v[108:111]
ds_read_b64_tr_b16 v[94:95], v232 offset:30720
v_mfma_f32_16x16x32_bf16 v[168:171], v[80:83], v[12:15], v[168:171]
ds_read_b64_tr_b16 v[96:97], v2 offset:28672
v_mfma_f32_16x16x32_bf16 v[172:175], v[80:83], v[16:19], v[172:175]
ds_read_b64_tr_b16 v[98:99], v2 offset:30720
s_waitcnt vmcnt(11)
s_barrier
s_waitcnt lgkmcnt(4)
v_mfma_f32_16x16x32_bf16 v[104:107], v[84:87], v[20:23], v[104:107]
ds_read_b64_tr_b16 v[80:81], v232 offset:32768
s_add_u32 s50, s7, 110592
buffer_load_dwordx4 v[188:191], v248, s[24:27], s50 offen sc1
v_mfma_f32_16x16x32_bf16 v[108:111], v[84:87], v[24:27], v[108:111]
ds_read_b64_tr_b16 v[82:83], v232 offset:34816
v_mfma_f32_16x16x32_bf16 v[168:171], v[88:91], v[20:23], v[168:171]
ds_read_b64_tr_b16 v[84:85], v2 offset:32768
v_mfma_f32_16x16x32_bf16 v[172:175], v[88:91], v[24:27], v[172:175]
ds_read_b64_tr_b16 v[86:87], v2 offset:34816
s_waitcnt lgkmcnt(4)
v_mfma_f32_16x16x32_bf16 v[104:107], v[92:95], v[28:31], v[104:107]
ds_read_b64_tr_b16 v[88:89], v232 offset:36864
v_mfma_f32_16x16x32_bf16 v[108:111], v[92:95], v[32:35], v[108:111]
ds_read_b64_tr_b16 v[90:91], v232 offset:38912
v_mfma_f32_16x16x32_bf16 v[168:171], v[96:99], v[28:31], v[168:171]
ds_read_b64_tr_b16 v[92:93], v2 offset:36864
v_mfma_f32_16x16x32_bf16 v[172:175], v[96:99], v[32:35], v[172:175]
ds_read_b64_tr_b16 v[94:95], v2 offset:38912
s_waitcnt lgkmcnt(4)
v_mfma_f32_16x16x32_bf16 v[104:107], v[80:83], v[36:39], v[104:107]
ds_read_b64_tr_b16 v[96:97], v232 offset:40960
v_mfma_f32_16x16x32_bf16 v[108:111], v[80:83], v[40:43], v[108:111]
ds_read_b64_tr_b16 v[98:99], v232 offset:43008
v_mfma_f32_16x16x32_bf16 v[168:171], v[84:87], v[36:39], v[168:171]
ds_read_b64_tr_b16 v[80:81], v2 offset:40960
v_mfma_f32_16x16x32_bf16 v[172:175], v[84:87], v[40:43], v[172:175]
ds_read_b64_tr_b16 v[82:83], v2 offset:43008
s_waitcnt lgkmcnt(4)
v_mfma_f32_16x16x32_bf16 v[104:107], v[88:91], v[44:47], v[104:107]
ds_read_b64_tr_b16 v[84:85], v233 offset:12288
s_add_u32 s50, s7, 119808
buffer_load_dwordx4 v[192:195], v248, s[24:27], s50 offen sc1
v_mfma_f32_16x16x32_bf16 v[108:111], v[88:91], v[48:51], v[108:111]
ds_read_b64_tr_b16 v[86:87], v233 offset:14336
s_waitcnt vmcnt(2)
s_add_u32 s50, s56, 196608
v_mov_b32 v244, s98
v_mov_b32 v245, s99
s_mov_b64 exec, 1
buffer_store_dwordx2 v[244:245], v248, s[24:27], s50 offen sc1
s_mov_b64 exec, -1
v_mfma_f32_16x16x32_bf16 v[168:171], v[92:95], v[44:47], v[168:171]
ds_read_b64_tr_b16 v[88:89], v3 offset:12288
v_mfma_f32_16x16x32_bf16 v[172:175], v[92:95], v[48:51], v[172:175]
ds_read_b64_tr_b16 v[90:91], v3 offset:14336
s_waitcnt lgkmcnt(4)
v_mfma_f32_16x16x32_bf16 v[104:107], v[96:99], v[68:71], v[104:107]
ds_read_b64_tr_b16 v[92:93], v233 offset:16384
v_mfma_f32_16x16x32_bf16 v[108:111], v[96:99], v[72:75], v[108:111]
ds_read_b64_tr_b16 v[94:95], v233 offset:18432
v_mfma_f32_16x16x32_bf16 v[168:171], v[80:83], v[68:71], v[168:171]
ds_read_b64_tr_b16 v[96:97], v3 offset:16384
v_mfma_f32_16x16x32_bf16 v[172:175], v[80:83], v[72:75], v[172:175]
ds_read_b64_tr_b16 v[98:99], v3 offset:18432
s_waitcnt lgkmcnt(4)
v_mfma_f32_16x16x32_bf16 v[104:107], v[84:87], v[76:79], v[104:107]
ds_read_b64_tr_b16 v[80:81], v233 offset:20480
v_mfma_f32_16x16x32_bf16 v[108:111], v[84:87], v[100:103], v[108:111]
ds_read_b64_tr_b16 v[82:83], v233 offset:22528
v_mfma_f32_16x16x32_bf16 v[168:171], v[88:91], v[76:79], v[168:171]
ds_read_b64_tr_b16 v[84:85], v3 offset:20480
v_mfma_f32_16x16x32_bf16 v[172:175], v[88:91], v[100:103], v[172:175]
ds_read_b64_tr_b16 v[86:87], v3 offset:22528
s_waitcnt lgkmcnt(4)
v_mfma_f32_16x16x32_bf16 v[152:155], v[92:95], v[200:203], 0
ds_read_b64_tr_b16 v[88:89], v233 offset:24576
s_add_u32 s50, s7, 129024
buffer_load_dwordx4 v[196:199], v248, s[24:27], s50 offen sc1
v_mfma_f32_16x16x32_bf16 v[156:159], v[92:95], v[204:207], 0
ds_read_b64_tr_b16 v[90:91], v233 offset:26624
v_mfma_f32_16x16x32_bf16 v[160:163], v[96:99], v[200:203], 0
ds_read_b64_tr_b16 v[92:93], v3 offset:24576
v_mfma_f32_16x16x32_bf16 v[184:187], v[96:99], v[204:207], 0
ds_read_b64_tr_b16 v[94:95], v3 offset:26624
s_waitcnt lgkmcnt(4)
v_mfma_f32_16x16x32_bf16 v[152:155], v[80:83], v[208:211], v[152:155]
ds_read_b64_tr_b16 v[96:97], v233 offset:45056
s_mov_b32 s50, s59
v_min_u32 v255, 7, v1
v_lshlrev_b32 v255, 3, v255
buffer_load_dwordx2 v[244:245], v255, s[24:27], s50 offen sc1
v_mfma_f32_16x16x32_bf16 v[156:159], v[80:83], v[212:215], v[156:159]
ds_read_b64_tr_b16 v[98:99], v233 offset:47104
v_mfma_f32_16x16x32_bf16 v[160:163], v[84:87], v[208:211], v[160:163]
ds_read_b64_tr_b16 v[80:81], v3 offset:45056
v_cvt_pk_bf16_f32 v104, v104, v105
v_cvt_pk_bf16_f32 v105, v106, v107
v_cvt_pk_bf16_f32 v106, v168, v169
v_cvt_pk_bf16_f32 v107, v170, v171
s_add_u32 s50, s55, 1376256
buffer_store_dwordx4 v[104:107], v248, s[24:27], s50 offen sc1
v_mfma_f32_16x16x32_bf16 v[184:187], v[84:87], v[212:215], v[184:187]
ds_read_b64_tr_b16 v[82:83], v3 offset:47104
s_waitcnt lgkmcnt(4)
v_mfma_f32_16x16x32_bf16 v[152:155], v[88:91], v[216:219], v[152:155]
ds_read_b64_tr_b16 v[84:85], v233 offset:49152
v_mfma_f32_16x16x32_bf16 v[156:159], v[88:91], v[220:223], v[156:159]
ds_read_b64_tr_b16 v[86:87], v233 offset:51200
v_mfma_f32_16x16x32_bf16 v[160:163], v[92:95], v[216:219], v[160:163]
ds_read_b64_tr_b16 v[88:89], v3 offset:49152
v_mfma_f32_16x16x32_bf16 v[184:187], v[92:95], v[220:223], v[184:187]
ds_read_b64_tr_b16 v[90:91], v3 offset:51200
s_barrier
s_waitcnt lgkmcnt(4)
v_mfma_f32_16x16x32_bf16 v[152:155], v[96:99], v[224:227], v[152:155]
ds_read_b64_tr_b16 v[92:93], v232 offset:45056
s_add_u32 s50, s7, 138240
buffer_load_dwordx4 v[104:107], v248, s[24:27], s50 offen sc1
v_mfma_f32_16x16x32_bf16 v[156:159], v[96:99], v[228:231], v[156:159]
ds_read_b64_tr_b16 v[94:95], v232 offset:47104
v_mfma_f32_16x16x32_bf16 v[160:163], v[80:83], v[224:227], v[160:163]
ds_read_b64_tr_b16 v[96:97], v2 offset:45056
v_cvt_pk_bf16_f32 v108, v108, v109
v_cvt_pk_bf16_f32 v109, v110, v111
v_cvt_pk_bf16_f32 v110, v172, v173
v_cvt_pk_bf16_f32 v111, v174, v175
s_add_u32 s50, s55, 1388544
buffer_store_dwordx4 v[108:111], v248, s[24:27], s50 offen sc1
v_mfma_f32_16x16x32_bf16 v[184:187], v[80:83], v[228:231], v[184:187]
ds_read_b64_tr_b16 v[98:99], v2 offset:47104
s_waitcnt lgkmcnt(4)
v_mfma_f32_16x16x32_bf16 v[152:155], v[84:87], v[4:7], v[152:155]
ds_read_b64_tr_b16 v[80:81], v232 offset:49152
v_mfma_f32_16x16x32_bf16 v[156:159], v[84:87], v[8:11], v[156:159]
ds_read_b64_tr_b16 v[82:83], v232 offset:51200
v_mfma_f32_16x16x32_bf16 v[160:163], v[88:91], v[4:7], v[160:163]
ds_read_b64_tr_b16 v[84:85], v2 offset:49152
v_mfma_f32_16x16x32_bf16 v[184:187], v[88:91], v[8:11], v[184:187]
ds_read_b64_tr_b16 v[86:87], v2 offset:51200
s_waitcnt lgkmcnt(4)
v_mfma_f32_16x16x32_bf16 v[152:155], v[92:95], v[12:15], v[152:155]
ds_read_b64_tr_b16 v[88:89], v233 offset:28672
v_mfma_f32_16x16x32_bf16 v[156:159], v[92:95], v[16:19], v[156:159]
ds_read_b64_tr_b16 v[90:91], v233 offset:30720
v_mfma_f32_16x16x32_bf16 v[160:163], v[96:99], v[12:15], v[160:163]
ds_read_b64_tr_b16 v[92:93], v3 offset:28672
v_mfma_f32_16x16x32_bf16 v[184:187], v[96:99], v[16:19], v[184:187]
ds_read_b64_tr_b16 v[94:95], v3 offset:30720
s_waitcnt lgkmcnt(4)
v_mfma_f32_16x16x32_bf16 v[152:155], v[80:83], v[20:23], v[152:155]
ds_read_b64_tr_b16 v[96:97], v233 offset:32768
s_add_u32 s50, s7, 147456
buffer_load_dwordx4 v[4:7], v248, s[24:27], s50 offen sc1
v_mfma_f32_16x16x32_bf16 v[156:159], v[80:83], v[24:27], v[156:159]
ds_read_b64_tr_b16 v[98:99], v233 offset:34816
s_waitcnt vmcnt(4)
s_mov_b32 s52, 0
L_spf1_3:
v_cmp_ne_u64 vcc, s[98:99], v[244:245]
s_nop 1
s_cmp_eq_u64 vcc, 0
s_cbranch_scc1 L_spf1_3x
s_add_u32 s52, s52, 1
s_cmp_ge_u32 s52, 0x10000
s_cbranch_scc1 L_spf1_3x
s_sleep 2
s_mov_b32 s50, s59
v_min_u32 v255, 7, v1
v_lshlrev_b32 v255, 3, v255
buffer_load_dwordx2 v[244:245], v255, s[24:27], s50 offen sc1
s_waitcnt vmcnt(0)
s_branch L_spf1_3
L_spf1_3x:
s_add_u32 m0, s48, 118784
s_add_u32 s50, s57, 0
buffer_load_dwordx4 v247, s[24:27], s50 offen sc1 lds
s_add_u32 m0, s48, 126976
s_add_u32 s50, s57, 8192
buffer_load_dwordx4 v247, s[24:27], s50 offen sc1 lds
s_add_u32 m0, s48, 135168
s_add_u32 s50, s57, 16384
buffer_load_dwordx4 v247, s[24:27], s50 offen sc1 lds
s_add_u32 m0, s48, 143360
s_add_u32 s50, s57, 24576
buffer_load_dwordx4 v247, s[24:27], s50 offen sc1 lds
v_mfma_f32_16x16x32_bf16 v[160:163], v[84:87], v[20:23], v[160:163]
ds_read_b64_tr_b16 v[80:81], v3 offset:32768
v_mfma_f32_16x16x32_bf16 v[184:187], v[84:87], v[24:27], v[184:187]
ds_read_b64_tr_b16 v[82:83], v3 offset:34816
s_waitcnt lgkmcnt(4)
v_mfma_f32_16x16x32_bf16 v[152:155], v[88:91], v[28:31], v[152:155]
ds_read_b64_tr_b16 v[84:85], v233 offset:36864
v_mfma_f32_16x16x32_bf16 v[156:159], v[88:91], v[32:35], v[156:159]
ds_read_b64_tr_b16 v[86:87], v233 offset:38912
v_mfma_f32_16x16x32_bf16 v[160:163], v[92:95], v[28:31], v[160:163]
ds_read_b64_tr_b16 v[88:89], v3 offset:36864
v_mfma_f32_16x16x32_bf16 v[184:187], v[92:95], v[32:35], v[184:187]
ds_read_b64_tr_b16 v[90:91], v3 offset:38912
s_waitcnt lgkmcnt(4)
v_mfma_f32_16x16x32_bf16 v[152:155], v[96:99], v[36:39], v[152:155]
ds_read_b64_tr_b16 v[92:93], v233 offset:53248
v_mfma_f32_16x16x32_bf16 v[156:159], v[96:99], v[40:43], v[156:159]
ds_read_b64_tr_b16 v[94:95], v233 offset:55296
v_mfma_f32_16x16x32_bf16 v[160:163], v[80:83], v[36:39], v[160:163]
ds_read_b64_tr_b16 v[96:97], v3 offset:53248
v_mfma_f32_16x16x32_bf16 v[184:187], v[80:83], v[40:43], v[184:187]
ds_read_b64_tr_b16 v[98:99], v3 offset:55296
s_waitcnt lgkmcnt(4)
v_mfma_f32_16x16x32_bf16 v[152:155], v[84:87], v[44:47], v[152:155]
ds_read_b64_tr_b16 v[80:81], v233 offset:57344
s_add_u32 s50, s7, 156672
buffer_load_dwordx4 v[8:11], v248, s[24:27], s50 offen sc1
v_mfma_f32_16x16x32_bf16 v[156:159], v[84:87], v[48:51], v[156:159]
ds_read_b64_tr_b16 v[82:83], v233 offset:59392
s_waitcnt vmcnt(6)
s_add_u32 s50, s56, 229376
v_mov_b32 v244, s98
v_mov_b32 v245, s99
s_mov_b64 exec, 1
buffer_store_dwordx2 v[244:245], v248, s[24:27], s50 offen sc1
s_mov_b64 exec, -1
v_mfma_f32_16x16x32_bf16 v[160:163], v[88:91], v[44:47], v[160:163]
ds_read_b64_tr_b16 v[84:85], v3 offset:57344
v_mfma_f32_16x16x32_bf16 v[184:187], v[88:91], v[48:51], v[184:187]
ds_read_b64_tr_b16 v[86:87], v3 offset:59392
s_waitcnt lgkmcnt(4)
v_mfma_f32_16x16x32_bf16 v[152:155], v[92:95], v[68:71], v[152:155]
v_mfma_f32_16x16x32_bf16 v[156:159], v[92:95], v[72:75], v[156:159]
v_mfma_f32_16x16x32_bf16 v[160:163], v[96:99], v[68:71], v[160:163]
v_mfma_f32_16x16x32_bf16 v[184:187], v[96:99], v[72:75], v[184:187]
s_waitcnt lgkmcnt(0)
v_mfma_f32_16x16x32_bf16 v[152:155], v[80:83], v[76:79], v[152:155]
s_mov_b32 s50, s59
v_min_u32 v255, 15, v1
v_lshlrev_b32 v255, 3, v255
buffer_load_dwordx2 v[244:245], v255, s[24:27], s50 offen sc1
v_mfma_f32_16x16x32_bf16 v[156:159], v[80:83], v[100:103], v[156:159]
v_mfma_f32_16x16x32_bf16 v[160:163], v[84:87], v[76:79], v[160:163]
v_mfma_f32_16x16x32_bf16 v[184:187], v[84:87], v[100:103], v[184:187]
s_nop 0
v_cvt_pk_bf16_f32 v152, v152, v153
v_cvt_pk_bf16_f32 v153, v154, v155
s_nop 3
v_cvt_pk_bf16_f32 v154, v160, v161
v_cvt_pk_bf16_f32 v155, v162, v163
s_add_u32 s50, s55, 1572864
buffer_store_dwordx4 v[152:155], v248, s[24:27], s50 offen sc1
v_cvt_pk_bf16_f32 v156, v156, v157
v_cvt_pk_bf16_f32 v157, v158, v159
v_cvt_pk_bf16_f32 v158, v184, v185
v_cvt_pk_bf16_f32 v159, v186, v187
s_add_u32 s50, s55, 1585152
buffer_store_dwordx4 v[156:159], v248, s[24:27], s50 offen sc1
s_waitcnt vmcnt(5)
s_barrier
s_setprio 3
v_add_u32 v242, 118784, v248
v_add_u32 v241, 0x10000, v247
s_waitcnt vmcnt(2)
s_mov_b32 s52, 0
L_spf1_4:
v_cmp_ne_u64 vcc, s[98:99], v[244:245]
s_nop 1
s_cmp_eq_u64 vcc, 0
s_cbranch_scc1 L_spf1_4x
s_add_u32 s52, s52, 1
s_cmp_ge_u32 s52, 0x10000
s_cbranch_scc1 L_spf1_4x
s_sleep 2
s_mov_b32 s50, s59
v_min_u32 v255, 15, v1
v_lshlrev_b32 v255, 3, v255
buffer_load_dwordx2 v[244:245], v255, s[24:27], s50 offen sc1
s_waitcnt vmcnt(0)
s_branch L_spf1_4
L_spf1_4x:
s_add_u32 m0, s48, 122880
s_add_u32 s50, s57, 4096
buffer_load_dwordx4 v247, s[24:27], s50 offen sc1 lds
s_add_u32 m0, s48, 131072
s_add_u32 s50, s57, 12288
buffer_load_dwordx4 v247, s[24:27], s50 offen sc1 lds
s_add_u32 m0, s48, 139264
s_add_u32 s50, s57, 20480
buffer_load_dwordx4 v247, s[24:27], s50 offen sc1 lds
s_add_u32 m0, s48, 147456
s_add_u32 s50, s57, 28672
buffer_load_dwordx4 v247, s[24:27], s50 offen sc1 lds
s_add_u32 m0, s48, 151552
s_add_u32 s50, s57, 32768
buffer_load_dwordx4 v247, s[24:27], s50 offen sc1 lds
s_waitcnt vmcnt(5)
s_add_u32 s50, s56, 262144
v_mov_b32 v244, s98
v_mov_b32 v245, s99
s_mov_b64 exec, 1
buffer_store_dwordx2 v[244:245], v248, s[24:27], s50 offen sc1
s_mov_b64 exec, -1
s_add_u32 s50, s5, 0
v_min_u32 v255, 11, v1
v_lshlrev_b32 v255, 3, v255
buffer_load_dwordx2 v[244:245], v255, s[24:27], s50 offen sc1
ds_read_b128 v[20:23], v242 offset:0
ds_read_b128 v[24:27], v242 offset:1024
ds_read_b128 v[28:31], v242 offset:8192
ds_read_b128 v[32:35], v242 offset:9216
ds_read_b128 v[36:39], v242 offset:16384
ds_read_b128 v[40:43], v242 offset:17408
ds_read_b128 v[44:47], v242 offset:24576
ds_read_b128 v[48:51], v242 offset:25600
s_waitcnt lgkmcnt(6)
v_mfma_f32_16x16x32_bf16 v[12:15], v[140:143], v[20:23], 0
v_mfma_f32_16x16x32_bf16 v[16:19], v[140:143], v[24:27], 0
ds_read_b128 v[20:23], v242 offset:2048
ds_read_b128 v[24:27], v242 offset:3072
s_waitcnt lgkmcnt(6)
v_mfma_f32_16x16x32_bf16 v[12:15], v[144:147], v[28:31], v[12:15]
v_mfma_f32_16x16x32_bf16 v[16:19], v[144:147], v[32:35], v[16:19]
ds_read_b128 v[28:31], v242 offset:10240
ds_read_b128 v[32:35], v242 offset:11264
s_waitcnt lgkmcnt(6)
v_mfma_f32_16x16x32_bf16 v[12:15], v[148:151], v[36:39], v[12:15]
v_mfma_f32_16x16x32_bf16 v[16:19], v[148:151], v[40:43], v[16:19]
ds_read_b128 v[36:39], v242 offset:18432
ds_read_b128 v[40:43], v242 offset:19456
s_waitcnt lgkmcnt(6)
v_mfma_f32_16x16x32_bf16 v[12:15], v[52:55], v[44:47], v[12:15]
v_mfma_f32_16x16x32_bf16 v[16:19], v[52:55], v[48:51], v[16:19]
ds_read_b128 v[44:47], v242 offset:26624
ds_read_b128 v[48:51], v242 offset:27648
s_waitcnt lgkmcnt(6)
v_mfma_f32_16x16x32_bf16 v[12:15], v[60:63], v[20:23], v[12:15]
v_mfma_f32_16x16x32_bf16 v[16:19], v[60:63], v[24:27], v[16:19]
s_waitcnt lgkmcnt(4)
v_mfma_f32_16x16x32_bf16 v[12:15], v[112:115], v[28:31], v[12:15]
v_mfma_f32_16x16x32_bf16 v[16:19], v[112:115], v[32:35], v[16:19]
s_waitcnt lgkmcnt(2)
v_mfma_f32_16x16x32_bf16 v[12:15], v[164:167], v[36:39], v[12:15]
v_mfma_f32_16x16x32_bf16 v[16:19], v[164:167], v[40:43], v[16:19]
s_waitcnt lgkmcnt(0)
v_mfma_f32_16x16x32_bf16 v[12:15], v[56:59], v[44:47], v[12:15]
v_mfma_f32_16x16x32_bf16 v[16:19], v[56:59], v[48:51], v[16:19]
s_waitcnt vmcnt(0)
s_mov_b32 s52, 0
L_spf1_5:
v_cmp_ne_u64 vcc, s[98:99], v[244:245]
s_nop 1
s_cmp_eq_u64 vcc, 0
s_cbranch_scc1 L_spf1_5x
s_add_u32 s52, s52, 1
s_cmp_ge_u32 s52, 0x10000
s_cbranch_scc1 L_spf1_5x
s_sleep 2
s_add_u32 s50, s5, 0
v_min_u32 v255, 11, v1
v_lshlrev_b32 v255, 3, v255
buffer_load_dwordx2 v[244:245], v255, s[24:27], s50 offen sc1
s_waitcnt vmcnt(0)
s_branch L_spf1_5
L_spf1_5x:
s_add_u32 s50, s4, 0
buffer_load_dwordx4 v[20:23], v235, s[24:27], s50 offen offset:0 sc1
s_add_u32 s50, s4, 0
buffer_load_dwordx4 v[24:27], v235, s[24:27], s50 offen offset:256 sc1
s_add_u32 s50, s4, 4096
buffer_load_dwordx4 v[28:31], v235, s[24:27], s50 offen offset:0 sc1
s_add_u32 s50, s4, 4096
buffer_load_dwordx4 v[32:35], v235, s[24:27], s50 offen offset:256 sc1
s_add_u32 s50, s4, 8192
buffer_load_dwordx4 v[36:39], v235, s[24:27], s50 offen offset:0 sc1
s_add_u32 s50, s4, 8192
buffer_load_dwordx4 v[40:43], v235, s[24:27], s50 offen offset:256 sc1
s_add_u32 s50, s4, 12288
buffer_load_dwordx4 v[44:47], v235, s[24:27], s50 offen offset:0 sc1
s_add_u32 s50, s4, 12288
buffer_load_dwordx4 v[48:51], v235, s[24:27], s50 offen offset:256 sc1
s_add_u32 s50, s4, 16384
buffer_load_dwordx4 v[52:55], v235, s[24:27], s50 offen offset:0 sc1
s_add_u32 s50, s4, 16384
buffer_load_dwordx4 v[56:59], v235, s[24:27], s50 offen offset:256 sc1
s_add_u32 s50, s4, 20480
buffer_load_dwordx4 v[60:63], v235, s[24:27], s50 offen offset:0 sc1
s_add_u32 s50, s4, 20480
buffer_load_dwordx4 v[68:71], v235, s[24:27], s50 offen offset:256 sc1
s_barrier
v_lshlrev_b32 v255, 2, v1
v_add_u32 v255, 151552, v255
ds_read2st64_b32 v[72:73], v255 offset0:0 offset1:1
ds_read2st64_b32 v[74:75], v255 offset0:2 offset1:3
ds_read2st64_b32 v[76:77], v255 offset0:4 offset1:5
ds_read2st64_b32 v[78:79], v255 offset0:6 offset1:7
ds_read2st64_b32 v[80:81], v255 offset0:8 offset1:9
ds_read2st64_b32 v[82:83], v255 offset0:10 offset1:11
ds_read2st64_b32 v[84:85], v255 offset0:12 offset1:13
ds_read2st64_b32 v[86:87], v255 offset0:14 offset1:15
ds_read_b128 v[88:91], v242 offset:4096
ds_read_b128 v[92:95], v242 offset:5120
ds_read_b128 v[96:99], v242 offset:12288
ds_read_b128 v[100:103], v242 offset:13312
ds_read_b128 v[108:111], v242 offset:20480
ds_read_b128 v[112:115], v242 offset:21504
ds_read_b128 v[140:143], v242 offset:28672
ds_read_b128 v[144:147], v242 offset:29696
s_waitcnt lgkmcnt(6)
v_mfma_f32_16x16x32_bf16 v[12:15], v[64:67], v[88:91], v[12:15]
v_mfma_f32_16x16x32_bf16 v[16:19], v[64:67], v[92:95], v[16:19]
ds_read_b128 v[64:67], v242 offset:6144
ds_read_b128 v[88:91], v242 offset:7168
s_waitcnt lgkmcnt(6)
v_mfma_f32_16x16x32_bf16 v[12:15], v[176:179], v[96:99], v[12:15]
v_mfma_f32_16x16x32_bf16 v[16:19], v[176:179], v[100:103], v[16:19]
ds_read_b128 v[92:95], v242 offset:14336
ds_read_b128 v[96:99], v242 offset:15360
s_waitcnt lgkmcnt(6)
v_mfma_f32_16x16x32_bf16 v[12:15], v[180:183], v[108:111], v[12:15]
v_mfma_f32_16x16x32_bf16 v[16:19], v[180:183], v[112:115], v[16:19]
ds_read_b128 v[100:103], v242 offset:22528
ds_read_b128 v[108:111], v242 offset:23552
s_mov_b32 s50, 0x05040100
s_mov_b32 s51, 0x07060302
v_perm_b32 v112, v73, v72, s50
v_perm_b32 v113, v75, v74, s50
v_perm_b32 v114, v77, v76, s50
v_perm_b32 v115, v79, v78, s50
v_perm_b32 v148, v73, v72, s51
v_perm_b32 v149, v75, v74, s51
v_perm_b32 v150, v77, v76, s51
v_perm_b32 v151, v79, v78, s51
v_perm_b32 v152, v81, v80, s50
v_perm_b32 v153, v83, v82, s50
v_perm_b32 v154, v85, v84, s50
v_perm_b32 v155, v87, v86, s50
v_perm_b32 v156, v81, v80, s51
v_perm_b32 v157, v83, v82, s51
v_perm_b32 v158, v85, v84, s51
v_perm_b32 v159, v87, v86, s51
s_waitcnt lgkmcnt(6)
v_mfma_f32_16x16x32_bf16 v[12:15], v[116:119], v[140:143], v[12:15]
v_mfma_f32_16x16x32_bf16 v[16:19], v[116:119], v[144:147], v[16:19]
ds_read_b128 v[116:119], v242 offset:30720
ds_read_b128 v[140:143], v242 offset:31744
s_waitcnt lgkmcnt(6)
v_mfma_f32_16x16x32_bf16 v[12:15], v[188:191], v[64:67], v[12:15]
v_mfma_f32_16x16x32_bf16 v[16:19], v[188:191], v[88:91], v[16:19]
s_waitcnt lgkmcnt(4)
v_mfma_f32_16x16x32_bf16 v[12:15], v[192:195], v[92:95], v[12:15]
v_mfma_f32_16x16x32_bf16 v[16:19], v[192:195], v[96:99], v[16:19]
s_waitcnt lgkmcnt(2)
v_mfma_f32_16x16x32_bf16 v[12:15], v[196:199], v[100:103], v[12:15]
v_mfma_f32_16x16x32_bf16 v[16:19], v[196:199], v[108:111], v[16:19]
s_waitcnt lgkmcnt(0)
v_mfma_f32_16x16x32_bf16 v[12:15], v[104:107], v[116:119], v[12:15]
v_mfma_f32_16x16x32_bf16 v[16:19], v[104:107], v[140:143], v[16:19]
v_mfma_f32_16x16x32_bf16 v[12:15], v[4:7], v[112:115], v[12:15]
v_mfma_f32_16x16x32_bf16 v[16:19], v[4:7], v[148:151], v[16:19]
v_mfma_f32_16x16x32_bf16 v[12:15], v[8:11], v[152:155], v[12:15]
v_mfma_f32_16x16x32_bf16 v[16:19], v[8:11], v[156:159], v[16:19]
s_waitcnt vmcnt(11)
v_mfma_f32_16x16x32_bf16 v[132:135], v[120:123], v[20:23], 0
s_waitcnt vmcnt(10)
v_mfma_f32_16x16x32_bf16 v[132:135], v[124:127], v[24:27], v[132:135]
s_waitcnt vmcnt(9)
v_mfma_f32_16x16x32_bf16 v[132:135], v[120:123], v[28:31], v[132:135]
s_waitcnt vmcnt(8)
v_mfma_f32_16x16x32_bf16 v[132:135], v[124:127], v[32:35], v[132:135]
s_waitcnt vmcnt(7)
v_mfma_f32_16x16x32_bf16 v[132:135], v[120:123], v[36:39], v[132:135]
s_waitcnt vmcnt(6)
v_mfma_f32_16x16x32_bf16 v[132:135], v[124:127], v[40:43], v[132:135]
s_waitcnt vmcnt(5)
v_mfma_f32_16x16x32_bf16 v[136:139], v[120:123], v[44:47], 0
s_waitcnt vmcnt(4)
v_mfma_f32_16x16x32_bf16 v[136:139], v[124:127], v[48:51], v[136:139]
s_waitcnt vmcnt(3)
v_mfma_f32_16x16x32_bf16 v[136:139], v[120:123], v[52:55], v[136:139]
s_waitcnt vmcnt(2)
v_mfma_f32_16x16x32_bf16 v[136:139], v[124:127], v[56:59], v[136:139]
s_waitcnt vmcnt(1)
v_mfma_f32_16x16x32_bf16 v[136:139], v[120:123], v[60:63], v[136:139]
s_waitcnt vmcnt(0)
v_mfma_f32_16x16x32_bf16 v[136:139], v[124:127], v[68:71], v[136:139]
v_exp_f32 v120, -v132
v_exp_f32 v121, -v133
v_exp_f32 v122, -v134
v_exp_f32 v123, -v135
s_nop 3
v_exp_f32 v124, -v136
v_exp_f32 v125, -v137
v_exp_f32 v126, -v138
v_exp_f32 v127, -v139
v_mul_f32 v132, 0x3ef5fdf0, v132
v_mul_f32 v133, 0x3ef5fdf0, v133
v_mul_f32 v134, 0x3ef5fdf0, v134
v_mul_f32 v135, 0x3ef5fdf0, v135
v_mul_f32 v136, 0x3ef5fdf0, v136
v_mul_f32 v137, 0x3ef5fdf0, v137
v_mul_f32 v138, 0x3ef5fdf0, v138
v_mul_f32 v139, 0x3ef5fdf0, v139
v_add_f32 v120, 1.0, v120
v_add_f32 v121, 1.0, v121
v_add_f32 v122, 1.0, v122
v_add_f32 v123, 1.0, v123
v_add_f32 v124, 1.0, v124
v_add_f32 v125, 1.0, v125
v_add_f32 v126, 1.0, v126
v_add_f32 v127, 1.0, v127
v_rcp_f32 v120, v120
v_rcp_f32 v121, v121
v_rcp_f32 v122, v122
v_rcp_f32 v123, v123
v_rcp_f32 v124, v124
v_rcp_f32 v125, v125
v_rcp_f32 v126, v126
v_rcp_f32 v127, v127
v_mul_f32 v132, v132, v120
v_mul_f32 v133, v133, v121
v_mul_f32 v134, v134, v122
v_mul_f32 v135, v135, v123
v_mul_f32 v136, v136, v124
v_mul_f32 v137, v137, v125
v_mul_f32 v138, v138, v126
v_mul_f32 v139, v139, v127
v_mul_f32 v132, v132, v12
v_mul_f32 v133, v133, v13
v_mul_f32 v134, v134, v14
v_mul_f32 v135, v135, v15
v_mul_f32 v136, v136, v16
v_mul_f32 v137, v137, v17
v_mul_f32 v138, v138, v18
v_mul_f32 v139, v139, v19
v_lshlrev_b32 v12, 16, v128
v_and_b32 v13, s53, v128
v_lshlrev_b32 v14, 16, v129
v_and_b32 v15, s53, v129
v_lshlrev_b32 v16, 16, v130
v_and_b32 v17, s53, v130
v_lshlrev_b32 v18, 16, v131
v_and_b32 v19, s53, v131
v_permlane32_swap_b32 v132, v136
v_permlane32_swap_b32 v133, v137
v_permlane32_swap_b32 v134, v138
v_permlane32_swap_b32 v135, v139
v_add_f32 v132, v132, v12
v_add_f32 v133, v133, v13
v_add_f32 v134, v134, v14
v_add_f32 v135, v135, v15
v_add_f32 v136, v136, v16
v_add_f32 v137, v137, v17
v_add_f32 v138, v138, v18
v_add_f32 v139, v139, v19
v_cvt_pk_bf16_f32 v128, v132, v133
v_cvt_pk_bf16_f32 v129, v134, v135
v_cvt_pk_bf16_f32 v130, v136, v137
v_cvt_pk_bf16_f32 v131, v138, v139
buffer_store_dwordx4 v[128:131], v243, s[92:95], s6 offen offset:0
s_endpgm
L_att_cut:
s_cmp_eq_u32 s43, 1
s_cbranch_scc1 L_att_c1
s_waitcnt vmcnt(17)
v_dot2_f32_bf16 v76, v4, s54, 0
v_dot2_f32_bf16 v78, v4, v4, 0
v_dot2_f32_bf16 v76, v5, s54, v76
v_dot2_f32_bf16 v78, v5, v5, v78
v_dot2_f32_bf16 v76, v6, s54, v76
v_dot2_f32_bf16 v78, v6, v6, v78
v_dot2_f32_bf16 v76, v7, s54, v76
v_dot2_f32_bf16 v78, v7, v7, v78
s_waitcnt vmcnt(16)
v_dot2_f32_bf16 v77, v40, s54, 0
v_dot2_f32_bf16 v79, v40, v40, 0
v_dot2_f32_bf16 v77, v41, s54, v77
v_dot2_f32_bf16 v79, v41, v41, v79
v_dot2_f32_bf16 v77, v42, s54, v77
v_dot2_f32_bf16 v79, v42, v42, v79
v_dot2_f32_bf16 v77, v43, s54, v77
v_dot2_f32_bf16 v79, v43, v43, v79
s_waitcnt vmcnt(15)
v_dot2_f32_bf16 v76, v8, s54, v76
v_dot2_f32_bf16 v78, v8, v8, v78
v_dot2_f32_bf16 v76, v9, s54, v76
v_dot2_f32_bf16 v78, v9, v9, v78
v_dot2_f32_bf16 v76, v10, s54, v76
v_dot2_f32_bf16 v78, v10, v10, v78
v_dot2_f32_bf16 v76, v11, s54, v76
v_dot2_f32_bf16 v78, v11, v11, v78
s_waitcnt vmcnt(14)
v_dot2_f32_bf16 v77, v44, s54, v77
v_dot2_f32_bf16 v79, v44, v44, v79
v_dot2_f32_bf16 v77, v45, s54, v77
v_dot2_f32_bf16 v79, v45, v45, v79
v_dot2_f32_bf16 v77, v46, s54, v77
v_dot2_f32_bf16 v79, v46, v46, v79
v_dot2_f32_bf16 v77, v47, s54, v77
v_dot2_f32_bf16 v79, v47, v47, v79
s_waitcnt vmcnt(13)
v_dot2_f32_bf16 v76, v12, s54, v76
v_dot2_f32_bf16 v78, v12, v12, v78
v_dot2_f32_bf16 v76, v13, s54, v76
v_dot2_f32_bf16 v78, v13, v13, v78
v_dot2_f32_bf16 v76, v14, s54, v76
v_dot2_f32_bf16 v78, v14, v14, v78
v_dot2_f32_bf16 v76, v15, s54, v76
v_dot2_f32_bf16 v78, v15, v15, v78
s_waitcnt vmcnt(12)
v_dot2_f32_bf16 v77, v48, s54, v77
v_dot2_f32_bf16 v79, v48, v48, v79
v_dot2_f32_bf16 v77, v49, s54, v77
v_dot2_f32_bf16 v79, v49, v49, v79
v_dot2_f32_bf16 v77, v50, s54, v77
v_dot2_f32_bf16 v79, v50, v50, v79
v_dot2_f32_bf16 v77, v51, s54, v77
v_dot2_f32_bf16 v79, v51, v51, v79
s_waitcnt vmcnt(11)
v_dot2_f32_bf16 v76, v16, s54, v76
v_dot2_f32_bf16 v78, v16, v16, v78
v_dot2_f32_bf16 v76, v17, s54, v76
v_dot2_f32_bf16 v78, v17, v17, v78
v_dot2_f32_bf16 v76, v18, s54, v76
v_dot2_f32_bf16 v78, v18, v18, v78
v_dot2_f32_bf16 v76, v19, s54, v76
v_dot2_f32_bf16 v78, v19, v19, v78
s_waitcnt vmcnt(10)
v_dot2_f32_bf16 v77, v52, s54, v77
v_dot2_f32_bf16 v79, v52, v52, v79
v_dot2_f32_bf16 v77, v53, s54, v77
v_dot2_f32_bf16 v79, v53, v53, v79
v_dot2_f32_bf16 v77, v54, s54, v77
v_dot2_f32_bf16 v79, v54, v54, v79
v_dot2_f32_bf16 v77, v55, s54, v77
v_dot2_f32_bf16 v79, v55, v55, v79
s_waitcnt vmcnt(9)
v_dot2_f32_bf16 v76, v20, s54, v76
v_dot2_f32_bf16 v78, v20, v20, v78
v_dot2_f32_bf16 v76, v21, s54, v76
v_dot2_f32_bf16 v78, v21, v21, v78
v_dot2_f32_bf16 v76, v22, s54, v76
v_dot2_f32_bf16 v78, v22, v22, v78
v_dot2_f32_bf16 v76, v23, s54, v76
v_dot2_f32_bf16 v78, v23, v23, v78
s_waitcnt vmcnt(8)
v_dot2_f32_bf16 v77, v56, s54, v77
v_dot2_f32_bf16 v79, v56, v56, v79
v_dot2_f32_bf16 v77, v57, s54, v77
v_dot2_f32_bf16 v79, v57, v57, v79
v_dot2_f32_bf16 v77, v58, s54, v77
v_dot2_f32_bf16 v79, v58, v58, v79
v_dot2_f32_bf16 v77, v59, s54, v77
v_dot2_f32_bf16 v79, v59, v59, v79
s_waitcnt vmcnt(7)
v_dot2_f32_bf16 v76, v24, s54, v76
v_dot2_f32_bf16 v78, v24, v24, v78
v_dot2_f32_bf16 v76, v25, s54, v76
v_dot2_f32_bf16 v78, v25, v25, v78
v_dot2_f32_bf16 v76, v26, s54, v76
v_dot2_f32_bf16 v78, v26, v26, v78
v_dot2_f32_bf16 v76, v27, s54, v76
v_dot2_f32_bf16 v78, v27, v27, v78
s_waitcnt vmcnt(6)
v_dot2_f32_bf16 v77, v60, s54, v77
v_dot2_f32_bf16 v79, v60, v60, v79
v_dot2_f32_bf16 v77, v61, s54, v77
v_dot2_f32_bf16 v79, v61, v61, v79
v_dot2_f32_bf16 v77, v62, s54, v77
v_dot2_f32_bf16 v79, v62, v62, v79
v_dot2_f32_bf16 v77, v63, s54, v77
v_dot2_f32_bf16 v79, v63, v63, v79
s_waitcnt vmcnt(5)
v_dot2_f32_bf16 v76, v28, s54, v76
v_dot2_f32_bf16 v78, v28, v28, v78
v_dot2_f32_bf16 v76, v29, s54, v76
v_dot2_f32_bf16 v78, v29, v29, v78
v_dot2_f32_bf16 v76, v30, s54, v76
v_dot2_f32_bf16 v78, v30, v30, v78
v_dot2_f32_bf16 v76, v31, s54, v76
v_dot2_f32_bf16 v78, v31, v31, v78
s_waitcnt vmcnt(4)
v_dot2_f32_bf16 v77, v64, s54, v77
v_dot2_f32_bf16 v79, v64, v64, v79
v_dot2_f32_bf16 v77, v65, s54, v77
v_dot2_f32_bf16 v79, v65, v65, v79
v_dot2_f32_bf16 v77, v66, s54, v77
v_dot2_f32_bf16 v79, v66, v66, v79
v_dot2_f32_bf16 v77, v67, s54, v77
v_dot2_f32_bf16 v79, v67, v67, v79
s_waitcnt vmcnt(3)
v_dot2_f32_bf16 v76, v32, s54, v76
v_dot2_f32_bf16 v78, v32, v32, v78
v_dot2_f32_bf16 v76, v33, s54, v76
v_dot2_f32_bf16 v78, v33, v33, v78
v_dot2_f32_bf16 v76, v34, s54, v76
v_dot2_f32_bf16 v78, v34, v34, v78
v_dot2_f32_bf16 v76, v35, s54, v76
v_dot2_f32_bf16 v78, v35, v35, v78
s_waitcnt vmcnt(2)
v_dot2_f32_bf16 v77, v68, s54, v77
v_dot2_f32_bf16 v79, v68, v68, v79
v_dot2_f32_bf16 v77, v69, s54, v77
v_dot2_f32_bf16 v79, v69, v69, v79
v_dot2_f32_bf16 v77, v70, s54, v77
v_dot2_f32_bf16 v79, v70, v70, v79
v_dot2_f32_bf16 v77, v71, s54, v77
v_dot2_f32_bf16 v79, v71, v71, v79
s_waitcnt vmcnt(1)
v_dot2_f32_bf16 v76, v36, s54, v76
v_dot2_f32_bf16 v78, v36, v36, v78
v_dot2_f32_bf16 v76, v37, s54, v76
v_dot2_f32_bf16 v78, v37, v37, v78
v_dot2_f32_bf16 v76, v38, s54, v76
v_dot2_f32_bf16 v78, v38, v38, v78
v_dot2_f32_bf16 v76, v39, s54, v76
v_dot2_f32_bf16 v78, v39, v39, v78
s_waitcnt vmcnt(0)
v_dot2_f32_bf16 v77, v72, s54, v77
v_dot2_f32_bf16 v79, v72, v72, v79
v_dot2_f32_bf16 v77, v73, s54, v77
v_dot2_f32_bf16 v79, v73, v73, v79
v_dot2_f32_bf16 v77, v74, s54, v77
v_dot2_f32_bf16 v79, v74, v74, v79
v_dot2_f32_bf16 v77, v75, s54, v77
v_dot2_f32_bf16 v79, v75, v75, v79
v_add_f32_dpp v76, v76, v76 quad_perm:[1,0,3,2] row_mask:0xf bank_mask:0xf
s_nop 0
v_add_f32_dpp v77, v77, v77 quad_perm:[1,0,3,2] row_mask:0xf bank_mask:0xf
v_add_f32_dpp v78, v78, v78 quad_perm:[1,0,3,2] row_mask:0xf bank_mask:0xf
v_add_f32_dpp v79, v79, v79 quad_perm:[1,0,3,2] row_mask:0xf bank_mask:0xf
v_add_f32_dpp v76, v76, v76 quad_perm:[2,3,0,1] row_mask:0xf bank_mask:0xf
v_add_f32_dpp v77, v77, v77 quad_perm:[2,3,0,1] row_mask:0xf bank_mask:0xf
v_add_f32_dpp v78, v78, v78 quad_perm:[2,3,0,1] row_mask:0xf bank_mask:0xf
v_add_f32_dpp v79, v79, v79 quad_perm:[2,3,0,1] row_mask:0xf bank_mask:0xf
v_add_f32_dpp v76, v76, v76 row_half_mirror row_mask:0xf bank_mask:0xf
v_add_f32_dpp v77, v77, v77 row_half_mirror row_mask:0xf bank_mask:0xf
v_add_f32_dpp v78, v78, v78 row_half_mirror row_mask:0xf bank_mask:0xf
v_add_f32_dpp v79, v79, v79 row_half_mirror row_mask:0xf bank_mask:0xf
v_mul_f32 v76, 0xbae38e39, v76
v_mul_f32 v77, 0xbae38e39, v77
v_mul_f32 v78, 0x3ae38e39, v78
v_mul_f32 v79, 0x3ae38e39, v79
v_fma_f32 v78, -v76, v76, v78
v_fma_f32 v79, -v77, v77, v79
v_max_f32 v78, 0, v78
v_max_f32 v79, 0, v79
v_add_f32 v78, 0x3727c5ac, v78
v_add_f32 v79, 0x3727c5ac, v79
v_rsq_f32 v78, v78
v_rsq_f32 v79, v79
v_mul_f32 v78, 1069066811, v78
v_mul_f32 v79, 1069066811, v79
v_mul_f32 v76, v76, v78
v_mul_f32 v77, v77, v79
v_lshlrev_b32 v245, 16, v4
v_and_b32 v244, s53, v4
v_lshlrev_b32 v243, 16, v5
v_and_b32 v242, s53, v5
v_lshlrev_b32 v241, 16, v6
v_and_b32 v240, s53, v6
v_lshlrev_b32 v239, 16, v7
v_and_b32 v238, s53, v7
v_fma_f32 v245, v245, v78, v76
v_fma_f32 v244, v244, v78, v76
v_fma_f32 v243, v243, v78, v76
v_fma_f32 v242, v242, v78, v76
v_fma_f32 v241, v241, v78, v76
v_fma_f32 v240, v240, v78, v76
v_fma_f32 v239, v239, v78, v76
v_fma_f32 v238, v238, v78, v76
v_cvt_pk_bf16_f32 v4, v245, v244
v_cvt_pk_bf16_f32 v5, v243, v242
v_cvt_pk_bf16_f32 v6, v241, v240
v_cvt_pk_bf16_f32 v7, v239, v238
ds_write_b128 v237, v[4:7] offset:0
v_lshlrev_b32 v245, 16, v40
v_and_b32 v244, s53, v40
v_lshlrev_b32 v243, 16, v41
v_and_b32 v242, s53, v41
v_lshlrev_b32 v241, 16, v42
v_and_b32 v240, s53, v42
v_lshlrev_b32 v239, 16, v43
v_and_b32 v238, s53, v43
v_fma_f32 v245, v245, v79, v77
v_fma_f32 v244, v244, v79, v77
v_fma_f32 v243, v243, v79, v77
v_fma_f32 v242, v242, v79, v77
v_fma_f32 v241, v241, v79, v77
v_fma_f32 v240, v240, v79, v77
v_fma_f32 v239, v239, v79, v77
v_fma_f32 v238, v238, v79, v77
v_cvt_pk_bf16_f32 v40, v245, v244
v_cvt_pk_bf16_f32 v41, v243, v242
v_cvt_pk_bf16_f32 v42, v241, v240
v_cvt_pk_bf16_f32 v43, v239, v238
ds_write_b128 v237, v[40:43] offset:128
v_lshlrev_b32 v245, 16, v8
v_and_b32 v244, s53, v8
v_lshlrev_b32 v243, 16, v9
v_and_b32 v242, s53, v9
v_lshlrev_b32 v241, 16, v10
v_and_b32 v240, s53, v10
v_lshlrev_b32 v239, 16, v11
v_and_b32 v238, s53, v11
v_fma_f32 v245, v245, v78, v76
v_fma_f32 v244, v244, v78, v76
v_fma_f32 v243, v243, v78, v76
v_fma_f32 v242, v242, v78, v76
v_fma_f32 v241, v241, v78, v76
v_fma_f32 v240, v240, v78, v76
v_fma_f32 v239, v239, v78, v76
v_fma_f32 v238, v238, v78, v76
v_cvt_pk_bf16_f32 v8, v245, v244
v_cvt_pk_bf16_f32 v9, v243, v242
v_cvt_pk_bf16_f32 v10, v241, v240
v_cvt_pk_bf16_f32 v11, v239, v238
ds_write_b128 v237, v[8:11] offset:16384
v_lshlrev_b32 v245, 16, v44
v_and_b32 v244, s53, v44
v_lshlrev_b32 v243, 16, v45
v_and_b32 v242, s53, v45
v_lshlrev_b32 v241, 16, v46
v_and_b32 v240, s53, v46
v_lshlrev_b32 v239, 16, v47
v_and_b32 v238, s53, v47
v_fma_f32 v245, v245, v79, v77
v_fma_f32 v244, v244, v79, v77
v_fma_f32 v243, v243, v79, v77
v_fma_f32 v242, v242, v79, v77
v_fma_f32 v241, v241, v79, v77
v_fma_f32 v240, v240, v79, v77
v_fma_f32 v239, v239, v79, v77
v_fma_f32 v238, v238, v79, v77
v_cvt_pk_bf16_f32 v44, v245, v244
v_cvt_pk_bf16_f32 v45, v243, v242
v_cvt_pk_bf16_f32 v46, v241, v240
v_cvt_pk_bf16_f32 v47, v239, v238
ds_write_b128 v237, v[44:47] offset:16512
s_add_u32 m0, s48, 0
s_add_u32 s49, s57, 0
buffer_load_dwordx4 v246, s[12:15], s49 offen lds
v_lshlrev_b32 v245, 16, v12
v_and_b32 v244, s53, v12
v_lshlrev_b32 v243, 16, v13
v_and_b32 v242, s53, v13
v_lshlrev_b32 v241, 16, v14
v_and_b32 v240, s53, v14
v_lshlrev_b32 v239, 16, v15
s_add_u32 m0, s48, 4096
s_add_u32 s49, s57, 128
buffer_load_dwordx4 v246, s[12:15], s49 offen lds
v_and_b32 v238, s53, v15
v_fma_f32 v245, v245, v78, v76
v_fma_f32 v244, v244, v78, v76
v_fma_f32 v243, v243, v78, v76
v_fma_f32 v242, v242, v78, v76
v_fma_f32 v241, v241, v78, v76
v_fma_f32 v240, v240, v78, v76
s_add_u32 m0, s48, 8192
s_add_u32 s49, s57, 256
buffer_load_dwordx4 v232, s[12:15], s49 offen lds
v_fma_f32 v239, v239, v78, v76
v_fma_f32 v238, v238, v78, v76
v_cvt_pk_bf16_f32 v12, v245, v244
v_cvt_pk_bf16_f32 v13, v243, v242
v_cvt_pk_bf16_f32 v14, v241, v240
v_cvt_pk_bf16_f32 v15, v239, v238
s_add_u32 m0, s48, 12288
s_add_u32 s49, s57, 110592
buffer_load_dwordx4 v246, s[12:15], s49 offen lds
v_lshlrev_b32 v245, 16, v48
v_and_b32 v244, s53, v48
v_lshlrev_b32 v243, 16, v49
v_and_b32 v242, s53, v49
v_lshlrev_b32 v241, 16, v50
v_and_b32 v240, s53, v50
v_lshlrev_b32 v239, 16, v51
s_add_u32 m0, s48, 16384
s_add_u32 s49, s57, 110720
buffer_load_dwordx4 v246, s[12:15], s49 offen lds
v_and_b32 v238, s53, v51
v_fma_f32 v245, v245, v79, v77
v_fma_f32 v244, v244, v79, v77
v_fma_f32 v243, v243, v79, v77
v_fma_f32 v242, v242, v79, v77
v_fma_f32 v241, v241, v79, v77
v_fma_f32 v240, v240, v79, v77
s_add_u32 m0, s48, 20480
s_add_u32 s49, s57, 110848
buffer_load_dwordx4 v232, s[12:15], s49 offen lds
v_fma_f32 v239, v239, v79, v77
v_fma_f32 v238, v238, v79, v77
v_cvt_pk_bf16_f32 v48, v245, v244
v_cvt_pk_bf16_f32 v49, v243, v242
v_cvt_pk_bf16_f32 v50, v241, v240
v_cvt_pk_bf16_f32 v51, v239, v238
s_add_u32 m0, s48, 24576
s_add_u32 s49, s57, 221184
buffer_load_dwordx4 v246, s[12:15], s49 offen lds
v_lshlrev_b32 v245, 16, v16
v_and_b32 v244, s53, v16
v_lshlrev_b32 v243, 16, v17
v_and_b32 v242, s53, v17
v_lshlrev_b32 v241, 16, v18
v_and_b32 v240, s53, v18
v_lshlrev_b32 v239, 16, v19
s_add_u32 m0, s48, 28672
s_add_u32 s49, s57, 221312
buffer_load_dwordx4 v246, s[12:15], s49 offen lds
v_and_b32 v238, s53, v19
v_fma_f32 v245, v245, v78, v76
v_fma_f32 v244, v244, v78, v76
v_fma_f32 v243, v243, v78, v76
v_fma_f32 v242, v242, v78, v76
v_fma_f32 v241, v241, v78, v76
v_fma_f32 v240, v240, v78, v76
s_add_u32 m0, s48, 32768
s_add_u32 s49, s57, 221440
buffer_load_dwordx4 v232, s[12:15], s49 offen lds
v_fma_f32 v239, v239, v78, v76
v_fma_f32 v238, v238, v78, v76
v_cvt_pk_bf16_f32 v16, v245, v244
v_cvt_pk_bf16_f32 v17, v243, v242
v_cvt_pk_bf16_f32 v18, v241, v240
v_cvt_pk_bf16_f32 v19, v239, v238
s_add_u32 m0, s48, 36864
s_add_u32 s49, s57, 331776
buffer_load_dwordx4 v246, s[12:15], s49 offen lds
v_lshlrev_b32 v245, 16, v52
v_and_b32 v244, s53, v52
v_lshlrev_b32 v243, 16, v53
v_and_b32 v242, s53, v53
v_lshlrev_b32 v241, 16, v54
v_and_b32 v240, s53, v54
v_lshlrev_b32 v239, 16, v55
s_add_u32 m0, s48, 40960
s_add_u32 s49, s57, 331904
buffer_load_dwordx4 v246, s[12:15], s49 offen lds
v_and_b32 v238, s53, v55
v_fma_f32 v245, v245, v79, v77
v_fma_f32 v244, v244, v79, v77
v_fma_f32 v243, v243, v79, v77
v_fma_f32 v242, v242, v79, v77
v_fma_f32 v241, v241, v79, v77
v_fma_f32 v240, v240, v79, v77
v_xor_b32 v255, v251, v252
v_mul_u32_u24 v254, 52, v255
v_lshrrev_b32 v254, 8, v254
v_mul_u32_u24 v253, 1072, v254
v_lshl_add_u32 v255, v255, 4, v253
v_mul_u32_u24 v253, 3456, v252
v_add3_u32 v255, v255, v253, s61
v_cmp_lt_u32 vcc, 1, v254
v_mov_b32 v253, 1879048192
s_nop 0
v_cndmask_b32 v255, v255, v253, vcc
s_lshl_b32 s51, s41, 2
s_add_u32 s51, s51, s45
s_mul_i32 s51, s51, 72
s_mul_i32 s50, s60, 110592
s_add_u32 s50, s50, s51
s_mul_i32 s51, s42, 8192
s_add_u32 s51, s51, 122880
s_add_u32 m0, s51, 0
s_nop 0
buffer_load_dwordx4 v255, s[12:15], s50 offen lds
s_add_u32 m0, s51, 1024
s_add_u32 s50, s50, 13824
buffer_load_dwordx4 v255, s[12:15], s50 offen lds
s_add_u32 m0, s51, 2048
s_add_u32 s50, s50, 13824
buffer_load_dwordx4 v255, s[12:15], s50 offen lds
s_add_u32 m0, s51, 3072
s_add_u32 s50, s50, 13824
buffer_load_dwordx4 v255, s[12:15], s50 offen lds
s_add_u32 m0, s51, 4096
s_add_u32 s50, s50, 13824
buffer_load_dwordx4 v255, s[12:15], s50 offen lds
s_add_u32 m0, s51, 5120
s_add_u32 s50, s50, 13824
buffer_load_dwordx4 v255, s[12:15], s50 offen lds
s_add_u32 m0, s51, 6144
s_add_u32 s50, s50, 13824
buffer_load_dwordx4 v255, s[12:15], s50 offen lds
s_add_u32 m0, s51, 7168
s_add_u32 s50, s50, 13824
buffer_load_dwordx4 v255, s[12:15], s50 offen lds
v_fma_f32 v239, v239, v79, v77
v_fma_f32 v238, v238, v79, v77
v_cvt_pk_bf16_f32 v52, v245, v244
v_cvt_pk_bf16_f32 v53, v243, v242
v_cvt_pk_bf16_f32 v54, v241, v240
v_cvt_pk_bf16_f32 v55, v239, v238
v_and_b32 v255, 1, v252
v_lshrrev_b32 v254, 1, v250
v_lshl_or_b32 v255, v255, 1, v254
v_lshlrev_b32 v255, 5, v255
v_lshl_add_u32 v254, v252, 3, v250
v_lshl_add_u32 v255, v254, 7, v255
v_lshl_add_u32 v255, v249, 3, v255
v_xor_b32 v233, 0, v255
v_add_u32 v3, 0x10000, v233
v_xor_b32 v2, 32, v255
v_add_u32 v231, 0x10000, v2
v_lshl_add_u32 v255, v252, 3, v250
v_and_b32 v254, 1, v249
v_mul_u32_u24 v254, 24, v254
v_add_u32 v254, 155776, v254
v_mad_u32_u24 v230, v255, 48, v254
v_add_u32 v229, 192, v230
v_add_u32 v228, 1536, v230
v_mov_b32 v254, 155648
v_cmp_gt_u32 vcc, 2, v249
v_cmp_le_u32 s[6:7], 18, v255
s_nop 0
s_xor_b64 s[6:7], s[6:7], vcc
v_cndmask_b32 v230, v254, v230, s[6:7]
v_cmp_le_u32 s[6:7], 14, v255
s_nop 0
s_xor_b64 s[6:7], s[6:7], vcc
v_cndmask_b32 v229, v254, v229, s[6:7]
v_cmp_gt_u32 s[6:7], 4, v255
s_nop 0
s_andn2_b64 s[6:7], s[6:7], vcc
v_cndmask_b32 v228, v254, v228, s[6:7]
v_mov_b32 v10, 0
v_mov_b32 v11, 0
v_add_u32 v227, s61, v248
s_lshr_b32 s49, s45, 1
s_mul_i32 s96, s49, 108
s_mul_i32 s49, s60, 6
s_add_u32 s96, s96, s49
s_and_b32 s49, s45, 1
s_mul_i32 s49, s49, 3
s_add_u32 s96, s96, s49
s_lshl_b32 s96, s96, 10
s_add_u32 s96, s96, s46
s_add_u32 s97, s96, 221184
s_waitcnt vmcnt(0)
s_mul_i32 s51, s42, 8192
s_add_u32 s51, s51, 122880
v_lshlrev_b32 v255, 11, v250
v_lshl_add_u32 v255, v249, 8, v255
v_add_u32 v255, s51, v255
v_lshlrev_b32 v253, 3, v252
s_mov_b32 s50, 134678021
v_bfe_u32 v254, s50, v253, 8
v_xor_b32 v254, v254, v249
v_lshl_add_u32 v254, v254, 4, v255
ds_read_b128 v[40:43], v254 offset:0
ds_read_b128 v[108:111], v254 offset:1024
s_mov_b32 s50, 151587081
v_bfe_u32 v254, s50, v253, 8
v_xor_b32 v254, v254, v249
v_lshl_add_u32 v254, v254, 4, v255
ds_read_b128 v[44:47], v254 offset:0
ds_read_b128 v[112:115], v254 offset:1024
s_mov_b32 s50, 50462976
v_bfe_u32 v254, s50, v253, 8
v_xor_b32 v254, v254, v249
v_lshl_add_u32 v254, v254, 4, v255
ds_read_b128 v[100:103], v254 offset:0
ds_read_b128 v[116:119], v254 offset:1024
s_mov_b32 s50, 67372036
v_bfe_u32 v254, s50, v253, 8
v_xor_b32 v254, v254, v249
v_lshl_add_u32 v254, v254, 4, v255
ds_read_b128 v[104:107], v254 offset:0
ds_read_b128 v[120:123], v254 offset:1024
s_waitcnt lgkmcnt(0)
s_barrier
s_setprio 3
ds_read_b128 v[124:127], v236 offset:0
ds_read_b128 v[128:131], v236 offset:1024
ds_read_b64_tr_b16 v[80:81], v233 offset:0
ds_read_b64_tr_b16 v[82:83], v233 offset:512
ds_read_b64_tr_b16 v[84:85], v2 offset:0
ds_read_b64_tr_b16 v[86:87], v2 offset:512
ds_read_b64_tr_b16 v[88:89], v233 offset:4096
ds_read_b64_tr_b16 v[90:91], v233 offset:4608
ds_read_b64_tr_b16 v[92:93], v2 offset:4096
ds_read_b64_tr_b16 v[94:95], v2 offset:4608
ds_read_b128 v[132:135], v235 offset:8192
ds_read_b128 v[136:139], v235 offset:9216
ds_read_b128 v[140:143], v236 offset:16384
ds_read_b128 v[144:147], v236 offset:17408
ds_read_b128 v[148:151], v235 offset:24576
ds_read_b128 v[152:155], v235 offset:25600
v_mov_b32 v255, 0
buffer_load_dwordx2 v[224:225], v255, s[36:39], 0 offen sc1
s_waitcnt lgkmcnt(14)
s_waitcnt lgkmcnt(10)
v_mfma_f32_16x16x32_bf16 v[156:159], v[80:83], v[124:127], 0
ds_read_b64_tr_b16 v[96:97], v233 offset:8192
s_add_u32 m0, s48, 49152
s_add_u32 s49, s57, 442368
buffer_load_dwordx4 v246, s[12:15], s49 offen lds
ds_write_b128 v237, v[12:15] offset:32768
v_mfma_f32_16x16x32_bf16 v[160:163], v[80:83], v[128:131], 0
ds_read_b64_tr_b16 v[98:99], v233 offset:8704
ds_read_b64_tr_b16 v[4:5], v230 offset:0
ds_read_b64_tr_b16 v[6:7], v229 offset:0
ds_read_b64_tr_b16 v[8:9], v228 offset:0
v_mfma_f32_16x16x32_bf16 v[164:167], v[84:87], v[124:127], 0
ds_read_b64_tr_b16 v[80:81], v233 offset:12288
v_mfma_f32_16x16x32_bf16 v[168:171], v[84:87], v[128:131], 0
ds_read_b64_tr_b16 v[82:83], v233 offset:12800
s_waitcnt lgkmcnt(14)
v_mfma_f32_16x16x32_bf16 v[172:175], v[88:91], v[124:127], 0
ds_read_b64_tr_b16 v[84:85], v2 offset:12288
s_add_u32 m0, s48, 57344
s_add_u32 s49, s57, 442624
buffer_load_dwordx4 v232, s[12:15], s49 offen lds
v_mfma_f32_16x16x32_bf16 v[176:179], v[88:91], v[128:131], 0
ds_read_b64_tr_b16 v[86:87], v2 offset:12800
s_waitcnt lgkmcnt(4)
v_mfma_f32_16x16x32_bf16 v[12:15], v[40:43], v[4:7], 0
v_mfma_f32_16x16x32_bf16 v[12:15], v[44:47], v[8:11], v[12:15]
v_mfma_f32_16x16x32_bf16 v[196:199], v[108:111], v[4:7], 0
v_mfma_f32_16x16x32_bf16 v[196:199], v[112:115], v[8:11], v[196:199]
v_mfma_f32_16x16x32_bf16 v[200:203], v[100:103], v[4:7], 0
v_mfma_f32_16x16x32_bf16 v[200:203], v[104:107], v[8:11], v[200:203]
v_mfma_f32_16x16x32_bf16 v[204:207], v[116:119], v[4:7], 0
v_mfma_f32_16x16x32_bf16 v[204:207], v[120:123], v[8:11], v[204:207]
v_mfma_f32_16x16x32_bf16 v[180:183], v[92:95], v[124:127], 0
ds_read_b64_tr_b16 v[88:89], v233 offset:16384
ds_write_b128 v237, v[48:51] offset:32896
v_mfma_f32_16x16x32_bf16 v[184:187], v[92:95], v[128:131], 0
ds_read_b64_tr_b16 v[90:91], v233 offset:16896
s_setprio 2
v_mfma_f32_16x16x32_bf16 v[188:191], v[96:99], v[124:127], 0
ds_read_b64_tr_b16 v[92:93], v2 offset:16384
s_add_u32 m0, s48, 65536
s_add_u32 s49, s57, 553088
buffer_load_dwordx4 v246, s[12:15], s49 offen lds
v_mfma_f32_16x16x32_bf16 v[192:195], v[96:99], v[128:131], 0
ds_read_b64_tr_b16 v[94:95], v2 offset:16896
ds_read_b64_tr_b16 v[4:5], v230 offset:8
ds_read_b64_tr_b16 v[6:7], v229 offset:8
ds_read_b64_tr_b16 v[8:9], v228 offset:8
s_waitcnt lgkmcnt(10)
v_mfma_f32_16x16x32_bf16 v[156:159], v[80:83], v[132:135], v[156:159]
ds_read_b64_tr_b16 v[96:97], v233 offset:20480
v_cvt_pk_bf16_f32 v12, v12, v13
v_cvt_pk_bf16_f32 v13, v14, v15
v_cvt_pk_bf16_f32 v14, v196, v197
v_cvt_pk_bf16_f32 v15, v198, v199
buffer_store_dwordx4 v[12:15], v227, s[24:27], s96 offen offset:0 sc1
v_cvt_pk_bf16_f32 v200, v200, v201
v_cvt_pk_bf16_f32 v201, v202, v203
v_cvt_pk_bf16_f32 v202, v204, v205
v_cvt_pk_bf16_f32 v203, v206, v207
buffer_store_dwordx4 v[200:203], v227, s[24:27], s97 offen offset:0 sc1
v_mfma_f32_16x16x32_bf16 v[160:163], v[80:83], v[136:139], v[160:163]
ds_read_b64_tr_b16 v[98:99], v233 offset:20992
s_waitcnt lgkmcnt(7)
v_mfma_f32_16x16x32_bf16 v[164:167], v[84:87], v[132:135], v[164:167]
ds_read_b64_tr_b16 v[80:81], v233 offset:24576
s_add_u32 m0, s48, 73728
s_add_u32 s49, s57, 663552
buffer_load_dwordx4 v246, s[12:15], s49 offen lds
v_mfma_f32_16x16x32_bf16 v[168:171], v[84:87], v[136:139], v[168:171]
ds_read_b64_tr_b16 v[82:83], v233 offset:25088
ds_write_b128 v237, v[16:19] offset:49152
v_mfma_f32_16x16x32_bf16 v[172:175], v[88:91], v[132:135], v[172:175]
ds_read_b64_tr_b16 v[84:85], v2 offset:24576
s_waitcnt lgkmcnt(6)
v_mfma_f32_16x16x32_bf16 v[12:15], v[40:43], v[4:7], 0
v_mfma_f32_16x16x32_bf16 v[12:15], v[44:47], v[8:11], v[12:15]
v_mfma_f32_16x16x32_bf16 v[16:19], v[108:111], v[4:7], 0
v_mfma_f32_16x16x32_bf16 v[16:19], v[112:115], v[8:11], v[16:19]
v_mfma_f32_16x16x32_bf16 v[48:51], v[100:103], v[4:7], 0
v_mfma_f32_16x16x32_bf16 v[48:51], v[104:107], v[8:11], v[48:51]
v_mfma_f32_16x16x32_bf16 v[196:199], v[116:119], v[4:7], 0
v_mfma_f32_16x16x32_bf16 v[196:199], v[120:123], v[8:11], v[196:199]
v_mfma_f32_16x16x32_bf16 v[176:179], v[88:91], v[136:139], v[176:179]
ds_read_b64_tr_b16 v[86:87], v2 offset:25088
ds_read_b64_tr_b16 v[4:5], v230 offset:16
ds_read_b64_tr_b16 v[6:7], v229 offset:16
ds_read_b64_tr_b16 v[8:9], v228 offset:16
s_setprio 1
v_mfma_f32_16x16x32_bf16 v[180:183], v[92:95], v[132:135], v[180:183]
ds_read_b64_tr_b16 v[88:89], v233 offset:28672
s_add_u32 m0, s48, 81920
s_add_u32 s49, s57, 663808
buffer_load_dwordx4 v232, s[12:15], s49 offen lds
v_mfma_f32_16x16x32_bf16 v[184:187], v[92:95], v[136:139], v[184:187]
ds_read_b64_tr_b16 v[90:91], v233 offset:29184
v_cvt_pk_bf16_f32 v12, v12, v13
v_cvt_pk_bf16_f32 v13, v14, v15
v_cvt_pk_bf16_f32 v14, v16, v17
v_cvt_pk_bf16_f32 v15, v18, v19
buffer_store_dwordx4 v[12:15], v227, s[24:27], s96 offen offset:1024 sc1
v_cvt_pk_bf16_f32 v48, v48, v49
v_cvt_pk_bf16_f32 v49, v50, v51
v_cvt_pk_bf16_f32 v50, v196, v197
v_cvt_pk_bf16_f32 v51, v198, v199
buffer_store_dwordx4 v[48:51], v227, s[24:27], s97 offen offset:1024 sc1
s_waitcnt lgkmcnt(10)
v_mfma_f32_16x16x32_bf16 v[188:191], v[96:99], v[132:135], v[188:191]
ds_read_b64_tr_b16 v[92:93], v2 offset:28672
ds_write_b128 v237, v[52:55] offset:49280
v_mfma_f32_16x16x32_bf16 v[192:195], v[96:99], v[136:139], v[192:195]
ds_read_b64_tr_b16 v[94:95], v2 offset:29184
s_waitcnt lgkmcnt(8)
v_mfma_f32_16x16x32_bf16 v[156:159], v[80:83], v[140:143], v[156:159]
ds_read_b64_tr_b16 v[96:97], v233 offset:32768
s_waitcnt lgkmcnt(6)
v_mfma_f32_16x16x32_bf16 v[12:15], v[40:43], v[4:7], 0
v_mfma_f32_16x16x32_bf16 v[12:15], v[44:47], v[8:11], v[12:15]
v_mfma_f32_16x16x32_bf16 v[16:19], v[108:111], v[4:7], 0
v_mfma_f32_16x16x32_bf16 v[16:19], v[112:115], v[8:11], v[16:19]
v_mfma_f32_16x16x32_bf16 v[48:51], v[100:103], v[4:7], 0
v_mfma_f32_16x16x32_bf16 v[48:51], v[104:107], v[8:11], v[48:51]
v_mfma_f32_16x16x32_bf16 v[52:55], v[116:119], v[4:7], 0
v_mfma_f32_16x16x32_bf16 v[52:55], v[120:123], v[8:11], v[52:55]
v_mfma_f32_16x16x32_bf16 v[160:163], v[80:83], v[144:147], v[160:163]
ds_read_b64_tr_b16 v[98:99], v233 offset:33280
v_mfma_f32_16x16x32_bf16 v[164:167], v[84:87], v[140:143], v[164:167]
ds_read_b64_tr_b16 v[80:81], v233 offset:36864
v_mfma_f32_16x16x32_bf16 v[168:171], v[84:87], v[144:147], v[168:171]
ds_read_b64_tr_b16 v[82:83], v233 offset:37376
s_setprio 0
s_waitcnt lgkmcnt(4)
v_mfma_f32_16x16x32_bf16 v[172:175], v[88:91], v[140:143], v[172:175]
ds_read_b64_tr_b16 v[84:85], v2 offset:36864
v_mfma_f32_16x16x32_bf16 v[176:179], v[88:91], v[144:147], v[176:179]
ds_read_b64_tr_b16 v[86:87], v2 offset:37376
v_mfma_f32_16x16x32_bf16 v[180:183], v[92:95], v[140:143], v[180:183]
ds_read_b64_tr_b16 v[88:89], v233 offset:40960
v_cvt_pk_bf16_f32 v12, v12, v13
v_cvt_pk_bf16_f32 v13, v14, v15
v_cvt_pk_bf16_f32 v14, v16, v17
v_cvt_pk_bf16_f32 v15, v18, v19
buffer_store_dwordx4 v[12:15], v227, s[24:27], s96 offen offset:2048 sc1
v_cvt_pk_bf16_f32 v48, v48, v49
v_cvt_pk_bf16_f32 v49, v50, v51
v_cvt_pk_bf16_f32 v50, v52, v53
v_cvt_pk_bf16_f32 v51, v54, v55
buffer_store_dwordx4 v[48:51], v227, s[24:27], s97 offen offset:2048 sc1
v_mfma_f32_16x16x32_bf16 v[184:187], v[92:95], v[144:147], v[184:187]
ds_read_b64_tr_b16 v[90:91], v233 offset:41472
s_waitcnt lgkmcnt(4)
v_mfma_f32_16x16x32_bf16 v[188:191], v[96:99], v[140:143], v[188:191]
ds_read_b64_tr_b16 v[92:93], v2 offset:40960
v_mfma_f32_16x16x32_bf16 v[192:195], v[96:99], v[144:147], v[192:195]
ds_read_b64_tr_b16 v[94:95], v2 offset:41472
s_waitcnt vmcnt(5)
s_barrier
s_setprio 3
ds_read_b128 v[4:7], v236 offset:32768
ds_read_b128 v[8:11], v236 offset:33792
ds_read_b128 v[12:15], v235 offset:40960
ds_read_b128 v[16:19], v235 offset:41984
ds_read_b128 v[40:43], v236 offset:49152
ds_read_b128 v[44:47], v236 offset:50176
ds_read_b128 v[48:51], v235 offset:57344
ds_read_b128 v[52:55], v235 offset:58368
v_mfma_f32_16x16x32_bf16 v[156:159], v[80:83], v[148:151], v[156:159]
ds_read_b64_tr_b16 v[96:97], v233 offset:45056
s_add_u32 m0, s48, 0
s_add_u32 s49, s57, 774272
buffer_load_dwordx4 v246, s[12:15], s49 offen lds
v_lshlrev_b32 v245, 16, v20
v_and_b32 v244, s53, v20
v_lshlrev_b32 v243, 16, v21
v_mfma_f32_16x16x32_bf16 v[160:163], v[80:83], v[152:155], v[160:163]
ds_read_b64_tr_b16 v[98:99], v233 offset:45568
v_and_b32 v242, s53, v21
v_lshlrev_b32 v241, 16, v22
v_and_b32 v240, s53, v22
v_lshlrev_b32 v239, 16, v23
s_waitcnt lgkmcnt(12)
v_mfma_f32_16x16x32_bf16 v[164:167], v[84:87], v[148:151], v[164:167]
ds_read_b64_tr_b16 v[80:81], v233 offset:49152
v_and_b32 v238, s53, v23
v_fma_f32 v245, v245, v78, v76
v_fma_f32 v244, v244, v78, v76
v_fma_f32 v243, v243, v78, v76
v_mfma_f32_16x16x32_bf16 v[168:171], v[84:87], v[152:155], v[168:171]
ds_read_b64_tr_b16 v[82:83], v233 offset:49664
v_fma_f32 v242, v242, v78, v76
v_fma_f32 v241, v241, v78, v76
v_fma_f32 v240, v240, v78, v76
v_mfma_f32_16x16x32_bf16 v[172:175], v[88:91], v[148:151], v[172:175]
ds_read_b64_tr_b16 v[84:85], v2 offset:49152
s_add_u32 m0, s48, 8192
s_add_u32 s49, s57, 884736
buffer_load_dwordx4 v246, s[12:15], s49 offen lds
v_fma_f32 v239, v239, v78, v76
v_fma_f32 v238, v238, v78, v76
v_cvt_pk_bf16_f32 v20, v245, v244
v_mfma_f32_16x16x32_bf16 v[176:179], v[88:91], v[152:155], v[176:179]
ds_read_b64_tr_b16 v[86:87], v2 offset:49664
v_cvt_pk_bf16_f32 v21, v243, v242
v_cvt_pk_bf16_f32 v22, v241, v240
v_cvt_pk_bf16_f32 v23, v239, v238
s_waitcnt lgkmcnt(4)
v_mfma_f32_16x16x32_bf16 v[180:183], v[92:95], v[148:151], v[180:183]
ds_read_b64_tr_b16 v[88:89], v233 offset:53248
ds_write_b128 v237, v[20:23] offset:0
v_lshlrev_b32 v245, 16, v56
v_and_b32 v244, s53, v56
v_lshlrev_b32 v243, 16, v57
v_mfma_f32_16x16x32_bf16 v[184:187], v[92:95], v[152:155], v[184:187]
ds_read_b64_tr_b16 v[90:91], v233 offset:53760
v_and_b32 v242, s53, v57
v_lshlrev_b32 v241, 16, v58
v_and_b32 v240, s53, v58
s_setprio 2
v_mfma_f32_16x16x32_bf16 v[188:191], v[96:99], v[148:151], v[188:191]
ds_read_b64_tr_b16 v[92:93], v2 offset:53248
s_add_u32 m0, s48, 16384
s_add_u32 s49, s57, 884992
buffer_load_dwordx4 v232, s[12:15], s49 offen lds
v_lshlrev_b32 v239, 16, v59
v_and_b32 v238, s53, v59
v_fma_f32 v245, v245, v79, v77
v_mfma_f32_16x16x32_bf16 v[192:195], v[96:99], v[152:155], v[192:195]
ds_read_b64_tr_b16 v[94:95], v2 offset:53760
v_fma_f32 v244, v244, v79, v77
v_fma_f32 v243, v243, v79, v77
v_fma_f32 v242, v242, v79, v77
s_waitcnt lgkmcnt(5)
v_mfma_f32_16x16x32_bf16 v[156:159], v[80:83], v[4:7], v[156:159]
ds_read_b64_tr_b16 v[96:97], v233 offset:57344
v_fma_f32 v241, v241, v79, v77
v_fma_f32 v240, v240, v79, v77
v_fma_f32 v239, v239, v79, v77
v_fma_f32 v238, v238, v79, v77
v_mfma_f32_16x16x32_bf16 v[160:163], v[80:83], v[8:11], v[160:163]
ds_read_b64_tr_b16 v[98:99], v233 offset:57856
v_cvt_pk_bf16_f32 v56, v245, v244
v_cvt_pk_bf16_f32 v57, v243, v242
v_cvt_pk_bf16_f32 v58, v241, v240
v_mfma_f32_16x16x32_bf16 v[164:167], v[84:87], v[4:7], v[164:167]
ds_read_b64_tr_b16 v[80:81], v233 offset:61440
s_add_u32 m0, s48, 24576
s_add_u32 s49, s57, 995456
buffer_load_dwordx4 v246, s[12:15], s49 offen lds
v_cvt_pk_bf16_f32 v59, v239, v238
ds_write_b128 v237, v[56:59] offset:128
v_lshlrev_b32 v245, 16, v24
v_mfma_f32_16x16x32_bf16 v[168:171], v[84:87], v[8:11], v[168:171]
ds_read_b64_tr_b16 v[82:83], v233 offset:61952
v_and_b32 v244, s53, v24
v_lshlrev_b32 v243, 16, v25
v_and_b32 v242, s53, v25
v_lshlrev_b32 v241, 16, v26
s_waitcnt lgkmcnt(5)
v_mfma_f32_16x16x32_bf16 v[172:175], v[88:91], v[4:7], v[172:175]
ds_read_b64_tr_b16 v[84:85], v2 offset:61440
v_and_b32 v240, s53, v26
v_lshlrev_b32 v239, 16, v27
v_and_b32 v238, s53, v27
v_mfma_f32_16x16x32_bf16 v[176:179], v[88:91], v[8:11], v[176:179]
ds_read_b64_tr_b16 v[86:87], v2 offset:61952
v_fma_f32 v245, v245, v78, v76
v_fma_f32 v244, v244, v78, v76
v_fma_f32 v243, v243, v78, v76
s_setprio 1
v_mfma_f32_16x16x32_bf16 v[180:183], v[92:95], v[4:7], v[180:183]
ds_read_b64_tr_b16 v[88:89], v3 offset:0
s_add_u32 m0, s48, 32768
s_add_u32 s49, s57, 1105920
buffer_load_dwordx4 v246, s[12:15], s49 offen lds
v_fma_f32 v242, v242, v78, v76
v_fma_f32 v241, v241, v78, v76
v_fma_f32 v240, v240, v78, v76
v_mfma_f32_16x16x32_bf16 v[184:187], v[92:95], v[8:11], v[184:187]
ds_read_b64_tr_b16 v[90:91], v3 offset:512
v_fma_f32 v239, v239, v78, v76
v_fma_f32 v238, v238, v78, v76
v_cvt_pk_bf16_f32 v24, v245, v244
v_cvt_pk_bf16_f32 v25, v243, v242
s_waitcnt lgkmcnt(4)
v_mfma_f32_16x16x32_bf16 v[188:191], v[96:99], v[4:7], v[188:191]
ds_read_b64_tr_b16 v[92:93], v231 offset:0
v_cvt_pk_bf16_f32 v26, v241, v240
v_cvt_pk_bf16_f32 v27, v239, v238
ds_write_b128 v237, v[24:27] offset:16384
v_mfma_f32_16x16x32_bf16 v[192:195], v[96:99], v[8:11], v[192:195]
ds_read_b64_tr_b16 v[94:95], v231 offset:512
v_lshlrev_b32 v245, 16, v60
v_and_b32 v244, s53, v60
v_lshlrev_b32 v243, 16, v61
v_mfma_f32_16x16x32_bf16 v[156:159], v[80:83], v[12:15], v[156:159]
ds_read_b64_tr_b16 v[96:97], v3 offset:4096
v_and_b32 v242, s53, v61
v_lshlrev_b32 v241, 16, v62
v_and_b32 v240, s53, v62
v_lshlrev_b32 v239, 16, v63
v_mfma_f32_16x16x32_bf16 v[160:163], v[80:83], v[16:19], v[160:163]
ds_read_b64_tr_b16 v[98:99], v3 offset:4608
v_and_b32 v238, s53, v63
v_fma_f32 v245, v245, v79, v77
v_fma_f32 v244, v244, v79, v77
s_waitcnt lgkmcnt(5)
v_mfma_f32_16x16x32_bf16 v[164:167], v[84:87], v[12:15], v[164:167]
ds_read_b64_tr_b16 v[80:81], v3 offset:8192
v_fma_f32 v243, v243, v79, v77
v_fma_f32 v242, v242, v79, v77
v_fma_f32 v241, v241, v79, v77
v_fma_f32 v240, v240, v79, v77
v_mfma_f32_16x16x32_bf16 v[168:171], v[84:87], v[16:19], v[168:171]
ds_read_b64_tr_b16 v[82:83], v3 offset:8704
v_fma_f32 v239, v239, v79, v77
v_fma_f32 v238, v238, v79, v77
v_cvt_pk_bf16_f32 v60, v245, v244
s_setprio 0
v_mfma_f32_16x16x32_bf16 v[172:175], v[88:91], v[12:15], v[172:175]
ds_read_b64_tr_b16 v[84:85], v231 offset:8192
v_cvt_pk_bf16_f32 v61, v243, v242
v_cvt_pk_bf16_f32 v62, v241, v240
v_cvt_pk_bf16_f32 v63, v239, v238
ds_write_b128 v237, v[60:63] offset:16512
v_mfma_f32_16x16x32_bf16 v[176:179], v[88:91], v[16:19], v[176:179]
ds_read_b64_tr_b16 v[86:87], v231 offset:8704
s_mov_b32 s52, 0
L_spa0_1:
v_cmp_eq_u32 vcc, 0, v224
s_nop 1
s_cmp_eq_u64 vcc, 0
s_cbranch_scc1 L_spa0_1x
s_add_u32 s52, s52, 1
s_cmp_ge_u32 s52, 0x10000
s_cbranch_scc1 L_spa0_1x
s_sleep 2
v_mov_b32 v255, 0
buffer_load_dwordx2 v[224:225], v255, s[36:39], 0 offen sc1
s_waitcnt vmcnt(0)
s_branch L_spa0_1
L_spa0_1x:
v_readfirstlane_b32 s98, v224
v_readfirstlane_b32 s99, v225
s_waitcnt vmcnt(5)
s_mul_i32 s50, s40, 5
s_add_u32 s50, s50, s44
s_lshl_b32 s51, s2, 4
s_add_u32 s51, s51, 0x10000
s_cmp_lt_u32 s44, 5
s_cselect_b32 s50, s50, s51
s_lshl_b32 s50, s50, 3
s_lshl_b32 s51, s41, 10
s_add_u32 s50, s50, s51
s_add_u32 s50, s50, 46137344
v_mov_b32 v228, s98
v_mov_b32 v229, s99
s_mov_b64 exec, 1
buffer_store_dwordx2 v[228:229], v248, s[24:27], s50 offen sc1
s_mov_b64 exec, -1
s_waitcnt lgkmcnt(5)
v_mfma_f32_16x16x32_bf16 v[180:183], v[92:95], v[12:15], v[180:183]
ds_read_b64_tr_b16 v[88:89], v3 offset:12288
v_mfma_f32_16x16x32_bf16 v[184:187], v[92:95], v[16:19], v[184:187]
ds_read_b64_tr_b16 v[90:91], v3 offset:12800
v_mfma_f32_16x16x32_bf16 v[188:191], v[96:99], v[12:15], v[188:191]
ds_read_b64_tr_b16 v[92:93], v231 offset:12288
v_mfma_f32_16x16x32_bf16 v[192:195], v[96:99], v[16:19], v[192:195]
ds_read_b64_tr_b16 v[94:95], v231 offset:12800
s_waitcnt vmcnt(2)
s_waitcnt lgkmcnt(5)
s_barrier
s_setprio 3
ds_read_b128 v[20:23], v236 offset:0
ds_read_b128 v[24:27], v236 offset:1024
ds_read_b128 v[56:59], v235 offset:8192
ds_read_b128 v[60:63], v235 offset:9216
ds_read_b128 v[100:103], v236 offset:16384
ds_read_b128 v[104:107], v236 offset:17408
ds_read_b128 v[108:111], v235 offset:24576
ds_read_b128 v[112:115], v235 offset:25600
v_mfma_f32_16x16x32_bf16 v[156:159], v[80:83], v[40:43], v[156:159]
ds_read_b64_tr_b16 v[96:97], v3 offset:16384
s_add_u32 m0, s48, 40960
s_add_u32 s49, s57, 1106176
buffer_load_dwordx4 v232, s[12:15], s49 offen lds
v_lshlrev_b32 v245, 16, v28
v_and_b32 v244, s53, v28
v_lshlrev_b32 v243, 16, v29
v_mfma_f32_16x16x32_bf16 v[160:163], v[80:83], v[44:47], v[160:163]
ds_read_b64_tr_b16 v[98:99], v3 offset:16896
v_and_b32 v242, s53, v29
v_lshlrev_b32 v241, 16, v30
v_and_b32 v240, s53, v30
v_lshlrev_b32 v239, 16, v31
s_waitcnt lgkmcnt(14)
v_mfma_f32_16x16x32_bf16 v[164:167], v[84:87], v[40:43], v[164:167]
ds_read_b64_tr_b16 v[80:81], v3 offset:20480
v_and_b32 v238, s53, v31
v_fma_f32 v245, v245, v78, v76
v_fma_f32 v244, v244, v78, v76
v_fma_f32 v243, v243, v78, v76
v_mfma_f32_16x16x32_bf16 v[168:171], v[84:87], v[44:47], v[168:171]
ds_read_b64_tr_b16 v[82:83], v3 offset:20992
v_fma_f32 v242, v242, v78, v76
v_fma_f32 v241, v241, v78, v76
v_fma_f32 v240, v240, v78, v76
s_waitcnt lgkmcnt(12)
v_mfma_f32_16x16x32_bf16 v[172:175], v[88:91], v[40:43], v[172:175]
ds_read_b64_tr_b16 v[84:85], v231 offset:20480
v_fma_f32 v239, v239, v78, v76
v_fma_f32 v238, v238, v78, v76
v_cvt_pk_bf16_f32 v28, v245, v244
v_mfma_f32_16x16x32_bf16 v[176:179], v[88:91], v[44:47], v[176:179]
ds_read_b64_tr_b16 v[86:87], v231 offset:20992
v_cvt_pk_bf16_f32 v29, v243, v242
v_cvt_pk_bf16_f32 v30, v241, v240
v_cvt_pk_bf16_f32 v31, v239, v238
v_mfma_f32_16x16x32_bf16 v[180:183], v[92:95], v[40:43], v[180:183]
ds_read_b64_tr_b16 v[88:89], v233 offset:0
s_add_u32 m0, s48, 49152
s_add_u32 s49, s57, 1216640
buffer_load_dwordx4 v246, s[12:15], s49 offen lds
ds_write_b128 v237, v[28:31] offset:32768
v_lshlrev_b32 v245, 16, v64
v_and_b32 v244, s53, v64
v_mfma_f32_16x16x32_bf16 v[184:187], v[92:95], v[44:47], v[184:187]
ds_read_b64_tr_b16 v[90:91], v233 offset:512
v_lshlrev_b32 v243, 16, v65
v_and_b32 v242, s53, v65
v_lshlrev_b32 v241, 16, v66
v_and_b32 v240, s53, v66
s_setprio 2
s_waitcnt lgkmcnt(5)
v_mfma_f32_16x16x32_bf16 v[188:191], v[96:99], v[40:43], v[188:191]
ds_read_b64_tr_b16 v[92:93], v2 offset:0
v_lshlrev_b32 v239, 16, v67
v_and_b32 v238, s53, v67
v_fma_f32 v245, v245, v79, v77
v_mfma_f32_16x16x32_bf16 v[192:195], v[96:99], v[44:47], v[192:195]
ds_read_b64_tr_b16 v[94:95], v2 offset:512
v_fma_f32 v244, v244, v79, v77
v_fma_f32 v243, v243, v79, v77
v_fma_f32 v242, v242, v79, v77
v_mfma_f32_16x16x32_bf16 v[156:159], v[80:83], v[48:51], v[156:159]
ds_read_b64_tr_b16 v[96:97], v233 offset:4096
v_fma_f32 v241, v241, v79, v77
v_fma_f32 v240, v240, v79, v77
v_fma_f32 v239, v239, v79, v77
v_fma_f32 v238, v238, v79, v77
v_mfma_f32_16x16x32_bf16 v[160:163], v[80:83], v[52:55], v[160:163]
ds_read_b64_tr_b16 v[98:99], v233 offset:4608
v_cvt_pk_bf16_f32 v64, v245, v244
v_cvt_pk_bf16_f32 v65, v243, v242
v_cvt_pk_bf16_f32 v66, v241, v240
s_waitcnt lgkmcnt(4)
v_mfma_f32_16x16x32_bf16 v[164:167], v[84:87], v[48:51], v[164:167]
ds_read_b64_tr_b16 v[80:81], v233 offset:8192
s_add_u32 m0, s48, 57344
s_add_u32 s49, s57, 1327104
buffer_load_dwordx4 v246, s[12:15], s49 offen lds
v_cvt_pk_bf16_f32 v67, v239, v238
ds_write_b128 v237, v[64:67] offset:32896
v_lshlrev_b32 v245, 16, v32
v_mfma_f32_16x16x32_bf16 v[168:171], v[84:87], v[52:55], v[168:171]
ds_read_b64_tr_b16 v[82:83], v233 offset:8704
v_and_b32 v244, s53, v32
v_lshlrev_b32 v243, 16, v33
v_and_b32 v242, s53, v33
v_lshlrev_b32 v241, 16, v34
v_mfma_f32_16x16x32_bf16 v[172:175], v[88:91], v[48:51], v[172:175]
ds_read_b64_tr_b16 v[84:85], v2 offset:8192
v_and_b32 v240, s53, v34
v_lshlrev_b32 v239, 16, v35
v_and_b32 v238, s53, v35
v_mfma_f32_16x16x32_bf16 v[176:179], v[88:91], v[52:55], v[176:179]
ds_read_b64_tr_b16 v[86:87], v2 offset:8704
v_fma_f32 v245, v245, v78, v76
v_fma_f32 v244, v244, v78, v76
v_fma_f32 v243, v243, v78, v76
s_setprio 1
s_waitcnt lgkmcnt(5)
v_mfma_f32_16x16x32_bf16 v[180:183], v[92:95], v[48:51], v[180:183]
ds_read_b64_tr_b16 v[88:89], v233 offset:12288
v_fma_f32 v242, v242, v78, v76
v_fma_f32 v241, v241, v78, v76
v_fma_f32 v240, v240, v78, v76
v_fma_f32 v239, v239, v78, v76
v_mfma_f32_16x16x32_bf16 v[184:187], v[92:95], v[52:55], v[184:187]
ds_read_b64_tr_b16 v[90:91], v233 offset:12800
v_fma_f32 v238, v238, v78, v76
v_cvt_pk_bf16_f32 v32, v245, v244
v_cvt_pk_bf16_f32 v33, v243, v242
v_mfma_f32_16x16x32_bf16 v[188:191], v[96:99], v[48:51], v[188:191]
ds_read_b64_tr_b16 v[92:93], v2 offset:12288
s_add_u32 m0, s48, 65536
s_add_u32 s49, s57, 1327360
buffer_load_dwordx4 v232, s[12:15], s49 offen lds
v_cvt_pk_bf16_f32 v34, v241, v240
v_cvt_pk_bf16_f32 v35, v239, v238
ds_write_b128 v237, v[32:35] offset:49152
v_mfma_f32_16x16x32_bf16 v[192:195], v[96:99], v[52:55], v[192:195]
ds_read_b64_tr_b16 v[94:95], v2 offset:12800
v_lshlrev_b32 v245, 16, v68
v_and_b32 v244, s53, v68
v_lshlrev_b32 v243, 16, v69
s_waitcnt lgkmcnt(5)
v_mfma_f32_16x16x32_bf16 v[156:159], v[80:83], v[20:23], v[156:159]
ds_read_b64_tr_b16 v[96:97], v233 offset:16384
v_and_b32 v242, s53, v69
v_lshlrev_b32 v241, 16, v70
v_and_b32 v240, s53, v70
v_lshlrev_b32 v239, 16, v71
v_mfma_f32_16x16x32_bf16 v[160:163], v[80:83], v[24:27], v[160:163]
ds_read_b64_tr_b16 v[98:99], v233 offset:16896
v_and_b32 v238, s53, v71
v_fma_f32 v245, v245, v79, v77
v_fma_f32 v244, v244, v79, v77
v_mfma_f32_16x16x32_bf16 v[164:167], v[84:87], v[20:23], v[164:167]
ds_read_b64_tr_b16 v[80:81], v233 offset:20480
v_fma_f32 v243, v243, v79, v77
v_fma_f32 v242, v242, v79, v77
v_fma_f32 v241, v241, v79, v77
v_fma_f32 v240, v240, v79, v77
v_mfma_f32_16x16x32_bf16 v[168:171], v[84:87], v[24:27], v[168:171]
ds_read_b64_tr_b16 v[82:83], v233 offset:20992
v_fma_f32 v239, v239, v79, v77
v_fma_f32 v238, v238, v79, v77
v_cvt_pk_bf16_f32 v68, v245, v244
s_setprio 0
s_waitcnt lgkmcnt(4)
v_mfma_f32_16x16x32_bf16 v[172:175], v[88:91], v[20:23], v[172:175]
ds_read_b64_tr_b16 v[84:85], v2 offset:20480
v_cvt_pk_bf16_f32 v69, v243, v242
v_cvt_pk_bf16_f32 v70, v241, v240
v_cvt_pk_bf16_f32 v71, v239, v238
v_mfma_f32_16x16x32_bf16 v[176:179], v[88:91], v[24:27], v[176:179]
ds_read_b64_tr_b16 v[86:87], v2 offset:20992
ds_write_b128 v237, v[68:71] offset:49280
v_mfma_f32_16x16x32_bf16 v[180:183], v[92:95], v[20:23], v[180:183]
ds_read_b64_tr_b16 v[88:89], v233 offset:24576
v_mfma_f32_16x16x32_bf16 v[184:187], v[92:95], v[24:27], v[184:187]
ds_read_b64_tr_b16 v[90:91], v233 offset:25088
s_waitcnt lgkmcnt(5)
v_mfma_f32_16x16x32_bf16 v[188:191], v[96:99], v[20:23], v[188:191]
ds_read_b64_tr_b16 v[92:93], v2 offset:24576
v_mfma_f32_16x16x32_bf16 v[192:195], v[96:99], v[24:27], v[192:195]
ds_read_b64_tr_b16 v[94:95], v2 offset:25088
s_waitcnt vmcnt(1)
s_waitcnt lgkmcnt(4)
s_barrier
s_setprio 3
ds_read_b128 v[28:31], v236 offset:32768
ds_read_b128 v[32:35], v236 offset:33792
ds_read_b128 v[64:67], v235 offset:40960
ds_read_b128 v[68:71], v235 offset:41984
ds_read_b128 v[116:119], v236 offset:49152
ds_read_b128 v[120:123], v236 offset:50176
ds_read_b128 v[196:199], v235 offset:57344
ds_read_b128 v[200:203], v235 offset:58368
s_lshl_b32 s50, s41, 10
s_add_u32 s50, s50, 46137344
v_min_u32 v255, 63, v1
v_lshlrev_b32 v255, 3, v255
buffer_load_dwordx2 v[228:229], v255, s[24:27], s50 offen sc1
v_mfma_f32_16x16x32_bf16 v[156:159], v[80:83], v[56:59], v[156:159]
ds_read_b64_tr_b16 v[96:97], v233 offset:28672
s_add_u32 m0, s48, 0
s_add_u32 s49, s57, 1437824
buffer_load_dwordx4 v246, s[12:15], s49 offen lds
v_lshlrev_b32 v245, 16, v36
v_and_b32 v244, s53, v36
v_mfma_f32_16x16x32_bf16 v[160:163], v[80:83], v[60:63], v[160:163]
ds_read_b64_tr_b16 v[98:99], v233 offset:29184
v_lshlrev_b32 v243, 16, v37
v_and_b32 v242, s53, v37
v_mfma_f32_16x16x32_bf16 v[164:167], v[84:87], v[56:59], v[164:167]
ds_read_b64_tr_b16 v[80:81], v233 offset:32768
s_add_u32 m0, s48, 8192
s_add_u32 s49, s57, 1548288
buffer_load_dwordx4 v246, s[12:15], s49 offen lds
v_lshlrev_b32 v241, 16, v38
v_mfma_f32_16x16x32_bf16 v[168:171], v[84:87], v[60:63], v[168:171]
ds_read_b64_tr_b16 v[82:83], v233 offset:33280
v_and_b32 v240, s53, v38
v_lshlrev_b32 v239, 16, v39
s_waitcnt lgkmcnt(14)
v_mfma_f32_16x16x32_bf16 v[172:175], v[88:91], v[56:59], v[172:175]
ds_read_b64_tr_b16 v[84:85], v2 offset:32768
s_add_u32 m0, s48, 16384
s_add_u32 s49, s57, 1548544
buffer_load_dwordx4 v232, s[12:15], s49 offen lds
v_and_b32 v238, s53, v39
v_mfma_f32_16x16x32_bf16 v[176:179], v[88:91], v[60:63], v[176:179]
ds_read_b64_tr_b16 v[86:87], v2 offset:33280
v_fma_f32 v245, v245, v78, v76
v_fma_f32 v244, v244, v78, v76
s_waitcnt lgkmcnt(4)
v_mfma_f32_16x16x32_bf16 v[180:183], v[92:95], v[56:59], v[180:183]
ds_read_b64_tr_b16 v[88:89], v233 offset:36864
s_add_u32 m0, s48, 77824
s_add_u32 s49, s57, 1659008
buffer_load_dwordx4 v246, s[12:15], s49 offen lds
v_fma_f32 v243, v243, v78, v76
v_fma_f32 v242, v242, v78, v76
v_mfma_f32_16x16x32_bf16 v[184:187], v[92:95], v[60:63], v[184:187]
ds_read_b64_tr_b16 v[90:91], v233 offset:37376
v_fma_f32 v241, v241, v78, v76
v_fma_f32 v240, v240, v78, v76
s_setprio 2
v_mfma_f32_16x16x32_bf16 v[188:191], v[96:99], v[56:59], v[188:191]
ds_read_b64_tr_b16 v[92:93], v2 offset:36864
s_add_u32 m0, s48, 86016
s_add_u32 s49, s57, 1769472
buffer_load_dwordx4 v246, s[12:15], s49 offen lds
v_fma_f32 v239, v239, v78, v76
v_mfma_f32_16x16x32_bf16 v[192:195], v[96:99], v[60:63], v[192:195]
ds_read_b64_tr_b16 v[94:95], v2 offset:37376
v_fma_f32 v238, v238, v78, v76
v_cvt_pk_bf16_f32 v36, v245, v244
s_waitcnt lgkmcnt(4)
v_mfma_f32_16x16x32_bf16 v[156:159], v[80:83], v[100:103], v[156:159]
ds_read_b64_tr_b16 v[96:97], v233 offset:40960
s_add_u32 m0, s48, 110592
s_add_u32 s49, s57, 1769728
buffer_load_dwordx4 v232, s[12:15], s49 offen lds
v_cvt_pk_bf16_f32 v37, v243, v242
v_mfma_f32_16x16x32_bf16 v[160:163], v[80:83], v[104:107], v[160:163]
ds_read_b64_tr_b16 v[98:99], v233 offset:41472
v_cvt_pk_bf16_f32 v38, v241, v240
v_cvt_pk_bf16_f32 v39, v239, v238
v_mfma_f32_16x16x32_bf16 v[164:167], v[84:87], v[100:103], v[164:167]
ds_read_b64_tr_b16 v[80:81], v233 offset:45056
s_add_u32 m0, s48, 118784
s_add_u32 s49, s57, 1880192
buffer_load_dwordx4 v246, s[12:15], s49 offen lds
ds_write_b128 v237, v[36:39] offset:0
v_lshlrev_b32 v245, 16, v72
v_mfma_f32_16x16x32_bf16 v[168:171], v[84:87], v[104:107], v[168:171]
ds_read_b64_tr_b16 v[82:83], v233 offset:45568
v_and_b32 v244, s53, v72
v_lshlrev_b32 v243, 16, v73
s_waitcnt lgkmcnt(5)
v_mfma_f32_16x16x32_bf16 v[172:175], v[88:91], v[100:103], v[172:175]
ds_read_b64_tr_b16 v[84:85], v2 offset:45056
v_and_b32 v242, s53, v73
v_lshlrev_b32 v241, 16, v74
v_mfma_f32_16x16x32_bf16 v[176:179], v[88:91], v[104:107], v[176:179]
ds_read_b64_tr_b16 v[86:87], v2 offset:45568
v_and_b32 v240, s53, v74
s_setprio 1
v_mfma_f32_16x16x32_bf16 v[180:183], v[92:95], v[100:103], v[180:183]
ds_read_b64_tr_b16 v[88:89], v233 offset:49152
v_lshlrev_b32 v239, 16, v75
v_and_b32 v238, s53, v75
v_mfma_f32_16x16x32_bf16 v[184:187], v[92:95], v[104:107], v[184:187]
ds_read_b64_tr_b16 v[90:91], v233 offset:49664
v_fma_f32 v245, v245, v79, v77
s_waitcnt lgkmcnt(4)
v_mfma_f32_16x16x32_bf16 v[188:191], v[96:99], v[100:103], v[188:191]
ds_read_b64_tr_b16 v[92:93], v2 offset:49152
v_fma_f32 v244, v244, v79, v77
v_fma_f32 v243, v243, v79, v77
v_mfma_f32_16x16x32_bf16 v[192:195], v[96:99], v[104:107], v[192:195]
ds_read_b64_tr_b16 v[94:95], v2 offset:49664
v_fma_f32 v242, v242, v79, v77
v_fma_f32 v241, v241, v79, v77
v_mfma_f32_16x16x32_bf16 v[156:159], v[80:83], v[108:111], v[156:159]
ds_read_b64_tr_b16 v[96:97], v233 offset:53248
v_fma_f32 v240, v240, v79, v77
v_fma_f32 v239, v239, v79, v77
v_mfma_f32_16x16x32_bf16 v[160:163], v[80:83], v[112:115], v[160:163]
ds_read_b64_tr_b16 v[98:99], v233 offset:53760
v_fma_f32 v238, v238, v79, v77
s_waitcnt lgkmcnt(4)
v_mfma_f32_16x16x32_bf16 v[164:167], v[84:87], v[108:111], v[164:167]
ds_read_b64_tr_b16 v[80:81], v233 offset:57344
v_cvt_pk_bf16_f32 v72, v245, v244
v_cvt_pk_bf16_f32 v73, v243, v242
v_mfma_f32_16x16x32_bf16 v[168:171], v[84:87], v[112:115], v[168:171]
ds_read_b64_tr_b16 v[82:83], v233 offset:57856
v_cvt_pk_bf16_f32 v74, v241, v240
s_setprio 0
v_mfma_f32_16x16x32_bf16 v[172:175], v[88:91], v[108:111], v[172:175]
ds_read_b64_tr_b16 v[84:85], v2 offset:57344
v_cvt_pk_bf16_f32 v75, v239, v238
ds_write_b128 v237, v[72:75] offset:128
v_mfma_f32_16x16x32_bf16 v[176:179], v[88:91], v[112:115], v[176:179]
ds_read_b64_tr_b16 v[86:87], v2 offset:57856
s_waitcnt lgkmcnt(5)
v_mfma_f32_16x16x32_bf16 v[180:183], v[92:95], v[108:111], v[180:183]
ds_read_b64_tr_b16 v[88:89], v233 offset:61440
v_mfma_f32_16x16x32_bf16 v[184:187], v[92:95], v[112:115], v[184:187]
ds_read_b64_tr_b16 v[90:91], v233 offset:61952
v_mfma_f32_16x16x32_bf16 v[188:191], v[96:99], v[108:111], v[188:191]
ds_read_b64_tr_b16 v[92:93], v2 offset:61440
v_mfma_f32_16x16x32_bf16 v[192:195], v[96:99], v[112:115], v[192:195]
ds_read_b64_tr_b16 v[94:95], v2 offset:61952
s_waitcnt vmcnt(7)
s_mov_b32 s52, 0
L_spa0_2:
v_cmp_ne_u64 vcc, s[98:99], v[228:229]
s_nop 1
s_cmp_eq_u64 vcc, 0
s_cbranch_scc1 L_spa0_2x
s_add_u32 s52, s52, 1
s_cmp_ge_u32 s52, 0x10000
s_cbranch_scc1 L_spa0_2x
s_sleep 2
s_lshl_b32 s50, s41, 10
s_add_u32 s50, s50, 46137344
v_min_u32 v255, 63, v1
v_lshlrev_b32 v255, 3, v255
buffer_load_dwordx2 v[228:229], v255, s[24:27], s50 offen sc1
s_waitcnt vmcnt(0)
s_branch L_spa0_2
L_spa0_2x:
s_waitcnt vmcnt(3)
s_waitcnt lgkmcnt(5)
s_barrier
s_setprio 3
ds_read_b128 v[36:39], v236 offset:0
ds_read_b128 v[72:75], v236 offset:1024
ds_read_b128 v[76:79], v235 offset:8192
ds_read_b128 v[204:207], v235 offset:9216
v_mfma_f32_16x16x32_bf16 v[156:159], v[80:83], v[28:31], v[156:159]
ds_read_b64_tr_b16 v[96:97], v3 offset:0
s_add_u32 m0, s48, 24576
s_add_u32 s49, s46, 0
buffer_load_dwordx4 v247, s[24:27], s49 offen sc1 lds
v_mfma_f32_16x16x32_bf16 v[160:163], v[80:83], v[32:35], v[160:163]
ds_read_b64_tr_b16 v[98:99], v3 offset:512
s_waitcnt lgkmcnt(10)
v_mfma_f32_16x16x32_bf16 v[164:167], v[84:87], v[28:31], v[164:167]
ds_read_b64_tr_b16 v[80:81], v3 offset:4096
v_mfma_f32_16x16x32_bf16 v[168:171], v[84:87], v[32:35], v[168:171]
ds_read_b64_tr_b16 v[82:83], v3 offset:4608
s_waitcnt lgkmcnt(8)
v_mfma_f32_16x16x32_bf16 v[172:175], v[88:91], v[28:31], v[172:175]
ds_read_b64_tr_b16 v[84:85], v231 offset:4096
v_mfma_f32_16x16x32_bf16 v[176:179], v[88:91], v[32:35], v[176:179]
ds_read_b64_tr_b16 v[86:87], v231 offset:4608
v_mfma_f32_16x16x32_bf16 v[180:183], v[92:95], v[28:31], v[180:183]
ds_read_b64_tr_b16 v[88:89], v233 offset:0
s_add_u32 m0, s48, 32768
s_add_u32 s49, s46, 8192
buffer_load_dwordx4 v247, s[24:27], s49 offen sc1 lds
v_mfma_f32_16x16x32_bf16 v[184:187], v[92:95], v[32:35], v[184:187]
ds_read_b64_tr_b16 v[90:91], v233 offset:512
s_setprio 2
s_waitcnt lgkmcnt(4)
v_mfma_f32_16x16x32_bf16 v[188:191], v[96:99], v[28:31], v[188:191]
ds_read_b64_tr_b16 v[92:93], v2 offset:0
v_mfma_f32_16x16x32_bf16 v[192:195], v[96:99], v[32:35], v[192:195]
ds_read_b64_tr_b16 v[94:95], v2 offset:512
v_mfma_f32_16x16x32_bf16 v[156:159], v[80:83], v[64:67], v[156:159]
ds_read_b64_tr_b16 v[96:97], v233 offset:4096
v_mfma_f32_16x16x32_bf16 v[160:163], v[80:83], v[68:71], v[160:163]
ds_read_b64_tr_b16 v[98:99], v233 offset:4608
s_waitcnt lgkmcnt(4)
v_mfma_f32_16x16x32_bf16 v[164:167], v[84:87], v[64:67], v[164:167]
ds_read_b64_tr_b16 v[80:81], v233 offset:8192
s_add_u32 m0, s48, 40960
s_add_u32 s49, s46, 16384
buffer_load_dwordx4 v247, s[24:27], s49 offen sc1 lds
v_mfma_f32_16x16x32_bf16 v[168:171], v[84:87], v[68:71], v[168:171]
ds_read_b64_tr_b16 v[82:83], v233 offset:8704
v_mfma_f32_16x16x32_bf16 v[172:175], v[88:91], v[64:67], v[172:175]
ds_read_b64_tr_b16 v[84:85], v2 offset:8192
v_mfma_f32_16x16x32_bf16 v[176:179], v[88:91], v[68:71], v[176:179]
ds_read_b64_tr_b16 v[86:87], v2 offset:8704
s_setprio 1
s_waitcnt lgkmcnt(4)
v_mfma_f32_16x16x32_bf16 v[180:183], v[92:95], v[64:67], v[180:183]
ds_read_b64_tr_b16 v[88:89], v233 offset:12288
v_mfma_f32_16x16x32_bf16 v[184:187], v[92:95], v[68:71], v[184:187]
ds_read_b64_tr_b16 v[90:91], v233 offset:12800
v_mfma_f32_16x16x32_bf16 v[188:191], v[96:99], v[64:67], v[188:191]
ds_read_b64_tr_b16 v[92:93], v2 offset:12288
s_add_u32 m0, s48, 49152
s_add_u32 s49, s46, 24576
buffer_load_dwordx4 v247, s[24:27], s49 offen sc1 lds
v_mfma_f32_16x16x32_bf16 v[192:195], v[96:99], v[68:71], v[192:195]
ds_read_b64_tr_b16 v[94:95], v2 offset:12800
s_waitcnt lgkmcnt(4)
v_mfma_f32_16x16x32_bf16 v[156:159], v[80:83], v[116:119], v[156:159]
ds_read_b64_tr_b16 v[96:97], v233 offset:16384
v_mfma_f32_16x16x32_bf16 v[160:163], v[80:83], v[120:123], v[160:163]
ds_read_b64_tr_b16 v[98:99], v233 offset:16896
v_mfma_f32_16x16x32_bf16 v[164:167], v[84:87], v[116:119], v[164:167]
ds_read_b64_tr_b16 v[80:81], v3 offset:8192
v_mfma_f32_16x16x32_bf16 v[168:171], v[84:87], v[120:123], v[168:171]
ds_read_b64_tr_b16 v[82:83], v3 offset:8704
s_setprio 0
s_waitcnt lgkmcnt(4)
v_mfma_f32_16x16x32_bf16 v[172:175], v[88:91], v[116:119], v[172:175]
ds_read_b64_tr_b16 v[84:85], v231 offset:8192
v_mfma_f32_16x16x32_bf16 v[176:179], v[88:91], v[120:123], v[176:179]
ds_read_b64_tr_b16 v[86:87], v231 offset:8704
v_mfma_f32_16x16x32_bf16 v[180:183], v[92:95], v[116:119], v[180:183]
ds_read_b64_tr_b16 v[88:89], v3 offset:12288
v_mfma_f32_16x16x32_bf16 v[184:187], v[92:95], v[120:123], v[184:187]
ds_read_b64_tr_b16 v[90:91], v3 offset:12800
s_waitcnt lgkmcnt(4)
v_mfma_f32_16x16x32_bf16 v[188:191], v[96:99], v[116:119], v[188:191]
ds_read_b64_tr_b16 v[92:93], v231 offset:12288
v_mfma_f32_16x16x32_bf16 v[192:195], v[96:99], v[120:123], v[192:195]
ds_read_b64_tr_b16 v[94:95], v231 offset:12800
s_waitcnt vmcnt(2)
s_barrier
s_setprio 3
v_mfma_f32_16x16x32_bf16 v[156:159], v[80:83], v[196:199], v[156:159]
ds_read_b64_tr_b16 v[96:97], v3 offset:16384
s_add_u32 m0, s48, 0
s_add_u32 s49, s46, 32768
buffer_load_dwordx4 v247, s[24:27], s49 offen sc1 lds
v_mfma_f32_16x16x32_bf16 v[160:163], v[80:83], v[200:203], v[160:163]
ds_read_b64_tr_b16 v[98:99], v3 offset:16896
s_waitcnt lgkmcnt(4)
v_mfma_f32_16x16x32_bf16 v[164:167], v[84:87], v[196:199], v[164:167]
ds_read_b64_tr_b16 v[80:81], v3 offset:20480
v_mfma_f32_16x16x32_bf16 v[168:171], v[84:87], v[200:203], v[168:171]
ds_read_b64_tr_b16 v[82:83], v3 offset:20992
v_mfma_f32_16x16x32_bf16 v[172:175], v[88:91], v[196:199], v[172:175]
ds_read_b64_tr_b16 v[84:85], v231 offset:20480
s_add_u32 m0, s48, 8192
s_add_u32 s49, s46, 40960
buffer_load_dwordx4 v247, s[24:27], s49 offen sc1 lds
v_mfma_f32_16x16x32_bf16 v[176:179], v[88:91], v[200:203], v[176:179]
ds_read_b64_tr_b16 v[86:87], v231 offset:20992
s_waitcnt lgkmcnt(4)
v_mfma_f32_16x16x32_bf16 v[180:183], v[92:95], v[196:199], v[180:183]
ds_read_b64_tr_b16 v[88:89], v3 offset:40960
v_mfma_f32_16x16x32_bf16 v[184:187], v[92:95], v[200:203], v[184:187]
ds_read_b64_tr_b16 v[90:91], v3 offset:41472
s_setprio 2
v_mfma_f32_16x16x32_bf16 v[188:191], v[96:99], v[196:199], v[188:191]
ds_read_b64_tr_b16 v[92:93], v231 offset:40960
s_add_u32 m0, s48, 16384
s_add_u32 s49, s46, 49152
buffer_load_dwordx4 v247, s[24:27], s49 offen sc1 lds
v_mfma_f32_16x16x32_bf16 v[192:195], v[96:99], v[200:203], v[192:195]
ds_read_b64_tr_b16 v[94:95], v231 offset:41472
s_waitcnt lgkmcnt(4)
v_mfma_f32_16x16x32_bf16 v[156:159], v[80:83], v[36:39], v[156:159]
ds_read_b64_tr_b16 v[96:97], v3 offset:45056
v_mfma_f32_16x16x32_bf16 v[160:163], v[80:83], v[72:75], v[160:163]
ds_read_b64_tr_b16 v[98:99], v3 offset:45568
v_mfma_f32_16x16x32_bf16 v[164:167], v[84:87], v[36:39], v[164:167]
ds_read_b64_tr_b16 v[80:81], v3 offset:49152
s_add_u32 m0, s48, 61440
s_add_u32 s49, s46, 57344
buffer_load_dwordx4 v247, s[24:27], s49 offen sc1 lds
v_mfma_f32_16x16x32_bf16 v[168:171], v[84:87], v[72:75], v[168:171]
ds_read_b64_tr_b16 v[82:83], v3 offset:49664
s_waitcnt lgkmcnt(4)
v_mfma_f32_16x16x32_bf16 v[172:175], v[88:91], v[36:39], v[172:175]
ds_read_b64_tr_b16 v[84:85], v231 offset:49152
v_mfma_f32_16x16x32_bf16 v[176:179], v[88:91], v[72:75], v[176:179]
ds_read_b64_tr_b16 v[86:87], v231 offset:49664
s_setprio 1
v_mfma_f32_16x16x32_bf16 v[180:183], v[92:95], v[36:39], v[180:183]
ds_read_b64_tr_b16 v[88:89], v3 offset:53248
s_add_u32 m0, s48, 69632
s_add_u32 s49, s46, 65536
buffer_load_dwordx4 v247, s[24:27], s49 offen sc1 lds
v_mfma_f32_16x16x32_bf16 v[184:187], v[92:95], v[72:75], v[184:187]
ds_read_b64_tr_b16 v[90:91], v3 offset:53760
s_waitcnt lgkmcnt(4)
v_mfma_f32_16x16x32_bf16 v[188:191], v[96:99], v[36:39], v[188:191]
ds_read_b64_tr_b16 v[92:93], v231 offset:53248
v_mfma_f32_16x16x32_bf16 v[192:195], v[96:99], v[72:75], v[192:195]
ds_read_b64_tr_b16 v[94:95], v231 offset:53760
v_mfma_f32_16x16x32_bf16 v[156:159], v[80:83], v[76:79], v[156:159]
ds_read_b64_tr_b16 v[96:97], v233 offset:20480
s_add_u32 m0, s48, 94208
s_add_u32 s49, s46, 73728
buffer_load_dwordx4 v247, s[24:27], s49 offen sc1 lds
v_mfma_f32_16x16x32_bf16 v[160:163], v[80:83], v[204:207], v[160:163]
ds_read_b64_tr_b16 v[98:99], v233 offset:20992
s_waitcnt lgkmcnt(4)
v_mfma_f32_16x16x32_bf16 v[164:167], v[84:87], v[76:79], v[164:167]
v_add_u32 v245, 0x10000, v248
ds_read_b128 v[80:83], v248 offset:24576
v_mfma_f32_16x16x32_bf16 v[168:171], v[84:87], v[204:207], v[168:171]
s_setprio 0
v_mfma_f32_16x16x32_bf16 v[172:175], v[88:91], v[76:79], v[172:175]
ds_read_b128 v[84:87], v248 offset:25600
v_mfma_f32_16x16x32_bf16 v[176:179], v[88:91], v[204:207], v[176:179]
s_waitcnt lgkmcnt(2)
v_mfma_f32_16x16x32_bf16 v[180:183], v[92:95], v[76:79], v[180:183]
ds_read_b128 v[88:91], v248 offset:26624
v_mfma_f32_16x16x32_bf16 v[184:187], v[92:95], v[204:207], v[184:187]
v_mfma_f32_16x16x32_bf16 v[188:191], v[96:99], v[76:79], v[188:191]
ds_read_b128 v[92:95], v248 offset:30720
v_mfma_f32_16x16x32_bf16 v[192:195], v[96:99], v[204:207], v[192:195]
s_waitcnt vmcnt(5)
s_barrier
s_setprio 3
s_waitcnt lgkmcnt(2)
v_mfma_f32_16x16x32_bf16 v[208:211], v[80:83], v[124:127], 0
ds_read_b128 v[96:99], v248 offset:31744
s_add_u32 m0, s48, 73728
s_add_u32 s49, s46, 81920
buffer_load_dwordx4 v247, s[24:27], s49 offen sc1 lds
v_mfma_f32_16x16x32_bf16 v[212:215], v[80:83], v[128:131], 0
v_mfma_f32_16x16x32_bf16 v[216:219], v[84:87], v[124:127], 0
ds_read_b128 v[80:83], v248 offset:32768
s_mul_i32 s50, s42, 9728
s_add_u32 s50, s50, 114688
v_mul_u32_u24 v253, 304, v251
v_add_u32 v253, s50, v253
v_lshl_add_u32 v244, v252, 3, v253
v_mov_b32 v2, 0x3f80
v_mov_b32 v3, 0
ds_write_b64 v253, v[2:3] offset:288
v_mfma_f32_16x16x32_bf16 v[220:223], v[84:87], v[128:131], 0
s_waitcnt lgkmcnt(3)
v_mfma_f32_16x16x32_bf16 v[224:227], v[88:91], v[124:127], 0
ds_read_b128 v[84:87], v248 offset:36864
v_cvt_pk_bf16_f32 v156, v156, v157
v_cvt_pk_bf16_f32 v157, v158, v159
ds_write_b64 v244, v[156:157] offset:0
v_mfma_f32_16x16x32_bf16 v[228:231], v[88:91], v[128:131], 0
v_mfma_f32_16x16x32_bf16 v[208:211], v[92:95], v[132:135], v[208:211]
ds_read_b128 v[88:91], v248 offset:37888
v_cvt_pk_bf16_f32 v160, v160, v161
v_cvt_pk_bf16_f32 v161, v162, v163
ds_write_b64 v244, v[160:161] offset:4864
v_mfma_f32_16x16x32_bf16 v[212:215], v[92:95], v[136:139], v[212:215]
s_setprio 2
s_waitcnt lgkmcnt(5)
v_mfma_f32_16x16x32_bf16 v[216:219], v[96:99], v[132:135], v[216:219]
ds_read_b128 v[92:95], v248 offset:38912
v_cvt_pk_bf16_f32 v164, v164, v165
v_cvt_pk_bf16_f32 v165, v166, v167
ds_write_b64 v244, v[164:165] offset:32
v_mfma_f32_16x16x32_bf16 v[220:223], v[96:99], v[136:139], v[220:223]
s_lshl_b32 s49, s40, 3
s_add_u32 s49, s49, s44
s_add_u32 s49, s49, 0
s_min_u32 s49, s49, 161
s_mul_i32 s52, s49, 7282
s_lshr_b32 s52, s52, 16
s_mul_i32 s50, s52, 9
s_sub_u32 s50, s49, s50
s_lshl_b32 s50, s50, 7
s_and_b32 s51, s4, 0x50
s_add_u32 s50, s50, s51
s_and_b32 s51, s52, 3
s_lshl_b32 s51, s51, 2
s_lshr_b32 s49, s52, 2
s_add_u32 s51, s51, s49
s_mul_i32 s51, s51, 41472
s_sub_u32 s49, s52, 16
s_mul_i32 s49, s49, 331776
s_add_u32 s49, s49, 9216
s_cmp_lt_u32 s52, 16
s_cselect_b32 s51, s51, s49
s_mov_b32 s52, 41472
s_cselect_b32 s52, 1152, s52
s_add_u32 s50, s50, s51
v_bfe_u32 v255, v1, 1, 3
v_mul_lo_u32 v255, v255, s52
v_mul_u32_u24 v254, 10368, v252
v_and_b32 v253, 1, v1
v_lshl_add_u32 v254, v253, 5, v254
v_add_u32 v255, v255, v254
s_add_u32 m0, s48, 98304
s_nop 0
buffer_load_dwordx4 v255, s[28:31], s50 offen lds
v_mfma_f32_16x16x32_bf16 v[224:227], v[80:83], v[132:135], v[224:227]
ds_read_b128 v[96:99], v248 offset:43008
v_cvt_pk_bf16_f32 v168, v168, v169
v_cvt_pk_bf16_f32 v169, v170, v171
ds_write_b64 v244, v[168:169] offset:4896
v_mfma_f32_16x16x32_bf16 v[228:231], v[80:83], v[136:139], v[228:231]
s_waitcnt lgkmcnt(5)
v_mfma_f32_16x16x32_bf16 v[208:211], v[84:87], v[140:143], v[208:211]
ds_read_b128 v[80:83], v248 offset:44032
s_add_u32 m0, s48, 81920
s_add_u32 s49, s46, 90112
buffer_load_dwordx4 v247, s[24:27], s49 offen sc1 lds
v_mfma_f32_16x16x32_bf16 v[212:215], v[84:87], v[144:147], v[212:215]
v_cvt_pk_bf16_f32 v172, v172, v173
v_cvt_pk_bf16_f32 v173, v174, v175
ds_write_b64 v244, v[172:173] offset:128
v_mfma_f32_16x16x32_bf16 v[216:219], v[88:91], v[140:143], v[216:219]
ds_read_b128 v[84:87], v248 offset:45056
v_cvt_pk_bf16_f32 v176, v176, v177
v_cvt_pk_bf16_f32 v177, v178, v179
ds_write_b64 v244, v[176:177] offset:4992
v_mfma_f32_16x16x32_bf16 v[220:223], v[88:91], v[144:147], v[220:223]
s_setprio 1
s_waitcnt lgkmcnt(5)
v_mfma_f32_16x16x32_bf16 v[224:227], v[92:95], v[140:143], v[224:227]
ds_read_b128 v[88:91], v248 offset:49152
v_cvt_pk_bf16_f32 v180, v180, v181
v_cvt_pk_bf16_f32 v181, v182, v183
ds_write_b64 v244, v[180:181] offset:160
v_mfma_f32_16x16x32_bf16 v[228:231], v[92:95], v[144:147], v[228:231]
v_mfma_f32_16x16x32_bf16 v[208:211], v[96:99], v[148:151], v[208:211]
ds_read_b128 v[92:95], v248 offset:50176
v_cvt_pk_bf16_f32 v184, v184, v185
v_cvt_pk_bf16_f32 v185, v186, v187
ds_write_b64 v244, v[184:185] offset:5024
v_mfma_f32_16x16x32_bf16 v[212:215], v[96:99], v[152:155], v[212:215]
s_lshl_b32 s49, s40, 3
s_add_u32 s49, s49, s44
s_add_u32 s49, s49, 128
s_min_u32 s49, s49, 161
s_mul_i32 s52, s49, 7282
s_lshr_b32 s52, s52, 16
s_mul_i32 s50, s52, 9
s_sub_u32 s50, s49, s50
s_lshl_b32 s50, s50, 7
s_and_b32 s51, s4, 0x50
s_add_u32 s50, s50, s51
s_and_b32 s51, s52, 3
s_lshl_b32 s51, s51, 2
s_lshr_b32 s49, s52, 2
s_add_u32 s51, s51, s49
s_mul_i32 s51, s51, 41472
s_sub_u32 s49, s52, 16
s_mul_i32 s49, s49, 331776
s_add_u32 s49, s49, 9216
s_cmp_lt_u32 s52, 16
s_cselect_b32 s51, s51, s49
s_mov_b32 s52, 41472
s_cselect_b32 s52, 1152, s52
s_add_u32 s50, s50, s51
v_bfe_u32 v255, v1, 1, 3
v_mul_lo_u32 v255, v255, s52
v_mul_u32_u24 v254, 10368, v252
v_and_b32 v253, 1, v1
v_lshl_add_u32 v254, v253, 5, v254
v_add_u32 v255, v255, v254
s_add_u32 m0, s48, 106496
s_nop 0
buffer_load_dwordx4 v255, s[28:31], s50 offen lds
s_waitcnt lgkmcnt(5)
v_mfma_f32_16x16x32_bf16 v[216:219], v[80:83], v[148:151], v[216:219]
ds_read_b128 v[96:99], v248 offset:51200
v_cvt_pk_bf16_f32 v188, v188, v189
v_cvt_pk_bf16_f32 v189, v190, v191
ds_write_b64 v244, v[188:189] offset:256
v_mfma_f32_16x16x32_bf16 v[220:223], v[80:83], v[152:155], v[220:223]
v_mfma_f32_16x16x32_bf16 v[224:227], v[84:87], v[148:151], v[224:227]
ds_read_b128 v[80:83], v248 offset:55296
v_cvt_pk_bf16_f32 v192, v192, v193
v_cvt_pk_bf16_f32 v193, v194, v195
ds_write_b64 v244, v[192:193] offset:5120
v_mfma_f32_16x16x32_bf16 v[228:231], v[84:87], v[152:155], v[228:231]
s_setprio 0
s_waitcnt lgkmcnt(5)
v_mfma_f32_16x16x32_bf16 v[208:211], v[88:91], v[4:7], v[208:211]
ds_read_b128 v[84:87], v248 offset:56320
v_mfma_f32_16x16x32_bf16 v[212:215], v[88:91], v[8:11], v[212:215]
v_mfma_f32_16x16x32_bf16 v[216:219], v[92:95], v[4:7], v[216:219]
ds_read_b128 v[88:91], v248 offset:0
v_mfma_f32_16x16x32_bf16 v[220:223], v[92:95], v[8:11], v[220:223]
s_waitcnt lgkmcnt(3)
v_mfma_f32_16x16x32_bf16 v[224:227], v[96:99], v[4:7], v[224:227]
ds_read_b128 v[92:95], v248 offset:4096
v_mfma_f32_16x16x32_bf16 v[228:231], v[96:99], v[8:11], v[228:231]
s_waitcnt vmcnt(6)
s_waitcnt lgkmcnt(3)
s_barrier
s_setprio 3
v_mfma_f32_16x16x32_bf16 v[208:211], v[80:83], v[12:15], v[208:211]
ds_read_b128 v[96:99], v248 offset:5120
s_add_u32 m0, s48, 24576
s_add_u32 s49, s46, 98304
buffer_load_dwordx4 v247, s[24:27], s49 offen sc1 lds
v_mfma_f32_16x16x32_bf16 v[212:215], v[80:83], v[16:19], v[212:215]
s_waitcnt lgkmcnt(2)
v_mfma_f32_16x16x32_bf16 v[216:219], v[84:87], v[12:15], v[216:219]
ds_read_b128 v[80:83], v248 offset:6144
v_mfma_f32_16x16x32_bf16 v[220:223], v[84:87], v[16:19], v[220:223]
v_mfma_f32_16x16x32_bf16 v[224:227], v[88:91], v[12:15], v[224:227]
ds_read_b128 v[84:87], v248 offset:10240
s_add_u32 m0, s48, 32768
s_add_u32 s49, s46, 106496
buffer_load_dwordx4 v247, s[24:27], s49 offen sc1 lds
v_mfma_f32_16x16x32_bf16 v[228:231], v[88:91], v[16:19], v[228:231]
s_setprio 2
s_waitcnt lgkmcnt(2)
v_mfma_f32_16x16x32_bf16 v[208:211], v[92:95], v[40:43], v[208:211]
ds_read_b128 v[88:91], v248 offset:11264
v_mfma_f32_16x16x32_bf16 v[212:215], v[92:95], v[44:47], v[212:215]
v_mfma_f32_16x16x32_bf16 v[216:219], v[96:99], v[40:43], v[216:219]
ds_read_b128 v[92:95], v248 offset:12288
s_add_u32 m0, s48, 40960
s_add_u32 s49, s46, 114688
buffer_load_dwordx4 v247, s[24:27], s49 offen sc1 lds
v_mfma_f32_16x16x32_bf16 v[220:223], v[96:99], v[44:47], v[220:223]
s_waitcnt lgkmcnt(2)
v_mfma_f32_16x16x32_bf16 v[224:227], v[80:83], v[40:43], v[224:227]
ds_read_b128 v[96:99], v248 offset:16384
v_mfma_f32_16x16x32_bf16 v[228:231], v[80:83], v[44:47], v[228:231]
s_setprio 1
v_mfma_f32_16x16x32_bf16 v[208:211], v[84:87], v[48:51], v[208:211]
ds_read_b128 v[80:83], v248 offset:17408
s_add_u32 m0, s48, 49152
s_add_u32 s49, s46, 122880
buffer_load_dwordx4 v247, s[24:27], s49 offen sc1 lds
v_mfma_f32_16x16x32_bf16 v[212:215], v[84:87], v[52:55], v[212:215]
s_waitcnt vmcnt(6)
v_lshlrev_b32 v255, 8, v252
v_lshl_add_u32 v255, v250, 5, v255
v_and_b32 v254, 1, v249
v_lshl_add_u32 v255, v254, 4, v255
v_lshrrev_b32 v254, 1, v249
v_lshl_add_u32 v255, v254, 3, v255
v_add_u32 v255, s48, v255
v_add_u32 v255, 98304, v255
ds_read_b64_tr_b16 v[156:157], v255 offset:0
ds_read_b64_tr_b16 v[158:159], v255 offset:128
s_lshl_b32 s51, s40, 3
s_add_u32 s51, s51, s44
s_add_u32 s51, s51, 0
s_cmp_lt_u32 s51, 162
s_cselect_b32 s50, 0, 1879048192
v_add_u32 v254, s50, v248
s_lshl_b32 s51, s51, 10
s_add_u32 s51, s51, s47
s_waitcnt lgkmcnt(0)
buffer_store_dwordx4 v[156:159], v254, s[24:27], s51 offen sc1
v_mfma_f32_16x16x32_bf16 v[216:219], v[88:91], v[48:51], v[216:219]
ds_read_b128 v[84:87], v248 offset:18432
v_mfma_f32_16x16x32_bf16 v[220:223], v[88:91], v[52:55], v[220:223]
v_mfma_f32_16x16x32_bf16 v[224:227], v[92:95], v[48:51], v[224:227]
ds_read_b128 v[88:91], v248 offset:59392
v_mfma_f32_16x16x32_bf16 v[228:231], v[92:95], v[52:55], v[228:231]
s_setprio 0
v_mfma_f32_16x16x32_bf16 v[208:211], v[96:99], v[20:23], v[208:211]
ds_read_b128 v[92:95], v248 offset:60416
s_waitcnt vmcnt(5)
v_lshlrev_b32 v255, 8, v252
v_lshl_add_u32 v255, v250, 5, v255
v_and_b32 v254, 1, v249
v_lshl_add_u32 v255, v254, 4, v255
v_lshrrev_b32 v254, 1, v249
v_lshl_add_u32 v255, v254, 3, v255
v_add_u32 v255, s48, v255
v_add_u32 v255, 106496, v255
ds_read_b64_tr_b16 v[156:157], v255 offset:0
ds_read_b64_tr_b16 v[158:159], v255 offset:128
s_lshl_b32 s51, s40, 3
s_add_u32 s51, s51, s44
s_add_u32 s51, s51, 128
s_cmp_lt_u32 s51, 162
s_cselect_b32 s50, 0, 1879048192
v_add_u32 v254, s50, v248
s_lshl_b32 s51, s51, 10
s_add_u32 s51, s51, s47
s_waitcnt lgkmcnt(0)
buffer_store_dwordx4 v[156:159], v254, s[24:27], s51 offen sc1
v_mfma_f32_16x16x32_bf16 v[212:215], v[96:99], v[24:27], v[212:215]
v_mfma_f32_16x16x32_bf16 v[216:219], v[80:83], v[20:23], v[216:219]
ds_read_b128 v[96:99], v248 offset:61440
v_mfma_f32_16x16x32_bf16 v[220:223], v[80:83], v[24:27], v[220:223]
v_mfma_f32_16x16x32_bf16 v[224:227], v[84:87], v[20:23], v[224:227]
ds_read_b128 v[80:83], v245 offset:0
v_mfma_f32_16x16x32_bf16 v[228:231], v[84:87], v[24:27], v[228:231]
s_barrier
s_setprio 3
v_mfma_f32_16x16x32_bf16 v[208:211], v[88:91], v[56:59], v[208:211]
ds_read_b128 v[84:87], v245 offset:1024
s_add_u32 m0, s48, 4096
s_add_u32 s49, s46, 131072
buffer_load_dwordx4 v247, s[24:27], s49 offen sc1 lds
v_mfma_f32_16x16x32_bf16 v[212:215], v[88:91], v[60:63], v[212:215]
v_mfma_f32_16x16x32_bf16 v[216:219], v[92:95], v[56:59], v[216:219]
ds_read_b128 v[88:91], v245 offset:2048
v_mfma_f32_16x16x32_bf16 v[220:223], v[92:95], v[60:63], v[220:223]
s_waitcnt lgkmcnt(3)
v_mfma_f32_16x16x32_bf16 v[224:227], v[96:99], v[56:59], v[224:227]
ds_read_b128 v[92:95], v245 offset:6144
v_mfma_f32_16x16x32_bf16 v[228:231], v[96:99], v[60:63], v[228:231]
s_waitcnt lgkmcnt(2)
v_mfma_f32_16x16x32_bf16 v[208:211], v[80:83], v[100:103], v[208:211]
ds_read_b128 v[96:99], v245 offset:7168
v_mfma_f32_16x16x32_bf16 v[212:215], v[80:83], v[104:107], v[212:215]
s_setprio 2
v_mfma_f32_16x16x32_bf16 v[216:219], v[84:87], v[100:103], v[216:219]
ds_read_b128 v[80:83], v245 offset:24576
s_add_u32 m0, s48, 12288
s_add_u32 s49, s46, 139264
buffer_load_dwordx4 v247, s[24:27], s49 offen sc1 lds
v_mfma_f32_16x16x32_bf16 v[220:223], v[84:87], v[104:107], v[220:223]
s_waitcnt lgkmcnt(2)
v_mfma_f32_16x16x32_bf16 v[224:227], v[88:91], v[100:103], v[224:227]
ds_read_b128 v[84:87], v245 offset:28672
v_mfma_f32_16x16x32_bf16 v[228:231], v[88:91], v[104:107], v[228:231]
v_mfma_f32_16x16x32_bf16 v[208:211], v[92:95], v[108:111], v[208:211]
ds_read_b128 v[88:91], v245 offset:29696
v_mfma_f32_16x16x32_bf16 v[212:215], v[92:95], v[112:115], v[212:215]
s_waitcnt lgkmcnt(2)
v_mfma_f32_16x16x32_bf16 v[216:219], v[96:99], v[108:111], v[216:219]
ds_read_b128 v[92:95], v245 offset:30720
s_lshl_b32 s50, s42, 8
v_lshl_add_u32 v255, v1, 2, s50
global_load_dword v244, v255, s[100:101]
v_mfma_f32_16x16x32_bf16 v[220:223], v[96:99], v[112:115], v[220:223]
s_setprio 1
v_mfma_f32_16x16x32_bf16 v[224:227], v[80:83], v[108:111], v[224:227]
ds_read_b128 v[96:99], v248 offset:22528
s_add_u32 m0, s48, 53248
s_add_u32 s49, s46, 147456
buffer_load_dwordx4 v247, s[24:27], s49 offen sc1 lds
v_mfma_f32_16x16x32_bf16 v[228:231], v[80:83], v[112:115], v[228:231]
s_waitcnt lgkmcnt(2)
v_mfma_f32_16x16x32_bf16 v[208:211], v[84:87], v[28:31], v[208:211]
ds_read_b128 v[80:83], v248 offset:23552
v_mfma_f32_16x16x32_bf16 v[212:215], v[84:87], v[32:35], v[212:215]
v_mfma_f32_16x16x32_bf16 v[216:219], v[88:91], v[28:31], v[216:219]
ds_read_b128 v[84:87], v245 offset:8192
v_mfma_f32_16x16x32_bf16 v[220:223], v[88:91], v[32:35], v[220:223]
s_waitcnt lgkmcnt(2)
v_mfma_f32_16x16x32_bf16 v[224:227], v[92:95], v[28:31], v[224:227]
ds_read_b128 v[88:91], v245 offset:12288
v_mfma_f32_16x16x32_bf16 v[228:231], v[92:95], v[32:35], v[228:231]
s_setprio 0
v_mfma_f32_16x16x32_bf16 v[208:211], v[96:99], v[64:67], v[208:211]
ds_read_b128 v[92:95], v245 offset:13312
v_mfma_f32_16x16x32_bf16 v[212:215], v[96:99], v[68:71], v[212:215]
s_waitcnt lgkmcnt(2)
v_mfma_f32_16x16x32_bf16 v[216:219], v[80:83], v[64:67], v[216:219]
ds_read_b128 v[96:99], v245 offset:14336
v_mfma_f32_16x16x32_bf16 v[220:223], v[80:83], v[68:71], v[220:223]
v_mfma_f32_16x16x32_bf16 v[224:227], v[84:87], v[64:67], v[224:227]
ds_read_b128 v[80:83], v245 offset:18432
v_mfma_f32_16x16x32_bf16 v[228:231], v[84:87], v[68:71], v[228:231]
s_waitcnt vmcnt(7)
s_barrier
s_setprio 3
s_waitcnt lgkmcnt(2)
v_mfma_f32_16x16x32_bf16 v[208:211], v[88:91], v[116:119], v[208:211]
ds_read_b128 v[84:87], v245 offset:19456
s_add_u32 m0, s48, 57344
s_add_u32 s49, s46, 155648
buffer_load_dwordx4 v247, s[24:27], s49 offen sc1 lds
v_mfma_f32_16x16x32_bf16 v[212:215], v[88:91], v[120:123], v[212:215]
v_mfma_f32_16x16x32_bf16 v[216:219], v[92:95], v[116:119], v[216:219]
ds_read_b128 v[88:91], v245 offset:20480
v_mfma_f32_16x16x32_bf16 v[220:223], v[92:95], v[120:123], v[220:223]
s_waitcnt lgkmcnt(2)
v_mfma_f32_16x16x32_bf16 v[224:227], v[96:99], v[116:119], v[224:227]
ds_read_b128 v[92:95], v248 offset:24576
v_mfma_f32_16x16x32_bf16 v[228:231], v[96:99], v[120:123], v[228:231]
s_setprio 2
v_mfma_f32_16x16x32_bf16 v[208:211], v[80:83], v[196:199], v[208:211]
ds_read_b128 v[96:99], v248 offset:25600
v_mfma_f32_16x16x32_bf16 v[212:215], v[80:83], v[200:203], v[212:215]
s_waitcnt lgkmcnt(2)
v_mfma_f32_16x16x32_bf16 v[216:219], v[84:87], v[196:199], v[216:219]
ds_read_b128 v[80:83], v248 offset:26624
v_mfma_f32_16x16x32_bf16 v[220:223], v[84:87], v[200:203], v[220:223]
v_mfma_f32_16x16x32_bf16 v[224:227], v[88:91], v[196:199], v[224:227]
ds_read_b128 v[84:87], v248 offset:30720
s_add_u32 m0, s48, 65536
s_add_u32 s49, s46, 163840
buffer_load_dwordx4 v247, s[24:27], s49 offen sc1 lds
v_mfma_f32_16x16x32_bf16 v[228:231], v[88:91], v[200:203], v[228:231]
s_setprio 1
s_waitcnt lgkmcnt(2)
v_mfma_f32_16x16x32_bf16 v[208:211], v[92:95], v[36:39], v[208:211]
ds_read_b128 v[88:91], v248 offset:31744
v_mfma_f32_16x16x32_bf16 v[212:215], v[92:95], v[72:75], v[212:215]
v_mfma_f32_16x16x32_bf16 v[216:219], v[96:99], v[36:39], v[216:219]
ds_read_b128 v[92:95], v248 offset:32768
v_mfma_f32_16x16x32_bf16 v[220:223], v[96:99], v[72:75], v[220:223]
s_waitcnt lgkmcnt(2)
v_mfma_f32_16x16x32_bf16 v[224:227], v[80:83], v[36:39], v[224:227]
ds_read_b128 v[96:99], v248 offset:36864
v_mfma_f32_16x16x32_bf16 v[228:231], v[80:83], v[72:75], v[228:231]
s_setprio 0
v_mfma_f32_16x16x32_bf16 v[208:211], v[84:87], v[76:79], v[208:211]
ds_read_b128 v[80:83], v248 offset:37888
v_mfma_f32_16x16x32_bf16 v[212:215], v[84:87], v[204:207], v[212:215]
s_waitcnt lgkmcnt(2)
v_mfma_f32_16x16x32_bf16 v[216:219], v[88:91], v[76:79], v[216:219]
ds_read_b128 v[84:87], v248 offset:38912
v_mfma_f32_16x16x32_bf16 v[220:223], v[88:91], v[204:207], v[220:223]
v_mfma_f32_16x16x32_bf16 v[224:227], v[92:95], v[76:79], v[224:227]
ds_read_b128 v[88:91], v248 offset:43008
v_mfma_f32_16x16x32_bf16 v[228:231], v[92:95], v[204:207], v[228:231]
s_waitcnt vmcnt(2)
s_barrier
s_setprio 3
s_waitcnt lgkmcnt(2)
v_mfma_f32_16x16x32_bf16 v[156:159], v[96:99], v[124:127], 0
ds_read_b128 v[92:95], v248 offset:44032
s_add_u32 m0, s48, 24576
s_add_u32 s49, s46, 172032
buffer_load_dwordx4 v247, s[24:27], s49 offen sc1 lds
v_mfma_f32_16x16x32_bf16 v[160:163], v[96:99], v[128:131], 0
v_max3_f32 v240, v208, v209, v210
v_max3_f32 v240, v240, v211, v216
v_max3_f32 v240, v240, v217, v218
v_mfma_f32_16x16x32_bf16 v[164:167], v[80:83], v[124:127], 0
ds_read_b128 v[96:99], v248 offset:45056
v_max3_f32 v240, v240, v219, v224
v_min3_f32 v239, v208, v209, v210
v_min3_f32 v239, v239, v211, v216
v_mfma_f32_16x16x32_bf16 v[168:171], v[80:83], v[128:131], 0
v_min3_f32 v239, v239, v217, v218
v_min3_f32 v239, v239, v219, v224
s_waitcnt lgkmcnt(2)
v_mfma_f32_16x16x32_bf16 v[172:175], v[84:87], v[124:127], 0
ds_read_b128 v[80:83], v248 offset:49152
v_mov_b32 v238, v240
v_mov_b32 v237, v239
s_nop 0
v_permlane16_swap_b32 v240, v238
v_mfma_f32_16x16x32_bf16 v[176:179], v[84:87], v[128:131], 0
v_permlane16_swap_b32 v239, v237
v_max_f32 v240, v240, v238
v_mfma_f32_16x16x32_bf16 v[156:159], v[88:91], v[132:135], v[156:159]
ds_read_b128 v[84:87], v248 offset:50176
v_min_f32 v239, v239, v237
v_sub_f32 v246, v208, v240
v_sub_f32 v208, v239, v208
v_mfma_f32_16x16x32_bf16 v[160:163], v[88:91], v[136:139], v[160:163]
v_exp_f32 v246, v246
v_exp_f32 v208, v208
s_setprio 2
s_waitcnt lgkmcnt(2)
v_mfma_f32_16x16x32_bf16 v[164:167], v[92:95], v[132:135], v[164:167]
ds_read_b128 v[88:91], v248 offset:51200
v_sub_f32 v3, v209, v240
v_sub_f32 v209, v239, v209
v_exp_f32 v3, v3
v_mfma_f32_16x16x32_bf16 v[168:171], v[92:95], v[136:139], v[168:171]
v_exp_f32 v209, v209
v_sub_f32 v2, v210, v240
v_mfma_f32_16x16x32_bf16 v[172:175], v[96:99], v[132:135], v[172:175]
ds_read_b128 v[92:95], v248 offset:2048
v_sub_f32 v210, v239, v210
v_exp_f32 v2, v2
v_exp_f32 v210, v210
v_mfma_f32_16x16x32_bf16 v[176:179], v[96:99], v[136:139], v[176:179]
v_sub_f32 v235, v211, v240
v_sub_f32 v211, v239, v211
s_waitcnt lgkmcnt(2)
v_mfma_f32_16x16x32_bf16 v[156:159], v[80:83], v[140:143], v[156:159]
ds_read_b128 v[96:99], v248 offset:3072
s_add_u32 m0, s48, 32768
s_add_u32 s49, s46, 180224
buffer_load_dwordx4 v247, s[24:27], s49 offen sc1 lds
v_exp_f32 v235, v235
v_exp_f32 v211, v211
v_mfma_f32_16x16x32_bf16 v[160:163], v[80:83], v[144:147], v[160:163]
v_sub_f32 v233, v216, v240
v_sub_f32 v216, v239, v216
v_exp_f32 v233, v233
v_mfma_f32_16x16x32_bf16 v[164:167], v[84:87], v[140:143], v[164:167]
ds_read_b128 v[80:83], v248 offset:4096
v_exp_f32 v216, v216
v_sub_f32 v232, v217, v240
v_mfma_f32_16x16x32_bf16 v[168:171], v[84:87], v[144:147], v[168:171]
v_sub_f32 v217, v239, v217
v_exp_f32 v232, v232
s_setprio 1
s_waitcnt lgkmcnt(2)
v_mfma_f32_16x16x32_bf16 v[172:175], v[88:91], v[140:143], v[172:175]
ds_read_b128 v[84:87], v248 offset:8192
v_exp_f32 v217, v217
v_sub_f32 v243, v218, v240
v_sub_f32 v218, v239, v218
v_mfma_f32_16x16x32_bf16 v[176:179], v[88:91], v[144:147], v[176:179]
v_exp_f32 v243, v243
v_exp_f32 v218, v218
v_mfma_f32_16x16x32_bf16 v[156:159], v[92:95], v[148:151], v[156:159]
ds_read_b128 v[88:91], v248 offset:9216
v_sub_f32 v242, v219, v240
v_sub_f32 v219, v239, v219
v_exp_f32 v242, v242
v_mfma_f32_16x16x32_bf16 v[160:163], v[92:95], v[152:155], v[160:163]
v_exp_f32 v219, v219
v_sub_f32 v241, v224, v240
s_waitcnt lgkmcnt(2)
v_mfma_f32_16x16x32_bf16 v[164:167], v[96:99], v[148:151], v[164:167]
ds_read_b128 v[92:95], v248 offset:10240
v_sub_f32 v224, v239, v224
v_exp_f32 v241, v241
v_exp_f32 v224, v224
v_mfma_f32_16x16x32_bf16 v[168:171], v[96:99], v[152:155], v[168:171]
v_add_f32 v240, v246, v3
v_add_f32 v239, v208, v209
v_mfma_f32_16x16x32_bf16 v[172:175], v[80:83], v[148:151], v[172:175]
ds_read_b128 v[96:99], v248 offset:14336
v_add_f32 v240, v240, v2
v_add_f32 v239, v239, v210
v_add_f32 v240, v240, v235
v_mfma_f32_16x16x32_bf16 v[176:179], v[80:83], v[152:155], v[176:179]
v_add_f32 v239, v239, v211
v_add_f32 v240, v240, v233
s_setprio 0
s_waitcnt lgkmcnt(2)
v_mfma_f32_16x16x32_bf16 v[156:159], v[84:87], v[4:7], v[156:159]
ds_read_b128 v[80:83], v248 offset:15360
v_add_f32 v239, v239, v216
v_add_f32 v240, v240, v232
v_add_f32 v239, v239, v217
v_mfma_f32_16x16x32_bf16 v[160:163], v[84:87], v[8:11], v[160:163]
v_add_f32 v240, v240, v243
v_add_f32 v239, v239, v218
v_mfma_f32_16x16x32_bf16 v[164:167], v[88:91], v[4:7], v[164:167]
ds_read_b128 v[84:87], v248 offset:16384
v_add_f32 v240, v240, v242
v_add_f32 v239, v239, v219
v_add_f32 v240, v240, v241
v_mfma_f32_16x16x32_bf16 v[168:171], v[88:91], v[8:11], v[168:171]
v_add_f32 v239, v239, v224
v_mov_b32 v238, v240
s_waitcnt lgkmcnt(2)
v_mfma_f32_16x16x32_bf16 v[172:175], v[92:95], v[4:7], v[172:175]
ds_read_b128 v[88:91], v248 offset:53248
v_mov_b32 v237, v239
v_permlane16_swap_b32 v240, v238
v_mfma_f32_16x16x32_bf16 v[176:179], v[92:95], v[8:11], v[176:179]
v_permlane16_swap_b32 v239, v237
v_add_f32 v240, v240, v238
s_waitcnt vmcnt(1)
s_barrier
s_setprio 3
v_mfma_f32_16x16x32_bf16 v[156:159], v[96:99], v[12:15], v[156:159]
ds_read_b128 v[92:95], v248 offset:54272
s_add_u32 m0, s48, 4096
s_add_u32 s49, s46, 188416
buffer_load_dwordx4 v247, s[24:27], s49 offen sc1 lds
v_add_f32 v239, v239, v237
v_rcp_f32 v240, v240
v_rcp_f32 v239, v239
v_mfma_f32_16x16x32_bf16 v[160:163], v[96:99], v[16:19], v[160:163]
v_mul_f32 v246, v246, v240
v_mul_f32 v208, v208, v239
v_mul_f32 v3, v3, v240
v_mul_f32 v209, v209, v239
s_waitcnt lgkmcnt(2)
v_mfma_f32_16x16x32_bf16 v[164:167], v[80:83], v[12:15], v[164:167]
ds_read_b128 v[96:99], v248 offset:55296
v_mul_f32 v2, v2, v240
v_mul_f32 v210, v210, v239
v_mul_f32 v235, v235, v240
v_mfma_f32_16x16x32_bf16 v[168:171], v[80:83], v[16:19], v[168:171]
v_mul_f32 v211, v211, v239
v_mul_f32 v233, v233, v240
v_mul_f32 v216, v216, v239
v_mfma_f32_16x16x32_bf16 v[172:175], v[84:87], v[12:15], v[172:175]
ds_read_b128 v[80:83], v248 offset:22528
v_mul_f32 v232, v232, v240
v_mul_f32 v217, v217, v239
v_mul_f32 v243, v243, v240
v_mfma_f32_16x16x32_bf16 v[176:179], v[84:87], v[16:19], v[176:179]
v_mul_f32 v218, v218, v239
v_mul_f32 v242, v242, v240
v_mul_f32 v219, v219, v239
s_setprio 2
s_waitcnt lgkmcnt(2)
v_mfma_f32_16x16x32_bf16 v[156:159], v[88:91], v[40:43], v[156:159]
ds_read_b128 v[84:87], v248 offset:23552
s_add_u32 m0, s48, 36864
s_add_u32 s49, s46, 196608
buffer_load_dwordx4 v247, s[24:27], s49 offen sc1 lds
v_mul_f32 v241, v241, v240
v_mul_f32 v224, v224, v239
v_cvt_pk_bf16_f32 v208, v208, v209
v_mfma_f32_16x16x32_bf16 v[160:163], v[88:91], v[44:47], v[160:163]
v_cvt_pk_bf16_f32 v209, v210, v211
v_cvt_pk_bf16_f32 v210, v216, v217
v_cvt_pk_bf16_f32 v211, v218, v219
v_mfma_f32_16x16x32_bf16 v[164:167], v[92:95], v[40:43], v[164:167]
ds_read_b128 v[88:91], v248 offset:57344
v_cvt_pk_bf16_f32 v216, v224, v246
v_cvt_pk_bf16_f32 v217, v3, v2
v_cvt_pk_bf16_f32 v218, v235, v233
v_mfma_f32_16x16x32_bf16 v[168:171], v[92:95], v[44:47], v[168:171]
v_cvt_pk_bf16_f32 v219, v232, v243
v_cvt_pk_bf16_f32 v224, v242, v241
v_mov_b32 v225, 0
s_waitcnt lgkmcnt(2)
v_mfma_f32_16x16x32_bf16 v[172:175], v[96:99], v[40:43], v[172:175]
ds_read_b128 v[92:95], v248 offset:61440
s_mul_i32 s50, s42, 5120
s_add_u32 s50, s50, 73728
v_mul_u32_u24 v253, 160, v251
v_mad_u32_u24 v253, v252, 40, v253
v_add_u32 v253, s50, v253
ds_write_b64 v253, v[208:209] offset:0
ds_write_b64 v253, v[210:211] offset:8
ds_write_b64 v253, v[216:217] offset:16
ds_write_b64 v253, v[218:219] offset:24
ds_write_b64 v253, v[224:225] offset:32
v_max3_f32 v240, v212, v213, v214
v_max3_f32 v240, v240, v215, v220
v_mfma_f32_16x16x32_bf16 v[176:179], v[96:99], v[44:47], v[176:179]
v_max3_f32 v240, v240, v221, v222
v_max3_f32 v240, v240, v223, v228
v_min3_f32 v239, v212, v213, v214
s_setprio 1
v_mfma_f32_16x16x32_bf16 v[156:159], v[80:83], v[48:51], v[156:159]
ds_read_b128 v[96:99], v248 offset:62464
s_add_u32 m0, s48, 45056
s_add_u32 s49, s46, 204800
buffer_load_dwordx4 v247, s[24:27], s49 offen sc1 lds
v_min3_f32 v239, v239, v215, v220
v_min3_f32 v239, v239, v221, v222
v_min3_f32 v239, v239, v223, v228
v_mfma_f32_16x16x32_bf16 v[160:163], v[80:83], v[52:55], v[160:163]
v_mov_b32 v238, v240
v_mov_b32 v237, v239
s_nop 0
v_permlane16_swap_b32 v240, v238
s_waitcnt lgkmcnt(7)
v_mfma_f32_16x16x32_bf16 v[164:167], v[84:87], v[48:51], v[164:167]
ds_read_b128 v[80:83], v248 offset:63488
v_permlane16_swap_b32 v239, v237
v_max_f32 v240, v240, v238
v_min_f32 v239, v239, v237
v_mfma_f32_16x16x32_bf16 v[168:171], v[84:87], v[52:55], v[168:171]
v_sub_f32 v246, v212, v240
v_sub_f32 v212, v239, v212
v_exp_f32 v246, v246
v_mfma_f32_16x16x32_bf16 v[172:175], v[88:91], v[48:51], v[172:175]
ds_read_b128 v[84:87], v245 offset:2048
v_exp_f32 v212, v212
v_sub_f32 v3, v213, v240
v_sub_f32 v213, v239, v213
v_mfma_f32_16x16x32_bf16 v[176:179], v[88:91], v[52:55], v[176:179]
v_exp_f32 v3, v3
v_exp_f32 v213, v213
v_sub_f32 v2, v214, v240
s_setprio 0
s_waitcnt lgkmcnt(2)
v_mfma_f32_16x16x32_bf16 v[156:159], v[92:95], v[20:23], v[156:159]
ds_read_b128 v[88:91], v245 offset:3072
v_sub_f32 v214, v239, v214
v_exp_f32 v2, v2
v_exp_f32 v214, v214
v_mfma_f32_16x16x32_bf16 v[160:163], v[92:95], v[24:27], v[160:163]
v_sub_f32 v235, v215, v240
v_sub_f32 v215, v239, v215
v_exp_f32 v235, v235
v_mfma_f32_16x16x32_bf16 v[164:167], v[96:99], v[20:23], v[164:167]
ds_read_b128 v[92:95], v245 offset:4096
v_exp_f32 v215, v215
v_sub_f32 v233, v220, v240
v_sub_f32 v220, v239, v220
v_mfma_f32_16x16x32_bf16 v[168:171], v[96:99], v[24:27], v[168:171]
v_exp_f32 v233, v233
v_exp_f32 v220, v220
v_sub_f32 v232, v221, v240
s_waitcnt lgkmcnt(2)
v_mfma_f32_16x16x32_bf16 v[172:175], v[80:83], v[20:23], v[172:175]
ds_read_b128 v[96:99], v248 offset:24576
v_sub_f32 v221, v239, v221
v_exp_f32 v232, v232
v_exp_f32 v221, v221
v_mfma_f32_16x16x32_bf16 v[176:179], v[80:83], v[24:27], v[176:179]
v_sub_f32 v243, v222, v240
v_sub_f32 v222, v239, v222
v_exp_f32 v243, v243
s_waitcnt vmcnt(0)
s_barrier
s_setprio 3
v_mfma_f32_16x16x32_bf16 v[156:159], v[84:87], v[56:59], v[156:159]
ds_read_b128 v[80:83], v248 offset:25600
s_add_u32 m0, s48, 12288
s_add_u32 s49, s46, 212992
buffer_load_dwordx4 v247, s[24:27], s49 offen sc1 lds
v_exp_f32 v222, v222
v_sub_f32 v242, v223, v240
v_mfma_f32_16x16x32_bf16 v[160:163], v[84:87], v[60:63], v[160:163]
v_sub_f32 v223, v239, v223
v_exp_f32 v242, v242
v_exp_f32 v223, v223
s_waitcnt lgkmcnt(2)
v_mfma_f32_16x16x32_bf16 v[164:167], v[88:91], v[56:59], v[164:167]
ds_read_b128 v[84:87], v248 offset:26624
v_sub_f32 v241, v228, v240
v_sub_f32 v228, v239, v228
v_exp_f32 v241, v241
v_mfma_f32_16x16x32_bf16 v[168:171], v[88:91], v[60:63], v[168:171]
v_exp_f32 v228, v228
v_add_f32 v240, v246, v3
v_mfma_f32_16x16x32_bf16 v[172:175], v[92:95], v[56:59], v[172:175]
ds_read_b128 v[88:91], v248 offset:30720
v_add_f32 v239, v212, v213
v_add_f32 v240, v240, v2
v_add_f32 v239, v239, v214
v_mfma_f32_16x16x32_bf16 v[176:179], v[92:95], v[60:63], v[176:179]
v_add_f32 v240, v240, v235
v_add_f32 v239, v239, v215
s_waitcnt lgkmcnt(2)
v_mfma_f32_16x16x32_bf16 v[156:159], v[96:99], v[100:103], v[156:159]
ds_read_b128 v[92:95], v248 offset:31744
v_add_f32 v240, v240, v233
v_add_f32 v239, v239, v220
v_mfma_f32_16x16x32_bf16 v[160:163], v[96:99], v[104:107], v[160:163]
v_add_f32 v240, v240, v232
v_add_f32 v239, v239, v221
s_setprio 2
v_mfma_f32_16x16x32_bf16 v[164:167], v[80:83], v[100:103], v[164:167]
ds_read_b128 v[96:99], v248 offset:32768
s_add_u32 m0, s48, 20480
s_add_u32 s49, s46, 221184
buffer_load_dwordx4 v247, s[24:27], s49 offen sc1 lds
v_add_f32 v240, v240, v243
v_add_f32 v239, v239, v222
v_mfma_f32_16x16x32_bf16 v[168:171], v[80:83], v[104:107], v[168:171]
v_add_f32 v240, v240, v242
v_add_f32 v239, v239, v223
v_add_f32 v240, v240, v241
s_waitcnt lgkmcnt(2)
v_mfma_f32_16x16x32_bf16 v[172:175], v[84:87], v[100:103], v[172:175]
ds_read_b128 v[80:83], v248 offset:0
v_add_f32 v239, v239, v228
v_mov_b32 v238, v240
v_mov_b32 v237, v239
v_mfma_f32_16x16x32_bf16 v[176:179], v[84:87], v[104:107], v[176:179]
v_permlane16_swap_b32 v240, v238
v_permlane16_swap_b32 v239, v237
v_mfma_f32_16x16x32_bf16 v[156:159], v[88:91], v[108:111], v[156:159]
ds_read_b128 v[84:87], v248 offset:1024
v_add_f32 v240, v240, v238
v_add_f32 v239, v239, v237
v_rcp_f32 v240, v240
v_mfma_f32_16x16x32_bf16 v[160:163], v[88:91], v[112:115], v[160:163]
v_rcp_f32 v239, v239
v_mul_f32 v246, v246, v240
s_waitcnt lgkmcnt(2)
v_mfma_f32_16x16x32_bf16 v[164:167], v[92:95], v[108:111], v[164:167]
ds_read_b128 v[88:91], v248 offset:2048
v_mul_f32 v212, v212, v239
v_mul_f32 v3, v3, v240
v_mfma_f32_16x16x32_bf16 v[168:171], v[92:95], v[112:115], v[168:171]
v_mul_f32 v213, v213, v239
v_mul_f32 v2, v2, v240
s_setprio 1
v_mfma_f32_16x16x32_bf16 v[172:175], v[96:99], v[108:111], v[172:175]
ds_read_b128 v[92:95], v248 offset:6144
s_add_u32 m0, s48, 57344
s_add_u32 s49, s46, 229376
buffer_load_dwordx4 v247, s[24:27], s49 offen sc1 lds
v_mul_f32 v214, v214, v239
v_mul_f32 v235, v235, v240
v_mfma_f32_16x16x32_bf16 v[176:179], v[96:99], v[112:115], v[176:179]
v_mul_f32 v215, v215, v239
v_mul_f32 v233, v233, v240
v_mul_f32 v220, v220, v239
s_waitcnt lgkmcnt(2)
v_mfma_f32_16x16x32_bf16 v[156:159], v[80:83], v[28:31], v[156:159]
ds_read_b128 v[96:99], v248 offset:7168
v_mul_f32 v232, v232, v240
v_mul_f32 v221, v221, v239
v_mul_f32 v243, v243, v240
v_mfma_f32_16x16x32_bf16 v[160:163], v[80:83], v[32:35], v[160:163]
v_mul_f32 v222, v222, v239
v_mul_f32 v242, v242, v240
v_mfma_f32_16x16x32_bf16 v[164:167], v[84:87], v[28:31], v[164:167]
ds_read_b128 v[80:83], v248 offset:8192
v_mul_f32 v223, v223, v239
v_mul_f32 v241, v241, v240
v_mul_f32 v228, v228, v239
v_mfma_f32_16x16x32_bf16 v[168:171], v[84:87], v[32:35], v[168:171]
v_cvt_pk_bf16_f32 v212, v212, v213
v_cvt_pk_bf16_f32 v213, v214, v215
s_waitcnt lgkmcnt(2)
v_mfma_f32_16x16x32_bf16 v[172:175], v[88:91], v[28:31], v[172:175]
ds_read_b128 v[84:87], v248 offset:36864
v_cvt_pk_bf16_f32 v214, v220, v221
v_cvt_pk_bf16_f32 v215, v222, v223
v_mfma_f32_16x16x32_bf16 v[176:179], v[88:91], v[32:35], v[176:179]
v_cvt_pk_bf16_f32 v220, v228, v246
v_cvt_pk_bf16_f32 v221, v3, v2
s_setprio 0
v_mfma_f32_16x16x32_bf16 v[156:159], v[92:95], v[64:67], v[156:159]
ds_read_b128 v[88:91], v248 offset:37888
v_cvt_pk_bf16_f32 v222, v235, v233
v_cvt_pk_bf16_f32 v223, v232, v243
v_cvt_pk_bf16_f32 v228, v242, v241
v_mfma_f32_16x16x32_bf16 v[160:163], v[92:95], v[68:71], v[160:163]
v_mov_b32 v229, 0
s_mul_i32 s50, s42, 5120
s_add_u32 s50, s50, 76288
v_mul_u32_u24 v253, 160, v251
v_mad_u32_u24 v253, v252, 40, v253
v_add_u32 v253, s50, v253
ds_write_b64 v253, v[212:213] offset:0
ds_write_b64 v253, v[214:215] offset:8
ds_write_b64 v253, v[220:221] offset:16
ds_write_b64 v253, v[222:223] offset:24
ds_write_b64 v253, v[228:229] offset:32
s_waitcnt lgkmcnt(7)
v_mfma_f32_16x16x32_bf16 v[164:167], v[96:99], v[64:67], v[164:167]
ds_read_b128 v[92:95], v248 offset:38912
v_mfma_f32_16x16x32_bf16 v[168:171], v[96:99], v[68:71], v[168:171]
v_mfma_f32_16x16x32_bf16 v[172:175], v[80:83], v[64:67], v[172:175]
ds_read_b128 v[96:99], v248 offset:43008
v_mfma_f32_16x16x32_bf16 v[176:179], v[80:83], v[68:71], v[176:179]
s_waitcnt vmcnt(0)
s_waitcnt lgkmcnt(2)
s_barrier
s_setprio 3
v_mfma_f32_16x16x32_bf16 v[156:159], v[84:87], v[116:119], v[156:159]
ds_read_b128 v[80:83], v248 offset:44032
s_add_u32 m0, s48, 0
s_add_u32 s49, s46, 237568
buffer_load_dwordx4 v247, s[24:27], s49 offen sc1 lds
v_lshl_add_u32 v255, v252, 2, v250
s_lshr_b32 s50, s42, 1
s_mul_i32 s51, s50, 80
s_add_u32 s51, s51, 73728
v_mul_u32_u24 v254, 160, v255
v_lshl_add_u32 v253, v249, 3, v254
v_add_u32 v2, s51, v253
s_lshl_b32 s51, s50, 5
s_add_u32 s51, s51, 0
v_lshl_add_u32 v254, v249, 3, s51
s_add_u32 s51, s51, 32
v_mov_b32 v253, s51
v_cmp_eq_u32 vcc, 0, v249
v_mov_b32 v3, 0x120
s_nop 0
v_cndmask_b32 v253, v3, v253, vcc
s_and_b32 s52, s42, 1
s_cmp_eq_u32 s52, 1
s_cselect_b64 vcc, -1, 0
v_cndmask_b32 v254, v254, v253, vcc
v_mul_u32_u24 v255, 304, v255
v_add_u32 v255, 114688, v255
v_add_u32 v3, v255, v254
v_mfma_f32_16x16x32_bf16 v[160:163], v[84:87], v[120:123], v[160:163]
ds_read_b64_tr_b16 v[192:193], v3 offset:0
ds_read_b64_tr_b16 v[194:195], v3 offset:4864
ds_read_b64_tr_b16 v[208:209], v2 offset:0
ds_read_b64_tr_b16 v[210:211], v2 offset:2560
ds_read_b64_tr_b16 v[212:213], v2 offset:32
ds_read_b64_tr_b16 v[214:215], v2 offset:2592
ds_read_b64_tr_b16 v[216:217], v2 offset:64
ds_read_b64_tr_b16 v[218:219], v2 offset:2624
v_mfma_f32_16x16x32_bf16 v[164:167], v[88:91], v[116:119], v[164:167]
ds_read_b128 v[84:87], v248 offset:45056
s_waitcnt lgkmcnt(1)
v_mfma_f32_16x16x32_bf16 v[180:183], v[208:211], v[192:195], 0
v_mfma_f32_16x16x32_bf16 v[184:187], v[212:215], v[192:195], 0
v_mfma_f32_16x16x32_bf16 v[188:191], v[216:219], v[192:195], 0
v_mfma_f32_16x16x32_bf16 v[168:171], v[88:91], v[120:123], v[168:171]
v_mfma_f32_16x16x32_bf16 v[172:175], v[92:95], v[116:119], v[172:175]
ds_read_b128 v[88:91], v248 offset:49152
s_add_u32 m0, s48, 8192
s_add_u32 s49, s46, 245760
buffer_load_dwordx4 v247, s[24:27], s49 offen sc1 lds
v_mfma_f32_16x16x32_bf16 v[176:179], v[92:95], v[120:123], v[176:179]
ds_read_b64_tr_b16 v[192:193], v3 offset:9728
ds_read_b64_tr_b16 v[194:195], v3 offset:14592
ds_read_b64_tr_b16 v[208:209], v2 offset:5120
ds_read_b64_tr_b16 v[210:211], v2 offset:7680
ds_read_b64_tr_b16 v[212:213], v2 offset:5152
ds_read_b64_tr_b16 v[214:215], v2 offset:7712
ds_read_b64_tr_b16 v[216:217], v2 offset:5184
ds_read_b64_tr_b16 v[218:219], v2 offset:7744
s_setprio 2
v_mfma_f32_16x16x32_bf16 v[156:159], v[96:99], v[196:199], v[156:159]
ds_read_b128 v[92:95], v248 offset:50176
s_waitcnt lgkmcnt(1)
v_mfma_f32_16x16x32_bf16 v[180:183], v[208:211], v[192:195], v[180:183]
v_mfma_f32_16x16x32_bf16 v[184:187], v[212:215], v[192:195], v[184:187]
v_mfma_f32_16x16x32_bf16 v[188:191], v[216:219], v[192:195], v[188:191]
v_mfma_f32_16x16x32_bf16 v[160:163], v[96:99], v[200:203], v[160:163]
v_mfma_f32_16x16x32_bf16 v[164:167], v[80:83], v[196:199], v[164:167]
ds_read_b128 v[96:99], v248 offset:51200
s_add_u32 m0, s48, 28672
s_add_u32 s49, s46, 253952
buffer_load_dwordx4 v247, s[24:27], s49 offen sc1 lds
v_mfma_f32_16x16x32_bf16 v[168:171], v[80:83], v[200:203], v[168:171]
ds_read_b64_tr_b16 v[192:193], v3 offset:19456
ds_read_b64_tr_b16 v[194:195], v3 offset:24320
ds_read_b64_tr_b16 v[208:209], v2 offset:10240
ds_read_b64_tr_b16 v[210:211], v2 offset:12800
ds_read_b64_tr_b16 v[212:213], v2 offset:10272
ds_read_b64_tr_b16 v[214:215], v2 offset:12832
ds_read_b64_tr_b16 v[216:217], v2 offset:10304
ds_read_b64_tr_b16 v[218:219], v2 offset:12864
v_mfma_f32_16x16x32_bf16 v[172:175], v[84:87], v[196:199], v[172:175]
ds_read_b128 v[80:83], v248 offset:14336
s_waitcnt lgkmcnt(1)
v_mfma_f32_16x16x32_bf16 v[180:183], v[208:211], v[192:195], v[180:183]
v_mfma_f32_16x16x32_bf16 v[184:187], v[212:215], v[192:195], v[184:187]
v_mfma_f32_16x16x32_bf16 v[188:191], v[216:219], v[192:195], v[188:191]
v_mfma_f32_16x16x32_bf16 v[176:179], v[84:87], v[200:203], v[176:179]
s_setprio 1
v_mfma_f32_16x16x32_bf16 v[156:159], v[88:91], v[36:39], v[156:159]
ds_read_b128 v[84:87], v248 offset:15360
s_add_u32 m0, s48, 65536
s_add_u32 s49, s46, 262144
buffer_load_dwordx4 v247, s[24:27], s49 offen sc1 lds
ds_read_b64_tr_b16 v[192:193], v3 offset:29184
ds_read_b64_tr_b16 v[194:195], v3 offset:34048
ds_read_b64_tr_b16 v[208:209], v2 offset:15360
ds_read_b64_tr_b16 v[210:211], v2 offset:17920
ds_read_b64_tr_b16 v[212:213], v2 offset:15392
ds_read_b64_tr_b16 v[214:215], v2 offset:17952
ds_read_b64_tr_b16 v[216:217], v2 offset:15424
ds_read_b64_tr_b16 v[218:219], v2 offset:17984
v_mfma_f32_16x16x32_bf16 v[160:163], v[88:91], v[72:75], v[160:163]
s_waitcnt lgkmcnt(0)
v_mfma_f32_16x16x32_bf16 v[180:183], v[208:211], v[192:195], v[180:183]
v_mfma_f32_16x16x32_bf16 v[184:187], v[212:215], v[192:195], v[184:187]
v_mfma_f32_16x16x32_bf16 v[188:191], v[216:219], v[192:195], v[188:191]
v_mfma_f32_16x16x32_bf16 v[164:167], v[92:95], v[36:39], v[164:167]
ds_read_b128 v[88:91], v248 offset:16384
v_mov_b32 v253, 7936
v_min_u32 v255, v253, v244
v_cmp_gt_u32 vcc, 2, v252
s_nop 1
v_cndmask_b32 v254, v253, v255, vcc
v_add_u32 v255, 155776, v255
v_add_u32 v254, 155776, v254
v_cvt_pk_bf16_f32 v180, v180, v181
v_cvt_pk_bf16_f32 v181, v182, v183
ds_write_b64 v255, v[180:181] offset:0
v_cvt_pk_bf16_f32 v184, v184, v185
v_cvt_pk_bf16_f32 v185, v186, v187
ds_write_b64 v255, v[184:185] offset:32
v_cvt_pk_bf16_f32 v188, v188, v189
v_cvt_pk_bf16_f32 v189, v190, v191
ds_write_b64 v254, v[188:189] offset:64
v_mfma_f32_16x16x32_bf16 v[168:171], v[92:95], v[72:75], v[168:171]
v_mfma_f32_16x16x32_bf16 v[172:175], v[96:99], v[36:39], v[172:175]
ds_read_b128 v[92:95], v248 offset:20480
v_mfma_f32_16x16x32_bf16 v[176:179], v[96:99], v[72:75], v[176:179]
s_setprio 0
v_mfma_f32_16x16x32_bf16 v[156:159], v[80:83], v[76:79], v[156:159]
ds_read_b128 v[96:99], v248 offset:21504
v_mfma_f32_16x16x32_bf16 v[160:163], v[80:83], v[204:207], v[160:163]
v_mfma_f32_16x16x32_bf16 v[164:167], v[84:87], v[76:79], v[164:167]
ds_read_b128 v[80:83], v248 offset:22528
v_mfma_f32_16x16x32_bf16 v[168:171], v[84:87], v[204:207], v[168:171]
s_waitcnt lgkmcnt(6)
v_mfma_f32_16x16x32_bf16 v[172:175], v[88:91], v[76:79], v[172:175]
ds_read_b128 v[84:87], v248 offset:55296
v_mfma_f32_16x16x32_bf16 v[176:179], v[88:91], v[204:207], v[176:179]
s_waitcnt vmcnt(1)
s_waitcnt lgkmcnt(4)
s_barrier
s_setprio 3
v_add_u32 v255, 155776, v247
ds_read_b128 v[216:219], v255
s_waitcnt lgkmcnt(3)
v_mfma_f32_16x16x32_bf16 v[180:183], v[92:95], v[124:127], 0
ds_read_b128 v[88:91], v248 offset:56320
s_add_u32 m0, s48, 12288
s_add_u32 s49, s46, 270336
buffer_load_dwordx4 v247, s[24:27], s49 offen sc1 lds
v_mfma_f32_16x16x32_bf16 v[184:187], v[92:95], v[128:131], 0
s_waitcnt lgkmcnt(1)
s_lshl_b32 s50, s41, 6
s_add_u32 s50, s50, s40
s_mul_i32 s50, s50, 3072
s_add_u32 s50, s50, 40894464
s_cmp_lt_u32 s42, 3
s_cselect_b32 s51, 0, 1879048192
v_add_u32 v255, s51, v247
buffer_store_dwordx4 v[216:219], v255, s[24:27], s50 offen sc1
v_mfma_f32_16x16x32_bf16 v[188:191], v[96:99], v[124:127], 0
ds_read_b128 v[92:95], v248 offset:57344
v_max3_f32 v240, v156, v157, v158
v_max3_f32 v240, v240, v159, v164
v_max3_f32 v240, v240, v165, v166
v_mfma_f32_16x16x32_bf16 v[192:195], v[96:99], v[128:131], 0
v_max3_f32 v240, v240, v167, v172
v_min3_f32 v239, v156, v157, v158
v_mfma_f32_16x16x32_bf16 v[208:211], v[80:83], v[124:127], 0
ds_read_b128 v[96:99], v248 offset:61440
v_min3_f32 v239, v239, v159, v164
v_min3_f32 v239, v239, v165, v166
v_min3_f32 v239, v239, v167, v172
v_mfma_f32_16x16x32_bf16 v[212:215], v[80:83], v[128:131], 0
v_mov_b32 v238, v240
v_mov_b32 v237, v239
v_mfma_f32_16x16x32_bf16 v[180:183], v[84:87], v[132:135], v[180:183]
ds_read_b128 v[80:83], v248 offset:62464
v_permlane16_swap_b32 v240, v238
v_permlane16_swap_b32 v239, v237
v_max_f32 v240, v240, v238
v_mfma_f32_16x16x32_bf16 v[184:187], v[84:87], v[136:139], v[184:187]
v_min_f32 v239, v239, v237
v_sub_f32 v246, v156, v240
s_setprio 2
s_waitcnt lgkmcnt(2)
v_mfma_f32_16x16x32_bf16 v[188:191], v[88:91], v[132:135], v[188:191]
ds_read_b128 v[84:87], v248 offset:63488
s_add_u32 m0, s48, 36864
s_add_u32 s49, s46, 278528
buffer_load_dwordx4 v247, s[24:27], s49 offen sc1 lds
v_sub_f32 v156, v239, v156
v_exp_f32 v246, v246
v_mfma_f32_16x16x32_bf16 v[192:195], v[88:91], v[136:139], v[192:195]
v_exp_f32 v156, v156
v_sub_f32 v3, v157, v240
v_sub_f32 v157, v239, v157
v_mfma_f32_16x16x32_bf16 v[208:211], v[92:95], v[132:135], v[208:211]
ds_read_b128 v[88:91], v248 offset:2048
v_exp_f32 v3, v3
v_exp_f32 v157, v157
v_sub_f32 v2, v158, v240
v_mfma_f32_16x16x32_bf16 v[212:215], v[92:95], v[136:139], v[212:215]
v_sub_f32 v158, v239, v158
v_exp_f32 v2, v2
s_waitcnt lgkmcnt(2)
v_mfma_f32_16x16x32_bf16 v[180:183], v[96:99], v[140:143], v[180:183]
ds_read_b128 v[92:95], v248 offset:3072
v_exp_f32 v158, v158
v_sub_f32 v235, v159, v240
v_sub_f32 v159, v239, v159
v_mfma_f32_16x16x32_bf16 v[184:187], v[96:99], v[144:147], v[184:187]
v_exp_f32 v235, v235
v_exp_f32 v159, v159
v_mfma_f32_16x16x32_bf16 v[188:191], v[80:83], v[140:143], v[188:191]
ds_read_b128 v[96:99], v248 offset:4096
v_sub_f32 v233, v164, v240
v_sub_f32 v164, v239, v164
v_exp_f32 v233, v233
v_mfma_f32_16x16x32_bf16 v[192:195], v[80:83], v[144:147], v[192:195]
v_exp_f32 v164, v164
v_sub_f32 v232, v165, v240
s_setprio 1
s_waitcnt lgkmcnt(2)
v_mfma_f32_16x16x32_bf16 v[208:211], v[84:87], v[140:143], v[208:211]
ds_read_b128 v[80:83], v248 offset:8192
s_add_u32 m0, s48, 45056
s_add_u32 s49, s46, 286720
buffer_load_dwordx4 v247, s[24:27], s49 offen sc1 lds
v_sub_f32 v165, v239, v165
v_exp_f32 v232, v232
v_mfma_f32_16x16x32_bf16 v[212:215], v[84:87], v[144:147], v[212:215]
v_exp_f32 v165, v165
v_sub_f32 v243, v166, v240
v_sub_f32 v166, v239, v166
v_mfma_f32_16x16x32_bf16 v[180:183], v[88:91], v[148:151], v[180:183]
ds_read_b128 v[84:87], v248 offset:9216
v_exp_f32 v243, v243
v_exp_f32 v166, v166
v_sub_f32 v242, v167, v240
v_mfma_f32_16x16x32_bf16 v[184:187], v[88:91], v[152:155], v[184:187]
v_sub_f32 v167, v239, v167
v_exp_f32 v242, v242
s_waitcnt lgkmcnt(2)
v_mfma_f32_16x16x32_bf16 v[188:191], v[92:95], v[148:151], v[188:191]
ds_read_b128 v[88:91], v248 offset:10240
v_exp_f32 v167, v167
v_sub_f32 v241, v172, v240
v_sub_f32 v172, v239, v172
v_mfma_f32_16x16x32_bf16 v[192:195], v[92:95], v[152:155], v[192:195]
v_exp_f32 v241, v241
v_exp_f32 v172, v172
v_mfma_f32_16x16x32_bf16 v[208:211], v[96:99], v[148:151], v[208:211]
ds_read_b128 v[92:95], v248 offset:26624
v_add_f32 v240, v246, v3
v_add_f32 v239, v156, v157
v_add_f32 v240, v240, v2
v_mfma_f32_16x16x32_bf16 v[212:215], v[96:99], v[152:155], v[212:215]
v_add_f32 v239, v239, v158
v_add_f32 v240, v240, v235
s_setprio 0
s_waitcnt lgkmcnt(2)
v_mfma_f32_16x16x32_bf16 v[180:183], v[80:83], v[4:7], v[180:183]
ds_read_b128 v[96:99], v248 offset:27648
v_add_f32 v239, v239, v159
v_add_f32 v240, v240, v233
v_add_f32 v239, v239, v164
v_mfma_f32_16x16x32_bf16 v[184:187], v[80:83], v[8:11], v[184:187]
v_add_f32 v240, v240, v232
v_add_f32 v239, v239, v165
v_mfma_f32_16x16x32_bf16 v[188:191], v[84:87], v[4:7], v[188:191]
ds_read_b128 v[80:83], v248 offset:28672
v_add_f32 v240, v240, v243
v_add_f32 v239, v239, v166
v_add_f32 v240, v240, v242
v_mfma_f32_16x16x32_bf16 v[192:195], v[84:87], v[8:11], v[192:195]
v_add_f32 v239, v239, v167
v_add_f32 v240, v240, v241
s_waitcnt lgkmcnt(2)
v_mfma_f32_16x16x32_bf16 v[208:211], v[88:91], v[4:7], v[208:211]
ds_read_b128 v[84:87], v248 offset:32768
v_add_f32 v239, v239, v172
v_mov_b32 v238, v240
v_mfma_f32_16x16x32_bf16 v[212:215], v[88:91], v[8:11], v[212:215]
v_mov_b32 v237, v239
v_permlane16_swap_b32 v240, v238
s_waitcnt vmcnt(2)
s_waitcnt vmcnt(1)
s_barrier
s_setprio 3
v_mfma_f32_16x16x32_bf16 v[180:183], v[92:95], v[12:15], v[180:183]
ds_read_b128 v[88:91], v248 offset:33792
s_add_u32 m0, s48, 0
s_add_u32 s49, s46, 294912
buffer_load_dwordx4 v247, s[24:27], s49 offen sc1 lds
v_permlane16_swap_b32 v239, v237
v_add_f32 v240, v240, v238
v_add_f32 v239, v239, v237
v_mfma_f32_16x16x32_bf16 v[184:187], v[92:95], v[16:19], v[184:187]
v_rcp_f32 v240, v240
v_rcp_f32 v239, v239
v_mul_f32 v246, v246, v240
v_mul_f32 v156, v156, v239
s_waitcnt lgkmcnt(2)
v_mfma_f32_16x16x32_bf16 v[188:191], v[96:99], v[12:15], v[188:191]
ds_read_b128 v[92:95], v248 offset:34816
v_mul_f32 v3, v3, v240
v_mul_f32 v157, v157, v239
v_mul_f32 v2, v2, v240
v_mfma_f32_16x16x32_bf16 v[192:195], v[96:99], v[16:19], v[192:195]
v_mul_f32 v158, v158, v239
v_mul_f32 v235, v235, v240
v_mul_f32 v159, v159, v239
v_mfma_f32_16x16x32_bf16 v[208:211], v[80:83], v[12:15], v[208:211]
ds_read_b128 v[96:99], v245 offset:2048
s_add_u32 m0, s48, 8192
s_add_u32 s49, s46, 303104
buffer_load_dwordx4 v247, s[24:27], s49 offen sc1 lds
v_mul_f32 v233, v233, v240
v_mul_f32 v164, v164, v239
v_mul_f32 v232, v232, v240
v_mfma_f32_16x16x32_bf16 v[212:215], v[80:83], v[16:19], v[212:215]
v_mul_f32 v165, v165, v239
v_mul_f32 v243, v243, v240
v_mul_f32 v166, v166, v239
s_setprio 2
s_waitcnt lgkmcnt(2)
v_mfma_f32_16x16x32_bf16 v[180:183], v[84:87], v[40:43], v[180:183]
ds_read_b128 v[80:83], v245 offset:3072
v_mul_f32 v242, v242, v240
v_mul_f32 v167, v167, v239
v_mul_f32 v241, v241, v240
v_mfma_f32_16x16x32_bf16 v[184:187], v[84:87], v[44:47], v[184:187]
v_mul_f32 v172, v172, v239
v_cvt_pk_bf16_f32 v156, v156, v157
v_cvt_pk_bf16_f32 v157, v158, v159
v_mfma_f32_16x16x32_bf16 v[188:191], v[88:91], v[40:43], v[188:191]
ds_read_b128 v[84:87], v245 offset:4096
s_add_u32 m0, s48, 53248
s_add_u32 s49, s46, 311296
buffer_load_dwordx4 v247, s[24:27], s49 offen sc1 lds
v_cvt_pk_bf16_f32 v158, v164, v165
v_cvt_pk_bf16_f32 v159, v166, v167
v_cvt_pk_bf16_f32 v164, v172, v246
v_mfma_f32_16x16x32_bf16 v[192:195], v[88:91], v[44:47], v[192:195]
v_cvt_pk_bf16_f32 v165, v3, v2
v_cvt_pk_bf16_f32 v166, v235, v233
v_cvt_pk_bf16_f32 v167, v232, v243
s_waitcnt lgkmcnt(2)
v_mfma_f32_16x16x32_bf16 v[208:211], v[92:95], v[40:43], v[208:211]
ds_read_b128 v[88:91], v248 offset:12288
v_cvt_pk_bf16_f32 v172, v242, v241
v_mov_b32 v173, 0
s_mul_i32 s50, s42, 5120
s_add_u32 s50, s50, 73728
v_mul_u32_u24 v253, 160, v251
v_mad_u32_u24 v253, v252, 40, v253
v_add_u32 v253, s50, v253
ds_write_b64 v253, v[156:157] offset:0
ds_write_b64 v253, v[158:159] offset:8
ds_write_b64 v253, v[164:165] offset:16
ds_write_b64 v253, v[166:167] offset:24
ds_write_b64 v253, v[172:173] offset:32
v_mfma_f32_16x16x32_bf16 v[212:215], v[92:95], v[44:47], v[212:215]
v_max3_f32 v240, v160, v161, v162
v_max3_f32 v240, v240, v163, v168
v_max3_f32 v240, v240, v169, v170
s_setprio 1
v_mfma_f32_16x16x32_bf16 v[180:183], v[96:99], v[48:51], v[180:183]
ds_read_b128 v[92:95], v248 offset:13312
s_add_u32 m0, s48, 61440
s_add_u32 s49, s46, 319488
buffer_load_dwordx4 v247, s[24:27], s49 offen sc1 lds
v_max3_f32 v240, v240, v171, v176
v_min3_f32 v239, v160, v161, v162
v_min3_f32 v239, v239, v163, v168
v_mfma_f32_16x16x32_bf16 v[184:187], v[96:99], v[52:55], v[184:187]
v_min3_f32 v239, v239, v169, v170
v_min3_f32 v239, v239, v171, v176
v_mov_b32 v238, v240
v_mov_b32 v237, v239
s_waitcnt lgkmcnt(7)
v_mfma_f32_16x16x32_bf16 v[188:191], v[80:83], v[48:51], v[188:191]
ds_read_b128 v[96:99], v248 offset:14336
v_permlane16_swap_b32 v240, v238
v_permlane16_swap_b32 v239, v237
v_max_f32 v240, v240, v238
v_mfma_f32_16x16x32_bf16 v[192:195], v[80:83], v[52:55], v[192:195]
v_min_f32 v239, v239, v237
v_sub_f32 v246, v160, v240
v_sub_f32 v160, v239, v160
v_mfma_f32_16x16x32_bf16 v[208:211], v[84:87], v[48:51], v[208:211]
ds_read_b128 v[80:83], v248 offset:18432
v_exp_f32 v246, v246
v_exp_f32 v160, v160
v_sub_f32 v3, v161, v240
v_mfma_f32_16x16x32_bf16 v[212:215], v[84:87], v[52:55], v[212:215]
v_sub_f32 v161, v239, v161
v_exp_f32 v3, v3
v_exp_f32 v161, v161
s_setprio 0
s_waitcnt lgkmcnt(2)
v_mfma_f32_16x16x32_bf16 v[180:183], v[88:91], v[20:23], v[180:183]
ds_read_b128 v[84:87], v248 offset:19456
v_sub_f32 v2, v162, v240
v_sub_f32 v162, v239, v162
v_exp_f32 v2, v2
v_mfma_f32_16x16x32_bf16 v[184:187], v[88:91], v[24:27], v[184:187]
v_exp_f32 v162, v162
v_sub_f32 v235, v163, v240
v_sub_f32 v163, v239, v163
v_mfma_f32_16x16x32_bf16 v[188:191], v[92:95], v[20:23], v[188:191]
ds_read_b128 v[88:91], v248 offset:36864
v_exp_f32 v235, v235
v_exp_f32 v163, v163
v_sub_f32 v233, v168, v240
v_mfma_f32_16x16x32_bf16 v[192:195], v[92:95], v[24:27], v[192:195]
v_sub_f32 v168, v239, v168
v_exp_f32 v233, v233
v_exp_f32 v168, v168
s_waitcnt lgkmcnt(2)
v_mfma_f32_16x16x32_bf16 v[208:211], v[96:99], v[20:23], v[208:211]
ds_read_b128 v[92:95], v248 offset:40960
v_sub_f32 v232, v169, v240
v_sub_f32 v169, v239, v169
v_exp_f32 v232, v232
v_mfma_f32_16x16x32_bf16 v[212:215], v[96:99], v[24:27], v[212:215]
v_exp_f32 v169, v169
v_sub_f32 v243, v170, v240
v_sub_f32 v170, v239, v170
s_waitcnt vmcnt(1)
s_barrier
s_setprio 3
v_mfma_f32_16x16x32_bf16 v[180:183], v[80:83], v[56:59], v[180:183]
ds_read_b128 v[96:99], v248 offset:41984
s_add_u32 m0, s48, 24576
s_add_u32 s49, s46, 327680
buffer_load_dwordx4 v247, s[24:27], s49 offen sc1 lds
v_exp_f32 v243, v243
v_exp_f32 v170, v170
v_mfma_f32_16x16x32_bf16 v[184:187], v[80:83], v[60:63], v[184:187]
v_sub_f32 v242, v171, v240
v_sub_f32 v171, v239, v171
v_exp_f32 v242, v242
s_waitcnt lgkmcnt(2)
v_mfma_f32_16x16x32_bf16 v[188:191], v[84:87], v[56:59], v[188:191]
ds_read_b128 v[80:83], v248 offset:43008
v_exp_f32 v171, v171
v_sub_f32 v241, v176, v240
v_sub_f32 v176, v239, v176
v_mfma_f32_16x16x32_bf16 v[192:195], v[84:87], v[60:63], v[192:195]
v_exp_f32 v241, v241
v_exp_f32 v176, v176
v_mfma_f32_16x16x32_bf16 v[208:211], v[88:91], v[56:59], v[208:211]
ds_read_b128 v[84:87], v248 offset:47104
v_add_f32 v240, v246, v3
v_add_f32 v239, v160, v161
v_add_f32 v240, v240, v2
v_mfma_f32_16x16x32_bf16 v[212:215], v[88:91], v[60:63], v[212:215]
v_add_f32 v239, v239, v162
v_add_f32 v240, v240, v235
s_waitcnt lgkmcnt(2)
v_mfma_f32_16x16x32_bf16 v[180:183], v[92:95], v[100:103], v[180:183]
ds_read_b128 v[88:91], v248 offset:48128
v_add_f32 v239, v239, v163
v_add_f32 v240, v240, v233
v_add_f32 v239, v239, v168
v_mfma_f32_16x16x32_bf16 v[184:187], v[92:95], v[104:107], v[184:187]
v_add_f32 v240, v240, v232
v_add_f32 v239, v239, v169
s_setprio 2
v_mfma_f32_16x16x32_bf16 v[188:191], v[96:99], v[100:103], v[188:191]
ds_read_b128 v[92:95], v248 offset:49152
s_add_u32 m0, s48, 32768
s_add_u32 s49, s46, 335872
buffer_load_dwordx4 v247, s[24:27], s49 offen sc1 lds
v_add_f32 v240, v240, v243
v_add_f32 v239, v239, v170
v_mfma_f32_16x16x32_bf16 v[192:195], v[96:99], v[104:107], v[192:195]
v_add_f32 v240, v240, v242
v_add_f32 v239, v239, v171
s_waitcnt lgkmcnt(2)
v_mfma_f32_16x16x32_bf16 v[208:211], v[80:83], v[100:103], v[208:211]
ds_read_b128 v[96:99], v248 offset:0
v_add_f32 v240, v240, v241
v_add_f32 v239, v239, v176
v_mov_b32 v238, v240
v_mfma_f32_16x16x32_bf16 v[212:215], v[80:83], v[104:107], v[212:215]
v_mov_b32 v237, v239
v_permlane16_swap_b32 v240, v238
v_mfma_f32_16x16x32_bf16 v[180:183], v[84:87], v[108:111], v[180:183]
ds_read_b128 v[80:83], v248 offset:1024
v_permlane16_swap_b32 v239, v237
v_add_f32 v240, v240, v238
v_add_f32 v239, v239, v237
v_mfma_f32_16x16x32_bf16 v[184:187], v[84:87], v[112:115], v[184:187]
v_rcp_f32 v240, v240
v_rcp_f32 v239, v239
s_waitcnt lgkmcnt(2)
v_mfma_f32_16x16x32_bf16 v[188:191], v[88:91], v[108:111], v[188:191]
ds_read_b128 v[84:87], v248 offset:2048
v_mul_f32 v246, v246, v240
v_mul_f32 v160, v160, v239
v_mul_f32 v3, v3, v240
v_mfma_f32_16x16x32_bf16 v[192:195], v[88:91], v[112:115], v[192:195]
v_mul_f32 v161, v161, v239
v_mul_f32 v2, v2, v240
s_setprio 1
v_mfma_f32_16x16x32_bf16 v[208:211], v[92:95], v[108:111], v[208:211]
ds_read_b128 v[88:91], v248 offset:6144
s_add_u32 m0, s48, 69632
s_add_u32 s49, s46, 344064
buffer_load_dwordx4 v247, s[24:27], s49 offen sc1 lds
v_mul_f32 v162, v162, v239
v_mul_f32 v235, v235, v240
v_mfma_f32_16x16x32_bf16 v[212:215], v[92:95], v[112:115], v[212:215]
v_mul_f32 v163, v163, v239
v_mul_f32 v233, v233, v240
v_mul_f32 v168, v168, v239
s_waitcnt lgkmcnt(2)
v_mfma_f32_16x16x32_bf16 v[180:183], v[96:99], v[28:31], v[180:183]
ds_read_b128 v[92:95], v248 offset:7168
v_mul_f32 v232, v232, v240
v_mul_f32 v169, v169, v239
v_mfma_f32_16x16x32_bf16 v[184:187], v[96:99], v[32:35], v[184:187]
v_mul_f32 v243, v243, v240
v_mul_f32 v170, v170, v239
v_mfma_f32_16x16x32_bf16 v[188:191], v[80:83], v[28:31], v[188:191]
ds_read_b128 v[96:99], v248 offset:8192
v_mul_f32 v242, v242, v240
v_mul_f32 v171, v171, v239
v_mul_f32 v241, v241, v240
v_mfma_f32_16x16x32_bf16 v[192:195], v[80:83], v[32:35], v[192:195]
v_mul_f32 v176, v176, v239
v_cvt_pk_bf16_f32 v160, v160, v161
s_waitcnt lgkmcnt(2)
v_mfma_f32_16x16x32_bf16 v[208:211], v[84:87], v[28:31], v[208:211]
ds_read_b128 v[80:83], v248 offset:20480
v_cvt_pk_bf16_f32 v161, v162, v163
v_cvt_pk_bf16_f32 v162, v168, v169
v_cvt_pk_bf16_f32 v163, v170, v171
v_mfma_f32_16x16x32_bf16 v[212:215], v[84:87], v[32:35], v[212:215]
v_cvt_pk_bf16_f32 v168, v176, v246
v_cvt_pk_bf16_f32 v169, v3, v2
s_setprio 0
v_mfma_f32_16x16x32_bf16 v[180:183], v[88:91], v[64:67], v[180:183]
ds_read_b128 v[84:87], v248 offset:21504
v_cvt_pk_bf16_f32 v170, v235, v233
v_cvt_pk_bf16_f32 v171, v232, v243
v_cvt_pk_bf16_f32 v176, v242, v241
v_mfma_f32_16x16x32_bf16 v[184:187], v[88:91], v[68:71], v[184:187]
v_mov_b32 v177, 0
s_mul_i32 s50, s42, 5120
s_add_u32 s50, s50, 76288
v_mul_u32_u24 v253, 160, v251
v_mad_u32_u24 v253, v252, 40, v253
v_add_u32 v253, s50, v253
ds_write_b64 v253, v[160:161] offset:0
ds_write_b64 v253, v[162:163] offset:8
ds_write_b64 v253, v[168:169] offset:16
ds_write_b64 v253, v[170:171] offset:24
ds_write_b64 v253, v[176:177] offset:32
s_waitcnt lgkmcnt(7)
v_mfma_f32_16x16x32_bf16 v[188:191], v[92:95], v[64:67], v[188:191]
ds_read_b128 v[88:91], v248 offset:22528
v_mfma_f32_16x16x32_bf16 v[192:195], v[92:95], v[68:71], v[192:195]
v_mfma_f32_16x16x32_bf16 v[208:211], v[96:99], v[64:67], v[208:211]
ds_read_b128 v[92:95], v248 offset:55296
v_mfma_f32_16x16x32_bf16 v[212:215], v[96:99], v[68:71], v[212:215]
s_waitcnt vmcnt(1)
s_waitcnt lgkmcnt(2)
s_barrier
s_setprio 3
s_lshl_b32 s50, s41, 7
s_add_u32 s50, s50, 46141440
v_min_u32 v255, 15, v1
v_lshlrev_b32 v255, 3, v255
buffer_load_dwordx2 v[2:3], v255, s[24:27], s50 offen sc1
v_mfma_f32_16x16x32_bf16 v[180:183], v[80:83], v[116:119], v[180:183]
ds_read_b128 v[96:99], v248 offset:56320
s_add_u32 m0, s48, 4096
s_add_u32 s49, s46, 352256
buffer_load_dwordx4 v247, s[24:27], s49 offen sc1 lds
v_lshl_add_u32 v255, v252, 2, v250
s_lshr_b32 s50, s42, 1
s_mul_i32 s51, s50, 80
s_add_u32 s51, s51, 73728
v_mul_u32_u24 v254, 160, v255
v_lshl_add_u32 v253, v249, 3, v254
v_add_u32 v232, s51, v253
s_lshl_b32 s51, s50, 5
s_add_u32 s51, s51, 144
v_lshl_add_u32 v254, v249, 3, s51
s_add_u32 s51, s51, 32
v_mov_b32 v253, s51
v_cmp_eq_u32 vcc, 0, v249
v_mov_b32 v233, 0x120
s_nop 0
v_cndmask_b32 v253, v233, v253, vcc
s_and_b32 s52, s42, 1
s_cmp_eq_u32 s52, 1
s_cselect_b64 vcc, -1, 0
v_cndmask_b32 v254, v254, v253, vcc
v_mul_u32_u24 v255, 304, v255
v_add_u32 v255, 114688, v255
v_add_u32 v233, v255, v254
v_mfma_f32_16x16x32_bf16 v[184:187], v[80:83], v[120:123], v[184:187]
ds_read_b64_tr_b16 v[168:169], v233 offset:0
ds_read_b64_tr_b16 v[170:171], v233 offset:4864
ds_read_b64_tr_b16 v[172:173], v232 offset:0
ds_read_b64_tr_b16 v[174:175], v232 offset:2560
ds_read_b64_tr_b16 v[176:177], v232 offset:32
ds_read_b64_tr_b16 v[178:179], v232 offset:2592
ds_read_b64_tr_b16 v[216:217], v232 offset:64
ds_read_b64_tr_b16 v[218:219], v232 offset:2624
v_mfma_f32_16x16x32_bf16 v[188:191], v[84:87], v[116:119], v[188:191]
ds_read_b128 v[80:83], v248 offset:57344
s_waitcnt lgkmcnt(1)
v_mfma_f32_16x16x32_bf16 v[156:159], v[172:175], v[168:171], 0
v_mfma_f32_16x16x32_bf16 v[160:163], v[176:179], v[168:171], 0
v_mfma_f32_16x16x32_bf16 v[164:167], v[216:219], v[168:171], 0
v_mfma_f32_16x16x32_bf16 v[192:195], v[84:87], v[120:123], v[192:195]
v_mfma_f32_16x16x32_bf16 v[208:211], v[88:91], v[116:119], v[208:211]
ds_read_b128 v[84:87], v248 offset:61440
s_add_u32 m0, s48, 16384
s_add_u32 s49, s46, 360448
buffer_load_dwordx4 v247, s[24:27], s49 offen sc1 lds
v_mfma_f32_16x16x32_bf16 v[212:215], v[88:91], v[120:123], v[212:215]
ds_read_b64_tr_b16 v[168:169], v233 offset:9728
ds_read_b64_tr_b16 v[170:171], v233 offset:14592
ds_read_b64_tr_b16 v[172:173], v232 offset:5120
ds_read_b64_tr_b16 v[174:175], v232 offset:7680
ds_read_b64_tr_b16 v[176:177], v232 offset:5152
ds_read_b64_tr_b16 v[178:179], v232 offset:7712
ds_read_b64_tr_b16 v[216:217], v232 offset:5184
ds_read_b64_tr_b16 v[218:219], v232 offset:7744
s_setprio 2
v_mfma_f32_16x16x32_bf16 v[180:183], v[92:95], v[196:199], v[180:183]
ds_read_b128 v[88:91], v248 offset:62464
s_waitcnt lgkmcnt(1)
v_mfma_f32_16x16x32_bf16 v[156:159], v[172:175], v[168:171], v[156:159]
v_mfma_f32_16x16x32_bf16 v[160:163], v[176:179], v[168:171], v[160:163]
v_mfma_f32_16x16x32_bf16 v[164:167], v[216:219], v[168:171], v[164:167]
v_mfma_f32_16x16x32_bf16 v[184:187], v[92:95], v[200:203], v[184:187]
v_mfma_f32_16x16x32_bf16 v[188:191], v[96:99], v[196:199], v[188:191]
ds_read_b128 v[92:95], v248 offset:63488
s_add_u32 m0, s48, 40960
s_add_u32 s49, s46, 368640
buffer_load_dwordx4 v247, s[24:27], s49 offen sc1 lds
v_mfma_f32_16x16x32_bf16 v[192:195], v[96:99], v[200:203], v[192:195]
ds_read_b64_tr_b16 v[168:169], v233 offset:19456
ds_read_b64_tr_b16 v[170:171], v233 offset:24320
ds_read_b64_tr_b16 v[172:173], v232 offset:10240
ds_read_b64_tr_b16 v[174:175], v232 offset:12800
ds_read_b64_tr_b16 v[176:177], v232 offset:10272
ds_read_b64_tr_b16 v[178:179], v232 offset:12832
ds_read_b64_tr_b16 v[216:217], v232 offset:10304
ds_read_b64_tr_b16 v[218:219], v232 offset:12864
v_mfma_f32_16x16x32_bf16 v[208:211], v[80:83], v[196:199], v[208:211]
ds_read_b128 v[96:99], v248 offset:14336
s_waitcnt lgkmcnt(1)
v_mfma_f32_16x16x32_bf16 v[156:159], v[172:175], v[168:171], v[156:159]
v_mfma_f32_16x16x32_bf16 v[160:163], v[176:179], v[168:171], v[160:163]
v_mfma_f32_16x16x32_bf16 v[164:167], v[216:219], v[168:171], v[164:167]
v_mfma_f32_16x16x32_bf16 v[212:215], v[80:83], v[200:203], v[212:215]
s_setprio 1
v_mfma_f32_16x16x32_bf16 v[180:183], v[84:87], v[36:39], v[180:183]
ds_read_b128 v[80:83], v248 offset:15360
s_add_u32 m0, s48, 49152
s_add_u32 s49, s46, 376832
buffer_load_dwordx4 v247, s[24:27], s49 offen sc1 lds
ds_read_b64_tr_b16 v[168:169], v233 offset:29184
ds_read_b64_tr_b16 v[170:171], v233 offset:34048
ds_read_b64_tr_b16 v[172:173], v232 offset:15360
ds_read_b64_tr_b16 v[174:175], v232 offset:17920
ds_read_b64_tr_b16 v[176:177], v232 offset:15392
ds_read_b64_tr_b16 v[178:179], v232 offset:17952
ds_read_b64_tr_b16 v[216:217], v232 offset:15424
ds_read_b64_tr_b16 v[218:219], v232 offset:17984
v_mfma_f32_16x16x32_bf16 v[184:187], v[84:87], v[72:75], v[184:187]
s_waitcnt lgkmcnt(0)
v_mfma_f32_16x16x32_bf16 v[156:159], v[172:175], v[168:171], v[156:159]
v_mfma_f32_16x16x32_bf16 v[160:163], v[176:179], v[168:171], v[160:163]
v_mfma_f32_16x16x32_bf16 v[164:167], v[216:219], v[168:171], v[164:167]
v_mfma_f32_16x16x32_bf16 v[188:191], v[88:91], v[36:39], v[188:191]
ds_read_b128 v[84:87], v248 offset:24576
v_mov_b32 v253, 7936
v_min_u32 v255, v253, v244
v_cmp_gt_u32 vcc, 2, v252
s_nop 1
v_cndmask_b32 v254, v253, v255, vcc
v_add_u32 v255, 155776, v255
v_add_u32 v254, 155776, v254
v_cvt_pk_bf16_f32 v156, v156, v157
v_cvt_pk_bf16_f32 v157, v158, v159
ds_write_b64 v255, v[156:157] offset:0
v_cvt_pk_bf16_f32 v160, v160, v161
v_cvt_pk_bf16_f32 v161, v162, v163
ds_write_b64 v255, v[160:161] offset:32
v_cvt_pk_bf16_f32 v164, v164, v165
v_cvt_pk_bf16_f32 v165, v166, v167
ds_write_b64 v254, v[164:165] offset:64
v_mfma_f32_16x16x32_bf16 v[192:195], v[88:91], v[72:75], v[192:195]
v_mfma_f32_16x16x32_bf16 v[208:211], v[92:95], v[36:39], v[208:211]
ds_read_b128 v[88:91], v248 offset:28672
v_mfma_f32_16x16x32_bf16 v[212:215], v[92:95], v[72:75], v[212:215]
s_setprio 0
v_mfma_f32_16x16x32_bf16 v[180:183], v[96:99], v[76:79], v[180:183]
ds_read_b128 v[92:95], v248 offset:29696
v_mfma_f32_16x16x32_bf16 v[184:187], v[96:99], v[204:207], v[184:187]
v_mfma_f32_16x16x32_bf16 v[188:191], v[80:83], v[76:79], v[188:191]
ds_read_b128 v[96:99], v248 offset:30720
v_mfma_f32_16x16x32_bf16 v[192:195], v[80:83], v[204:207], v[192:195]
s_waitcnt lgkmcnt(6)
v_mfma_f32_16x16x32_bf16 v[208:211], v[84:87], v[76:79], v[208:211]
ds_read_b128 v[80:83], v248 offset:34816
v_mfma_f32_16x16x32_bf16 v[212:215], v[84:87], v[204:207], v[212:215]
s_waitcnt vmcnt(4)
s_mov_b32 s52, 0
L_spa0_3:
v_cmp_ne_u64 vcc, s[98:99], v[2:3]
s_nop 1
s_cmp_eq_u64 vcc, 0
s_cbranch_scc1 L_spa0_3x
s_add_u32 s52, s52, 1
s_cmp_ge_u32 s52, 0x10000
s_cbranch_scc1 L_spa0_3x
s_sleep 2
s_lshl_b32 s50, s41, 7
s_add_u32 s50, s50, 46141440
v_min_u32 v255, 15, v1
v_lshlrev_b32 v255, 3, v255
buffer_load_dwordx2 v[2:3], v255, s[24:27], s50 offen sc1
s_waitcnt vmcnt(0)
s_branch L_spa0_3
L_spa0_3x:
s_waitcnt vmcnt(1)
s_waitcnt lgkmcnt(4)
s_barrier
s_setprio 3
v_add_u32 v255, 155776, v247
ds_read_b128 v[216:219], v255
s_waitcnt lgkmcnt(3)
v_mfma_f32_16x16x32_bf16 v[156:159], v[88:91], v[124:127], 0
ds_read_b128 v[84:87], v248 offset:35840
s_add_u32 m0, s48, 20480
s_add_u32 s49, s46, 385024
buffer_load_dwordx4 v247, s[24:27], s49 offen sc1 lds
v_mfma_f32_16x16x32_bf16 v[160:163], v[88:91], v[128:131], 0
s_waitcnt lgkmcnt(1)
s_lshl_b32 s50, s41, 6
s_add_u32 s50, s50, s40
s_mul_i32 s50, s50, 3072
s_add_u32 s50, s50, 40992768
s_cmp_lt_u32 s42, 3
s_cselect_b32 s51, 0, 1879048192
v_add_u32 v255, s51, v247
buffer_store_dwordx4 v[216:219], v255, s[24:27], s50 offen sc1
v_mfma_f32_16x16x32_bf16 v[164:167], v[92:95], v[124:127], 0
ds_read_b128 v[88:91], v245 offset:0
s_add_u32 m0, s48, 53248
s_add_u32 s49, s46, 393216
buffer_load_dwordx4 v247, s[24:27], s49 offen sc1 lds
v_max3_f32 v241, v180, v181, v182
v_max3_f32 v241, v241, v183, v188
v_mfma_f32_16x16x32_bf16 v[168:171], v[92:95], v[128:131], 0
v_max3_f32 v241, v241, v189, v190
v_max3_f32 v241, v241, v191, v208
v_min3_f32 v240, v180, v181, v182
v_mfma_f32_16x16x32_bf16 v[172:175], v[96:99], v[124:127], 0
ds_read_b128 v[92:95], v245 offset:4096
s_add_u32 m0, s48, 61440
s_add_u32 s49, s46, 401408
buffer_load_dwordx4 v247, s[24:27], s49 offen sc1 lds
v_min3_f32 v240, v240, v183, v188
v_min3_f32 v240, v240, v189, v190
v_mfma_f32_16x16x32_bf16 v[176:179], v[96:99], v[128:131], 0
v_min3_f32 v240, v240, v191, v208
v_mov_b32 v239, v241
v_mov_b32 v238, v240
v_mfma_f32_16x16x32_bf16 v[156:159], v[80:83], v[132:135], v[156:159]
ds_read_b128 v[96:99], v245 offset:5120
s_add_u32 m0, s48, 77824
s_add_u32 s49, s46, 409600
buffer_load_dwordx4 v247, s[24:27], s49 offen sc1 lds
v_permlane16_swap_b32 v241, v239
v_permlane16_swap_b32 v240, v238
v_mfma_f32_16x16x32_bf16 v[160:163], v[80:83], v[136:139], v[160:163]
v_max_f32 v241, v241, v239
v_min_f32 v240, v240, v238
v_sub_f32 v246, v180, v241
s_setprio 2
s_waitcnt lgkmcnt(2)
v_mfma_f32_16x16x32_bf16 v[164:167], v[84:87], v[132:135], v[164:167]
ds_read_b128 v[80:83], v245 offset:6144
s_add_u32 m0, s48, 86016
s_add_u32 s49, s46, 417792
buffer_load_dwordx4 v247, s[24:27], s49 offen sc1 lds
v_sub_f32 v180, v240, v180
v_exp_f32 v246, v246
v_mfma_f32_16x16x32_bf16 v[168:171], v[84:87], v[136:139], v[168:171]
v_exp_f32 v180, v180
v_sub_f32 v244, v181, v241
v_mfma_f32_16x16x32_bf16 v[172:175], v[88:91], v[132:135], v[172:175]
ds_read_b128 v[84:87], v248 offset:2048
s_add_u32 m0, s48, 94208
s_add_u32 s49, s46, 425984
buffer_load_dwordx4 v247, s[24:27], s49 offen sc1 lds
v_sub_f32 v181, v240, v181
v_exp_f32 v244, v244
v_mfma_f32_16x16x32_bf16 v[176:179], v[88:91], v[136:139], v[176:179]
v_exp_f32 v181, v181
v_sub_f32 v3, v182, v241
v_sub_f32 v182, v240, v182
s_waitcnt lgkmcnt(2)
v_mfma_f32_16x16x32_bf16 v[156:159], v[92:95], v[140:143], v[156:159]
ds_read_b128 v[88:91], v248 offset:3072
s_add_u32 m0, s48, 102400
s_add_u32 s49, s46, 434176
buffer_load_dwordx4 v247, s[24:27], s49 offen sc1 lds
v_exp_f32 v3, v3
v_exp_f32 v182, v182
v_mfma_f32_16x16x32_bf16 v[160:163], v[92:95], v[144:147], v[160:163]
v_sub_f32 v2, v183, v241
v_sub_f32 v183, v240, v183
v_exp_f32 v2, v2
v_mfma_f32_16x16x32_bf16 v[164:167], v[96:99], v[140:143], v[164:167]
ds_read_b128 v[92:95], v248 offset:4096
v_exp_f32 v183, v183
v_sub_f32 v235, v188, v241
v_sub_f32 v188, v240, v188
v_mfma_f32_16x16x32_bf16 v[168:171], v[96:99], v[144:147], v[168:171]
v_exp_f32 v235, v235
v_exp_f32 v188, v188
s_setprio 1
s_waitcnt lgkmcnt(2)
v_mfma_f32_16x16x32_bf16 v[172:175], v[80:83], v[140:143], v[172:175]
ds_read_b128 v[96:99], v248 offset:8192
v_sub_f32 v233, v189, v241
v_sub_f32 v189, v240, v189
v_exp_f32 v233, v233
v_mfma_f32_16x16x32_bf16 v[176:179], v[80:83], v[144:147], v[176:179]
v_exp_f32 v189, v189
v_sub_f32 v232, v190, v241
v_mfma_f32_16x16x32_bf16 v[156:159], v[84:87], v[148:151], v[156:159]
ds_read_b128 v[80:83], v248 offset:9216
v_sub_f32 v190, v240, v190
v_exp_f32 v232, v232
v_exp_f32 v190, v190
v_mfma_f32_16x16x32_bf16 v[160:163], v[84:87], v[152:155], v[160:163]
v_sub_f32 v243, v191, v241
v_and_b32 v255, 1, v1
v_lshlrev_b32 v255, 4, v255
v_mov_b32 v254, 0x3f80
v_lshlrev_b32 v255, v255, v254
v_lshrrev_b32 v254, 1, v251
v_cmp_eq_u32 vcc, 0, v254
s_nop 1
v_cndmask_b32 v124, 0, v255, vcc
v_cmp_eq_u32 vcc, 1, v254
s_nop 1
v_cndmask_b32 v125, 0, v255, vcc
v_cmp_eq_u32 vcc, 2, v254
s_nop 1
v_cndmask_b32 v126, 0, v255, vcc
v_cmp_eq_u32 vcc, 3, v254
s_nop 1
v_cndmask_b32 v127, 0, v255, vcc
v_cmp_eq_u32 vcc, 4, v254
s_nop 1
v_cndmask_b32 v128, 0, v255, vcc
v_cmp_eq_u32 vcc, 5, v254
s_nop 1
v_cndmask_b32 v129, 0, v255, vcc
v_cmp_eq_u32 vcc, 6, v254
s_nop 1
v_cndmask_b32 v130, 0, v255, vcc
v_cmp_eq_u32 vcc, 7, v254
s_nop 1
v_cndmask_b32 v131, 0, v255, vcc
v_lshlrev_b32 v255, 4, v251
v_lshl_add_u32 v237, v252, 10, v255
s_waitcnt lgkmcnt(2)
v_mfma_f32_16x16x32_bf16 v[164:167], v[88:91], v[148:151], v[164:167]
ds_read_b128 v[84:87], v248 offset:10240
v_sub_f32 v191, v240, v191
v_exp_f32 v243, v243
v_exp_f32 v191, v191
v_mfma_f32_16x16x32_bf16 v[168:171], v[88:91], v[152:155], v[168:171]
v_sub_f32 v242, v208, v241
v_sub_f32 v208, v240, v208
v_mfma_f32_16x16x32_bf16 v[172:175], v[92:95], v[148:151], v[172:175]
ds_read_b128 v[88:91], v248 offset:18432
v_exp_f32 v242, v242
v_exp_f32 v208, v208
v_add_f32 v241, v246, v244
v_mfma_f32_16x16x32_bf16 v[176:179], v[92:95], v[152:155], v[176:179]
v_add_f32 v240, v180, v181
v_add_f32 v241, v241, v3
s_setprio 0
s_waitcnt lgkmcnt(2)
v_mfma_f32_16x16x32_bf16 v[156:159], v[96:99], v[4:7], v[156:159]
ds_read_b128 v[92:95], v248 offset:19456
v_add_f32 v240, v240, v182
v_add_f32 v241, v241, v2
v_add_f32 v240, v240, v183
v_mfma_f32_16x16x32_bf16 v[160:163], v[96:99], v[8:11], v[160:163]
v_add_f32 v241, v241, v235
v_add_f32 v240, v240, v188
v_mul_u32_u24 v255, 3072, v252
v_lshl_add_u32 v255, v251, 4, v255
s_mul_i32 s50, s42, 768
s_mul_i32 s51, s41, 196608
s_add_u32 s51, s51, s50
s_add_u32 s50, s51, 40894464
buffer_load_dwordx4 v[132:135], v255, s[24:27], s50 offen offset:0 sc1
buffer_load_dwordx4 v[136:139], v255, s[24:27], s50 offen offset:256 sc1
buffer_load_dwordx4 v[140:143], v255, s[24:27], s50 offen offset:512 sc1
s_add_u32 s50, s51, 40906752
buffer_load_dwordx4 v[144:147], v255, s[24:27], s50 offen offset:0 sc1
buffer_load_dwordx4 v[148:151], v255, s[24:27], s50 offen offset:256 sc1
buffer_load_dwordx4 v[152:155], v255, s[24:27], s50 offen offset:512 sc1
v_mfma_f32_16x16x32_bf16 v[164:167], v[80:83], v[4:7], v[164:167]
ds_read_b128 v[96:99], v248 offset:36864
v_add_f32 v241, v241, v233
v_add_f32 v240, v240, v189
v_add_f32 v241, v241, v232
v_mfma_f32_16x16x32_bf16 v[168:171], v[80:83], v[8:11], v[168:171]
v_add_f32 v240, v240, v190
v_add_f32 v241, v241, v243
s_waitcnt lgkmcnt(2)
v_mfma_f32_16x16x32_bf16 v[172:175], v[84:87], v[4:7], v[172:175]
ds_read_b128 v[80:83], v248 offset:40960
v_add_f32 v240, v240, v191
v_add_f32 v241, v241, v242
v_mfma_f32_16x16x32_bf16 v[176:179], v[84:87], v[8:11], v[176:179]
v_add_f32 v240, v240, v208
v_mov_b32 v239, v241
s_waitcnt vmcnt(12)
s_waitcnt vmcnt(11)
s_barrier
s_setprio 3
v_mfma_f32_16x16x32_bf16 v[156:159], v[88:91], v[12:15], v[156:159]
ds_read_b128 v[84:87], v248 offset:41984
v_mov_b32 v238, v240
v_permlane16_swap_b32 v241, v239
s_nop 0
v_permlane16_swap_b32 v240, v238
v_mfma_f32_16x16x32_bf16 v[160:163], v[88:91], v[16:19], v[160:163]
v_add_f32 v241, v241, v239
v_add_f32 v240, v240, v238
v_rcp_f32 v241, v241
s_waitcnt lgkmcnt(2)
v_mfma_f32_16x16x32_bf16 v[164:167], v[92:95], v[12:15], v[164:167]
ds_read_b128 v[88:91], v248 offset:43008
v_rcp_f32 v240, v240
v_mul_f32 v246, v246, v241
v_mul_f32 v180, v180, v240
v_mfma_f32_16x16x32_bf16 v[168:171], v[92:95], v[16:19], v[168:171]
v_mul_f32 v244, v244, v241
v_mul_f32 v181, v181, v240
v_mul_f32 v3, v3, v241
v_mfma_f32_16x16x32_bf16 v[172:175], v[96:99], v[12:15], v[172:175]
ds_read_b128 v[92:95], v248 offset:47104
v_mul_f32 v182, v182, v240
v_mul_f32 v2, v2, v241
v_mul_f32 v183, v183, v240
v_mfma_f32_16x16x32_bf16 v[176:179], v[96:99], v[16:19], v[176:179]
v_mul_f32 v235, v235, v241
v_mul_f32 v188, v188, v240
v_mul_f32 v233, v233, v241
s_setprio 2
s_waitcnt lgkmcnt(2)
v_mfma_f32_16x16x32_bf16 v[156:159], v[80:83], v[40:43], v[156:159]
ds_read_b128 v[96:99], v248 offset:48128
v_mul_f32 v189, v189, v240
v_mul_f32 v232, v232, v241
v_mul_f32 v190, v190, v240
v_mul_f32 v243, v243, v241
v_mfma_f32_16x16x32_bf16 v[160:163], v[80:83], v[44:47], v[160:163]
v_mul_f32 v191, v191, v240
v_mul_f32 v242, v242, v241
v_mul_u32_u24 v255, 3072, v252
v_lshl_add_u32 v255, v251, 4, v255
s_mul_i32 s50, s42, 768
s_mul_i32 s51, s41, 196608
s_add_u32 s51, s51, s50
s_add_u32 s50, s51, 40919040
buffer_load_dwordx4 v[4:7], v255, s[24:27], s50 offen offset:0 sc1
buffer_load_dwordx4 v[8:11], v255, s[24:27], s50 offen offset:256 sc1
buffer_load_dwordx4 v[12:15], v255, s[24:27], s50 offen offset:512 sc1
s_add_u32 s50, s51, 40931328
buffer_load_dwordx4 v[16:19], v255, s[24:27], s50 offen offset:0 sc1
buffer_load_dwordx4 v[216:219], v255, s[24:27], s50 offen offset:256 sc1
buffer_load_dwordx4 v[220:223], v255, s[24:27], s50 offen offset:512 sc1
v_mfma_f32_16x16x32_bf16 v[164:167], v[84:87], v[40:43], v[164:167]
ds_read_b128 v[80:83], v248 offset:49152
v_mul_f32 v208, v208, v240
v_cvt_pk_bf16_f32 v180, v180, v181
v_cvt_pk_bf16_f32 v181, v182, v183
v_mfma_f32_16x16x32_bf16 v[168:171], v[84:87], v[44:47], v[168:171]
v_cvt_pk_bf16_f32 v182, v188, v189
v_cvt_pk_bf16_f32 v183, v190, v191
v_cvt_pk_bf16_f32 v188, v208, v246
s_waitcnt lgkmcnt(2)
v_mfma_f32_16x16x32_bf16 v[172:175], v[88:91], v[40:43], v[172:175]
ds_read_b128 v[84:87], v248 offset:12288
v_cvt_pk_bf16_f32 v189, v244, v3
v_cvt_pk_bf16_f32 v190, v2, v235
v_cvt_pk_bf16_f32 v191, v233, v232
v_mfma_f32_16x16x32_bf16 v[176:179], v[88:91], v[44:47], v[176:179]
v_cvt_pk_bf16_f32 v208, v243, v242
v_mov_b32 v209, 0
v_mov_b32 v210, 0
s_setprio 1
v_mfma_f32_16x16x32_bf16 v[156:159], v[92:95], v[48:51], v[156:159]
ds_read_b128 v[88:91], v248 offset:13312
v_mov_b32 v211, 0
v_max3_f32 v241, v184, v185, v186
v_max3_f32 v241, v241, v187, v192
v_mfma_f32_16x16x32_bf16 v[160:163], v[92:95], v[52:55], v[160:163]
v_max3_f32 v241, v241, v193, v194
v_max3_f32 v241, v241, v195, v212
v_min3_f32 v240, v184, v185, v186
s_waitcnt lgkmcnt(2)
v_mfma_f32_16x16x32_bf16 v[164:167], v[96:99], v[48:51], v[164:167]
ds_read_b128 v[92:95], v248 offset:14336
v_min3_f32 v240, v240, v187, v192
v_min3_f32 v240, v240, v193, v194
v_min3_f32 v240, v240, v195, v212
v_mfma_f32_16x16x32_bf16 v[168:171], v[96:99], v[52:55], v[168:171]
v_mov_b32 v239, v241
v_mov_b32 v238, v240
s_nop 0
v_permlane16_swap_b32 v241, v239
v_mfma_f32_16x16x32_bf16 v[172:175], v[80:83], v[48:51], v[172:175]
ds_read_b128 v[96:99], v248 offset:22528
v_permlane16_swap_b32 v240, v238
v_max_f32 v241, v241, v239
v_min_f32 v240, v240, v238
v_mfma_f32_16x16x32_bf16 v[176:179], v[80:83], v[52:55], v[176:179]
v_sub_f32 v246, v184, v241
v_sub_f32 v184, v240, v184
v_exp_f32 v246, v246
s_setprio 0
s_waitcnt lgkmcnt(2)
v_mfma_f32_16x16x32_bf16 v[156:159], v[84:87], v[20:23], v[156:159]
ds_read_b128 v[80:83], v248 offset:23552
v_exp_f32 v184, v184
v_sub_f32 v244, v185, v241
v_sub_f32 v185, v240, v185
v_mfma_f32_16x16x32_bf16 v[160:163], v[84:87], v[24:27], v[160:163]
v_exp_f32 v244, v244
v_exp_f32 v185, v185
v_sub_f32 v3, v186, v241
v_mfma_f32_16x16x32_bf16 v[164:167], v[88:91], v[20:23], v[164:167]
ds_read_b128 v[84:87], v248 offset:24576
v_sub_f32 v186, v240, v186
v_exp_f32 v3, v3
v_exp_f32 v186, v186
v_mfma_f32_16x16x32_bf16 v[168:171], v[88:91], v[24:27], v[168:171]
v_sub_f32 v2, v187, v241
v_sub_f32 v187, v240, v187
v_exp_f32 v2, v2
s_waitcnt lgkmcnt(2)
v_mfma_f32_16x16x32_bf16 v[172:175], v[92:95], v[20:23], v[172:175]
ds_read_b128 v[88:91], v248 offset:53248
v_exp_f32 v187, v187
v_sub_f32 v235, v192, v241
v_sub_f32 v192, v240, v192
v_mfma_f32_16x16x32_bf16 v[176:179], v[92:95], v[24:27], v[176:179]
v_exp_f32 v235, v235
v_exp_f32 v192, v192
v_sub_f32 v233, v193, v241
s_waitcnt vmcnt(13)
s_barrier
s_setprio 3
v_mfma_f32_16x16x32_bf16 v[156:159], v[96:99], v[56:59], v[156:159]
ds_read_b128 v[92:95], v248 offset:54272
v_sub_f32 v193, v240, v193
v_exp_f32 v233, v233
v_exp_f32 v193, v193
v_mfma_f32_16x16x32_bf16 v[160:163], v[96:99], v[60:63], v[160:163]
v_sub_f32 v232, v194, v241
v_sub_f32 v194, v240, v194
s_waitcnt lgkmcnt(2)
v_mfma_f32_16x16x32_bf16 v[164:167], v[80:83], v[56:59], v[164:167]
ds_read_b128 v[96:99], v248 offset:55296
v_exp_f32 v232, v232
v_exp_f32 v194, v194
v_sub_f32 v243, v195, v241
v_mfma_f32_16x16x32_bf16 v[168:171], v[80:83], v[60:63], v[168:171]
v_sub_f32 v195, v240, v195
v_exp_f32 v243, v243
v_mfma_f32_16x16x32_bf16 v[172:175], v[84:87], v[56:59], v[172:175]
ds_read_b128 v[80:83], v248 offset:59392
v_exp_f32 v195, v195
v_sub_f32 v242, v212, v241
v_mfma_f32_16x16x32_bf16 v[176:179], v[84:87], v[60:63], v[176:179]
v_sub_f32 v212, v240, v212
v_exp_f32 v242, v242
s_waitcnt lgkmcnt(2)
v_mfma_f32_16x16x32_bf16 v[156:159], v[88:91], v[100:103], v[156:159]
ds_read_b128 v[84:87], v248 offset:60416
v_exp_f32 v212, v212
v_add_f32 v241, v246, v244
v_add_f32 v240, v184, v185
v_mfma_f32_16x16x32_bf16 v[160:163], v[88:91], v[104:107], v[160:163]
v_add_f32 v241, v241, v3
v_add_f32 v240, v240, v186
s_waitcnt vmcnt(9)
v_mfma_f32_16x16x32_bf16 v[20:23], v[124:127], v[132:135], 0
v_mfma_f32_16x16x32_bf16 v[20:23], v[128:131], v[136:139], v[20:23]
v_mfma_f32_16x16x32_bf16 v[24:27], v[124:127], v[140:143], 0
s_waitcnt vmcnt(6)
v_mfma_f32_16x16x32_bf16 v[20:23], v[124:127], v[144:147], v[20:23]
v_mfma_f32_16x16x32_bf16 v[20:23], v[128:131], v[148:151], v[20:23]
v_mfma_f32_16x16x32_bf16 v[24:27], v[124:127], v[152:155], v[24:27]
s_waitcnt vmcnt(3)
v_mfma_f32_16x16x32_bf16 v[20:23], v[124:127], v[4:7], v[20:23]
v_mfma_f32_16x16x32_bf16 v[20:23], v[128:131], v[8:11], v[20:23]
v_mfma_f32_16x16x32_bf16 v[24:27], v[124:127], v[12:15], v[24:27]
s_waitcnt vmcnt(0)
v_mfma_f32_16x16x32_bf16 v[20:23], v[124:127], v[16:19], v[20:23]
v_mfma_f32_16x16x32_bf16 v[20:23], v[128:131], v[216:219], v[20:23]
v_mfma_f32_16x16x32_bf16 v[24:27], v[124:127], v[220:223], v[24:27]
s_setprio 2
v_mfma_f32_16x16x32_bf16 v[164:167], v[92:95], v[100:103], v[164:167]
ds_read_b128 v[88:91], v248 offset:61440
v_add_f32 v241, v241, v2
v_add_f32 v240, v240, v187
v_add_f32 v241, v241, v235
v_mfma_f32_16x16x32_bf16 v[168:171], v[92:95], v[104:107], v[168:171]
v_add_f32 v240, v240, v192
v_add_f32 v241, v241, v233
s_waitcnt lgkmcnt(2)
v_mfma_f32_16x16x32_bf16 v[172:175], v[96:99], v[100:103], v[172:175]
ds_read_b128 v[92:95], v245 offset:8192
v_add_f32 v240, v240, v193
v_add_f32 v241, v241, v232
v_mfma_f32_16x16x32_bf16 v[176:179], v[96:99], v[104:107], v[176:179]
v_add_f32 v240, v240, v194
v_add_f32 v241, v241, v243
v_mfma_f32_16x16x32_bf16 v[156:159], v[80:83], v[108:111], v[156:159]
ds_read_b128 v[96:99], v245 offset:9216
v_add_f32 v240, v240, v195
v_add_f32 v241, v241, v242
v_add_f32 v240, v240, v212
v_mfma_f32_16x16x32_bf16 v[160:163], v[80:83], v[112:115], v[160:163]
v_mov_b32 v239, v241
v_mov_b32 v238, v240
s_waitcnt lgkmcnt(2)
v_mfma_f32_16x16x32_bf16 v[164:167], v[84:87], v[108:111], v[164:167]
ds_read_b128 v[80:83], v245 offset:10240
v_permlane16_swap_b32 v241, v239
v_permlane16_swap_b32 v240, v238
v_add_f32 v241, v241, v239
v_mfma_f32_16x16x32_bf16 v[168:171], v[84:87], v[112:115], v[168:171]
v_add_f32 v240, v240, v238
v_rcp_f32 v241, v241
v_lshrrev_b32 v255, 1, v252
v_lshlrev_b32 v255, 5, v255
v_lshl_add_u32 v255, v251, 1, v255
v_and_b32 v254, 1, v252
s_mul_i32 s50, s42, 96
v_add3_u32 v255, v255, v254, s50
v_cmp_gt_u32 vcc, 380, v255
v_mul_u32_u24 v254, 205, v255
v_lshrrev_b32 v254, 10, v254
v_add_u32 v254, v255, v254
v_lshlrev_b32 v254, 3, v254
v_add_u32 v254, 155776, v254
v_mov_b32 v253, 163712
v_cndmask_b32 v236, v253, v254, vcc
v_cvt_pk_bf16_f32 v20, v20, v21
v_cvt_pk_bf16_f32 v21, v22, v23
ds_write_b64 v236, v[20:21]
v_add_u32 v255, 64, v255
v_cmp_gt_u32 vcc, 380, v255
s_mov_b32 vcc_hi, 0
v_mul_u32_u24 v254, 205, v255
v_lshrrev_b32 v254, 10, v254
v_add_u32 v254, v255, v254
v_lshlrev_b32 v254, 3, v254
v_add_u32 v254, 155776, v254
v_mov_b32 v253, 163712
v_cndmask_b32 v236, v253, v254, vcc
v_cvt_pk_bf16_f32 v24, v24, v25
v_cvt_pk_bf16_f32 v25, v26, v27
ds_write_b64 v236, v[24:25]
s_setprio 1
v_mfma_f32_16x16x32_bf16 v[172:175], v[88:91], v[108:111], v[172:175]
ds_read_b128 v[84:87], v245 offset:14336
v_rcp_f32 v240, v240
v_mul_f32 v246, v246, v241
v_mfma_f32_16x16x32_bf16 v[176:179], v[88:91], v[112:115], v[176:179]
v_mul_f32 v184, v184, v240
v_mul_f32 v244, v244, v241
s_waitcnt lgkmcnt(4)
v_mfma_f32_16x16x32_bf16 v[156:159], v[92:95], v[28:31], v[156:159]
ds_read_b128 v[88:91], v245 offset:15360
v_mul_f32 v185, v185, v240
v_mul_f32 v3, v3, v241
v_mul_f32 v186, v186, v240
v_mfma_f32_16x16x32_bf16 v[160:163], v[92:95], v[32:35], v[160:163]
v_mul_f32 v2, v2, v241
v_mul_f32 v187, v187, v240
s_lshl_b32 s50, s41, 7
s_add_u32 s50, s50, 46142464
v_min_u32 v255, 15, v1
v_lshlrev_b32 v255, 3, v255
buffer_load_dwordx2 v[230:231], v255, s[24:27], s50 offen sc1
v_mfma_f32_16x16x32_bf16 v[164:167], v[96:99], v[28:31], v[164:167]
ds_read_b128 v[92:95], v245 offset:16384
v_mul_f32 v235, v235, v241
v_mul_f32 v192, v192, v240
v_mul_f32 v233, v233, v241
v_mfma_f32_16x16x32_bf16 v[168:171], v[96:99], v[32:35], v[168:171]
v_mul_f32 v193, v193, v240
v_mul_f32 v232, v232, v241
s_waitcnt lgkmcnt(2)
v_mfma_f32_16x16x32_bf16 v[172:175], v[80:83], v[28:31], v[172:175]
ds_read_b128 v[96:99], v245 offset:20480
v_mul_f32 v194, v194, v240
v_mul_f32 v243, v243, v241
v_mfma_f32_16x16x32_bf16 v[176:179], v[80:83], v[32:35], v[176:179]
v_mul_f32 v195, v195, v240
v_mul_f32 v242, v242, v241
s_setprio 0
v_mfma_f32_16x16x32_bf16 v[156:159], v[84:87], v[64:67], v[156:159]
ds_read_b128 v[80:83], v245 offset:21504
v_mul_f32 v212, v212, v240
v_cvt_pk_bf16_f32 v184, v184, v185
v_cvt_pk_bf16_f32 v185, v186, v187
v_mfma_f32_16x16x32_bf16 v[160:163], v[84:87], v[68:71], v[160:163]
v_cvt_pk_bf16_f32 v186, v192, v193
v_cvt_pk_bf16_f32 v187, v194, v195
s_waitcnt lgkmcnt(2)
v_mfma_f32_16x16x32_bf16 v[164:167], v[88:91], v[64:67], v[164:167]
ds_read_b128 v[84:87], v245 offset:22528
v_cvt_pk_bf16_f32 v192, v212, v246
v_cvt_pk_bf16_f32 v193, v244, v3
v_cvt_pk_bf16_f32 v194, v2, v235
v_mfma_f32_16x16x32_bf16 v[168:171], v[88:91], v[68:71], v[168:171]
v_cvt_pk_bf16_f32 v195, v233, v232
v_cvt_pk_bf16_f32 v212, v243, v242
v_mfma_f32_16x16x32_bf16 v[172:175], v[92:95], v[64:67], v[172:175]
ds_read_b128 v[88:91], v245 offset:26624
v_mov_b32 v213, 0
v_mov_b32 v214, 0
v_mfma_f32_16x16x32_bf16 v[176:179], v[92:95], v[68:71], v[176:179]
v_mov_b32 v215, 0
s_barrier
s_setprio 3
s_waitcnt lgkmcnt(2)
v_mfma_f32_16x16x32_bf16 v[156:159], v[96:99], v[116:119], v[156:159]
ds_read_b128 v[92:95], v245 offset:27648
v_lshrrev_b32 v255, 1, v250
v_and_b32 v254, 1, v250
v_mul_u32_u24 v254, 9, v254
v_mad_u32_u24 v254, v255, 19, v254
v_add_u32 v254, v254, v249
v_and_b32 v253, 1, v252
v_mul_u32_u24 v253, 48, v253
v_add_u32 v253, 155776, v253
v_mul_u32_u24 v4, 96, v254
v_add_u32 v4, v4, v253
v_add_u32 v5, 384, v4
v_add_u32 v6, 768, v4
v_mul_u32_u24 v254, 1824, v255
v_add_u32 v254, v254, v253
v_add_u32 v254, 1728, v254
v_cmp_eq_u32 vcc, 0, v249
s_nop 1
v_cndmask_b32 v6, v254, v6, vcc
v_lshrrev_b32 v254, 1, v252
v_cmp_eq_u32 vcc, v255, v254
v_mov_b32 v253, 155648
s_nop 0
v_cndmask_b32 v4, v253, v4, vcc
v_cndmask_b32 v5, v253, v5, vcc
v_cndmask_b32 v6, v253, v6, vcc
ds_read_b128 v[8:11], v4 offset:0
ds_read_b128 v[12:15], v4 offset:16
ds_read_b128 v[16:19], v4 offset:32
ds_read_b128 v[20:23], v5 offset:0
ds_read_b128 v[24:27], v5 offset:16
ds_read_b128 v[28:31], v5 offset:32
ds_read_b128 v[32:35], v6 offset:0
ds_read_b128 v[40:43], v6 offset:16
ds_read_b128 v[44:47], v6 offset:32
v_mfma_f32_16x16x32_bf16 v[160:163], v[96:99], v[120:123], v[160:163]
v_mfma_f32_16x16x32_bf16 v[164:167], v[80:83], v[116:119], v[164:167]
ds_read_b128 v[96:99], v245 offset:28672
v_mfma_f32_16x16x32_bf16 v[168:171], v[80:83], v[120:123], v[168:171]
s_waitcnt lgkmcnt(11)
v_mfma_f32_16x16x32_bf16 v[172:175], v[84:87], v[116:119], v[172:175]
ds_read_b128 v[80:83], v245 offset:32768
s_waitcnt lgkmcnt(8)
v_mfma_f32_16x16x32_bf16 v[48:51], v[8:11], v[180:183], 0
v_mfma_f32_16x16x32_bf16 v[60:63], v[8:11], v[184:187], 0
v_mfma_f32_16x16x32_bf16 v[48:51], v[12:15], v[188:191], v[48:51]
v_mfma_f32_16x16x32_bf16 v[60:63], v[12:15], v[192:195], v[60:63]
v_mfma_f32_16x16x32_bf16 v[48:51], v[16:19], v[208:211], v[48:51]
v_mfma_f32_16x16x32_bf16 v[60:63], v[16:19], v[212:215], v[60:63]
v_mfma_f32_16x16x32_bf16 v[176:179], v[84:87], v[120:123], v[176:179]
s_setprio 2
v_mfma_f32_16x16x32_bf16 v[156:159], v[88:91], v[196:199], v[156:159]
ds_read_b128 v[84:87], v245 offset:33792
v_mfma_f32_16x16x32_bf16 v[160:163], v[88:91], v[200:203], v[160:163]
v_mfma_f32_16x16x32_bf16 v[164:167], v[92:95], v[196:199], v[164:167]
ds_read_b128 v[88:91], v245 offset:34816
s_waitcnt lgkmcnt(7)
v_mfma_f32_16x16x32_bf16 v[52:55], v[20:23], v[180:183], 0
v_mfma_f32_16x16x32_bf16 v[64:67], v[20:23], v[184:187], 0
v_mfma_f32_16x16x32_bf16 v[52:55], v[24:27], v[188:191], v[52:55]
v_mfma_f32_16x16x32_bf16 v[64:67], v[24:27], v[192:195], v[64:67]
v_mfma_f32_16x16x32_bf16 v[52:55], v[28:31], v[208:211], v[52:55]
v_mfma_f32_16x16x32_bf16 v[64:67], v[28:31], v[212:215], v[64:67]
v_mfma_f32_16x16x32_bf16 v[168:171], v[92:95], v[200:203], v[168:171]
s_waitcnt vmcnt(0)
s_mov_b32 s52, 0
L_spa0_4:
v_cmp_ne_u64 vcc, s[98:99], v[230:231]
s_nop 1
s_cmp_eq_u64 vcc, 0
s_cbranch_scc1 L_spa0_4x
s_add_u32 s52, s52, 1
s_cmp_ge_u32 s52, 0x10000
s_cbranch_scc1 L_spa0_4x
s_sleep 2
s_lshl_b32 s50, s41, 7
s_add_u32 s50, s50, 46142464
v_min_u32 v255, 15, v1
v_lshlrev_b32 v255, 3, v255
buffer_load_dwordx2 v[230:231], v255, s[24:27], s50 offen sc1
s_waitcnt vmcnt(0)
s_branch L_spa0_4
L_spa0_4x:
v_mul_u32_u24 v255, 3072, v252
v_lshl_add_u32 v255, v251, 4, v255
s_mul_i32 s50, s42, 768
s_mul_i32 s51, s41, 196608
s_add_u32 s51, s51, s50
s_add_u32 s50, s51, 40992768
buffer_load_dwordx4 v[100:103], v255, s[24:27], s50 offen offset:0 sc1
buffer_load_dwordx4 v[104:107], v255, s[24:27], s50 offen offset:256 sc1
buffer_load_dwordx4 v[108:111], v255, s[24:27], s50 offen offset:512 sc1
s_add_u32 s50, s51, 41005056
buffer_load_dwordx4 v[112:115], v255, s[24:27], s50 offen offset:0 sc1
buffer_load_dwordx4 v[116:119], v255, s[24:27], s50 offen offset:256 sc1
buffer_load_dwordx4 v[120:123], v255, s[24:27], s50 offen offset:512 sc1
s_add_u32 s50, s51, 41017344
buffer_load_dwordx4 v[132:135], v255, s[24:27], s50 offen offset:0 sc1
buffer_load_dwordx4 v[136:139], v255, s[24:27], s50 offen offset:256 sc1
buffer_load_dwordx4 v[140:143], v255, s[24:27], s50 offen offset:512 sc1
s_add_u32 s50, s51, 41029632
buffer_load_dwordx4 v[144:147], v255, s[24:27], s50 offen offset:0 sc1
buffer_load_dwordx4 v[148:151], v255, s[24:27], s50 offen offset:256 sc1
buffer_load_dwordx4 v[152:155], v255, s[24:27], s50 offen offset:512 sc1
s_waitcnt lgkmcnt(3)
v_mfma_f32_16x16x32_bf16 v[172:175], v[96:99], v[196:199], v[172:175]
ds_read_b128 v[92:95], v245 offset:38912
v_mfma_f32_16x16x32_bf16 v[56:59], v[32:35], v[180:183], 0
v_mfma_f32_16x16x32_bf16 v[68:71], v[32:35], v[184:187], 0
v_mfma_f32_16x16x32_bf16 v[56:59], v[40:43], v[188:191], v[56:59]
v_mfma_f32_16x16x32_bf16 v[68:71], v[40:43], v[192:195], v[68:71]
v_mfma_f32_16x16x32_bf16 v[56:59], v[44:47], v[208:211], v[56:59]
v_mfma_f32_16x16x32_bf16 v[68:71], v[44:47], v[212:215], v[68:71]
v_mfma_f32_16x16x32_bf16 v[176:179], v[96:99], v[200:203], v[176:179]
s_setprio 1
s_waitcnt lgkmcnt(2)
v_mfma_f32_16x16x32_bf16 v[156:159], v[80:83], v[36:39], v[156:159]
ds_read_b128 v[96:99], v245 offset:39936
v_mfma_f32_16x16x32_bf16 v[160:163], v[80:83], v[72:75], v[160:163]
v_mfma_f32_16x16x32_bf16 v[164:167], v[84:87], v[36:39], v[164:167]
ds_read_b128 v[80:83], v245 offset:40960
v_mfma_f32_16x16x32_bf16 v[168:171], v[84:87], v[72:75], v[168:171]
s_waitcnt lgkmcnt(2)
v_mfma_f32_16x16x32_bf16 v[172:175], v[88:91], v[36:39], v[172:175]
v_add_f32 v57, 0x358637bd, v57
v_rcp_f32 v57, v57
s_nop 0
v_mul_f32 v48, v48, v57
v_mul_f32 v49, v49, v57
v_mul_f32 v50, v50, v57
v_mul_f32 v51, v51, v57
v_mul_f32 v52, v52, v57
v_mul_f32 v53, v53, v57
v_mul_f32 v54, v54, v57
v_mul_f32 v55, v55, v57
v_mul_f32 v56, v56, v57
v_cvt_pk_bf16_f32 v48, v48, v49
v_cvt_pk_bf16_f32 v49, v50, v51
v_cvt_pk_bf16_f32 v50, v52, v53
v_cvt_pk_bf16_f32 v51, v54, v55
s_lshl_b32 s50, s41, 13
s_add_u32 s50, s50, s59
s_add_u32 s50, s50, 0
buffer_store_dwordx4 v[48:51], v234, s[24:27], s50 offen sc1
v_mfma_f32_16x16x32_bf16 v[176:179], v[88:91], v[72:75], v[176:179]
s_setprio 0
v_mfma_f32_16x16x32_bf16 v[156:159], v[92:95], v[76:79], v[156:159]
v_add_f32 v69, 0x358637bd, v69
v_rcp_f32 v69, v69
s_nop 0
v_mul_f32 v60, v60, v69
v_mul_f32 v61, v61, v69
v_mul_f32 v62, v62, v69
v_mul_f32 v63, v63, v69
v_mul_f32 v64, v64, v69
v_mul_f32 v65, v65, v69
v_mul_f32 v66, v66, v69
v_mul_f32 v67, v67, v69
v_mul_f32 v68, v68, v69
v_cvt_pk_bf16_f32 v60, v60, v61
v_cvt_pk_bf16_f32 v61, v62, v63
v_cvt_pk_bf16_f32 v62, v64, v65
v_cvt_pk_bf16_f32 v63, v66, v67
s_lshl_b32 s50, s41, 13
s_add_u32 s50, s50, s59
s_add_u32 s50, s50, 1024
buffer_store_dwordx4 v[60:63], v234, s[24:27], s50 offen sc1
v_cvt_pk_bf16_f32 v56, v56, v68
s_mul_i32 s50, s42, 36864
s_lshl_b32 s51, s41, 10
s_add_u32 s50, s50, s51
s_add_u32 s50, s50, s59
s_add_u32 s50, s50, 32768
v_lshlrev_b32 v255, 2, v1
buffer_store_dword v56, v255, s[24:27], s50 offen sc1
s_nop 0
v_mfma_f32_16x16x32_bf16 v[160:163], v[92:95], v[204:207], v[160:163]
s_waitcnt lgkmcnt(0)
v_mfma_f32_16x16x32_bf16 v[164:167], v[96:99], v[76:79], v[164:167]
v_mfma_f32_16x16x32_bf16 v[168:171], v[96:99], v[204:207], v[168:171]
v_mfma_f32_16x16x32_bf16 v[172:175], v[80:83], v[76:79], v[172:175]
v_mfma_f32_16x16x32_bf16 v[176:179], v[80:83], v[204:207], v[176:179]
s_barrier
s_setprio 3
v_max3_f32 v232, v156, v157, v158
s_nop 1
v_max3_f32 v232, v232, v159, v164
v_max3_f32 v232, v232, v165, v166
v_max3_f32 v232, v232, v167, v172
v_min3_f32 v243, v156, v157, v158
v_min3_f32 v243, v243, v159, v164
v_min3_f32 v243, v243, v165, v166
v_min3_f32 v243, v243, v167, v172
v_mov_b32 v242, v232
v_mov_b32 v241, v243
s_nop 0
v_permlane16_swap_b32 v232, v242
v_permlane16_swap_b32 v243, v241
v_max_f32 v232, v232, v242
v_min_f32 v243, v243, v241
v_sub_f32 v246, v156, v232
v_sub_f32 v156, v243, v156
v_exp_f32 v246, v246
v_exp_f32 v156, v156
v_sub_f32 v244, v157, v232
v_sub_f32 v157, v243, v157
v_exp_f32 v244, v244
v_exp_f32 v157, v157
v_sub_f32 v3, v158, v232
v_sub_f32 v158, v243, v158
v_exp_f32 v3, v3
v_exp_f32 v158, v158
v_sub_f32 v2, v159, v232
v_sub_f32 v159, v243, v159
v_exp_f32 v2, v2
v_exp_f32 v159, v159
v_sub_f32 v239, v164, v232
v_sub_f32 v164, v243, v164
v_exp_f32 v239, v239
v_exp_f32 v164, v164
v_sub_f32 v238, v165, v232
v_sub_f32 v165, v243, v165
v_exp_f32 v238, v238
v_exp_f32 v165, v165
v_sub_f32 v236, v166, v232
v_sub_f32 v166, v243, v166
v_exp_f32 v236, v236
v_exp_f32 v166, v166
v_sub_f32 v235, v167, v232
v_sub_f32 v167, v243, v167
v_exp_f32 v235, v235
v_exp_f32 v167, v167
v_sub_f32 v233, v172, v232
v_sub_f32 v172, v243, v172
v_exp_f32 v233, v233
v_exp_f32 v172, v172
v_add_f32 v232, v246, v244
v_add_f32 v243, v156, v157
v_add_f32 v232, v232, v3
v_add_f32 v243, v243, v158
v_add_f32 v232, v232, v2
v_add_f32 v243, v243, v159
v_add_f32 v232, v232, v239
v_add_f32 v243, v243, v164
v_add_f32 v232, v232, v238
v_add_f32 v243, v243, v165
v_add_f32 v232, v232, v236
v_add_f32 v243, v243, v166
v_add_f32 v232, v232, v235
v_add_f32 v243, v243, v167
v_add_f32 v232, v232, v233
v_add_f32 v243, v243, v172
v_mov_b32 v242, v232
v_mov_b32 v241, v243
s_nop 0
v_permlane16_swap_b32 v232, v242
v_permlane16_swap_b32 v243, v241
v_add_f32 v232, v232, v242
v_add_f32 v243, v243, v241
v_rcp_f32 v232, v232
v_rcp_f32 v243, v243
v_mul_f32 v246, v246, v232
v_mul_f32 v156, v156, v243
v_mul_f32 v244, v244, v232
v_mul_f32 v157, v157, v243
v_mul_f32 v3, v3, v232
v_mul_f32 v158, v158, v243
v_mul_f32 v2, v2, v232
v_mul_f32 v159, v159, v243
v_mul_f32 v239, v239, v232
v_mul_f32 v164, v164, v243
v_mul_f32 v238, v238, v232
v_mul_f32 v165, v165, v243
v_mul_f32 v236, v236, v232
v_mul_f32 v166, v166, v243
v_mul_f32 v235, v235, v232
v_mul_f32 v167, v167, v243
v_mul_f32 v233, v233, v232
v_mul_f32 v172, v172, v243
v_cvt_pk_bf16_f32 v156, v156, v157
v_cvt_pk_bf16_f32 v157, v158, v159
v_cvt_pk_bf16_f32 v158, v164, v165
v_cvt_pk_bf16_f32 v159, v166, v167
v_cvt_pk_bf16_f32 v164, v172, v246
v_cvt_pk_bf16_f32 v165, v244, v3
v_cvt_pk_bf16_f32 v166, v2, v239
v_cvt_pk_bf16_f32 v167, v238, v236
v_cvt_pk_bf16_f32 v172, v235, v233
v_mov_b32 v173, 0
v_mov_b32 v174, 0
v_mov_b32 v175, 0
s_waitcnt vmcnt(12)
v_mfma_f32_16x16x32_bf16 v[4:7], v[124:127], v[100:103], 0
v_mfma_f32_16x16x32_bf16 v[4:7], v[128:131], v[104:107], v[4:7]
v_mfma_f32_16x16x32_bf16 v[8:11], v[124:127], v[108:111], 0
s_waitcnt vmcnt(9)
v_mfma_f32_16x16x32_bf16 v[4:7], v[124:127], v[112:115], v[4:7]
v_mfma_f32_16x16x32_bf16 v[4:7], v[128:131], v[116:119], v[4:7]
v_mfma_f32_16x16x32_bf16 v[8:11], v[124:127], v[120:123], v[8:11]
s_waitcnt vmcnt(6)
v_mfma_f32_16x16x32_bf16 v[4:7], v[124:127], v[132:135], v[4:7]
v_mfma_f32_16x16x32_bf16 v[4:7], v[128:131], v[136:139], v[4:7]
v_mfma_f32_16x16x32_bf16 v[8:11], v[124:127], v[140:143], v[8:11]
s_waitcnt vmcnt(3)
v_mfma_f32_16x16x32_bf16 v[4:7], v[124:127], v[144:147], v[4:7]
v_mfma_f32_16x16x32_bf16 v[4:7], v[128:131], v[148:151], v[4:7]
v_mfma_f32_16x16x32_bf16 v[8:11], v[124:127], v[152:155], v[8:11]
v_lshrrev_b32 v255, 1, v252
v_lshlrev_b32 v255, 5, v255
v_lshl_add_u32 v255, v251, 1, v255
v_and_b32 v254, 1, v252
s_mul_i32 s50, s42, 96
v_add3_u32 v255, v255, v254, s50
v_cmp_gt_u32 vcc, 380, v255
v_mul_u32_u24 v254, 205, v255
v_lshrrev_b32 v254, 10, v254
v_add_u32 v254, v255, v254
v_lshlrev_b32 v254, 3, v254
v_add_u32 v254, 147456, v254
v_mov_b32 v253, 163712
v_cndmask_b32 v240, v253, v254, vcc
v_cvt_pk_bf16_f32 v4, v4, v5
v_cvt_pk_bf16_f32 v5, v6, v7
ds_write_b64 v240, v[4:5]
v_add_u32 v255, 64, v255
v_cmp_gt_u32 vcc, 380, v255
s_mov_b32 vcc_hi, 0
v_mul_u32_u24 v254, 205, v255
v_lshrrev_b32 v254, 10, v254
v_add_u32 v254, v255, v254
v_lshlrev_b32 v254, 3, v254
v_add_u32 v254, 147456, v254
v_mov_b32 v253, 163712
v_cndmask_b32 v240, v253, v254, vcc
v_cvt_pk_bf16_f32 v8, v8, v9
v_cvt_pk_bf16_f32 v9, v10, v11
ds_write_b64 v240, v[8:9]
s_waitcnt vmcnt(0)
s_lshl_b32 s50, s40, 2
s_add_u32 s50, s50, s42
s_lshl_b32 s50, s50, 8
s_add_u32 s50, s50, 46153728
s_lshl_b32 s51, s41, 4
s_add_u32 s50, s50, s51
v_mov_b32 v230, s98
v_mov_b32 v231, s99
s_mov_b64 exec, 1
buffer_store_dwordx2 v[230:231], v248, s[24:27], s50 offen sc1
s_mov_b64 exec, -1
s_waitcnt lgkmcnt(0)
s_barrier
v_max3_f32 v232, v160, v161, v162
v_max3_f32 v232, v232, v163, v168
v_max3_f32 v232, v232, v169, v170
v_max3_f32 v232, v232, v171, v176
v_min3_f32 v243, v160, v161, v162
v_min3_f32 v243, v243, v163, v168
v_min3_f32 v243, v243, v169, v170
v_min3_f32 v243, v243, v171, v176
v_mov_b32 v242, v232
v_mov_b32 v241, v243
s_nop 0
v_permlane16_swap_b32 v232, v242
v_permlane16_swap_b32 v243, v241
v_max_f32 v232, v232, v242
v_min_f32 v243, v243, v241
v_sub_f32 v246, v160, v232
v_sub_f32 v160, v243, v160
v_exp_f32 v246, v246
v_exp_f32 v160, v160
v_sub_f32 v244, v161, v232
v_sub_f32 v161, v243, v161
v_exp_f32 v244, v244
v_exp_f32 v161, v161
v_sub_f32 v3, v162, v232
v_sub_f32 v162, v243, v162
v_exp_f32 v3, v3
v_exp_f32 v162, v162
v_sub_f32 v2, v163, v232
v_sub_f32 v163, v243, v163
v_exp_f32 v2, v2
v_exp_f32 v163, v163
v_sub_f32 v239, v168, v232
v_sub_f32 v168, v243, v168
v_exp_f32 v239, v239
v_exp_f32 v168, v168
v_sub_f32 v238, v169, v232
v_sub_f32 v169, v243, v169
v_exp_f32 v238, v238
v_exp_f32 v169, v169
v_sub_f32 v236, v170, v232
v_sub_f32 v170, v243, v170
v_exp_f32 v236, v236
v_exp_f32 v170, v170
v_sub_f32 v235, v171, v232
v_sub_f32 v171, v243, v171
v_exp_f32 v235, v235
v_exp_f32 v171, v171
v_sub_f32 v233, v176, v232
v_sub_f32 v176, v243, v176
v_exp_f32 v233, v233
v_exp_f32 v176, v176
v_add_f32 v232, v246, v244
v_add_f32 v243, v160, v161
v_add_f32 v232, v232, v3
v_add_f32 v243, v243, v162
v_add_f32 v232, v232, v2
v_add_f32 v243, v243, v163
v_add_f32 v232, v232, v239
v_add_f32 v243, v243, v168
v_add_f32 v232, v232, v238
v_add_f32 v243, v243, v169
v_add_f32 v232, v232, v236
v_add_f32 v243, v243, v170
v_add_f32 v232, v232, v235
v_add_f32 v243, v243, v171
v_add_f32 v232, v232, v233
v_add_f32 v243, v243, v176
v_mov_b32 v242, v232
v_mov_b32 v241, v243
s_nop 0
v_permlane16_swap_b32 v232, v242
v_permlane16_swap_b32 v243, v241
v_add_f32 v232, v232, v242
v_add_f32 v243, v243, v241
v_rcp_f32 v232, v232
v_rcp_f32 v243, v243
v_mul_f32 v246, v246, v232
v_mul_f32 v160, v160, v243
v_mul_f32 v244, v244, v232
v_mul_f32 v161, v161, v243
v_mul_f32 v3, v3, v232
v_mul_f32 v162, v162, v243
v_mul_f32 v2, v2, v232
v_mul_f32 v163, v163, v243
v_mul_f32 v239, v239, v232
v_mul_f32 v168, v168, v243
v_mul_f32 v238, v238, v232
v_mul_f32 v169, v169, v243
v_mul_f32 v236, v236, v232
v_mul_f32 v170, v170, v243
v_mul_f32 v235, v235, v232
v_mul_f32 v171, v171, v243
v_mul_f32 v233, v233, v232
v_mul_f32 v176, v176, v243
v_cvt_pk_bf16_f32 v160, v160, v161
v_cvt_pk_bf16_f32 v161, v162, v163
v_cvt_pk_bf16_f32 v162, v168, v169
v_cvt_pk_bf16_f32 v163, v170, v171
v_cvt_pk_bf16_f32 v168, v176, v246
v_cvt_pk_bf16_f32 v169, v244, v3
v_cvt_pk_bf16_f32 v170, v2, v239
v_cvt_pk_bf16_f32 v171, v238, v236
v_cvt_pk_bf16_f32 v176, v235, v233
v_mov_b32 v177, 0
v_mov_b32 v178, 0
v_mov_b32 v179, 0
v_lshrrev_b32 v255, 1, v250
v_and_b32 v254, 1, v250
v_mul_u32_u24 v254, 9, v254
v_mad_u32_u24 v254, v255, 19, v254
v_add_u32 v254, v254, v249
v_and_b32 v253, 1, v252
v_mul_u32_u24 v253, 48, v253
v_add_u32 v253, 147456, v253
v_mul_u32_u24 v4, 96, v254
v_add_u32 v4, v4, v253
v_add_u32 v5, 384, v4
v_add_u32 v6, 768, v4
v_mul_u32_u24 v254, 1824, v255
v_add_u32 v254, v254, v253
v_add_u32 v254, 1728, v254
v_cmp_eq_u32 vcc, 0, v249
s_nop 1
v_cndmask_b32 v6, v254, v6, vcc
v_lshrrev_b32 v254, 1, v252
v_cmp_eq_u32 vcc, v255, v254
v_mov_b32 v253, 155648
s_nop 0
v_cndmask_b32 v4, v253, v4, vcc
v_cndmask_b32 v5, v253, v5, vcc
v_cndmask_b32 v6, v253, v6, vcc
ds_read_b128 v[8:11], v4 offset:0
ds_read_b128 v[12:15], v4 offset:16
ds_read_b128 v[16:19], v4 offset:32
ds_read_b128 v[20:23], v5 offset:0
ds_read_b128 v[24:27], v5 offset:16
ds_read_b128 v[28:31], v5 offset:32
ds_read_b128 v[32:35], v6 offset:0
ds_read_b128 v[36:39], v6 offset:16
ds_read_b128 v[40:43], v6 offset:32
s_waitcnt lgkmcnt(6)
v_mfma_f32_16x16x32_bf16 v[44:47], v[8:11], v[156:159], 0
v_mfma_f32_16x16x32_bf16 v[56:59], v[8:11], v[160:163], 0
v_mfma_f32_16x16x32_bf16 v[44:47], v[12:15], v[164:167], v[44:47]
v_mfma_f32_16x16x32_bf16 v[56:59], v[12:15], v[168:171], v[56:59]
v_mfma_f32_16x16x32_bf16 v[44:47], v[16:19], v[172:175], v[44:47]
v_mfma_f32_16x16x32_bf16 v[56:59], v[16:19], v[176:179], v[56:59]
s_waitcnt lgkmcnt(3)
v_mfma_f32_16x16x32_bf16 v[48:51], v[20:23], v[156:159], 0
v_mfma_f32_16x16x32_bf16 v[60:63], v[20:23], v[160:163], 0
v_mfma_f32_16x16x32_bf16 v[48:51], v[24:27], v[164:167], v[48:51]
v_mfma_f32_16x16x32_bf16 v[60:63], v[24:27], v[168:171], v[60:63]
v_mfma_f32_16x16x32_bf16 v[48:51], v[28:31], v[172:175], v[48:51]
v_mfma_f32_16x16x32_bf16 v[60:63], v[28:31], v[176:179], v[60:63]
s_waitcnt lgkmcnt(0)
v_mfma_f32_16x16x32_bf16 v[52:55], v[32:35], v[156:159], 0
v_mfma_f32_16x16x32_bf16 v[64:67], v[32:35], v[160:163], 0
v_mfma_f32_16x16x32_bf16 v[52:55], v[36:39], v[164:167], v[52:55]
v_mfma_f32_16x16x32_bf16 v[64:67], v[36:39], v[168:171], v[64:67]
v_mfma_f32_16x16x32_bf16 v[52:55], v[40:43], v[172:175], v[52:55]
v_mfma_f32_16x16x32_bf16 v[64:67], v[40:43], v[176:179], v[64:67]
s_nop 6
v_add_f32 v53, 0x358637bd, v53
v_rcp_f32 v53, v53
s_nop 0
v_mul_f32 v44, v44, v53
v_mul_f32 v45, v45, v53
v_mul_f32 v46, v46, v53
v_mul_f32 v47, v47, v53
v_mul_f32 v48, v48, v53
v_mul_f32 v49, v49, v53
v_mul_f32 v50, v50, v53
v_mul_f32 v51, v51, v53
v_mul_f32 v52, v52, v53
v_cvt_pk_bf16_f32 v44, v44, v45
v_cvt_pk_bf16_f32 v45, v46, v47
v_cvt_pk_bf16_f32 v46, v48, v49
v_cvt_pk_bf16_f32 v47, v50, v51
s_lshl_b32 s50, s41, 13
s_add_u32 s50, s50, s59
s_add_u32 s50, s50, 4096
buffer_store_dwordx4 v[44:47], v234, s[24:27], s50 offen sc1
v_add_f32 v65, 0x358637bd, v65
v_rcp_f32 v65, v65
s_nop 0
v_mul_f32 v56, v56, v65
v_mul_f32 v57, v57, v65
v_mul_f32 v58, v58, v65
v_mul_f32 v59, v59, v65
v_mul_f32 v60, v60, v65
v_mul_f32 v61, v61, v65
v_mul_f32 v62, v62, v65
v_mul_f32 v63, v63, v65
v_mul_f32 v64, v64, v65
v_cvt_pk_bf16_f32 v56, v56, v57
v_cvt_pk_bf16_f32 v57, v58, v59
v_cvt_pk_bf16_f32 v58, v60, v61
v_cvt_pk_bf16_f32 v59, v62, v63
s_lshl_b32 s50, s41, 13
s_add_u32 s50, s50, s59
s_add_u32 s50, s50, 5120
buffer_store_dwordx4 v[56:59], v234, s[24:27], s50 offen sc1
v_cvt_pk_bf16_f32 v52, v52, v64
s_mul_i32 s50, s42, 36864
s_lshl_b32 s51, s41, 10
s_add_u32 s50, s50, s51
s_add_u32 s50, s50, s59
s_add_u32 s50, s50, 33280
v_lshlrev_b32 v255, 2, v1
buffer_store_dword v52, v255, s[24:27], s50 offen sc1
s_nop 0
s_waitcnt vmcnt(0)
s_lshl_b32 s50, s40, 2
s_add_u32 s50, s50, s42
s_lshl_b32 s50, s50, 8
s_add_u32 s50, s50, 46153792
s_lshl_b32 s51, s41, 4
s_add_u32 s50, s50, s51
v_mov_b32 v2, s98
v_mov_b32 v3, s99
s_mov_b64 exec, 1
buffer_store_dwordx2 v[2:3], v248, s[24:27], s50 offen sc1
s_mov_b64 exec, -1
s_endpgm
L_att_c1:
s_setprio 2
s_waitcnt vmcnt(17)
v_dot2_f32_bf16 v76, v4, s54, 0
v_dot2_f32_bf16 v78, v4, v4, 0
v_dot2_f32_bf16 v76, v5, s54, v76
v_dot2_f32_bf16 v78, v5, v5, v78
v_dot2_f32_bf16 v76, v6, s54, v76
v_dot2_f32_bf16 v78, v6, v6, v78
v_dot2_f32_bf16 v76, v7, s54, v76
v_dot2_f32_bf16 v78, v7, v7, v78
s_waitcnt vmcnt(16)
v_dot2_f32_bf16 v77, v40, s54, 0
v_dot2_f32_bf16 v79, v40, v40, 0
v_dot2_f32_bf16 v77, v41, s54, v77
v_dot2_f32_bf16 v79, v41, v41, v79
v_dot2_f32_bf16 v77, v42, s54, v77
v_dot2_f32_bf16 v79, v42, v42, v79
v_dot2_f32_bf16 v77, v43, s54, v77
v_dot2_f32_bf16 v79, v43, v43, v79
s_waitcnt vmcnt(15)
v_dot2_f32_bf16 v76, v8, s54, v76
v_dot2_f32_bf16 v78, v8, v8, v78
v_dot2_f32_bf16 v76, v9, s54, v76
v_dot2_f32_bf16 v78, v9, v9, v78
v_dot2_f32_bf16 v76, v10, s54, v76
v_dot2_f32_bf16 v78, v10, v10, v78
v_dot2_f32_bf16 v76, v11, s54, v76
v_dot2_f32_bf16 v78, v11, v11, v78
s_waitcnt vmcnt(14)
v_dot2_f32_bf16 v77, v44, s54, v77
v_dot2_f32_bf16 v79, v44, v44, v79
v_dot2_f32_bf16 v77, v45, s54, v77
v_dot2_f32_bf16 v79, v45, v45, v79
v_dot2_f32_bf16 v77, v46, s54, v77
v_dot2_f32_bf16 v79, v46, v46, v79
v_dot2_f32_bf16 v77, v47, s54, v77
v_dot2_f32_bf16 v79, v47, v47, v79
s_waitcnt vmcnt(13)
v_dot2_f32_bf16 v76, v12, s54, v76
v_dot2_f32_bf16 v78, v12, v12, v78
v_dot2_f32_bf16 v76, v13, s54, v76
v_dot2_f32_bf16 v78, v13, v13, v78
v_dot2_f32_bf16 v76, v14, s54, v76
v_dot2_f32_bf16 v78, v14, v14, v78
v_dot2_f32_bf16 v76, v15, s54, v76
v_dot2_f32_bf16 v78, v15, v15, v78
s_waitcnt vmcnt(12)
v_dot2_f32_bf16 v77, v48, s54, v77
v_dot2_f32_bf16 v79, v48, v48, v79
v_dot2_f32_bf16 v77, v49, s54, v77
v_dot2_f32_bf16 v79, v49, v49, v79
v_dot2_f32_bf16 v77, v50, s54, v77
v_dot2_f32_bf16 v79, v50, v50, v79
v_dot2_f32_bf16 v77, v51, s54, v77
v_dot2_f32_bf16 v79, v51, v51, v79
s_waitcnt vmcnt(11)
v_dot2_f32_bf16 v76, v16, s54, v76
v_dot2_f32_bf16 v78, v16, v16, v78
v_dot2_f32_bf16 v76, v17, s54, v76
v_dot2_f32_bf16 v78, v17, v17, v78
v_dot2_f32_bf16 v76, v18, s54, v76
v_dot2_f32_bf16 v78, v18, v18, v78
v_dot2_f32_bf16 v76, v19, s54, v76
v_dot2_f32_bf16 v78, v19, v19, v78
s_waitcnt vmcnt(10)
v_dot2_f32_bf16 v77, v52, s54, v77
v_dot2_f32_bf16 v79, v52, v52, v79
v_dot2_f32_bf16 v77, v53, s54, v77
v_dot2_f32_bf16 v79, v53, v53, v79
v_dot2_f32_bf16 v77, v54, s54, v77
v_dot2_f32_bf16 v79, v54, v54, v79
v_dot2_f32_bf16 v77, v55, s54, v77
v_dot2_f32_bf16 v79, v55, v55, v79
s_waitcnt vmcnt(9)
v_dot2_f32_bf16 v76, v20, s54, v76
v_dot2_f32_bf16 v78, v20, v20, v78
v_dot2_f32_bf16 v76, v21, s54, v76
v_dot2_f32_bf16 v78, v21, v21, v78
v_dot2_f32_bf16 v76, v22, s54, v76
v_dot2_f32_bf16 v78, v22, v22, v78
v_dot2_f32_bf16 v76, v23, s54, v76
v_dot2_f32_bf16 v78, v23, v23, v78
s_waitcnt vmcnt(8)
v_dot2_f32_bf16 v77, v56, s54, v77
v_dot2_f32_bf16 v79, v56, v56, v79
v_dot2_f32_bf16 v77, v57, s54, v77
v_dot2_f32_bf16 v79, v57, v57, v79
v_dot2_f32_bf16 v77, v58, s54, v77
v_dot2_f32_bf16 v79, v58, v58, v79
v_dot2_f32_bf16 v77, v59, s54, v77
v_dot2_f32_bf16 v79, v59, v59, v79
s_waitcnt vmcnt(7)
v_dot2_f32_bf16 v76, v24, s54, v76
v_dot2_f32_bf16 v78, v24, v24, v78
v_dot2_f32_bf16 v76, v25, s54, v76
v_dot2_f32_bf16 v78, v25, v25, v78
v_dot2_f32_bf16 v76, v26, s54, v76
v_dot2_f32_bf16 v78, v26, v26, v78
v_dot2_f32_bf16 v76, v27, s54, v76
v_dot2_f32_bf16 v78, v27, v27, v78
s_waitcnt vmcnt(6)
v_dot2_f32_bf16 v77, v60, s54, v77
v_dot2_f32_bf16 v79, v60, v60, v79
v_dot2_f32_bf16 v77, v61, s54, v77
v_dot2_f32_bf16 v79, v61, v61, v79
v_dot2_f32_bf16 v77, v62, s54, v77
v_dot2_f32_bf16 v79, v62, v62, v79
v_dot2_f32_bf16 v77, v63, s54, v77
v_dot2_f32_bf16 v79, v63, v63, v79
s_waitcnt vmcnt(5)
v_dot2_f32_bf16 v76, v28, s54, v76
v_dot2_f32_bf16 v78, v28, v28, v78
v_dot2_f32_bf16 v76, v29, s54, v76
v_dot2_f32_bf16 v78, v29, v29, v78
v_dot2_f32_bf16 v76, v30, s54, v76
v_dot2_f32_bf16 v78, v30, v30, v78
v_dot2_f32_bf16 v76, v31, s54, v76
v_dot2_f32_bf16 v78, v31, v31, v78
s_waitcnt vmcnt(4)
v_dot2_f32_bf16 v77, v64, s54, v77
v_dot2_f32_bf16 v79, v64, v64, v79
v_dot2_f32_bf16 v77, v65, s54, v77
v_dot2_f32_bf16 v79, v65, v65, v79
v_dot2_f32_bf16 v77, v66, s54, v77
v_dot2_f32_bf16 v79, v66, v66, v79
v_dot2_f32_bf16 v77, v67, s54, v77
v_dot2_f32_bf16 v79, v67, v67, v79
s_waitcnt vmcnt(3)
v_dot2_f32_bf16 v76, v32, s54, v76
v_dot2_f32_bf16 v78, v32, v32, v78
v_dot2_f32_bf16 v76, v33, s54, v76
v_dot2_f32_bf16 v78, v33, v33, v78
v_dot2_f32_bf16 v76, v34, s54, v76
v_dot2_f32_bf16 v78, v34, v34, v78
v_dot2_f32_bf16 v76, v35, s54, v76
v_dot2_f32_bf16 v78, v35, v35, v78
s_waitcnt vmcnt(2)
v_dot2_f32_bf16 v77, v68, s54, v77
v_dot2_f32_bf16 v79, v68, v68, v79
v_dot2_f32_bf16 v77, v69, s54, v77
v_dot2_f32_bf16 v79, v69, v69, v79
v_dot2_f32_bf16 v77, v70, s54, v77
v_dot2_f32_bf16 v79, v70, v70, v79
v_dot2_f32_bf16 v77, v71, s54, v77
v_dot2_f32_bf16 v79, v71, v71, v79
s_waitcnt vmcnt(1)
v_dot2_f32_bf16 v76, v36, s54, v76
v_dot2_f32_bf16 v78, v36, v36, v78
v_dot2_f32_bf16 v76, v37, s54, v76
v_dot2_f32_bf16 v78, v37, v37, v78
v_dot2_f32_bf16 v76, v38, s54, v76
v_dot2_f32_bf16 v78, v38, v38, v78
v_dot2_f32_bf16 v76, v39, s54, v76
v_dot2_f32_bf16 v78, v39, v39, v78
s_waitcnt vmcnt(0)
v_dot2_f32_bf16 v77, v72, s54, v77
v_dot2_f32_bf16 v79, v72, v72, v79
v_dot2_f32_bf16 v77, v73, s54, v77
v_dot2_f32_bf16 v79, v73, v73, v79
v_dot2_f32_bf16 v77, v74, s54, v77
v_dot2_f32_bf16 v79, v74, v74, v79
v_dot2_f32_bf16 v77, v75, s54, v77
v_dot2_f32_bf16 v79, v75, v75, v79
v_add_f32_dpp v76, v76, v76 quad_perm:[1,0,3,2] row_mask:0xf bank_mask:0xf
s_nop 0
v_add_f32_dpp v77, v77, v77 quad_perm:[1,0,3,2] row_mask:0xf bank_mask:0xf
v_add_f32_dpp v78, v78, v78 quad_perm:[1,0,3,2] row_mask:0xf bank_mask:0xf
v_add_f32_dpp v79, v79, v79 quad_perm:[1,0,3,2] row_mask:0xf bank_mask:0xf
v_add_f32_dpp v76, v76, v76 quad_perm:[2,3,0,1] row_mask:0xf bank_mask:0xf
v_add_f32_dpp v77, v77, v77 quad_perm:[2,3,0,1] row_mask:0xf bank_mask:0xf
v_add_f32_dpp v78, v78, v78 quad_perm:[2,3,0,1] row_mask:0xf bank_mask:0xf
v_add_f32_dpp v79, v79, v79 quad_perm:[2,3,0,1] row_mask:0xf bank_mask:0xf
v_add_f32_dpp v76, v76, v76 row_half_mirror row_mask:0xf bank_mask:0xf
v_add_f32_dpp v77, v77, v77 row_half_mirror row_mask:0xf bank_mask:0xf
v_add_f32_dpp v78, v78, v78 row_half_mirror row_mask:0xf bank_mask:0xf
v_add_f32_dpp v79, v79, v79 row_half_mirror row_mask:0xf bank_mask:0xf
v_mul_f32 v76, 0xbae38e39, v76
v_mul_f32 v77, 0xbae38e39, v77
v_mul_f32 v78, 0x3ae38e39, v78
v_mul_f32 v79, 0x3ae38e39, v79
v_fma_f32 v78, -v76, v76, v78
v_fma_f32 v79, -v77, v77, v79
v_max_f32 v78, 0, v78
v_max_f32 v79, 0, v79
v_add_f32 v78, 0x3727c5ac, v78
v_add_f32 v79, 0x3727c5ac, v79
v_rsq_f32 v78, v78
v_rsq_f32 v79, v79
v_mul_f32 v78, 1069066811, v78
v_mul_f32 v79, 1069066811, v79
v_mul_f32 v76, v76, v78
v_mul_f32 v77, v77, v79
v_xor_b32 v255, v251, v252
v_mul_u32_u24 v254, 52, v255
v_lshrrev_b32 v254, 8, v254
v_mul_u32_u24 v253, 1072, v254
v_lshl_add_u32 v255, v255, 4, v253
v_mul_u32_u24 v253, 3456, v252
v_add3_u32 v255, v255, v253, s61
v_cmp_lt_u32 vcc, 1, v254
v_mov_b32 v253, 1879048192
s_nop 0
v_cndmask_b32 v255, v255, v253, vcc
s_lshl_b32 s51, s41, 2
s_add_u32 s51, s51, s45
s_mul_i32 s51, s51, 72
s_mul_i32 s50, s60, 110592
s_add_u32 s50, s50, s51
s_mul_i32 s51, s42, 8192
s_mov_b32 s51, 77824
s_cmp_lg_u32 s42, 0
s_cbranch_scc1 L_att_nf
s_add_u32 m0, s51, 0
s_nop 0
buffer_load_dwordx4 v255, s[12:15], s50 offen lds
s_add_u32 m0, s51, 1024
s_add_u32 s50, s50, 13824
buffer_load_dwordx4 v255, s[12:15], s50 offen lds
s_add_u32 m0, s51, 2048
s_add_u32 s50, s50, 13824
buffer_load_dwordx4 v255, s[12:15], s50 offen lds
s_add_u32 m0, s51, 3072
s_add_u32 s50, s50, 13824
buffer_load_dwordx4 v255, s[12:15], s50 offen lds
s_add_u32 m0, s51, 4096
s_add_u32 s50, s50, 13824
buffer_load_dwordx4 v255, s[12:15], s50 offen lds
s_add_u32 m0, s51, 5120
s_add_u32 s50, s50, 13824
buffer_load_dwordx4 v255, s[12:15], s50 offen lds
s_add_u32 m0, s51, 6144
s_add_u32 s50, s50, 13824
buffer_load_dwordx4 v255, s[12:15], s50 offen lds
s_add_u32 m0, s51, 7168
s_add_u32 s50, s50, 13824
buffer_load_dwordx4 v255, s[12:15], s50 offen lds
L_att_nf:
v_lshlrev_b32 v245, 16, v4
v_and_b32 v244, s53, v4
v_lshlrev_b32 v243, 16, v5
v_and_b32 v242, s53, v5
v_lshlrev_b32 v241, 16, v6
v_and_b32 v240, s53, v6
v_lshlrev_b32 v239, 16, v7
v_and_b32 v238, s53, v7
v_fma_f32 v245, v245, v78, v76
v_fma_f32 v244, v244, v78, v76
v_fma_f32 v243, v243, v78, v76
v_fma_f32 v242, v242, v78, v76
v_fma_f32 v241, v241, v78, v76
v_fma_f32 v240, v240, v78, v76
v_fma_f32 v239, v239, v78, v76
v_fma_f32 v238, v238, v78, v76
v_cvt_pk_bf16_f32 v4, v245, v244
v_cvt_pk_bf16_f32 v5, v243, v242
v_cvt_pk_bf16_f32 v6, v241, v240
v_cvt_pk_bf16_f32 v7, v239, v238
ds_write_b128 v237, v[4:7] offset:0
v_lshlrev_b32 v245, 16, v40
v_and_b32 v244, s53, v40
v_lshlrev_b32 v243, 16, v41
v_and_b32 v242, s53, v41
v_lshlrev_b32 v241, 16, v42
v_and_b32 v240, s53, v42
v_lshlrev_b32 v239, 16, v43
v_and_b32 v238, s53, v43
v_fma_f32 v245, v245, v79, v77
v_fma_f32 v244, v244, v79, v77
v_fma_f32 v243, v243, v79, v77
v_fma_f32 v242, v242, v79, v77
v_fma_f32 v241, v241, v79, v77
v_fma_f32 v240, v240, v79, v77
v_fma_f32 v239, v239, v79, v77
v_fma_f32 v238, v238, v79, v77
v_cvt_pk_bf16_f32 v40, v245, v244
v_cvt_pk_bf16_f32 v41, v243, v242
v_cvt_pk_bf16_f32 v42, v241, v240
v_cvt_pk_bf16_f32 v43, v239, v238
ds_write_b128 v237, v[40:43] offset:128
v_lshlrev_b32 v245, 16, v8
v_and_b32 v244, s53, v8
v_lshlrev_b32 v243, 16, v9
v_and_b32 v242, s53, v9
v_lshlrev_b32 v241, 16, v10
v_and_b32 v240, s53, v10
v_lshlrev_b32 v239, 16, v11
v_and_b32 v238, s53, v11
v_fma_f32 v245, v245, v78, v76
v_fma_f32 v244, v244, v78, v76
v_fma_f32 v243, v243, v78, v76
v_fma_f32 v242, v242, v78, v76
v_fma_f32 v241, v241, v78, v76
v_fma_f32 v240, v240, v78, v76
v_fma_f32 v239, v239, v78, v76
v_fma_f32 v238, v238, v78, v76
v_cvt_pk_bf16_f32 v8, v245, v244
v_cvt_pk_bf16_f32 v9, v243, v242
v_cvt_pk_bf16_f32 v10, v241, v240
v_cvt_pk_bf16_f32 v11, v239, v238
ds_write_b128 v237, v[8:11] offset:16384
v_lshlrev_b32 v245, 16, v44
v_and_b32 v244, s53, v44
v_lshlrev_b32 v243, 16, v45
v_and_b32 v242, s53, v45
v_lshlrev_b32 v241, 16, v46
v_and_b32 v240, s53, v46
v_lshlrev_b32 v239, 16, v47
v_and_b32 v238, s53, v47
v_fma_f32 v245, v245, v79, v77
v_fma_f32 v244, v244, v79, v77
v_fma_f32 v243, v243, v79, v77
v_fma_f32 v242, v242, v79, v77
v_fma_f32 v241, v241, v79, v77
v_fma_f32 v240, v240, v79, v77
v_fma_f32 v239, v239, v79, v77
v_fma_f32 v238, v238, v79, v77
v_cvt_pk_bf16_f32 v44, v245, v244
v_cvt_pk_bf16_f32 v45, v243, v242
v_cvt_pk_bf16_f32 v46, v241, v240
v_cvt_pk_bf16_f32 v47, v239, v238
ds_write_b128 v237, v[44:47] offset:16512
v_and_b32 v255, 1, v252
v_lshrrev_b32 v254, 1, v250
v_lshl_or_b32 v255, v255, 1, v254
v_lshlrev_b32 v255, 5, v255
v_lshl_add_u32 v254, v252, 3, v250
v_lshl_add_u32 v255, v254, 7, v255
v_lshl_add_u32 v255, v249, 3, v255
v_xor_b32 v233, 64, v255
v_add_u32 v3, 0x10000, v233
v_xor_b32 v2, 96, v255
v_add_u32 v231, 0x10000, v2
v_lshl_add_u32 v255, v252, 3, v250
v_and_b32 v254, 1, v249
v_mul_u32_u24 v254, 24, v254
v_add_u32 v254, 155776, v254
v_mad_u32_u24 v230, v255, 48, v254
v_add_u32 v229, 192, v230
v_add_u32 v228, 1536, v230
v_mov_b32 v254, 155648
v_cmp_gt_u32 vcc, 2, v249
v_cmp_le_u32 s[6:7], 18, v255
s_nop 0
s_xor_b64 s[6:7], s[6:7], vcc
v_cndmask_b32 v230, v254, v230, s[6:7]
v_cmp_le_u32 s[6:7], 14, v255
s_nop 0
s_xor_b64 s[6:7], s[6:7], vcc
v_cndmask_b32 v229, v254, v229, s[6:7]
v_cmp_gt_u32 s[6:7], 4, v255
s_nop 0
s_andn2_b64 s[6:7], s[6:7], vcc
v_cndmask_b32 v228, v254, v228, s[6:7]
v_mov_b32 v10, 0
v_mov_b32 v11, 0
v_add_u32 v227, s61, v248
s_lshr_b32 s49, s45, 1
s_mul_i32 s96, s49, 108
s_mul_i32 s49, s60, 6
s_add_u32 s96, s96, s49
s_and_b32 s49, s45, 1
s_mul_i32 s49, s49, 3
s_add_u32 s96, s96, s49
s_lshl_b32 s96, s96, 10
s_add_u32 s96, s96, s46
s_add_u32 s97, s96, 221184
s_waitcnt vmcnt(0)
s_mul_i32 s51, s42, 8192
s_mov_b32 s51, 77824
v_lshlrev_b32 v255, 11, v250
v_lshl_add_u32 v255, v249, 8, v255
v_add_u32 v255, s51, v255
v_lshlrev_b32 v253, 3, v252
s_mov_b32 s50, 134678021
v_bfe_u32 v254, s50, v253, 8
v_xor_b32 v254, v254, v249
v_lshl_add_u32 v254, v254, 4, v255
ds_read_b128 v[40:43], v254 offset:0
ds_read_b128 v[108:111], v254 offset:1024
s_mov_b32 s50, 151587081
v_bfe_u32 v254, s50, v253, 8
v_xor_b32 v254, v254, v249
v_lshl_add_u32 v254, v254, 4, v255
ds_read_b128 v[44:47], v254 offset:0
ds_read_b128 v[112:115], v254 offset:1024
s_mov_b32 s50, 50462976
v_bfe_u32 v254, s50, v253, 8
v_xor_b32 v254, v254, v249
v_lshl_add_u32 v254, v254, 4, v255
ds_read_b128 v[100:103], v254 offset:0
ds_read_b128 v[116:119], v254 offset:1024
s_mov_b32 s50, 67372036
v_bfe_u32 v254, s50, v253, 8
v_xor_b32 v254, v254, v249
v_lshl_add_u32 v254, v254, 4, v255
ds_read_b128 v[104:107], v254 offset:0
ds_read_b128 v[120:123], v254 offset:1024
s_waitcnt lgkmcnt(0)
s_barrier
s_setprio 3
ds_read_b128 v[124:127], v236 offset:0
ds_read_b128 v[128:131], v236 offset:1024
ds_read_b64_tr_b16 v[80:81], v233 offset:0
ds_read_b64_tr_b16 v[82:83], v233 offset:512
ds_read_b64_tr_b16 v[84:85], v2 offset:0
ds_read_b64_tr_b16 v[86:87], v2 offset:512
ds_read_b64_tr_b16 v[88:89], v233 offset:4096
ds_read_b64_tr_b16 v[90:91], v233 offset:4608
ds_read_b64_tr_b16 v[92:93], v2 offset:4096
ds_read_b64_tr_b16 v[94:95], v2 offset:4608
ds_read_b128 v[132:135], v235 offset:8192
ds_read_b128 v[136:139], v235 offset:9216
ds_read_b128 v[140:143], v236 offset:16384
ds_read_b128 v[144:147], v236 offset:17408
ds_read_b128 v[148:151], v235 offset:24576
ds_read_b128 v[152:155], v235 offset:25600
v_mov_b32 v255, 0
buffer_load_dwordx2 v[224:225], v255, s[36:39], 0 offen sc1
s_waitcnt lgkmcnt(14)
s_waitcnt lgkmcnt(10)
v_mfma_f32_16x16x32_bf16 v[156:159], v[80:83], v[124:127], 0
ds_read_b64_tr_b16 v[96:97], v233 offset:12288
v_lshlrev_b32 v245, 16, v12
ds_read_b64_tr_b16 v[4:5], v230 offset:0
ds_read_b64_tr_b16 v[6:7], v229 offset:0
ds_read_b64_tr_b16 v[8:9], v228 offset:0
v_and_b32 v244, s53, v12
v_lshlrev_b32 v243, 16, v13
v_and_b32 v242, s53, v13
v_mfma_f32_16x16x32_bf16 v[160:163], v[80:83], v[128:131], 0
ds_read_b64_tr_b16 v[98:99], v233 offset:12800
v_lshlrev_b32 v241, 16, v14
v_and_b32 v240, s53, v14
v_lshlrev_b32 v239, 16, v15
v_and_b32 v238, s53, v15
v_fma_f32 v245, v245, v78, v76
v_mfma_f32_16x16x32_bf16 v[164:167], v[84:87], v[124:127], 0
ds_read_b64_tr_b16 v[80:81], v2 offset:12288
s_add_u32 m0, s48, 45056
s_add_u32 s49, s57, 332032
buffer_load_dwordx4 v232, s[12:15], s49 offen lds
v_fma_f32 v244, v244, v78, v76
v_fma_f32 v243, v243, v78, v76
v_fma_f32 v242, v242, v78, v76
v_mfma_f32_16x16x32_bf16 v[168:171], v[84:87], v[128:131], 0
ds_read_b64_tr_b16 v[82:83], v2 offset:12800
v_fma_f32 v241, v241, v78, v76
v_fma_f32 v240, v240, v78, v76
v_fma_f32 v239, v239, v78, v76
v_fma_f32 v238, v238, v78, v76
v_cvt_pk_bf16_f32 v12, v245, v244
s_waitcnt lgkmcnt(13)
v_mfma_f32_16x16x32_bf16 v[172:175], v[88:91], v[124:127], 0
ds_read_b64_tr_b16 v[84:85], v233 offset:16384
s_add_u32 m0, s48, 53248
s_add_u32 s49, s57, 442496
buffer_load_dwordx4 v246, s[12:15], s49 offen lds
s_waitcnt lgkmcnt(4)
v_mfma_f32_16x16x32_bf16 v[188:191], v[40:43], v[4:7], 0
v_mfma_f32_16x16x32_bf16 v[188:191], v[44:47], v[8:11], v[188:191]
v_mfma_f32_16x16x32_bf16 v[192:195], v[108:111], v[4:7], 0
v_mfma_f32_16x16x32_bf16 v[192:195], v[112:115], v[8:11], v[192:195]
v_mfma_f32_16x16x32_bf16 v[196:199], v[100:103], v[4:7], 0
v_mfma_f32_16x16x32_bf16 v[196:199], v[104:107], v[8:11], v[196:199]
v_mfma_f32_16x16x32_bf16 v[200:203], v[116:119], v[4:7], 0
v_mfma_f32_16x16x32_bf16 v[200:203], v[120:123], v[8:11], v[200:203]
v_cvt_pk_bf16_f32 v13, v243, v242
v_cvt_pk_bf16_f32 v14, v241, v240
v_cvt_pk_bf16_f32 v15, v239, v238
v_mfma_f32_16x16x32_bf16 v[176:179], v[88:91], v[128:131], 0
ds_read_b64_tr_b16 v[86:87], v233 offset:16896
ds_write_b128 v237, v[12:15] offset:32768
v_lshlrev_b32 v245, 16, v48
v_and_b32 v244, s53, v48
v_lshlrev_b32 v243, 16, v49
v_and_b32 v242, s53, v49
s_setprio 2
v_mfma_f32_16x16x32_bf16 v[180:183], v[92:95], v[124:127], 0
ds_read_b64_tr_b16 v[88:89], v2 offset:16384
s_add_u32 m0, s48, 61440
s_add_u32 s49, s57, 552960
buffer_load_dwordx4 v246, s[12:15], s49 offen lds
ds_read_b64_tr_b16 v[4:5], v230 offset:8
ds_read_b64_tr_b16 v[6:7], v229 offset:8
ds_read_b64_tr_b16 v[8:9], v228 offset:8
v_lshlrev_b32 v241, 16, v50
v_and_b32 v240, s53, v50
v_lshlrev_b32 v239, 16, v51
v_mfma_f32_16x16x32_bf16 v[184:187], v[92:95], v[128:131], 0
ds_read_b64_tr_b16 v[90:91], v2 offset:16896
v_and_b32 v238, s53, v51
v_fma_f32 v245, v245, v79, v77
v_fma_f32 v244, v244, v79, v77
v_fma_f32 v243, v243, v79, v77
v_fma_f32 v242, v242, v79, v77
s_waitcnt lgkmcnt(8)
v_mfma_f32_16x16x32_bf16 v[156:159], v[96:99], v[132:135], v[156:159]
ds_read_b64_tr_b16 v[92:93], v233 offset:24576
s_add_u32 m0, s48, 69632
s_add_u32 s49, s57, 553216
buffer_load_dwordx4 v232, s[12:15], s49 offen lds
v_fma_f32 v241, v241, v79, v77
v_cvt_pk_bf16_f32 v188, v188, v189
v_cvt_pk_bf16_f32 v189, v190, v191
v_cvt_pk_bf16_f32 v190, v192, v193
v_cvt_pk_bf16_f32 v191, v194, v195
buffer_store_dwordx4 v[188:191], v227, s[24:27], s96 offen offset:0 sc1
v_cvt_pk_bf16_f32 v196, v196, v197
v_cvt_pk_bf16_f32 v197, v198, v199
v_cvt_pk_bf16_f32 v198, v200, v201
v_cvt_pk_bf16_f32 v199, v202, v203
buffer_store_dwordx4 v[196:199], v227, s[24:27], s97 offen offset:0 sc1
v_fma_f32 v240, v240, v79, v77
v_fma_f32 v239, v239, v79, v77
v_fma_f32 v238, v238, v79, v77
v_mfma_f32_16x16x32_bf16 v[160:163], v[96:99], v[136:139], v[160:163]
ds_read_b64_tr_b16 v[94:95], v233 offset:25088
v_cvt_pk_bf16_f32 v48, v245, v244
v_cvt_pk_bf16_f32 v49, v243, v242
v_cvt_pk_bf16_f32 v50, v241, v240
v_cvt_pk_bf16_f32 v51, v239, v238
ds_write_b128 v237, v[48:51] offset:32896
v_mfma_f32_16x16x32_bf16 v[164:167], v[80:83], v[132:135], v[164:167]
ds_read_b64_tr_b16 v[96:97], v2 offset:24576
s_add_u32 m0, s48, 77824
s_add_u32 s49, s57, 663680
buffer_load_dwordx4 v246, s[12:15], s49 offen lds
s_waitcnt lgkmcnt(5)
v_mfma_f32_16x16x32_bf16 v[12:15], v[40:43], v[4:7], 0
v_mfma_f32_16x16x32_bf16 v[12:15], v[44:47], v[8:11], v[12:15]
v_mfma_f32_16x16x32_bf16 v[48:51], v[108:111], v[4:7], 0
v_mfma_f32_16x16x32_bf16 v[48:51], v[112:115], v[8:11], v[48:51]
v_mfma_f32_16x16x32_bf16 v[188:191], v[100:103], v[4:7], 0
v_mfma_f32_16x16x32_bf16 v[188:191], v[104:107], v[8:11], v[188:191]
v_mfma_f32_16x16x32_bf16 v[192:195], v[116:119], v[4:7], 0
v_mfma_f32_16x16x32_bf16 v[192:195], v[120:123], v[8:11], v[192:195]
v_lshlrev_b32 v245, 16, v16
v_and_b32 v244, s53, v16
v_lshlrev_b32 v243, 16, v17
v_mfma_f32_16x16x32_bf16 v[168:171], v[80:83], v[136:139], v[168:171]
ds_read_b64_tr_b16 v[98:99], v2 offset:25088
v_and_b32 v242, s53, v17
v_lshlrev_b32 v241, 16, v18
v_and_b32 v240, s53, v18
v_lshlrev_b32 v239, 16, v19
v_and_b32 v238, s53, v19
s_setprio 1
v_mfma_f32_16x16x32_bf16 v[172:175], v[84:87], v[132:135], v[172:175]
ds_read_b64_tr_b16 v[80:81], v233 offset:28672
s_add_u32 m0, s48, 86016
s_add_u32 s49, s57, 774144
buffer_load_dwordx4 v246, s[12:15], s49 offen lds
ds_read_b64_tr_b16 v[4:5], v230 offset:16
ds_read_b64_tr_b16 v[6:7], v229 offset:16
ds_read_b64_tr_b16 v[8:9], v228 offset:16
v_fma_f32 v245, v245, v78, v76
v_fma_f32 v244, v244, v78, v76
v_fma_f32 v243, v243, v78, v76
v_mfma_f32_16x16x32_bf16 v[176:179], v[84:87], v[136:139], v[176:179]
ds_read_b64_tr_b16 v[82:83], v233 offset:29184
v_fma_f32 v242, v242, v78, v76
v_fma_f32 v241, v241, v78, v76
v_fma_f32 v240, v240, v78, v76
v_fma_f32 v239, v239, v78, v76
v_fma_f32 v238, v238, v78, v76
s_waitcnt lgkmcnt(10)
v_mfma_f32_16x16x32_bf16 v[180:183], v[88:91], v[132:135], v[180:183]
ds_read_b64_tr_b16 v[84:85], v2 offset:28672
v_cvt_pk_bf16_f32 v12, v12, v13
v_cvt_pk_bf16_f32 v13, v14, v15
v_cvt_pk_bf16_f32 v14, v48, v49
v_cvt_pk_bf16_f32 v15, v50, v51
buffer_store_dwordx4 v[12:15], v227, s[24:27], s96 offen offset:1024 sc1
v_cvt_pk_bf16_f32 v188, v188, v189
v_cvt_pk_bf16_f32 v189, v190, v191
v_cvt_pk_bf16_f32 v190, v192, v193
v_cvt_pk_bf16_f32 v191, v194, v195
buffer_store_dwordx4 v[188:191], v227, s[24:27], s97 offen offset:1024 sc1
v_cvt_pk_bf16_f32 v16, v245, v244
v_cvt_pk_bf16_f32 v17, v243, v242
v_cvt_pk_bf16_f32 v18, v241, v240
v_cvt_pk_bf16_f32 v19, v239, v238
v_mfma_f32_16x16x32_bf16 v[184:187], v[88:91], v[136:139], v[184:187]
ds_read_b64_tr_b16 v[86:87], v2 offset:29184
ds_write_b128 v237, v[16:19] offset:49152
v_lshlrev_b32 v245, 16, v52
v_and_b32 v244, s53, v52
v_lshlrev_b32 v243, 16, v53
s_waitcnt lgkmcnt(8)
v_mfma_f32_16x16x32_bf16 v[156:159], v[92:95], v[140:143], v[156:159]
ds_read_b64_tr_b16 v[88:89], v233 offset:36864
v_and_b32 v242, s53, v53
s_waitcnt lgkmcnt(5)
v_mfma_f32_16x16x32_bf16 v[12:15], v[40:43], v[4:7], 0
v_mfma_f32_16x16x32_bf16 v[12:15], v[44:47], v[8:11], v[12:15]
v_mfma_f32_16x16x32_bf16 v[16:19], v[108:111], v[4:7], 0
v_mfma_f32_16x16x32_bf16 v[16:19], v[112:115], v[8:11], v[16:19]
v_mfma_f32_16x16x32_bf16 v[48:51], v[100:103], v[4:7], 0
v_mfma_f32_16x16x32_bf16 v[48:51], v[104:107], v[8:11], v[48:51]
v_mfma_f32_16x16x32_bf16 v[188:191], v[116:119], v[4:7], 0
v_mfma_f32_16x16x32_bf16 v[188:191], v[120:123], v[8:11], v[188:191]
v_lshlrev_b32 v241, 16, v54
v_and_b32 v240, s53, v54
v_lshlrev_b32 v239, 16, v55
v_mfma_f32_16x16x32_bf16 v[160:163], v[92:95], v[144:147], v[160:163]
ds_read_b64_tr_b16 v[90:91], v233 offset:37376
v_and_b32 v238, s53, v55
v_fma_f32 v245, v245, v79, v77
v_fma_f32 v244, v244, v79, v77
v_fma_f32 v243, v243, v79, v77
v_fma_f32 v242, v242, v79, v77
s_setprio 0
v_mfma_f32_16x16x32_bf16 v[164:167], v[96:99], v[140:143], v[164:167]
ds_read_b64_tr_b16 v[92:93], v2 offset:36864
v_fma_f32 v241, v241, v79, v77
v_fma_f32 v240, v240, v79, v77
v_fma_f32 v239, v239, v79, v77
v_fma_f32 v238, v238, v79, v77
v_mfma_f32_16x16x32_bf16 v[168:171], v[96:99], v[144:147], v[168:171]
ds_read_b64_tr_b16 v[94:95], v2 offset:37376
v_cvt_pk_bf16_f32 v52, v245, v244
v_cvt_pk_bf16_f32 v53, v243, v242
v_cvt_pk_bf16_f32 v54, v241, v240
v_cvt_pk_bf16_f32 v55, v239, v238
s_waitcnt lgkmcnt(5)
v_mfma_f32_16x16x32_bf16 v[172:175], v[80:83], v[140:143], v[172:175]
ds_read_b64_tr_b16 v[96:97], v233 offset:40960
v_cvt_pk_bf16_f32 v12, v12, v13
v_cvt_pk_bf16_f32 v13, v14, v15
v_cvt_pk_bf16_f32 v14, v16, v17
v_cvt_pk_bf16_f32 v15, v18, v19
buffer_store_dwordx4 v[12:15], v227, s[24:27], s96 offen offset:2048 sc1
v_cvt_pk_bf16_f32 v48, v48, v49
v_cvt_pk_bf16_f32 v49, v50, v51
v_cvt_pk_bf16_f32 v50, v188, v189
v_cvt_pk_bf16_f32 v51, v190, v191
buffer_store_dwordx4 v[48:51], v227, s[24:27], s97 offen offset:2048 sc1
ds_write_b128 v237, v[52:55] offset:49280
v_mfma_f32_16x16x32_bf16 v[176:179], v[80:83], v[144:147], v[176:179]
ds_read_b64_tr_b16 v[98:99], v233 offset:41472
v_mfma_f32_16x16x32_bf16 v[180:183], v[84:87], v[140:143], v[180:183]
ds_read_b64_tr_b16 v[80:81], v2 offset:40960
v_mfma_f32_16x16x32_bf16 v[184:187], v[84:87], v[144:147], v[184:187]
ds_read_b64_tr_b16 v[82:83], v2 offset:41472
s_waitcnt vmcnt(5)
s_waitcnt lgkmcnt(3)
s_barrier
s_setprio 3
ds_read_b128 v[4:7], v236 offset:32768
ds_read_b128 v[8:11], v236 offset:33792
ds_read_b128 v[12:15], v235 offset:40960
ds_read_b128 v[16:19], v235 offset:41984
ds_read_b128 v[40:43], v236 offset:49152
ds_read_b128 v[44:47], v236 offset:50176
ds_read_b128 v[48:51], v235 offset:57344
ds_read_b128 v[52:55], v235 offset:58368
v_mfma_f32_16x16x32_bf16 v[156:159], v[88:91], v[148:151], v[156:159]
ds_read_b64_tr_b16 v[84:85], v233 offset:49152
v_lshlrev_b32 v245, 16, v20
v_and_b32 v244, s53, v20
v_lshlrev_b32 v243, 16, v21
v_and_b32 v242, s53, v21
v_lshlrev_b32 v241, 16, v22
v_mfma_f32_16x16x32_bf16 v[160:163], v[88:91], v[152:155], v[160:163]
ds_read_b64_tr_b16 v[86:87], v233 offset:49664
v_and_b32 v240, s53, v22
v_lshlrev_b32 v239, 16, v23
v_and_b32 v238, s53, v23
v_fma_f32 v245, v245, v78, v76
v_mfma_f32_16x16x32_bf16 v[164:167], v[92:95], v[148:151], v[164:167]
ds_read_b64_tr_b16 v[88:89], v2 offset:49152
s_add_u32 m0, s48, 4096
s_add_u32 s49, s57, 774400
buffer_load_dwordx4 v232, s[12:15], s49 offen lds
v_fma_f32 v244, v244, v78, v76
v_fma_f32 v243, v243, v78, v76
v_fma_f32 v242, v242, v78, v76
v_fma_f32 v241, v241, v78, v76
v_mfma_f32_16x16x32_bf16 v[168:171], v[92:95], v[152:155], v[168:171]
ds_read_b64_tr_b16 v[90:91], v2 offset:49664
v_fma_f32 v240, v240, v78, v76
v_fma_f32 v239, v239, v78, v76
v_fma_f32 v238, v238, v78, v76
v_cvt_pk_bf16_f32 v20, v245, v244
s_waitcnt lgkmcnt(12)
v_mfma_f32_16x16x32_bf16 v[172:175], v[96:99], v[148:151], v[172:175]
ds_read_b64_tr_b16 v[92:93], v233 offset:53248
v_cvt_pk_bf16_f32 v21, v243, v242
v_cvt_pk_bf16_f32 v22, v241, v240
v_cvt_pk_bf16_f32 v23, v239, v238
ds_write_b128 v237, v[20:23] offset:0
v_mfma_f32_16x16x32_bf16 v[176:179], v[96:99], v[152:155], v[176:179]
ds_read_b64_tr_b16 v[94:95], v233 offset:53760
v_lshlrev_b32 v245, 16, v56
v_and_b32 v244, s53, v56
v_lshlrev_b32 v243, 16, v57
v_and_b32 v242, s53, v57
s_setprio 2
v_mfma_f32_16x16x32_bf16 v[180:183], v[80:83], v[148:151], v[180:183]
ds_read_b64_tr_b16 v[96:97], v2 offset:53248
s_add_u32 m0, s48, 12288
s_add_u32 s49, s57, 884864
buffer_load_dwordx4 v246, s[12:15], s49 offen lds
v_lshlrev_b32 v241, 16, v58
v_and_b32 v240, s53, v58
v_lshlrev_b32 v239, 16, v59
v_and_b32 v238, s53, v59
v_mfma_f32_16x16x32_bf16 v[184:187], v[80:83], v[152:155], v[184:187]
ds_read_b64_tr_b16 v[98:99], v2 offset:53760
v_fma_f32 v245, v245, v79, v77
v_fma_f32 v244, v244, v79, v77
v_fma_f32 v243, v243, v79, v77
v_fma_f32 v242, v242, v79, v77
s_waitcnt lgkmcnt(15)
s_waitcnt lgkmcnt(5)
v_mfma_f32_16x16x32_bf16 v[156:159], v[84:87], v[4:7], v[156:159]
ds_read_b64_tr_b16 v[80:81], v233 offset:61440
v_fma_f32 v241, v241, v79, v77
v_fma_f32 v240, v240, v79, v77
v_fma_f32 v239, v239, v79, v77
v_fma_f32 v238, v238, v79, v77
v_cvt_pk_bf16_f32 v56, v245, v244
v_mfma_f32_16x16x32_bf16 v[160:163], v[84:87], v[8:11], v[160:163]
ds_read_b64_tr_b16 v[82:83], v233 offset:61952
v_cvt_pk_bf16_f32 v57, v243, v242
v_cvt_pk_bf16_f32 v58, v241, v240
v_cvt_pk_bf16_f32 v59, v239, v238
ds_write_b128 v237, v[56:59] offset:128
v_mfma_f32_16x16x32_bf16 v[164:167], v[88:91], v[4:7], v[164:167]
ds_read_b64_tr_b16 v[84:85], v2 offset:61440
s_add_u32 m0, s48, 20480
s_add_u32 s49, s57, 995328
buffer_load_dwordx4 v246, s[12:15], s49 offen lds
v_lshlrev_b32 v245, 16, v24
v_and_b32 v244, s53, v24
v_lshlrev_b32 v243, 16, v25
v_and_b32 v242, s53, v25
v_mfma_f32_16x16x32_bf16 v[168:171], v[88:91], v[8:11], v[168:171]
ds_read_b64_tr_b16 v[86:87], v2 offset:61952
v_lshlrev_b32 v241, 16, v26
v_and_b32 v240, s53, v26
v_lshlrev_b32 v239, 16, v27
v_and_b32 v238, s53, v27
s_setprio 1
s_waitcnt lgkmcnt(5)
v_mfma_f32_16x16x32_bf16 v[172:175], v[92:95], v[4:7], v[172:175]
ds_read_b64_tr_b16 v[88:89], v3 offset:0
v_fma_f32 v245, v245, v78, v76
v_fma_f32 v244, v244, v78, v76
v_fma_f32 v243, v243, v78, v76
v_fma_f32 v242, v242, v78, v76
v_mfma_f32_16x16x32_bf16 v[176:179], v[92:95], v[8:11], v[176:179]
ds_read_b64_tr_b16 v[90:91], v3 offset:512
v_fma_f32 v241, v241, v78, v76
v_fma_f32 v240, v240, v78, v76
v_fma_f32 v239, v239, v78, v76
v_fma_f32 v238, v238, v78, v76
v_mfma_f32_16x16x32_bf16 v[180:183], v[96:99], v[4:7], v[180:183]
ds_read_b64_tr_b16 v[92:93], v231 offset:0
s_add_u32 m0, s48, 28672
s_add_u32 s49, s57, 995584
buffer_load_dwordx4 v232, s[12:15], s49 offen lds
v_cvt_pk_bf16_f32 v24, v245, v244
v_cvt_pk_bf16_f32 v25, v243, v242
v_cvt_pk_bf16_f32 v26, v241, v240
v_cvt_pk_bf16_f32 v27, v239, v238
v_mfma_f32_16x16x32_bf16 v[184:187], v[96:99], v[8:11], v[184:187]
ds_read_b64_tr_b16 v[94:95], v231 offset:512
ds_write_b128 v237, v[24:27] offset:16384
v_lshlrev_b32 v245, 16, v60
v_and_b32 v244, s53, v60
v_lshlrev_b32 v243, 16, v61
s_waitcnt lgkmcnt(5)
v_mfma_f32_16x16x32_bf16 v[156:159], v[80:83], v[12:15], v[156:159]
ds_read_b64_tr_b16 v[96:97], v3 offset:8192
v_and_b32 v242, s53, v61
v_lshlrev_b32 v241, 16, v62
v_and_b32 v240, s53, v62
v_lshlrev_b32 v239, 16, v63
v_and_b32 v238, s53, v63
v_mfma_f32_16x16x32_bf16 v[160:163], v[80:83], v[16:19], v[160:163]
ds_read_b64_tr_b16 v[98:99], v3 offset:8704
v_fma_f32 v245, v245, v79, v77
v_fma_f32 v244, v244, v79, v77
v_fma_f32 v243, v243, v79, v77
v_fma_f32 v242, v242, v79, v77
s_setprio 0
v_mfma_f32_16x16x32_bf16 v[164:167], v[84:87], v[12:15], v[164:167]
ds_read_b64_tr_b16 v[80:81], v231 offset:8192
v_fma_f32 v241, v241, v79, v77
v_fma_f32 v240, v240, v79, v77
v_fma_f32 v239, v239, v79, v77
v_fma_f32 v238, v238, v79, v77
v_cvt_pk_bf16_f32 v60, v245, v244
v_mfma_f32_16x16x32_bf16 v[168:171], v[84:87], v[16:19], v[168:171]
ds_read_b64_tr_b16 v[82:83], v231 offset:8704
v_cvt_pk_bf16_f32 v61, v243, v242
v_cvt_pk_bf16_f32 v62, v241, v240
v_cvt_pk_bf16_f32 v63, v239, v238
s_mov_b32 s52, 0
L_spa1_1:
v_cmp_eq_u32 vcc, 0, v224
s_nop 1
s_cmp_eq_u64 vcc, 0
s_cbranch_scc1 L_spa1_1x
s_add_u32 s52, s52, 1
s_cmp_ge_u32 s52, 0x10000
s_cbranch_scc1 L_spa1_1x
s_sleep 2
v_mov_b32 v255, 0
buffer_load_dwordx2 v[224:225], v255, s[36:39], 0 offen sc1
s_waitcnt vmcnt(0)
s_branch L_spa1_1
L_spa1_1x:
v_readfirstlane_b32 s98, v224
v_readfirstlane_b32 s99, v225
s_waitcnt vmcnt(4)
s_mul_i32 s50, s40, 5
s_add_u32 s50, s50, s44
s_lshl_b32 s51, s2, 4
s_add_u32 s51, s51, 0x10000
s_cmp_lt_u32 s44, 5
s_cselect_b32 s50, s50, s51
s_lshl_b32 s50, s50, 3
s_lshl_b32 s51, s41, 10
s_add_u32 s50, s50, s51
s_add_u32 s50, s50, 46137344
v_mov_b32 v228, s98
v_mov_b32 v229, s99
s_mov_b64 exec, 1
buffer_store_dwordx2 v[228:229], v248, s[24:27], s50 offen sc1
s_mov_b64 exec, -1
s_waitcnt lgkmcnt(5)
v_mfma_f32_16x16x32_bf16 v[172:175], v[88:91], v[12:15], v[172:175]
ds_read_b64_tr_b16 v[84:85], v3 offset:12288
ds_write_b128 v237, v[60:63] offset:16512
v_mfma_f32_16x16x32_bf16 v[176:179], v[88:91], v[16:19], v[176:179]
ds_read_b64_tr_b16 v[86:87], v3 offset:12800
v_mfma_f32_16x16x32_bf16 v[180:183], v[92:95], v[12:15], v[180:183]
ds_read_b64_tr_b16 v[88:89], v231 offset:12288
v_mfma_f32_16x16x32_bf16 v[184:187], v[92:95], v[16:19], v[184:187]
ds_read_b64_tr_b16 v[90:91], v231 offset:12800
s_waitcnt vmcnt(2)
s_waitcnt lgkmcnt(3)
s_barrier
s_setprio 3
ds_read_b128 v[20:23], v236 offset:0
ds_read_b128 v[24:27], v236 offset:1024
ds_read_b128 v[56:59], v235 offset:8192
ds_read_b128 v[60:63], v235 offset:9216
ds_read_b128 v[100:103], v236 offset:16384
ds_read_b128 v[104:107], v236 offset:17408
ds_read_b128 v[108:111], v235 offset:24576
ds_read_b128 v[112:115], v235 offset:25600
v_mfma_f32_16x16x32_bf16 v[156:159], v[96:99], v[40:43], v[156:159]
ds_read_b64_tr_b16 v[92:93], v3 offset:20480
v_lshlrev_b32 v245, 16, v28
v_and_b32 v244, s53, v28
v_lshlrev_b32 v243, 16, v29
v_and_b32 v242, s53, v29
v_lshlrev_b32 v241, 16, v30
v_mfma_f32_16x16x32_bf16 v[160:163], v[96:99], v[44:47], v[160:163]
ds_read_b64_tr_b16 v[94:95], v3 offset:20992
v_and_b32 v240, s53, v30
v_lshlrev_b32 v239, 16, v31
v_and_b32 v238, s53, v31
v_fma_f32 v245, v245, v78, v76
v_mfma_f32_16x16x32_bf16 v[164:167], v[80:83], v[40:43], v[164:167]
ds_read_b64_tr_b16 v[96:97], v231 offset:20480
s_add_u32 m0, s48, 36864
s_add_u32 s49, s57, 1106048
buffer_load_dwordx4 v246, s[12:15], s49 offen lds
v_fma_f32 v244, v244, v78, v76
v_fma_f32 v243, v243, v78, v76
v_fma_f32 v242, v242, v78, v76
v_fma_f32 v241, v241, v78, v76
v_mfma_f32_16x16x32_bf16 v[168:171], v[80:83], v[44:47], v[168:171]
ds_read_b64_tr_b16 v[98:99], v231 offset:20992
v_fma_f32 v240, v240, v78, v76
v_fma_f32 v239, v239, v78, v76
v_fma_f32 v238, v238, v78, v76
v_cvt_pk_bf16_f32 v28, v245, v244
s_waitcnt lgkmcnt(12)
v_mfma_f32_16x16x32_bf16 v[172:175], v[84:87], v[40:43], v[172:175]
ds_read_b64_tr_b16 v[80:81], v233 offset:0
v_cvt_pk_bf16_f32 v29, v243, v242
v_cvt_pk_bf16_f32 v30, v241, v240
v_cvt_pk_bf16_f32 v31, v239, v238
ds_write_b128 v237, v[28:31] offset:32768
v_mfma_f32_16x16x32_bf16 v[176:179], v[84:87], v[44:47], v[176:179]
ds_read_b64_tr_b16 v[82:83], v233 offset:512
v_lshlrev_b32 v245, 16, v64
v_and_b32 v244, s53, v64
v_lshlrev_b32 v243, 16, v65
v_and_b32 v242, s53, v65
s_setprio 2
v_mfma_f32_16x16x32_bf16 v[180:183], v[88:91], v[40:43], v[180:183]
ds_read_b64_tr_b16 v[84:85], v2 offset:0
s_add_u32 m0, s48, 45056
s_add_u32 s49, s57, 1216512
buffer_load_dwordx4 v246, s[12:15], s49 offen lds
v_lshlrev_b32 v241, 16, v66
v_and_b32 v240, s53, v66
v_lshlrev_b32 v239, 16, v67
v_and_b32 v238, s53, v67
v_mfma_f32_16x16x32_bf16 v[184:187], v[88:91], v[44:47], v[184:187]
ds_read_b64_tr_b16 v[86:87], v2 offset:512
v_fma_f32 v245, v245, v79, v77
v_fma_f32 v244, v244, v79, v77
v_fma_f32 v243, v243, v79, v77
v_fma_f32 v242, v242, v79, v77
s_waitcnt lgkmcnt(5)
v_mfma_f32_16x16x32_bf16 v[156:159], v[92:95], v[48:51], v[156:159]
ds_read_b64_tr_b16 v[88:89], v233 offset:8192
v_fma_f32 v241, v241, v79, v77
v_fma_f32 v240, v240, v79, v77
v_fma_f32 v239, v239, v79, v77
v_fma_f32 v238, v238, v79, v77
v_cvt_pk_bf16_f32 v64, v245, v244
v_mfma_f32_16x16x32_bf16 v[160:163], v[92:95], v[52:55], v[160:163]
ds_read_b64_tr_b16 v[90:91], v233 offset:8704
v_cvt_pk_bf16_f32 v65, v243, v242
v_cvt_pk_bf16_f32 v66, v241, v240
v_cvt_pk_bf16_f32 v67, v239, v238
ds_write_b128 v237, v[64:67] offset:32896
v_mfma_f32_16x16x32_bf16 v[164:167], v[96:99], v[48:51], v[164:167]
ds_read_b64_tr_b16 v[92:93], v2 offset:8192
s_add_u32 m0, s48, 53248
s_add_u32 s49, s57, 1216768
buffer_load_dwordx4 v232, s[12:15], s49 offen lds
v_lshlrev_b32 v245, 16, v32
v_and_b32 v244, s53, v32
v_lshlrev_b32 v243, 16, v33
v_and_b32 v242, s53, v33
v_mfma_f32_16x16x32_bf16 v[168:171], v[96:99], v[52:55], v[168:171]
ds_read_b64_tr_b16 v[94:95], v2 offset:8704
v_lshlrev_b32 v241, 16, v34
v_and_b32 v240, s53, v34
v_lshlrev_b32 v239, 16, v35
v_and_b32 v238, s53, v35
s_setprio 1
s_waitcnt lgkmcnt(5)
v_mfma_f32_16x16x32_bf16 v[172:175], v[80:83], v[48:51], v[172:175]
ds_read_b64_tr_b16 v[96:97], v233 offset:12288
v_fma_f32 v245, v245, v78, v76
v_fma_f32 v244, v244, v78, v76
v_fma_f32 v243, v243, v78, v76
v_fma_f32 v242, v242, v78, v76
v_mfma_f32_16x16x32_bf16 v[176:179], v[80:83], v[52:55], v[176:179]
ds_read_b64_tr_b16 v[98:99], v233 offset:12800
v_fma_f32 v241, v241, v78, v76
v_fma_f32 v240, v240, v78, v76
v_fma_f32 v239, v239, v78, v76
v_fma_f32 v238, v238, v78, v76
v_mfma_f32_16x16x32_bf16 v[180:183], v[84:87], v[48:51], v[180:183]
ds_read_b64_tr_b16 v[80:81], v2 offset:12288
s_add_u32 m0, s48, 61440
s_add_u32 s49, s57, 1327232
buffer_load_dwordx4 v246, s[12:15], s49 offen lds
v_cvt_pk_bf16_f32 v32, v245, v244
v_cvt_pk_bf16_f32 v33, v243, v242
v_cvt_pk_bf16_f32 v34, v241, v240
v_cvt_pk_bf16_f32 v35, v239, v238
v_mfma_f32_16x16x32_bf16 v[184:187], v[84:87], v[52:55], v[184:187]
ds_read_b64_tr_b16 v[82:83], v2 offset:12800
ds_write_b128 v237, v[32:35] offset:49152
v_lshlrev_b32 v245, 16, v68
v_and_b32 v244, s53, v68
v_lshlrev_b32 v243, 16, v69
s_waitcnt lgkmcnt(5)
v_mfma_f32_16x16x32_bf16 v[156:159], v[88:91], v[20:23], v[156:159]
ds_read_b64_tr_b16 v[84:85], v233 offset:20480
v_and_b32 v242, s53, v69
v_lshlrev_b32 v241, 16, v70
v_and_b32 v240, s53, v70
v_lshlrev_b32 v239, 16, v71
v_and_b32 v238, s53, v71
v_mfma_f32_16x16x32_bf16 v[160:163], v[88:91], v[24:27], v[160:163]
ds_read_b64_tr_b16 v[86:87], v233 offset:20992
v_fma_f32 v245, v245, v79, v77
v_fma_f32 v244, v244, v79, v77
v_fma_f32 v243, v243, v79, v77
v_fma_f32 v242, v242, v79, v77
s_setprio 0
v_mfma_f32_16x16x32_bf16 v[164:167], v[92:95], v[20:23], v[164:167]
ds_read_b64_tr_b16 v[88:89], v2 offset:20480
s_add_u32 m0, s48, 69632
s_add_u32 s49, s57, 1437696
buffer_load_dwordx4 v246, s[12:15], s49 offen lds
v_fma_f32 v241, v241, v79, v77
v_fma_f32 v240, v240, v79, v77
v_fma_f32 v239, v239, v79, v77
v_fma_f32 v238, v238, v79, v77
v_mfma_f32_16x16x32_bf16 v[168:171], v[92:95], v[24:27], v[168:171]
ds_read_b64_tr_b16 v[90:91], v2 offset:20992
v_cvt_pk_bf16_f32 v68, v245, v244
v_cvt_pk_bf16_f32 v69, v243, v242
v_cvt_pk_bf16_f32 v70, v241, v240
v_cvt_pk_bf16_f32 v71, v239, v238
s_waitcnt lgkmcnt(5)
v_mfma_f32_16x16x32_bf16 v[172:175], v[96:99], v[20:23], v[172:175]
ds_read_b64_tr_b16 v[92:93], v233 offset:24576
ds_write_b128 v237, v[68:71] offset:49280
v_mfma_f32_16x16x32_bf16 v[176:179], v[96:99], v[24:27], v[176:179]
ds_read_b64_tr_b16 v[94:95], v233 offset:25088
v_mfma_f32_16x16x32_bf16 v[180:183], v[80:83], v[20:23], v[180:183]
ds_read_b64_tr_b16 v[96:97], v2 offset:24576
v_mfma_f32_16x16x32_bf16 v[184:187], v[80:83], v[24:27], v[184:187]
ds_read_b64_tr_b16 v[98:99], v2 offset:25088
s_waitcnt vmcnt(1)
s_waitcnt lgkmcnt(3)
s_barrier
s_setprio 3
ds_read_b128 v[28:31], v236 offset:32768
ds_read_b128 v[32:35], v236 offset:33792
ds_read_b128 v[64:67], v235 offset:40960
ds_read_b128 v[68:71], v235 offset:41984
ds_read_b128 v[116:119], v236 offset:49152
ds_read_b128 v[120:123], v236 offset:50176
ds_read_b128 v[188:191], v235 offset:57344
ds_read_b128 v[192:195], v235 offset:58368
s_lshl_b32 s50, s41, 10
s_add_u32 s50, s50, 46137856
v_min_u32 v255, 15, v1
v_lshlrev_b32 v255, 3, v255
buffer_load_dwordx2 v[228:229], v255, s[24:27], s50 offen sc1
v_mfma_f32_16x16x32_bf16 v[156:159], v[84:87], v[56:59], v[156:159]
ds_read_b64_tr_b16 v[80:81], v233 offset:32768
v_lshlrev_b32 v245, 16, v36
v_and_b32 v244, s53, v36
v_lshlrev_b32 v243, 16, v37
v_mfma_f32_16x16x32_bf16 v[160:163], v[84:87], v[60:63], v[160:163]
ds_read_b64_tr_b16 v[82:83], v233 offset:33280
v_and_b32 v242, s53, v37
v_lshlrev_b32 v241, 16, v38
v_mfma_f32_16x16x32_bf16 v[164:167], v[88:91], v[56:59], v[164:167]
ds_read_b64_tr_b16 v[84:85], v2 offset:32768
s_add_u32 m0, s48, 4096
s_add_u32 s49, s57, 1437952
buffer_load_dwordx4 v232, s[12:15], s49 offen lds
v_and_b32 v240, s53, v38
v_lshlrev_b32 v239, 16, v39
v_mfma_f32_16x16x32_bf16 v[168:171], v[88:91], v[60:63], v[168:171]
ds_read_b64_tr_b16 v[86:87], v2 offset:33280
v_and_b32 v238, s53, v39
v_fma_f32 v245, v245, v78, v76
s_waitcnt lgkmcnt(12)
v_mfma_f32_16x16x32_bf16 v[172:175], v[92:95], v[56:59], v[172:175]
ds_read_b64_tr_b16 v[88:89], v233 offset:36864
s_add_u32 m0, s48, 12288
s_add_u32 s49, s57, 1548416
buffer_load_dwordx4 v246, s[12:15], s49 offen lds
v_fma_f32 v244, v244, v78, v76
v_fma_f32 v243, v243, v78, v76
v_mfma_f32_16x16x32_bf16 v[176:179], v[92:95], v[60:63], v[176:179]
ds_read_b64_tr_b16 v[90:91], v233 offset:37376
v_fma_f32 v242, v242, v78, v76
v_fma_f32 v241, v241, v78, v76
s_setprio 2
v_mfma_f32_16x16x32_bf16 v[180:183], v[96:99], v[56:59], v[180:183]
ds_read_b64_tr_b16 v[92:93], v2 offset:36864
s_add_u32 m0, s48, 73728
s_add_u32 s49, s57, 1658880
buffer_load_dwordx4 v246, s[12:15], s49 offen lds
v_fma_f32 v240, v240, v78, v76
v_fma_f32 v239, v239, v78, v76
v_mfma_f32_16x16x32_bf16 v[184:187], v[96:99], v[60:63], v[184:187]
ds_read_b64_tr_b16 v[94:95], v2 offset:37376
v_fma_f32 v238, v238, v78, v76
v_cvt_pk_bf16_f32 v36, v245, v244
s_waitcnt lgkmcnt(4)
v_mfma_f32_16x16x32_bf16 v[156:159], v[80:83], v[100:103], v[156:159]
ds_read_b64_tr_b16 v[96:97], v233 offset:45056
s_add_u32 m0, s48, 81920
s_add_u32 s49, s57, 1659136
buffer_load_dwordx4 v232, s[12:15], s49 offen lds
v_cvt_pk_bf16_f32 v37, v243, v242
v_cvt_pk_bf16_f32 v38, v241, v240
v_mfma_f32_16x16x32_bf16 v[160:163], v[80:83], v[104:107], v[160:163]
ds_read_b64_tr_b16 v[98:99], v233 offset:45568
v_cvt_pk_bf16_f32 v39, v239, v238
ds_write_b128 v237, v[36:39] offset:0
v_mfma_f32_16x16x32_bf16 v[164:167], v[84:87], v[100:103], v[164:167]
ds_read_b64_tr_b16 v[80:81], v2 offset:45056
s_add_u32 m0, s48, 106496
s_add_u32 s49, s57, 1769600
buffer_load_dwordx4 v246, s[12:15], s49 offen lds
v_lshlrev_b32 v245, 16, v72
v_and_b32 v244, s53, v72
v_mfma_f32_16x16x32_bf16 v[168:171], v[84:87], v[104:107], v[168:171]
ds_read_b64_tr_b16 v[82:83], v2 offset:45568
v_lshlrev_b32 v243, 16, v73
v_and_b32 v242, s53, v73
s_setprio 1
s_waitcnt lgkmcnt(5)
v_mfma_f32_16x16x32_bf16 v[172:175], v[88:91], v[100:103], v[172:175]
ds_read_b64_tr_b16 v[84:85], v233 offset:49152
s_add_u32 m0, s48, 114688
s_add_u32 s49, s57, 1880064
buffer_load_dwordx4 v246, s[12:15], s49 offen lds
v_lshlrev_b32 v241, 16, v74
v_and_b32 v240, s53, v74
v_mfma_f32_16x16x32_bf16 v[176:179], v[88:91], v[104:107], v[176:179]
ds_read_b64_tr_b16 v[86:87], v233 offset:49664
v_lshlrev_b32 v239, 16, v75
v_and_b32 v238, s53, v75
v_fma_f32 v245, v245, v79, v77
v_mfma_f32_16x16x32_bf16 v[180:183], v[92:95], v[100:103], v[180:183]
ds_read_b64_tr_b16 v[88:89], v2 offset:49152
v_fma_f32 v244, v244, v79, v77
v_fma_f32 v243, v243, v79, v77
v_mfma_f32_16x16x32_bf16 v[184:187], v[92:95], v[104:107], v[184:187]
ds_read_b64_tr_b16 v[90:91], v2 offset:49664
v_fma_f32 v242, v242, v79, v77
v_fma_f32 v241, v241, v79, v77
s_waitcnt lgkmcnt(4)
v_mfma_f32_16x16x32_bf16 v[156:159], v[96:99], v[108:111], v[156:159]
ds_read_b64_tr_b16 v[92:93], v233 offset:57344
v_fma_f32 v240, v240, v79, v77
v_fma_f32 v239, v239, v79, v77
v_mfma_f32_16x16x32_bf16 v[160:163], v[96:99], v[112:115], v[160:163]
ds_read_b64_tr_b16 v[94:95], v233 offset:57856
v_fma_f32 v238, v238, v79, v77
v_cvt_pk_bf16_f32 v72, v245, v244
s_setprio 0
v_mfma_f32_16x16x32_bf16 v[164:167], v[80:83], v[108:111], v[164:167]
ds_read_b64_tr_b16 v[96:97], v2 offset:57344
v_cvt_pk_bf16_f32 v73, v243, v242
v_cvt_pk_bf16_f32 v74, v241, v240
v_mfma_f32_16x16x32_bf16 v[168:171], v[80:83], v[112:115], v[168:171]
ds_read_b64_tr_b16 v[98:99], v2 offset:57856
v_cvt_pk_bf16_f32 v75, v239, v238
ds_write_b128 v237, v[72:75] offset:128
s_waitcnt lgkmcnt(5)
v_mfma_f32_16x16x32_bf16 v[172:175], v[84:87], v[108:111], v[172:175]
ds_read_b64_tr_b16 v[80:81], v233 offset:61440
v_mfma_f32_16x16x32_bf16 v[176:179], v[84:87], v[112:115], v[176:179]
ds_read_b64_tr_b16 v[82:83], v233 offset:61952
v_mfma_f32_16x16x32_bf16 v[180:183], v[88:91], v[108:111], v[180:183]
ds_read_b64_tr_b16 v[84:85], v2 offset:61440
v_mfma_f32_16x16x32_bf16 v[184:187], v[88:91], v[112:115], v[184:187]
ds_read_b64_tr_b16 v[86:87], v2 offset:61952
s_waitcnt vmcnt(6)
s_mov_b32 s52, 0
L_spa1_2:
v_cmp_ne_u64 vcc, s[98:99], v[228:229]
s_nop 1
s_cmp_eq_u64 vcc, 0
s_cbranch_scc1 L_spa1_2x
s_add_u32 s52, s52, 1
s_cmp_ge_u32 s52, 0x10000
s_cbranch_scc1 L_spa1_2x
s_sleep 2
s_lshl_b32 s50, s41, 10
s_add_u32 s50, s50, 46137856
v_min_u32 v255, 15, v1
v_lshlrev_b32 v255, 3, v255
buffer_load_dwordx2 v[228:229], v255, s[24:27], s50 offen sc1
s_waitcnt vmcnt(0)
s_branch L_spa1_2
L_spa1_2x:
s_waitcnt vmcnt(3)
s_waitcnt lgkmcnt(4)
s_barrier
s_setprio 3
ds_read_b128 v[36:39], v236 offset:0
ds_read_b128 v[72:75], v236 offset:1024
ds_read_b128 v[76:79], v235 offset:8192
ds_read_b128 v[196:199], v235 offset:9216
v_mfma_f32_16x16x32_bf16 v[156:159], v[92:95], v[28:31], v[156:159]
ds_read_b64_tr_b16 v[88:89], v3 offset:4096
v_mfma_f32_16x16x32_bf16 v[160:163], v[92:95], v[32:35], v[160:163]
ds_read_b64_tr_b16 v[90:91], v3 offset:4608
v_mfma_f32_16x16x32_bf16 v[164:167], v[96:99], v[28:31], v[164:167]
ds_read_b64_tr_b16 v[92:93], v231 offset:4096
s_add_u32 m0, s48, 20480
s_add_u32 s49, s57, 1880320
buffer_load_dwordx4 v232, s[12:15], s49 offen lds
v_mfma_f32_16x16x32_bf16 v[168:171], v[96:99], v[32:35], v[168:171]
ds_read_b64_tr_b16 v[94:95], v231 offset:4608
s_waitcnt lgkmcnt(8)
v_mfma_f32_16x16x32_bf16 v[172:175], v[80:83], v[28:31], v[172:175]
ds_read_b64_tr_b16 v[96:97], v233 offset:0
v_mfma_f32_16x16x32_bf16 v[176:179], v[80:83], v[32:35], v[176:179]
ds_read_b64_tr_b16 v[98:99], v233 offset:512
s_setprio 2
v_mfma_f32_16x16x32_bf16 v[180:183], v[84:87], v[28:31], v[180:183]
ds_read_b64_tr_b16 v[80:81], v2 offset:0
s_add_u32 m0, s48, 28672
s_add_u32 s49, s46, 4096
buffer_load_dwordx4 v247, s[24:27], s49 offen sc1 lds
v_mfma_f32_16x16x32_bf16 v[184:187], v[84:87], v[32:35], v[184:187]
ds_read_b64_tr_b16 v[82:83], v2 offset:512
s_waitcnt lgkmcnt(4)
v_mfma_f32_16x16x32_bf16 v[156:159], v[88:91], v[64:67], v[156:159]
ds_read_b64_tr_b16 v[84:85], v233 offset:8192
v_mfma_f32_16x16x32_bf16 v[160:163], v[88:91], v[68:71], v[160:163]
ds_read_b64_tr_b16 v[86:87], v233 offset:8704
v_mfma_f32_16x16x32_bf16 v[164:167], v[92:95], v[64:67], v[164:167]
ds_read_b64_tr_b16 v[88:89], v2 offset:8192
s_add_u32 m0, s48, 36864
s_add_u32 s49, s46, 12288
buffer_load_dwordx4 v247, s[24:27], s49 offen sc1 lds
v_mfma_f32_16x16x32_bf16 v[168:171], v[92:95], v[68:71], v[168:171]
ds_read_b64_tr_b16 v[90:91], v2 offset:8704
s_setprio 1
s_waitcnt lgkmcnt(4)
v_mfma_f32_16x16x32_bf16 v[172:175], v[96:99], v[64:67], v[172:175]
ds_read_b64_tr_b16 v[92:93], v233 offset:12288
v_mfma_f32_16x16x32_bf16 v[176:179], v[96:99], v[68:71], v[176:179]
ds_read_b64_tr_b16 v[94:95], v233 offset:12800
v_mfma_f32_16x16x32_bf16 v[180:183], v[80:83], v[64:67], v[180:183]
ds_read_b64_tr_b16 v[96:97], v2 offset:12288
s_add_u32 m0, s48, 45056
s_add_u32 s49, s46, 20480
buffer_load_dwordx4 v247, s[24:27], s49 offen sc1 lds
v_mfma_f32_16x16x32_bf16 v[184:187], v[80:83], v[68:71], v[184:187]
ds_read_b64_tr_b16 v[98:99], v2 offset:12800
s_waitcnt lgkmcnt(4)
v_mfma_f32_16x16x32_bf16 v[156:159], v[84:87], v[116:119], v[156:159]
ds_read_b64_tr_b16 v[80:81], v3 offset:8192
v_mfma_f32_16x16x32_bf16 v[160:163], v[84:87], v[120:123], v[160:163]
ds_read_b64_tr_b16 v[82:83], v3 offset:8704
s_setprio 0
v_mfma_f32_16x16x32_bf16 v[164:167], v[88:91], v[116:119], v[164:167]
ds_read_b64_tr_b16 v[84:85], v231 offset:8192
s_add_u32 m0, s48, 53248
s_add_u32 s49, s46, 28672
buffer_load_dwordx4 v247, s[24:27], s49 offen sc1 lds
v_mfma_f32_16x16x32_bf16 v[168:171], v[88:91], v[120:123], v[168:171]
ds_read_b64_tr_b16 v[86:87], v231 offset:8704
s_waitcnt lgkmcnt(4)
v_mfma_f32_16x16x32_bf16 v[172:175], v[92:95], v[116:119], v[172:175]
ds_read_b64_tr_b16 v[88:89], v3 offset:12288
v_mfma_f32_16x16x32_bf16 v[176:179], v[92:95], v[120:123], v[176:179]
ds_read_b64_tr_b16 v[90:91], v3 offset:12800
v_mfma_f32_16x16x32_bf16 v[180:183], v[96:99], v[116:119], v[180:183]
ds_read_b64_tr_b16 v[92:93], v231 offset:12288
v_mfma_f32_16x16x32_bf16 v[184:187], v[96:99], v[120:123], v[184:187]
ds_read_b64_tr_b16 v[94:95], v231 offset:12800
s_waitcnt vmcnt(3)
s_barrier
s_setprio 3
s_waitcnt lgkmcnt(4)
v_mfma_f32_16x16x32_bf16 v[156:159], v[80:83], v[188:191], v[156:159]
ds_read_b64_tr_b16 v[96:97], v3 offset:20480
v_mfma_f32_16x16x32_bf16 v[160:163], v[80:83], v[192:195], v[160:163]
ds_read_b64_tr_b16 v[98:99], v3 offset:20992
v_mfma_f32_16x16x32_bf16 v[164:167], v[84:87], v[188:191], v[164:167]
ds_read_b64_tr_b16 v[80:81], v231 offset:20480
s_add_u32 m0, s48, 4096
s_add_u32 s49, s46, 36864
buffer_load_dwordx4 v247, s[24:27], s49 offen sc1 lds
v_mfma_f32_16x16x32_bf16 v[168:171], v[84:87], v[192:195], v[168:171]
ds_read_b64_tr_b16 v[82:83], v231 offset:20992
s_waitcnt lgkmcnt(4)
v_mfma_f32_16x16x32_bf16 v[172:175], v[88:91], v[188:191], v[172:175]
ds_read_b64_tr_b16 v[84:85], v3 offset:40960
v_mfma_f32_16x16x32_bf16 v[176:179], v[88:91], v[192:195], v[176:179]
ds_read_b64_tr_b16 v[86:87], v3 offset:41472
s_setprio 2
v_mfma_f32_16x16x32_bf16 v[180:183], v[92:95], v[188:191], v[180:183]
ds_read_b64_tr_b16 v[88:89], v231 offset:40960
s_add_u32 m0, s48, 12288
s_add_u32 s49, s46, 45056
buffer_load_dwordx4 v247, s[24:27], s49 offen sc1 lds
v_mfma_f32_16x16x32_bf16 v[184:187], v[92:95], v[192:195], v[184:187]
ds_read_b64_tr_b16 v[90:91], v231 offset:41472
s_waitcnt lgkmcnt(4)
v_mfma_f32_16x16x32_bf16 v[156:159], v[96:99], v[36:39], v[156:159]
ds_read_b64_tr_b16 v[92:93], v3 offset:49152
v_mfma_f32_16x16x32_bf16 v[160:163], v[96:99], v[72:75], v[160:163]
ds_read_b64_tr_b16 v[94:95], v3 offset:49664
v_mfma_f32_16x16x32_bf16 v[164:167], v[80:83], v[36:39], v[164:167]
ds_read_b64_tr_b16 v[96:97], v231 offset:49152
s_add_u32 m0, s48, 57344
s_add_u32 s49, s46, 53248
buffer_load_dwordx4 v247, s[24:27], s49 offen sc1 lds
v_mfma_f32_16x16x32_bf16 v[168:171], v[80:83], v[72:75], v[168:171]
ds_read_b64_tr_b16 v[98:99], v231 offset:49664
s_setprio 1
s_waitcnt lgkmcnt(4)
v_mfma_f32_16x16x32_bf16 v[172:175], v[84:87], v[36:39], v[172:175]
ds_read_b64_tr_b16 v[80:81], v3 offset:53248
v_mfma_f32_16x16x32_bf16 v[176:179], v[84:87], v[72:75], v[176:179]
ds_read_b64_tr_b16 v[82:83], v3 offset:53760
v_mfma_f32_16x16x32_bf16 v[180:183], v[88:91], v[36:39], v[180:183]
ds_read_b64_tr_b16 v[84:85], v231 offset:53248
s_add_u32 m0, s48, 65536
s_add_u32 s49, s46, 61440
buffer_load_dwordx4 v247, s[24:27], s49 offen sc1 lds
v_mfma_f32_16x16x32_bf16 v[184:187], v[88:91], v[72:75], v[184:187]
ds_read_b64_tr_b16 v[86:87], v231 offset:53760
s_waitcnt lgkmcnt(4)
v_mfma_f32_16x16x32_bf16 v[156:159], v[92:95], v[76:79], v[156:159]
v_add_u32 v245, 0x10000, v248
ds_read_b128 v[88:91], v248 offset:27648
v_mfma_f32_16x16x32_bf16 v[160:163], v[92:95], v[196:199], v[160:163]
s_setprio 0
v_mfma_f32_16x16x32_bf16 v[164:167], v[96:99], v[76:79], v[164:167]
ds_read_b128 v[92:95], v248 offset:28672
s_add_u32 m0, s48, 90112
s_add_u32 s49, s46, 69632
buffer_load_dwordx4 v247, s[24:27], s49 offen sc1 lds
v_mfma_f32_16x16x32_bf16 v[168:171], v[96:99], v[196:199], v[168:171]
s_waitcnt lgkmcnt(2)
v_mfma_f32_16x16x32_bf16 v[172:175], v[80:83], v[76:79], v[172:175]
ds_read_b128 v[96:99], v248 offset:29696
v_mfma_f32_16x16x32_bf16 v[176:179], v[80:83], v[196:199], v[176:179]
v_mfma_f32_16x16x32_bf16 v[180:183], v[84:87], v[76:79], v[180:183]
ds_read_b128 v[80:83], v248 offset:33792
v_mfma_f32_16x16x32_bf16 v[184:187], v[84:87], v[196:199], v[184:187]
s_waitcnt vmcnt(4)
s_barrier
s_setprio 3
s_waitcnt lgkmcnt(2)
v_mfma_f32_16x16x32_bf16 v[200:203], v[88:91], v[124:127], 0
ds_read_b128 v[84:87], v248 offset:34816
v_mfma_f32_16x16x32_bf16 v[204:207], v[88:91], v[128:131], 0
v_mfma_f32_16x16x32_bf16 v[208:211], v[92:95], v[124:127], 0
ds_read_b128 v[88:91], v248 offset:35840
s_add_u32 m0, s48, 20480
s_add_u32 s49, s46, 77824
buffer_load_dwordx4 v247, s[24:27], s49 offen sc1 lds
v_mfma_f32_16x16x32_bf16 v[212:215], v[92:95], v[128:131], 0
s_mul_i32 s50, s42, 9728
s_add_u32 s50, s50, 114688
v_mul_u32_u24 v253, 304, v251
v_add_u32 v253, s50, v253
v_lshl_add_u32 v244, v252, 3, v253
v_mov_b32 v2, 0x3f80
v_mov_b32 v3, 0
ds_write_b64 v253, v[2:3] offset:5152
s_waitcnt lgkmcnt(3)
v_mfma_f32_16x16x32_bf16 v[216:219], v[96:99], v[124:127], 0
ds_read_b128 v[92:95], v248 offset:39936
v_cvt_pk_bf16_f32 v156, v156, v157
v_cvt_pk_bf16_f32 v157, v158, v159
ds_write_b64 v244, v[156:157] offset:64
v_mfma_f32_16x16x32_bf16 v[220:223], v[96:99], v[128:131], 0
v_mfma_f32_16x16x32_bf16 v[200:203], v[80:83], v[132:135], v[200:203]
ds_read_b128 v[96:99], v248 offset:40960
v_cvt_pk_bf16_f32 v160, v160, v161
v_cvt_pk_bf16_f32 v161, v162, v163
ds_write_b64 v244, v[160:161] offset:4928
v_mfma_f32_16x16x32_bf16 v[204:207], v[80:83], v[136:139], v[204:207]
s_setprio 2
s_waitcnt lgkmcnt(5)
v_mfma_f32_16x16x32_bf16 v[208:211], v[84:87], v[132:135], v[208:211]
ds_read_b128 v[80:83], v248 offset:41984
s_lshl_b32 s49, s40, 3
s_add_u32 s49, s49, s44
s_add_u32 s49, s49, 0
s_min_u32 s49, s49, 161
s_mul_i32 s52, s49, 7282
s_lshr_b32 s52, s52, 16
s_mul_i32 s50, s52, 9
s_sub_u32 s50, s49, s50
s_lshl_b32 s50, s50, 7
s_and_b32 s51, s4, 0x50
s_add_u32 s50, s50, s51
s_and_b32 s51, s52, 3
s_lshl_b32 s51, s51, 2
s_lshr_b32 s49, s52, 2
s_add_u32 s51, s51, s49
s_mul_i32 s51, s51, 41472
s_sub_u32 s49, s52, 16
s_mul_i32 s49, s49, 331776
s_add_u32 s49, s49, 9216
s_cmp_lt_u32 s52, 16
s_cselect_b32 s51, s51, s49
s_mov_b32 s52, 41472
s_cselect_b32 s52, 1152, s52
s_add_u32 s50, s50, s51
v_bfe_u32 v255, v1, 1, 3
v_mul_lo_u32 v255, v255, s52
v_mul_u32_u24 v254, 10368, v252
v_and_b32 v253, 1, v1
v_lshl_add_u32 v254, v253, 5, v254
v_add_u32 v255, v255, v254
s_add_u32 m0, s48, 102400
s_nop 0
buffer_load_dwordx4 v255, s[28:31], s50 offen lds
v_mfma_f32_16x16x32_bf16 v[212:215], v[84:87], v[136:139], v[212:215]
v_mfma_f32_16x16x32_bf16 v[216:219], v[88:91], v[132:135], v[216:219]
ds_read_b128 v[84:87], v248 offset:46080
s_add_u32 m0, s48, 77824
s_add_u32 s49, s46, 86016
buffer_load_dwordx4 v247, s[24:27], s49 offen sc1 lds
v_mfma_f32_16x16x32_bf16 v[220:223], v[88:91], v[136:139], v[220:223]
v_cvt_pk_bf16_f32 v164, v164, v165
v_cvt_pk_bf16_f32 v165, v166, v167
ds_write_b64 v244, v[164:165] offset:96
s_waitcnt lgkmcnt(4)
v_mfma_f32_16x16x32_bf16 v[200:203], v[92:95], v[140:143], v[200:203]
ds_read_b128 v[88:91], v248 offset:47104
v_cvt_pk_bf16_f32 v168, v168, v169
v_cvt_pk_bf16_f32 v169, v170, v171
ds_write_b64 v244, v[168:169] offset:4960
v_mfma_f32_16x16x32_bf16 v[204:207], v[92:95], v[144:147], v[204:207]
v_mfma_f32_16x16x32_bf16 v[208:211], v[96:99], v[140:143], v[208:211]
ds_read_b128 v[92:95], v248 offset:48128
v_cvt_pk_bf16_f32 v172, v172, v173
v_cvt_pk_bf16_f32 v173, v174, v175
ds_write_b64 v244, v[172:173] offset:192
v_mfma_f32_16x16x32_bf16 v[212:215], v[96:99], v[144:147], v[212:215]
s_setprio 1
s_waitcnt lgkmcnt(5)
v_mfma_f32_16x16x32_bf16 v[216:219], v[80:83], v[140:143], v[216:219]
ds_read_b128 v[96:99], v248 offset:52224
v_cvt_pk_bf16_f32 v176, v176, v177
v_cvt_pk_bf16_f32 v177, v178, v179
ds_write_b64 v244, v[176:177] offset:5056
v_mfma_f32_16x16x32_bf16 v[220:223], v[80:83], v[144:147], v[220:223]
v_mfma_f32_16x16x32_bf16 v[200:203], v[84:87], v[148:151], v[200:203]
ds_read_b128 v[80:83], v248 offset:53248
s_add_u32 m0, s48, 86016
s_add_u32 s49, s46, 94208
buffer_load_dwordx4 v247, s[24:27], s49 offen sc1 lds
v_mfma_f32_16x16x32_bf16 v[204:207], v[84:87], v[152:155], v[204:207]
s_lshl_b32 s49, s40, 3
s_add_u32 s49, s49, s44
s_add_u32 s49, s49, 128
s_min_u32 s49, s49, 161
s_mul_i32 s52, s49, 7282
s_lshr_b32 s52, s52, 16
s_mul_i32 s50, s52, 9
s_sub_u32 s50, s49, s50
s_lshl_b32 s50, s50, 7
s_and_b32 s51, s4, 0x50
s_add_u32 s50, s50, s51
s_and_b32 s51, s52, 3
s_lshl_b32 s51, s51, 2
s_lshr_b32 s49, s52, 2
s_add_u32 s51, s51, s49
s_mul_i32 s51, s51, 41472
s_sub_u32 s49, s52, 16
s_mul_i32 s49, s49, 331776
s_add_u32 s49, s49, 9216
s_cmp_lt_u32 s52, 16
s_cselect_b32 s51, s51, s49
s_mov_b32 s52, 41472
s_cselect_b32 s52, 1152, s52
s_add_u32 s50, s50, s51
v_bfe_u32 v255, v1, 1, 3
v_mul_lo_u32 v255, v255, s52
v_mul_u32_u24 v254, 10368, v252
v_and_b32 v253, 1, v1
v_lshl_add_u32 v254, v253, 5, v254
v_add_u32 v255, v255, v254
s_add_u32 m0, s48, 110592
s_nop 0
buffer_load_dwordx4 v255, s[28:31], s50 offen lds
s_waitcnt lgkmcnt(4)
v_mfma_f32_16x16x32_bf16 v[208:211], v[88:91], v[148:151], v[208:211]
ds_read_b128 v[84:87], v248 offset:54272
v_cvt_pk_bf16_f32 v180, v180, v181
v_cvt_pk_bf16_f32 v181, v182, v183
ds_write_b64 v244, v[180:181] offset:224
v_mfma_f32_16x16x32_bf16 v[212:215], v[88:91], v[152:155], v[212:215]
v_mfma_f32_16x16x32_bf16 v[216:219], v[92:95], v[148:151], v[216:219]
ds_read_b128 v[88:91], v248 offset:1024
v_cvt_pk_bf16_f32 v184, v184, v185
v_cvt_pk_bf16_f32 v185, v186, v187
ds_write_b64 v244, v[184:185] offset:5088
v_mfma_f32_16x16x32_bf16 v[220:223], v[92:95], v[152:155], v[220:223]
s_setprio 0
s_waitcnt lgkmcnt(4)
v_mfma_f32_16x16x32_bf16 v[200:203], v[96:99], v[4:7], v[200:203]
ds_read_b128 v[92:95], v248 offset:2048
v_mfma_f32_16x16x32_bf16 v[204:207], v[96:99], v[8:11], v[204:207]
v_mfma_f32_16x16x32_bf16 v[208:211], v[80:83], v[4:7], v[208:211]
ds_read_b128 v[96:99], v248 offset:3072
v_mfma_f32_16x16x32_bf16 v[212:215], v[80:83], v[8:11], v[212:215]
s_waitcnt lgkmcnt(3)
v_mfma_f32_16x16x32_bf16 v[216:219], v[84:87], v[4:7], v[216:219]
ds_read_b128 v[80:83], v248 offset:7168
v_mfma_f32_16x16x32_bf16 v[220:223], v[84:87], v[8:11], v[220:223]
s_waitcnt vmcnt(6)
s_waitcnt lgkmcnt(3)
s_barrier
s_setprio 3
v_mfma_f32_16x16x32_bf16 v[200:203], v[88:91], v[12:15], v[200:203]
ds_read_b128 v[84:87], v248 offset:8192
v_mfma_f32_16x16x32_bf16 v[204:207], v[88:91], v[16:19], v[204:207]
s_waitcnt lgkmcnt(2)
v_mfma_f32_16x16x32_bf16 v[208:211], v[92:95], v[12:15], v[208:211]
ds_read_b128 v[88:91], v248 offset:9216
s_add_u32 m0, s48, 28672
s_add_u32 s49, s46, 102400
buffer_load_dwordx4 v247, s[24:27], s49 offen sc1 lds
v_mfma_f32_16x16x32_bf16 v[212:215], v[92:95], v[16:19], v[212:215]
v_mfma_f32_16x16x32_bf16 v[216:219], v[96:99], v[12:15], v[216:219]
ds_read_b128 v[92:95], v248 offset:13312
v_mfma_f32_16x16x32_bf16 v[220:223], v[96:99], v[16:19], v[220:223]
s_setprio 2
s_waitcnt lgkmcnt(2)
v_mfma_f32_16x16x32_bf16 v[200:203], v[80:83], v[40:43], v[200:203]
ds_read_b128 v[96:99], v248 offset:14336
v_mfma_f32_16x16x32_bf16 v[204:207], v[80:83], v[44:47], v[204:207]
v_mfma_f32_16x16x32_bf16 v[208:211], v[84:87], v[40:43], v[208:211]
ds_read_b128 v[80:83], v248 offset:15360
s_add_u32 m0, s48, 36864
s_add_u32 s49, s46, 110592
buffer_load_dwordx4 v247, s[24:27], s49 offen sc1 lds
v_mfma_f32_16x16x32_bf16 v[212:215], v[84:87], v[44:47], v[212:215]
s_waitcnt lgkmcnt(2)
v_mfma_f32_16x16x32_bf16 v[216:219], v[88:91], v[40:43], v[216:219]
ds_read_b128 v[84:87], v248 offset:19456
v_mfma_f32_16x16x32_bf16 v[220:223], v[88:91], v[44:47], v[220:223]
s_setprio 1
v_mfma_f32_16x16x32_bf16 v[200:203], v[92:95], v[48:51], v[200:203]
ds_read_b128 v[88:91], v248 offset:57344
s_waitcnt vmcnt(5)
v_lshlrev_b32 v255, 8, v252
v_lshl_add_u32 v255, v250, 5, v255
v_and_b32 v254, 1, v249
v_lshl_add_u32 v255, v254, 4, v255
v_lshrrev_b32 v254, 1, v249
v_lshl_add_u32 v255, v254, 3, v255
v_add_u32 v255, s48, v255
v_add_u32 v255, 102400, v255
ds_read_b64_tr_b16 v[156:157], v255 offset:0
ds_read_b64_tr_b16 v[158:159], v255 offset:128
s_lshl_b32 s51, s40, 3
s_add_u32 s51, s51, s44
s_add_u32 s51, s51, 0
s_cmp_lt_u32 s51, 162
s_cselect_b32 s50, 0, 1879048192
v_add_u32 v254, s50, v248
s_lshl_b32 s51, s51, 10
s_add_u32 s51, s51, s47
s_waitcnt lgkmcnt(0)
buffer_store_dwordx4 v[156:159], v254, s[24:27], s51 offen sc1
v_mfma_f32_16x16x32_bf16 v[204:207], v[92:95], v[52:55], v[204:207]
v_mfma_f32_16x16x32_bf16 v[208:211], v[96:99], v[48:51], v[208:211]
ds_read_b128 v[92:95], v248 offset:58368
s_add_u32 m0, s48, 45056
s_add_u32 s49, s46, 118784
buffer_load_dwordx4 v247, s[24:27], s49 offen sc1 lds
v_mfma_f32_16x16x32_bf16 v[212:215], v[96:99], v[52:55], v[212:215]
v_mfma_f32_16x16x32_bf16 v[216:219], v[80:83], v[48:51], v[216:219]
ds_read_b128 v[96:99], v248 offset:62464
v_mfma_f32_16x16x32_bf16 v[220:223], v[80:83], v[52:55], v[220:223]
s_setprio 0
v_mfma_f32_16x16x32_bf16 v[200:203], v[84:87], v[20:23], v[200:203]
ds_read_b128 v[80:83], v248 offset:63488
s_waitcnt vmcnt(4)
v_lshlrev_b32 v255, 8, v252
v_lshl_add_u32 v255, v250, 5, v255
v_and_b32 v254, 1, v249
v_lshl_add_u32 v255, v254, 4, v255
v_lshrrev_b32 v254, 1, v249
v_lshl_add_u32 v255, v254, 3, v255
v_add_u32 v255, s48, v255
v_add_u32 v255, 110592, v255
ds_read_b64_tr_b16 v[156:157], v255 offset:0
ds_read_b64_tr_b16 v[158:159], v255 offset:128
s_lshl_b32 s51, s40, 3
s_add_u32 s51, s51, s44
s_add_u32 s51, s51, 128
s_cmp_lt_u32 s51, 162
s_cselect_b32 s50, 0, 1879048192
v_add_u32 v254, s50, v248
s_lshl_b32 s51, s51, 10
s_add_u32 s51, s51, s47
s_waitcnt lgkmcnt(0)
buffer_store_dwordx4 v[156:159], v254, s[24:27], s51 offen sc1
v_mfma_f32_16x16x32_bf16 v[204:207], v[84:87], v[24:27], v[204:207]
v_mfma_f32_16x16x32_bf16 v[208:211], v[88:91], v[20:23], v[208:211]
ds_read_b128 v[84:87], v248 offset:64512
v_mfma_f32_16x16x32_bf16 v[212:215], v[88:91], v[24:27], v[212:215]
v_mfma_f32_16x16x32_bf16 v[216:219], v[92:95], v[20:23], v[216:219]
ds_read_b128 v[88:91], v245 offset:3072
v_mfma_f32_16x16x32_bf16 v[220:223], v[92:95], v[24:27], v[220:223]
s_barrier
s_setprio 3
v_mfma_f32_16x16x32_bf16 v[200:203], v[96:99], v[56:59], v[200:203]
ds_read_b128 v[92:95], v245 offset:4096
v_mfma_f32_16x16x32_bf16 v[204:207], v[96:99], v[60:63], v[204:207]
v_mfma_f32_16x16x32_bf16 v[208:211], v[80:83], v[56:59], v[208:211]
ds_read_b128 v[96:99], v245 offset:5120
s_add_u32 m0, s48, 0
s_add_u32 s49, s46, 126976
buffer_load_dwordx4 v247, s[24:27], s49 offen sc1 lds
v_mfma_f32_16x16x32_bf16 v[212:215], v[80:83], v[60:63], v[212:215]
s_waitcnt lgkmcnt(3)
v_mfma_f32_16x16x32_bf16 v[216:219], v[84:87], v[56:59], v[216:219]
ds_read_b128 v[80:83], v245 offset:25600
v_mfma_f32_16x16x32_bf16 v[220:223], v[84:87], v[60:63], v[220:223]
s_waitcnt lgkmcnt(2)
v_mfma_f32_16x16x32_bf16 v[200:203], v[88:91], v[100:103], v[200:203]
ds_read_b128 v[84:87], v245 offset:26624
v_mfma_f32_16x16x32_bf16 v[204:207], v[88:91], v[104:107], v[204:207]
s_setprio 2
v_mfma_f32_16x16x32_bf16 v[208:211], v[92:95], v[100:103], v[208:211]
ds_read_b128 v[88:91], v245 offset:27648
v_mfma_f32_16x16x32_bf16 v[212:215], v[92:95], v[104:107], v[212:215]
s_waitcnt lgkmcnt(2)
v_mfma_f32_16x16x32_bf16 v[216:219], v[96:99], v[100:103], v[216:219]
ds_read_b128 v[92:95], v245 offset:31744
s_add_u32 m0, s48, 8192
s_add_u32 s49, s46, 135168
buffer_load_dwordx4 v247, s[24:27], s49 offen sc1 lds
v_mfma_f32_16x16x32_bf16 v[220:223], v[96:99], v[104:107], v[220:223]
v_mfma_f32_16x16x32_bf16 v[200:203], v[80:83], v[108:111], v[200:203]
ds_read_b128 v[96:99], v248 offset:20480
v_mfma_f32_16x16x32_bf16 v[204:207], v[80:83], v[112:115], v[204:207]
s_waitcnt lgkmcnt(2)
v_mfma_f32_16x16x32_bf16 v[208:211], v[84:87], v[108:111], v[208:211]
ds_read_b128 v[80:83], v248 offset:21504
s_lshl_b32 s50, s42, 8
v_lshl_add_u32 v255, v1, 2, s50
global_load_dword v244, v255, s[100:101]
v_mfma_f32_16x16x32_bf16 v[212:215], v[84:87], v[112:115], v[212:215]
s_setprio 1
v_mfma_f32_16x16x32_bf16 v[216:219], v[88:91], v[108:111], v[216:219]
ds_read_b128 v[84:87], v245 offset:9216
v_mfma_f32_16x16x32_bf16 v[220:223], v[88:91], v[112:115], v[220:223]
s_waitcnt lgkmcnt(2)
v_mfma_f32_16x16x32_bf16 v[200:203], v[92:95], v[28:31], v[200:203]
ds_read_b128 v[88:91], v245 offset:10240
s_add_u32 m0, s48, 16384
s_add_u32 s49, s46, 143360
buffer_load_dwordx4 v247, s[24:27], s49 offen sc1 lds
v_mfma_f32_16x16x32_bf16 v[204:207], v[92:95], v[32:35], v[204:207]
v_mfma_f32_16x16x32_bf16 v[208:211], v[96:99], v[28:31], v[208:211]
ds_read_b128 v[92:95], v245 offset:11264
v_mfma_f32_16x16x32_bf16 v[212:215], v[96:99], v[32:35], v[212:215]
s_waitcnt lgkmcnt(2)
v_mfma_f32_16x16x32_bf16 v[216:219], v[80:83], v[28:31], v[216:219]
ds_read_b128 v[96:99], v245 offset:15360
v_mfma_f32_16x16x32_bf16 v[220:223], v[80:83], v[32:35], v[220:223]
s_setprio 0
v_mfma_f32_16x16x32_bf16 v[200:203], v[84:87], v[64:67], v[200:203]
ds_read_b128 v[80:83], v245 offset:16384
v_mfma_f32_16x16x32_bf16 v[204:207], v[84:87], v[68:71], v[204:207]
s_waitcnt lgkmcnt(2)
v_mfma_f32_16x16x32_bf16 v[208:211], v[88:91], v[64:67], v[208:211]
ds_read_b128 v[84:87], v245 offset:17408
v_mfma_f32_16x16x32_bf16 v[212:215], v[88:91], v[68:71], v[212:215]
v_mfma_f32_16x16x32_bf16 v[216:219], v[92:95], v[64:67], v[216:219]
ds_read_b128 v[88:91], v245 offset:21504
v_mfma_f32_16x16x32_bf16 v[220:223], v[92:95], v[68:71], v[220:223]
s_waitcnt vmcnt(5)
s_barrier
s_setprio 3
s_waitcnt lgkmcnt(2)
v_mfma_f32_16x16x32_bf16 v[200:203], v[96:99], v[116:119], v[200:203]
ds_read_b128 v[92:95], v245 offset:22528
v_mfma_f32_16x16x32_bf16 v[204:207], v[96:99], v[120:123], v[204:207]
v_mfma_f32_16x16x32_bf16 v[208:211], v[80:83], v[116:119], v[208:211]
ds_read_b128 v[96:99], v245 offset:23552
s_add_u32 m0, s48, 20480
s_add_u32 s49, s46, 151552
buffer_load_dwordx4 v247, s[24:27], s49 offen sc1 lds
v_mfma_f32_16x16x32_bf16 v[212:215], v[80:83], v[120:123], v[212:215]
s_waitcnt lgkmcnt(2)
v_mfma_f32_16x16x32_bf16 v[216:219], v[84:87], v[116:119], v[216:219]
ds_read_b128 v[80:83], v248 offset:27648
v_mfma_f32_16x16x32_bf16 v[220:223], v[84:87], v[120:123], v[220:223]
s_setprio 2
v_mfma_f32_16x16x32_bf16 v[200:203], v[88:91], v[188:191], v[200:203]
ds_read_b128 v[84:87], v248 offset:28672
v_mfma_f32_16x16x32_bf16 v[204:207], v[88:91], v[192:195], v[204:207]
s_waitcnt lgkmcnt(2)
v_mfma_f32_16x16x32_bf16 v[208:211], v[92:95], v[188:191], v[208:211]
ds_read_b128 v[88:91], v248 offset:29696
s_add_u32 m0, s48, 61440
s_add_u32 s49, s46, 159744
buffer_load_dwordx4 v247, s[24:27], s49 offen sc1 lds
v_mfma_f32_16x16x32_bf16 v[212:215], v[92:95], v[192:195], v[212:215]
v_mfma_f32_16x16x32_bf16 v[216:219], v[96:99], v[188:191], v[216:219]
ds_read_b128 v[92:95], v248 offset:33792
v_mfma_f32_16x16x32_bf16 v[220:223], v[96:99], v[192:195], v[220:223]
s_setprio 1
s_waitcnt lgkmcnt(2)
v_mfma_f32_16x16x32_bf16 v[200:203], v[80:83], v[36:39], v[200:203]
ds_read_b128 v[96:99], v248 offset:34816
v_mfma_f32_16x16x32_bf16 v[204:207], v[80:83], v[72:75], v[204:207]
v_mfma_f32_16x16x32_bf16 v[208:211], v[84:87], v[36:39], v[208:211]
ds_read_b128 v[80:83], v248 offset:35840
s_add_u32 m0, s48, 69632
s_add_u32 s49, s46, 167936
buffer_load_dwordx4 v247, s[24:27], s49 offen sc1 lds
v_mfma_f32_16x16x32_bf16 v[212:215], v[84:87], v[72:75], v[212:215]
s_waitcnt lgkmcnt(2)
v_mfma_f32_16x16x32_bf16 v[216:219], v[88:91], v[36:39], v[216:219]
ds_read_b128 v[84:87], v248 offset:39936
v_mfma_f32_16x16x32_bf16 v[220:223], v[88:91], v[72:75], v[220:223]
s_setprio 0
v_mfma_f32_16x16x32_bf16 v[200:203], v[92:95], v[76:79], v[200:203]
ds_read_b128 v[88:91], v248 offset:40960
v_mfma_f32_16x16x32_bf16 v[204:207], v[92:95], v[196:199], v[204:207]
s_waitcnt lgkmcnt(2)
v_mfma_f32_16x16x32_bf16 v[208:211], v[96:99], v[76:79], v[208:211]
ds_read_b128 v[92:95], v248 offset:41984
v_mfma_f32_16x16x32_bf16 v[212:215], v[96:99], v[196:199], v[212:215]
v_mfma_f32_16x16x32_bf16 v[216:219], v[80:83], v[76:79], v[216:219]
ds_read_b128 v[96:99], v248 offset:46080
v_mfma_f32_16x16x32_bf16 v[220:223], v[80:83], v[196:199], v[220:223]
s_waitcnt vmcnt(3)
s_barrier
s_setprio 3
s_waitcnt lgkmcnt(2)
v_mfma_f32_16x16x32_bf16 v[156:159], v[84:87], v[124:127], 0
ds_read_b128 v[80:83], v248 offset:47104
v_max3_f32 v240, v200, v201, v202
v_mfma_f32_16x16x32_bf16 v[160:163], v[84:87], v[128:131], 0
v_max3_f32 v240, v240, v203, v208
v_max3_f32 v240, v240, v209, v210
v_mfma_f32_16x16x32_bf16 v[164:167], v[88:91], v[124:127], 0
ds_read_b128 v[84:87], v248 offset:48128
s_add_u32 m0, s48, 28672
s_add_u32 s49, s46, 176128
buffer_load_dwordx4 v247, s[24:27], s49 offen sc1 lds
v_max3_f32 v240, v240, v211, v216
v_min3_f32 v239, v200, v201, v202
v_mfma_f32_16x16x32_bf16 v[168:171], v[88:91], v[128:131], 0
v_min3_f32 v239, v239, v203, v208
v_min3_f32 v239, v239, v209, v210
v_min3_f32 v239, v239, v211, v216
s_waitcnt lgkmcnt(2)
v_mfma_f32_16x16x32_bf16 v[172:175], v[92:95], v[124:127], 0
ds_read_b128 v[88:91], v248 offset:52224
v_mov_b32 v238, v240
v_mov_b32 v237, v239
s_nop 0
v_permlane16_swap_b32 v240, v238
v_mfma_f32_16x16x32_bf16 v[176:179], v[92:95], v[128:131], 0
v_permlane16_swap_b32 v239, v237
v_max_f32 v240, v240, v238
v_mfma_f32_16x16x32_bf16 v[156:159], v[96:99], v[132:135], v[156:159]
ds_read_b128 v[92:95], v248 offset:0
v_min_f32 v239, v239, v237
v_sub_f32 v246, v200, v240
v_sub_f32 v200, v239, v200
v_mfma_f32_16x16x32_bf16 v[160:163], v[96:99], v[136:139], v[160:163]
v_exp_f32 v246, v246
v_exp_f32 v200, v200
s_setprio 2
s_waitcnt lgkmcnt(2)
v_mfma_f32_16x16x32_bf16 v[164:167], v[80:83], v[132:135], v[164:167]
ds_read_b128 v[96:99], v248 offset:1024
v_sub_f32 v3, v201, v240
v_sub_f32 v201, v239, v201
v_exp_f32 v3, v3
v_mfma_f32_16x16x32_bf16 v[168:171], v[80:83], v[136:139], v[168:171]
v_exp_f32 v201, v201
v_sub_f32 v2, v202, v240
v_mfma_f32_16x16x32_bf16 v[172:175], v[84:87], v[132:135], v[172:175]
ds_read_b128 v[80:83], v248 offset:5120
v_sub_f32 v202, v239, v202
v_exp_f32 v2, v2
v_exp_f32 v202, v202
v_mfma_f32_16x16x32_bf16 v[176:179], v[84:87], v[136:139], v[176:179]
v_sub_f32 v235, v203, v240
v_sub_f32 v203, v239, v203
s_waitcnt lgkmcnt(2)
v_mfma_f32_16x16x32_bf16 v[156:159], v[88:91], v[140:143], v[156:159]
ds_read_b128 v[84:87], v248 offset:6144
v_exp_f32 v235, v235
v_exp_f32 v203, v203
v_sub_f32 v233, v208, v240
v_mfma_f32_16x16x32_bf16 v[160:163], v[88:91], v[144:147], v[160:163]
v_sub_f32 v208, v239, v208
v_exp_f32 v233, v233
v_mfma_f32_16x16x32_bf16 v[164:167], v[92:95], v[140:143], v[164:167]
ds_read_b128 v[88:91], v248 offset:7168
v_exp_f32 v208, v208
v_sub_f32 v232, v209, v240
v_mfma_f32_16x16x32_bf16 v[168:171], v[92:95], v[144:147], v[168:171]
v_sub_f32 v209, v239, v209
v_exp_f32 v232, v232
s_setprio 1
s_waitcnt lgkmcnt(2)
v_mfma_f32_16x16x32_bf16 v[172:175], v[96:99], v[140:143], v[172:175]
ds_read_b128 v[92:95], v248 offset:11264
v_exp_f32 v209, v209
v_sub_f32 v243, v210, v240
v_sub_f32 v210, v239, v210
v_mfma_f32_16x16x32_bf16 v[176:179], v[96:99], v[144:147], v[176:179]
v_exp_f32 v243, v243
v_exp_f32 v210, v210
v_mfma_f32_16x16x32_bf16 v[156:159], v[80:83], v[148:151], v[156:159]
ds_read_b128 v[96:99], v248 offset:12288
v_sub_f32 v242, v211, v240
v_sub_f32 v211, v239, v211
v_exp_f32 v242, v242
v_mfma_f32_16x16x32_bf16 v[160:163], v[80:83], v[152:155], v[160:163]
v_exp_f32 v211, v211
v_sub_f32 v241, v216, v240
s_waitcnt lgkmcnt(2)
v_mfma_f32_16x16x32_bf16 v[164:167], v[84:87], v[148:151], v[164:167]
ds_read_b128 v[80:83], v248 offset:13312
v_sub_f32 v216, v239, v216
v_exp_f32 v241, v241
v_exp_f32 v216, v216
v_mfma_f32_16x16x32_bf16 v[168:171], v[84:87], v[152:155], v[168:171]
v_add_f32 v240, v246, v3
v_add_f32 v239, v200, v201
v_mfma_f32_16x16x32_bf16 v[172:175], v[88:91], v[148:151], v[172:175]
ds_read_b128 v[84:87], v248 offset:17408
v_add_f32 v240, v240, v2
v_add_f32 v239, v239, v202
v_add_f32 v240, v240, v235
v_mfma_f32_16x16x32_bf16 v[176:179], v[88:91], v[152:155], v[176:179]
v_add_f32 v239, v239, v203
v_add_f32 v240, v240, v233
s_setprio 0
s_waitcnt lgkmcnt(2)
v_mfma_f32_16x16x32_bf16 v[156:159], v[92:95], v[4:7], v[156:159]
ds_read_b128 v[88:91], v248 offset:18432
v_add_f32 v239, v239, v208
v_add_f32 v240, v240, v232
v_add_f32 v239, v239, v209
v_mfma_f32_16x16x32_bf16 v[160:163], v[92:95], v[8:11], v[160:163]
v_add_f32 v240, v240, v243
v_add_f32 v239, v239, v210
v_mfma_f32_16x16x32_bf16 v[164:167], v[96:99], v[4:7], v[164:167]
ds_read_b128 v[92:95], v248 offset:19456
v_add_f32 v240, v240, v242
v_add_f32 v239, v239, v211
v_add_f32 v240, v240, v241
v_mfma_f32_16x16x32_bf16 v[168:171], v[96:99], v[8:11], v[168:171]
v_add_f32 v239, v239, v216
v_mov_b32 v238, v240
s_waitcnt lgkmcnt(2)
v_mfma_f32_16x16x32_bf16 v[172:175], v[80:83], v[4:7], v[172:175]
ds_read_b128 v[96:99], v248 offset:56320
v_mov_b32 v237, v239
v_permlane16_swap_b32 v240, v238
v_mfma_f32_16x16x32_bf16 v[176:179], v[80:83], v[8:11], v[176:179]
v_permlane16_swap_b32 v239, v237
v_add_f32 v240, v240, v238
s_waitcnt vmcnt(1)
s_barrier
s_setprio 3
v_mfma_f32_16x16x32_bf16 v[156:159], v[84:87], v[12:15], v[156:159]
ds_read_b128 v[80:83], v248 offset:20480
v_add_f32 v239, v239, v237
v_rcp_f32 v240, v240
v_rcp_f32 v239, v239
v_mul_f32 v246, v246, v240
v_mfma_f32_16x16x32_bf16 v[160:163], v[84:87], v[16:19], v[160:163]
v_mul_f32 v200, v200, v239
v_mul_f32 v3, v3, v240
v_mul_f32 v201, v201, v239
s_waitcnt lgkmcnt(2)
v_mfma_f32_16x16x32_bf16 v[164:167], v[88:91], v[12:15], v[164:167]
ds_read_b128 v[84:87], v248 offset:21504
s_add_u32 m0, s48, 0
s_add_u32 s49, s46, 184320
buffer_load_dwordx4 v247, s[24:27], s49 offen sc1 lds
v_mul_f32 v2, v2, v240
v_mul_f32 v202, v202, v239
v_mul_f32 v235, v235, v240
v_mfma_f32_16x16x32_bf16 v[168:171], v[88:91], v[16:19], v[168:171]
v_mul_f32 v203, v203, v239
v_mul_f32 v233, v233, v240
v_mul_f32 v208, v208, v239
v_mfma_f32_16x16x32_bf16 v[172:175], v[92:95], v[12:15], v[172:175]
ds_read_b128 v[88:91], v248 offset:58368
v_mul_f32 v232, v232, v240
v_mul_f32 v209, v209, v239
v_mul_f32 v243, v243, v240
v_mfma_f32_16x16x32_bf16 v[176:179], v[92:95], v[16:19], v[176:179]
v_mul_f32 v210, v210, v239
v_mul_f32 v242, v242, v240
v_mul_f32 v211, v211, v239
s_setprio 2
s_waitcnt lgkmcnt(2)
v_mfma_f32_16x16x32_bf16 v[156:159], v[96:99], v[40:43], v[156:159]
ds_read_b128 v[92:95], v248 offset:59392
s_add_u32 m0, s48, 8192
s_add_u32 s49, s46, 192512
buffer_load_dwordx4 v247, s[24:27], s49 offen sc1 lds
v_mul_f32 v241, v241, v240
v_mul_f32 v216, v216, v239
v_cvt_pk_bf16_f32 v200, v200, v201
v_mfma_f32_16x16x32_bf16 v[160:163], v[96:99], v[44:47], v[160:163]
v_cvt_pk_bf16_f32 v201, v202, v203
v_cvt_pk_bf16_f32 v202, v208, v209
v_cvt_pk_bf16_f32 v203, v210, v211
v_mfma_f32_16x16x32_bf16 v[164:167], v[80:83], v[40:43], v[164:167]
ds_read_b128 v[96:99], v248 offset:60416
v_cvt_pk_bf16_f32 v208, v216, v246
v_cvt_pk_bf16_f32 v209, v3, v2
v_cvt_pk_bf16_f32 v210, v235, v233
v_mfma_f32_16x16x32_bf16 v[168:171], v[80:83], v[44:47], v[168:171]
v_cvt_pk_bf16_f32 v211, v232, v243
v_cvt_pk_bf16_f32 v216, v242, v241
v_mov_b32 v217, 0
s_waitcnt lgkmcnt(2)
v_mfma_f32_16x16x32_bf16 v[172:175], v[84:87], v[40:43], v[172:175]
ds_read_b128 v[80:83], v248 offset:64512
s_add_u32 m0, s48, 40960
s_add_u32 s49, s46, 200704
buffer_load_dwordx4 v247, s[24:27], s49 offen sc1 lds
s_mul_i32 s50, s42, 5120
s_add_u32 s50, s50, 94208
v_mul_u32_u24 v253, 160, v251
v_mad_u32_u24 v253, v252, 40, v253
v_add_u32 v253, s50, v253
ds_write_b64 v253, v[200:201] offset:0
ds_write_b64 v253, v[202:203] offset:8
ds_write_b64 v253, v[208:209] offset:16
ds_write_b64 v253, v[210:211] offset:24
ds_write_b64 v253, v[216:217] offset:32
v_max3_f32 v240, v204, v205, v206
v_max3_f32 v240, v240, v207, v212
v_mfma_f32_16x16x32_bf16 v[176:179], v[84:87], v[44:47], v[176:179]
v_max3_f32 v240, v240, v213, v214
v_max3_f32 v240, v240, v215, v220
v_min3_f32 v239, v204, v205, v206
s_setprio 1
v_mfma_f32_16x16x32_bf16 v[156:159], v[88:91], v[48:51], v[156:159]
ds_read_b128 v[84:87], v245 offset:0
v_min3_f32 v239, v239, v207, v212
v_min3_f32 v239, v239, v213, v214
v_min3_f32 v239, v239, v215, v220
v_mfma_f32_16x16x32_bf16 v[160:163], v[88:91], v[52:55], v[160:163]
v_mov_b32 v238, v240
v_mov_b32 v237, v239
s_nop 0
v_permlane16_swap_b32 v240, v238
s_waitcnt lgkmcnt(7)
v_mfma_f32_16x16x32_bf16 v[164:167], v[92:95], v[48:51], v[164:167]
ds_read_b128 v[88:91], v245 offset:1024
s_add_u32 m0, s48, 49152
s_add_u32 s49, s46, 208896
buffer_load_dwordx4 v247, s[24:27], s49 offen sc1 lds
v_permlane16_swap_b32 v239, v237
v_max_f32 v240, v240, v238
v_min_f32 v239, v239, v237
v_mfma_f32_16x16x32_bf16 v[168:171], v[92:95], v[52:55], v[168:171]
v_sub_f32 v246, v204, v240
v_sub_f32 v204, v239, v204
v_exp_f32 v246, v246
v_mfma_f32_16x16x32_bf16 v[172:175], v[96:99], v[48:51], v[172:175]
ds_read_b128 v[92:95], v245 offset:5120
v_exp_f32 v204, v204
v_sub_f32 v3, v205, v240
v_sub_f32 v205, v239, v205
v_mfma_f32_16x16x32_bf16 v[176:179], v[96:99], v[52:55], v[176:179]
v_exp_f32 v3, v3
v_exp_f32 v205, v205
v_sub_f32 v2, v206, v240
s_setprio 0
s_waitcnt lgkmcnt(2)
v_mfma_f32_16x16x32_bf16 v[156:159], v[80:83], v[20:23], v[156:159]
ds_read_b128 v[96:99], v245 offset:6144
v_sub_f32 v206, v239, v206
v_exp_f32 v2, v2
v_exp_f32 v206, v206
v_mfma_f32_16x16x32_bf16 v[160:163], v[80:83], v[24:27], v[160:163]
v_sub_f32 v235, v207, v240
v_sub_f32 v207, v239, v207
v_exp_f32 v235, v235
v_mfma_f32_16x16x32_bf16 v[164:167], v[84:87], v[20:23], v[164:167]
ds_read_b128 v[80:83], v245 offset:7168
v_exp_f32 v207, v207
v_sub_f32 v233, v212, v240
v_sub_f32 v212, v239, v212
v_mfma_f32_16x16x32_bf16 v[168:171], v[84:87], v[24:27], v[168:171]
v_exp_f32 v233, v233
v_exp_f32 v212, v212
v_sub_f32 v232, v213, v240
s_waitcnt lgkmcnt(2)
v_mfma_f32_16x16x32_bf16 v[172:175], v[88:91], v[20:23], v[172:175]
ds_read_b128 v[84:87], v248 offset:27648
v_sub_f32 v213, v239, v213
v_exp_f32 v232, v232
v_exp_f32 v213, v213
v_mfma_f32_16x16x32_bf16 v[176:179], v[88:91], v[24:27], v[176:179]
v_sub_f32 v243, v214, v240
v_sub_f32 v214, v239, v214
v_exp_f32 v243, v243
s_waitcnt vmcnt(1)
s_barrier
s_setprio 3
v_mfma_f32_16x16x32_bf16 v[156:159], v[92:95], v[56:59], v[156:159]
ds_read_b128 v[88:91], v248 offset:28672
v_exp_f32 v214, v214
v_sub_f32 v242, v215, v240
v_sub_f32 v215, v239, v215
v_mfma_f32_16x16x32_bf16 v[160:163], v[92:95], v[60:63], v[160:163]
v_exp_f32 v242, v242
v_exp_f32 v215, v215
s_waitcnt lgkmcnt(2)
v_mfma_f32_16x16x32_bf16 v[164:167], v[96:99], v[56:59], v[164:167]
ds_read_b128 v[92:95], v248 offset:29696
s_add_u32 m0, s48, 16384
s_add_u32 s49, s46, 217088
buffer_load_dwordx4 v247, s[24:27], s49 offen sc1 lds
v_sub_f32 v241, v220, v240
v_sub_f32 v220, v239, v220
v_mfma_f32_16x16x32_bf16 v[168:171], v[96:99], v[60:63], v[168:171]
v_exp_f32 v241, v241
v_exp_f32 v220, v220
v_add_f32 v240, v246, v3
v_mfma_f32_16x16x32_bf16 v[172:175], v[80:83], v[56:59], v[172:175]
ds_read_b128 v[96:99], v248 offset:33792
v_add_f32 v239, v204, v205
v_add_f32 v240, v240, v2
v_add_f32 v239, v239, v206
v_mfma_f32_16x16x32_bf16 v[176:179], v[80:83], v[60:63], v[176:179]
v_add_f32 v240, v240, v235
v_add_f32 v239, v239, v207
s_waitcnt lgkmcnt(2)
v_mfma_f32_16x16x32_bf16 v[156:159], v[84:87], v[100:103], v[156:159]
ds_read_b128 v[80:83], v248 offset:34816
v_add_f32 v240, v240, v233
v_add_f32 v239, v239, v212
v_mfma_f32_16x16x32_bf16 v[160:163], v[84:87], v[104:107], v[160:163]
v_add_f32 v240, v240, v232
v_add_f32 v239, v239, v213
s_setprio 2
v_mfma_f32_16x16x32_bf16 v[164:167], v[88:91], v[100:103], v[164:167]
ds_read_b128 v[84:87], v248 offset:35840
v_add_f32 v240, v240, v243
v_add_f32 v239, v239, v214
v_add_f32 v240, v240, v242
v_mfma_f32_16x16x32_bf16 v[168:171], v[88:91], v[104:107], v[168:171]
v_add_f32 v239, v239, v215
v_add_f32 v240, v240, v241
s_waitcnt lgkmcnt(2)
v_mfma_f32_16x16x32_bf16 v[172:175], v[92:95], v[100:103], v[172:175]
ds_read_b128 v[88:91], v248 offset:3072
s_add_u32 m0, s48, 53248
s_add_u32 s49, s46, 225280
buffer_load_dwordx4 v247, s[24:27], s49 offen sc1 lds
v_add_f32 v239, v239, v220
v_mov_b32 v238, v240
v_mfma_f32_16x16x32_bf16 v[176:179], v[92:95], v[104:107], v[176:179]
v_mov_b32 v237, v239
v_permlane16_swap_b32 v240, v238
s_nop 0
v_permlane16_swap_b32 v239, v237
v_mfma_f32_16x16x32_bf16 v[156:159], v[96:99], v[108:111], v[156:159]
ds_read_b128 v[92:95], v248 offset:4096
v_add_f32 v240, v240, v238
v_add_f32 v239, v239, v237
v_rcp_f32 v240, v240
v_mfma_f32_16x16x32_bf16 v[160:163], v[96:99], v[112:115], v[160:163]
v_rcp_f32 v239, v239
v_mul_f32 v246, v246, v240
s_waitcnt lgkmcnt(2)
v_mfma_f32_16x16x32_bf16 v[164:167], v[80:83], v[108:111], v[164:167]
ds_read_b128 v[96:99], v248 offset:5120
v_mul_f32 v204, v204, v239
v_mul_f32 v3, v3, v240
v_mfma_f32_16x16x32_bf16 v[168:171], v[80:83], v[112:115], v[168:171]
v_mul_f32 v205, v205, v239
v_mul_f32 v2, v2, v240
s_setprio 1
v_mfma_f32_16x16x32_bf16 v[172:175], v[84:87], v[108:111], v[172:175]
ds_read_b128 v[80:83], v248 offset:9216
v_mul_f32 v206, v206, v239
v_mul_f32 v235, v235, v240
v_mul_f32 v207, v207, v239
v_mfma_f32_16x16x32_bf16 v[176:179], v[84:87], v[112:115], v[176:179]
v_mul_f32 v233, v233, v240
v_mul_f32 v212, v212, v239
s_waitcnt lgkmcnt(2)
v_mfma_f32_16x16x32_bf16 v[156:159], v[88:91], v[28:31], v[156:159]
ds_read_b128 v[84:87], v248 offset:10240
s_add_u32 m0, s48, 61440
s_add_u32 s49, s46, 233472
buffer_load_dwordx4 v247, s[24:27], s49 offen sc1 lds
v_mul_f32 v232, v232, v240
v_mul_f32 v213, v213, v239
v_mfma_f32_16x16x32_bf16 v[160:163], v[88:91], v[32:35], v[160:163]
v_mul_f32 v243, v243, v240
v_mul_f32 v214, v214, v239
v_mul_f32 v242, v242, v240
v_mfma_f32_16x16x32_bf16 v[164:167], v[92:95], v[28:31], v[164:167]
ds_read_b128 v[88:91], v248 offset:11264
v_mul_f32 v215, v215, v239
v_mul_f32 v241, v241, v240
v_mul_f32 v220, v220, v239
v_mfma_f32_16x16x32_bf16 v[168:171], v[92:95], v[32:35], v[168:171]
v_cvt_pk_bf16_f32 v204, v204, v205
v_cvt_pk_bf16_f32 v205, v206, v207
s_waitcnt lgkmcnt(2)
v_mfma_f32_16x16x32_bf16 v[172:175], v[96:99], v[28:31], v[172:175]
ds_read_b128 v[92:95], v248 offset:39936
v_cvt_pk_bf16_f32 v206, v212, v213
v_cvt_pk_bf16_f32 v207, v214, v215
v_mfma_f32_16x16x32_bf16 v[176:179], v[96:99], v[32:35], v[176:179]
v_cvt_pk_bf16_f32 v212, v220, v246
v_cvt_pk_bf16_f32 v213, v3, v2
s_setprio 0
v_mfma_f32_16x16x32_bf16 v[156:159], v[80:83], v[64:67], v[156:159]
ds_read_b128 v[96:99], v248 offset:40960
v_cvt_pk_bf16_f32 v214, v235, v233
v_cvt_pk_bf16_f32 v215, v232, v243
v_cvt_pk_bf16_f32 v220, v242, v241
v_mfma_f32_16x16x32_bf16 v[160:163], v[80:83], v[68:71], v[160:163]
v_mov_b32 v221, 0
s_mul_i32 s50, s42, 5120
s_add_u32 s50, s50, 96768
v_mul_u32_u24 v253, 160, v251
v_mad_u32_u24 v253, v252, 40, v253
v_add_u32 v253, s50, v253
ds_write_b64 v253, v[204:205] offset:0
ds_write_b64 v253, v[206:207] offset:8
ds_write_b64 v253, v[212:213] offset:16
ds_write_b64 v253, v[214:215] offset:24
ds_write_b64 v253, v[220:221] offset:32
s_waitcnt lgkmcnt(7)
v_mfma_f32_16x16x32_bf16 v[164:167], v[84:87], v[64:67], v[164:167]
ds_read_b128 v[80:83], v248 offset:41984
v_mfma_f32_16x16x32_bf16 v[168:171], v[84:87], v[68:71], v[168:171]
v_mfma_f32_16x16x32_bf16 v[172:175], v[88:91], v[64:67], v[172:175]
ds_read_b128 v[84:87], v248 offset:46080
v_mfma_f32_16x16x32_bf16 v[176:179], v[88:91], v[68:71], v[176:179]
s_waitcnt vmcnt(1)
s_waitcnt lgkmcnt(2)
s_barrier
s_setprio 3
v_mfma_f32_16x16x32_bf16 v[156:159], v[92:95], v[116:119], v[156:159]
ds_read_b128 v[88:91], v248 offset:47104
v_lshl_add_u32 v255, v252, 2, v250
s_lshr_b32 s50, s42, 1
s_mul_i32 s51, s50, 80
s_add_u32 s51, s51, 94208
v_mul_u32_u24 v254, 160, v255
v_lshl_add_u32 v253, v249, 3, v254
v_add_u32 v2, s51, v253
s_lshl_b32 s51, s50, 5
s_add_u32 s51, s51, 72
v_lshl_add_u32 v254, v249, 3, s51
s_add_u32 s51, s51, 32
v_mov_b32 v253, s51
v_cmp_eq_u32 vcc, 0, v249
v_mov_b32 v3, 0x120
s_nop 0
v_cndmask_b32 v253, v3, v253, vcc
s_and_b32 s52, s42, 1
s_cmp_eq_u32 s52, 1
s_cselect_b64 vcc, -1, 0
v_cndmask_b32 v254, v254, v253, vcc
v_mul_u32_u24 v255, 304, v255
v_add_u32 v255, 114688, v255
v_add_u32 v3, v255, v254
v_mfma_f32_16x16x32_bf16 v[160:163], v[92:95], v[120:123], v[160:163]
ds_read_b64_tr_b16 v[204:205], v3 offset:0
ds_read_b64_tr_b16 v[206:207], v3 offset:4864
ds_read_b64_tr_b16 v[208:209], v2 offset:0
ds_read_b64_tr_b16 v[210:211], v2 offset:2560
ds_read_b64_tr_b16 v[212:213], v2 offset:32
ds_read_b64_tr_b16 v[214:215], v2 offset:2592
ds_read_b64_tr_b16 v[216:217], v2 offset:64
ds_read_b64_tr_b16 v[218:219], v2 offset:2624
v_mfma_f32_16x16x32_bf16 v[164:167], v[96:99], v[116:119], v[164:167]
ds_read_b128 v[92:95], v248 offset:48128
s_add_u32 m0, s48, 4096
s_add_u32 s49, s46, 241664
buffer_load_dwordx4 v247, s[24:27], s49 offen sc1 lds
v_mfma_f32_16x16x32_bf16 v[168:171], v[96:99], v[120:123], v[168:171]
s_waitcnt lgkmcnt(1)
v_mfma_f32_16x16x32_bf16 v[180:183], v[208:211], v[204:207], 0
v_mfma_f32_16x16x32_bf16 v[184:187], v[212:215], v[204:207], 0
v_mfma_f32_16x16x32_bf16 v[200:203], v[216:219], v[204:207], 0
v_mfma_f32_16x16x32_bf16 v[172:175], v[80:83], v[116:119], v[172:175]
ds_read_b128 v[96:99], v248 offset:52224
ds_read_b64_tr_b16 v[204:205], v3 offset:9728
ds_read_b64_tr_b16 v[206:207], v3 offset:14592
ds_read_b64_tr_b16 v[208:209], v2 offset:5120
ds_read_b64_tr_b16 v[210:211], v2 offset:7680
ds_read_b64_tr_b16 v[212:213], v2 offset:5152
ds_read_b64_tr_b16 v[214:215], v2 offset:7712
ds_read_b64_tr_b16 v[216:217], v2 offset:5184
ds_read_b64_tr_b16 v[218:219], v2 offset:7744
v_mfma_f32_16x16x32_bf16 v[176:179], v[80:83], v[120:123], v[176:179]
s_setprio 2
v_mfma_f32_16x16x32_bf16 v[156:159], v[84:87], v[188:191], v[156:159]
ds_read_b128 v[80:83], v248 offset:12288
s_add_u32 m0, s48, 24576
s_add_u32 s49, s46, 249856
buffer_load_dwordx4 v247, s[24:27], s49 offen sc1 lds
v_mfma_f32_16x16x32_bf16 v[160:163], v[84:87], v[192:195], v[160:163]
s_waitcnt lgkmcnt(1)
v_mfma_f32_16x16x32_bf16 v[180:183], v[208:211], v[204:207], v[180:183]
v_mfma_f32_16x16x32_bf16 v[184:187], v[212:215], v[204:207], v[184:187]
v_mfma_f32_16x16x32_bf16 v[200:203], v[216:219], v[204:207], v[200:203]
v_mfma_f32_16x16x32_bf16 v[164:167], v[88:91], v[188:191], v[164:167]
ds_read_b128 v[84:87], v248 offset:13312
ds_read_b64_tr_b16 v[204:205], v3 offset:19456
ds_read_b64_tr_b16 v[206:207], v3 offset:24320
ds_read_b64_tr_b16 v[208:209], v2 offset:10240
ds_read_b64_tr_b16 v[210:211], v2 offset:12800
ds_read_b64_tr_b16 v[212:213], v2 offset:10272
ds_read_b64_tr_b16 v[214:215], v2 offset:12832
ds_read_b64_tr_b16 v[216:217], v2 offset:10304
ds_read_b64_tr_b16 v[218:219], v2 offset:12864
v_mfma_f32_16x16x32_bf16 v[168:171], v[88:91], v[192:195], v[168:171]
v_mfma_f32_16x16x32_bf16 v[172:175], v[92:95], v[188:191], v[172:175]
ds_read_b128 v[88:91], v248 offset:17408
s_add_u32 m0, s48, 32768
s_add_u32 s49, s46, 258048
buffer_load_dwordx4 v247, s[24:27], s49 offen sc1 lds
v_mfma_f32_16x16x32_bf16 v[176:179], v[92:95], v[192:195], v[176:179]
s_waitcnt lgkmcnt(1)
v_mfma_f32_16x16x32_bf16 v[180:183], v[208:211], v[204:207], v[180:183]
v_mfma_f32_16x16x32_bf16 v[184:187], v[212:215], v[204:207], v[184:187]
v_mfma_f32_16x16x32_bf16 v[200:203], v[216:219], v[204:207], v[200:203]
s_setprio 1
v_mfma_f32_16x16x32_bf16 v[156:159], v[96:99], v[36:39], v[156:159]
ds_read_b128 v[92:95], v248 offset:18432
ds_read_b64_tr_b16 v[204:205], v3 offset:29184
ds_read_b64_tr_b16 v[206:207], v3 offset:34048
ds_read_b64_tr_b16 v[208:209], v2 offset:15360
ds_read_b64_tr_b16 v[210:211], v2 offset:17920
ds_read_b64_tr_b16 v[212:213], v2 offset:15392
ds_read_b64_tr_b16 v[214:215], v2 offset:17952
ds_read_b64_tr_b16 v[216:217], v2 offset:15424
ds_read_b64_tr_b16 v[218:219], v2 offset:17984
v_mfma_f32_16x16x32_bf16 v[160:163], v[96:99], v[72:75], v[160:163]
s_waitcnt lgkmcnt(0)
v_mfma_f32_16x16x32_bf16 v[180:183], v[208:211], v[204:207], v[180:183]
v_mfma_f32_16x16x32_bf16 v[184:187], v[212:215], v[204:207], v[184:187]
v_mfma_f32_16x16x32_bf16 v[200:203], v[216:219], v[204:207], v[200:203]
v_mfma_f32_16x16x32_bf16 v[164:167], v[80:83], v[36:39], v[164:167]
ds_read_b128 v[96:99], v248 offset:19456
s_add_u32 m0, s48, 69632
s_add_u32 s49, s46, 266240
buffer_load_dwordx4 v247, s[24:27], s49 offen sc1 lds
v_mfma_f32_16x16x32_bf16 v[168:171], v[80:83], v[72:75], v[168:171]
v_mov_b32 v253, 4288
v_min_u32 v255, v253, v244
v_cmp_gt_u32 vcc, 2, v252
s_nop 1
v_cndmask_b32 v254, v253, v255, vcc
v_add_u32 v255, 159424, v255
v_add_u32 v254, 159424, v254
v_cvt_pk_bf16_f32 v180, v180, v181
v_cvt_pk_bf16_f32 v181, v182, v183
ds_write_b64 v255, v[180:181] offset:0
v_cvt_pk_bf16_f32 v184, v184, v185
v_cvt_pk_bf16_f32 v185, v186, v187
ds_write_b64 v255, v[184:185] offset:32
v_cvt_pk_bf16_f32 v200, v200, v201
v_cvt_pk_bf16_f32 v201, v202, v203
ds_write_b64 v254, v[200:201] offset:64
v_mfma_f32_16x16x32_bf16 v[172:175], v[84:87], v[36:39], v[172:175]
ds_read_b128 v[80:83], v248 offset:23552
v_mfma_f32_16x16x32_bf16 v[176:179], v[84:87], v[72:75], v[176:179]
s_setprio 0
v_mfma_f32_16x16x32_bf16 v[156:159], v[88:91], v[76:79], v[156:159]
ds_read_b128 v[84:87], v248 offset:53248
v_mfma_f32_16x16x32_bf16 v[160:163], v[88:91], v[196:199], v[160:163]
v_mfma_f32_16x16x32_bf16 v[164:167], v[92:95], v[76:79], v[164:167]
ds_read_b128 v[88:91], v248 offset:54272
v_mfma_f32_16x16x32_bf16 v[168:171], v[92:95], v[196:199], v[168:171]
s_waitcnt lgkmcnt(6)
v_mfma_f32_16x16x32_bf16 v[172:175], v[96:99], v[76:79], v[172:175]
ds_read_b128 v[92:95], v248 offset:58368
v_mfma_f32_16x16x32_bf16 v[176:179], v[96:99], v[196:199], v[176:179]
s_waitcnt vmcnt(1)
s_waitcnt lgkmcnt(4)
s_barrier
s_setprio 3
v_add_u32 v255, 159424, v247
ds_read_b128 v[216:219], v255
s_waitcnt lgkmcnt(3)
v_mfma_f32_16x16x32_bf16 v[180:183], v[80:83], v[124:127], 0
ds_read_b128 v[96:99], v248 offset:59392
v_mfma_f32_16x16x32_bf16 v[184:187], v[80:83], v[128:131], 0
s_waitcnt lgkmcnt(1)
s_lshl_b32 s50, s41, 6
s_add_u32 s50, s50, s40
s_mul_i32 s50, s50, 3072
s_add_u32 s50, s50, 40943616
s_cmp_lt_u32 s42, 3
s_cselect_b32 s51, 0, 1879048192
v_add_u32 v255, s51, v247
buffer_store_dwordx4 v[216:219], v255, s[24:27], s50 offen sc1
v_mfma_f32_16x16x32_bf16 v[200:203], v[84:87], v[124:127], 0
ds_read_b128 v[80:83], v248 offset:60416
s_add_u32 m0, s48, 16384
s_add_u32 s49, s46, 274432
buffer_load_dwordx4 v247, s[24:27], s49 offen sc1 lds
v_max3_f32 v240, v156, v157, v158
v_max3_f32 v240, v240, v159, v164
v_mfma_f32_16x16x32_bf16 v[204:207], v[84:87], v[128:131], 0
v_max3_f32 v240, v240, v165, v166
v_max3_f32 v240, v240, v167, v172
v_min3_f32 v239, v156, v157, v158
v_mfma_f32_16x16x32_bf16 v[208:211], v[88:91], v[124:127], 0
ds_read_b128 v[84:87], v248 offset:64512
v_min3_f32 v239, v239, v159, v164
v_min3_f32 v239, v239, v165, v166
v_min3_f32 v239, v239, v167, v172
v_mfma_f32_16x16x32_bf16 v[212:215], v[88:91], v[128:131], 0
v_mov_b32 v238, v240
v_mov_b32 v237, v239
v_mfma_f32_16x16x32_bf16 v[180:183], v[92:95], v[132:135], v[180:183]
ds_read_b128 v[88:91], v248 offset:0
v_permlane16_swap_b32 v240, v238
v_permlane16_swap_b32 v239, v237
v_max_f32 v240, v240, v238
v_mfma_f32_16x16x32_bf16 v[184:187], v[92:95], v[136:139], v[184:187]
v_min_f32 v239, v239, v237
v_sub_f32 v246, v156, v240
s_setprio 2
s_waitcnt lgkmcnt(2)
v_mfma_f32_16x16x32_bf16 v[200:203], v[96:99], v[132:135], v[200:203]
ds_read_b128 v[92:95], v248 offset:1024
v_sub_f32 v156, v239, v156
v_exp_f32 v246, v246
v_exp_f32 v156, v156
v_mfma_f32_16x16x32_bf16 v[204:207], v[96:99], v[136:139], v[204:207]
v_sub_f32 v3, v157, v240
v_sub_f32 v157, v239, v157
v_mfma_f32_16x16x32_bf16 v[208:211], v[80:83], v[132:135], v[208:211]
ds_read_b128 v[96:99], v248 offset:5120
s_add_u32 m0, s48, 40960
s_add_u32 s49, s46, 282624
buffer_load_dwordx4 v247, s[24:27], s49 offen sc1 lds
v_exp_f32 v3, v3
v_exp_f32 v157, v157
v_mfma_f32_16x16x32_bf16 v[212:215], v[80:83], v[136:139], v[212:215]
v_sub_f32 v2, v158, v240
v_sub_f32 v158, v239, v158
v_exp_f32 v2, v2
s_waitcnt lgkmcnt(2)
v_mfma_f32_16x16x32_bf16 v[180:183], v[84:87], v[140:143], v[180:183]
ds_read_b128 v[80:83], v248 offset:6144
v_exp_f32 v158, v158
v_sub_f32 v235, v159, v240
v_sub_f32 v159, v239, v159
v_mfma_f32_16x16x32_bf16 v[184:187], v[84:87], v[144:147], v[184:187]
v_exp_f32 v235, v235
v_exp_f32 v159, v159
v_mfma_f32_16x16x32_bf16 v[200:203], v[88:91], v[140:143], v[200:203]
ds_read_b128 v[84:87], v248 offset:7168
v_sub_f32 v233, v164, v240
v_sub_f32 v164, v239, v164
v_exp_f32 v233, v233
v_mfma_f32_16x16x32_bf16 v[204:207], v[88:91], v[144:147], v[204:207]
v_exp_f32 v164, v164
v_sub_f32 v232, v165, v240
s_setprio 1
s_waitcnt lgkmcnt(2)
v_mfma_f32_16x16x32_bf16 v[208:211], v[92:95], v[140:143], v[208:211]
ds_read_b128 v[88:91], v248 offset:11264
v_sub_f32 v165, v239, v165
v_exp_f32 v232, v232
v_exp_f32 v165, v165
v_mfma_f32_16x16x32_bf16 v[212:215], v[92:95], v[144:147], v[212:215]
v_sub_f32 v243, v166, v240
v_sub_f32 v166, v239, v166
v_mfma_f32_16x16x32_bf16 v[180:183], v[96:99], v[148:151], v[180:183]
ds_read_b128 v[92:95], v248 offset:24576
s_add_u32 m0, s48, 49152
s_add_u32 s49, s46, 290816
buffer_load_dwordx4 v247, s[24:27], s49 offen sc1 lds
v_exp_f32 v243, v243
v_exp_f32 v166, v166
v_mfma_f32_16x16x32_bf16 v[184:187], v[96:99], v[152:155], v[184:187]
v_sub_f32 v242, v167, v240
v_sub_f32 v167, v239, v167
v_exp_f32 v242, v242
s_waitcnt lgkmcnt(2)
v_mfma_f32_16x16x32_bf16 v[200:203], v[80:83], v[148:151], v[200:203]
ds_read_b128 v[96:99], v248 offset:25600
v_exp_f32 v167, v167
v_sub_f32 v241, v172, v240
v_sub_f32 v172, v239, v172
v_mfma_f32_16x16x32_bf16 v[204:207], v[80:83], v[152:155], v[204:207]
v_exp_f32 v241, v241
v_exp_f32 v172, v172
v_mfma_f32_16x16x32_bf16 v[208:211], v[84:87], v[148:151], v[208:211]
ds_read_b128 v[80:83], v248 offset:29696
v_add_f32 v240, v246, v3
v_add_f32 v239, v156, v157
v_add_f32 v240, v240, v2
v_mfma_f32_16x16x32_bf16 v[212:215], v[84:87], v[152:155], v[212:215]
v_add_f32 v239, v239, v158
v_add_f32 v240, v240, v235
s_setprio 0
s_waitcnt lgkmcnt(2)
v_mfma_f32_16x16x32_bf16 v[180:183], v[88:91], v[4:7], v[180:183]
ds_read_b128 v[84:87], v248 offset:30720
v_add_f32 v239, v239, v159
v_add_f32 v240, v240, v233
v_add_f32 v239, v239, v164
v_mfma_f32_16x16x32_bf16 v[184:187], v[88:91], v[8:11], v[184:187]
v_add_f32 v240, v240, v232
v_add_f32 v239, v239, v165
v_mfma_f32_16x16x32_bf16 v[200:203], v[92:95], v[4:7], v[200:203]
ds_read_b128 v[88:91], v248 offset:31744
v_add_f32 v240, v240, v243
v_add_f32 v239, v239, v166
v_add_f32 v240, v240, v242
v_mfma_f32_16x16x32_bf16 v[204:207], v[92:95], v[8:11], v[204:207]
v_add_f32 v239, v239, v167
v_add_f32 v240, v240, v241
s_waitcnt lgkmcnt(2)
v_mfma_f32_16x16x32_bf16 v[208:211], v[96:99], v[4:7], v[208:211]
ds_read_b128 v[92:95], v248 offset:35840
v_add_f32 v239, v239, v172
v_mov_b32 v238, v240
v_mfma_f32_16x16x32_bf16 v[212:215], v[96:99], v[8:11], v[212:215]
v_mov_b32 v237, v239
v_permlane16_swap_b32 v240, v238
s_waitcnt vmcnt(3)
s_waitcnt vmcnt(1)
s_barrier
s_setprio 3
s_lshl_b32 s50, s41, 7
s_add_u32 s50, s50, 46141440
s_lshl_b32 s51, s40, 3
s_add_u32 s50, s50, s51
v_mov_b32 v230, s98
v_mov_b32 v231, s99
s_cmp_eq_u32 s42, 0
s_cselect_b64 exec, 1, 0
s_cbranch_scc0 L_fsa1_3
buffer_store_dwordx2 v[230:231], v248, s[24:27], s50 offen sc1
L_fsa1_3:
s_mov_b64 exec, -1
v_mfma_f32_16x16x32_bf16 v[180:183], v[80:83], v[12:15], v[180:183]
ds_read_b128 v[96:99], v245 offset:0
v_permlane16_swap_b32 v239, v237
v_add_f32 v240, v240, v238
v_add_f32 v239, v239, v237
v_rcp_f32 v240, v240
v_mfma_f32_16x16x32_bf16 v[184:187], v[80:83], v[16:19], v[184:187]
v_rcp_f32 v239, v239
v_mul_f32 v246, v246, v240
v_mul_f32 v156, v156, v239
s_waitcnt lgkmcnt(2)
v_mfma_f32_16x16x32_bf16 v[200:203], v[84:87], v[12:15], v[200:203]
ds_read_b128 v[80:83], v245 offset:1024
s_add_u32 m0, s48, 4096
s_add_u32 s49, s46, 299008
buffer_load_dwordx4 v247, s[24:27], s49 offen sc1 lds
v_mul_f32 v3, v3, v240
v_mul_f32 v157, v157, v239
v_mul_f32 v2, v2, v240
v_mfma_f32_16x16x32_bf16 v[204:207], v[84:87], v[16:19], v[204:207]
v_mul_f32 v158, v158, v239
v_mul_f32 v235, v235, v240
v_mul_f32 v159, v159, v239
v_mfma_f32_16x16x32_bf16 v[208:211], v[88:91], v[12:15], v[208:211]
ds_read_b128 v[84:87], v245 offset:5120
v_mul_f32 v233, v233, v240
v_mul_f32 v164, v164, v239
v_mul_f32 v232, v232, v240
v_mfma_f32_16x16x32_bf16 v[212:215], v[88:91], v[16:19], v[212:215]
v_mul_f32 v165, v165, v239
v_mul_f32 v243, v243, v240
v_mul_f32 v166, v166, v239
s_setprio 2
s_waitcnt lgkmcnt(2)
v_mfma_f32_16x16x32_bf16 v[180:183], v[92:95], v[40:43], v[180:183]
ds_read_b128 v[88:91], v245 offset:6144
v_mul_f32 v242, v242, v240
v_mul_f32 v167, v167, v239
v_mul_f32 v241, v241, v240
v_mfma_f32_16x16x32_bf16 v[184:187], v[92:95], v[44:47], v[184:187]
v_mul_f32 v172, v172, v239
v_cvt_pk_bf16_f32 v156, v156, v157
v_cvt_pk_bf16_f32 v157, v158, v159
v_mfma_f32_16x16x32_bf16 v[200:203], v[96:99], v[40:43], v[200:203]
ds_read_b128 v[92:95], v245 offset:7168
s_add_u32 m0, s48, 20480
s_add_u32 s49, s46, 307200
buffer_load_dwordx4 v247, s[24:27], s49 offen sc1 lds
v_cvt_pk_bf16_f32 v158, v164, v165
v_cvt_pk_bf16_f32 v159, v166, v167
v_cvt_pk_bf16_f32 v164, v172, v246
v_mfma_f32_16x16x32_bf16 v[204:207], v[96:99], v[44:47], v[204:207]
v_cvt_pk_bf16_f32 v165, v3, v2
v_cvt_pk_bf16_f32 v166, v235, v233
v_cvt_pk_bf16_f32 v167, v232, v243
s_waitcnt lgkmcnt(2)
v_mfma_f32_16x16x32_bf16 v[208:211], v[80:83], v[40:43], v[208:211]
ds_read_b128 v[96:99], v248 offset:15360
v_cvt_pk_bf16_f32 v172, v242, v241
v_mov_b32 v173, 0
s_mul_i32 s50, s42, 5120
s_add_u32 s50, s50, 94208
v_mul_u32_u24 v253, 160, v251
v_mad_u32_u24 v253, v252, 40, v253
v_add_u32 v253, s50, v253
ds_write_b64 v253, v[156:157] offset:0
ds_write_b64 v253, v[158:159] offset:8
ds_write_b64 v253, v[164:165] offset:16
ds_write_b64 v253, v[166:167] offset:24
ds_write_b64 v253, v[172:173] offset:32
v_mfma_f32_16x16x32_bf16 v[212:215], v[80:83], v[44:47], v[212:215]
v_max3_f32 v240, v160, v161, v162
v_max3_f32 v240, v240, v163, v168
v_max3_f32 v240, v240, v169, v170
s_setprio 1
v_mfma_f32_16x16x32_bf16 v[180:183], v[84:87], v[48:51], v[180:183]
ds_read_b128 v[80:83], v248 offset:16384
v_max3_f32 v240, v240, v171, v176
v_min3_f32 v239, v160, v161, v162
v_min3_f32 v239, v239, v163, v168
v_min3_f32 v239, v239, v169, v170
v_mfma_f32_16x16x32_bf16 v[184:187], v[84:87], v[52:55], v[184:187]
v_min3_f32 v239, v239, v171, v176
v_mov_b32 v238, v240
v_mov_b32 v237, v239
s_waitcnt lgkmcnt(7)
v_mfma_f32_16x16x32_bf16 v[200:203], v[88:91], v[48:51], v[200:203]
ds_read_b128 v[84:87], v248 offset:17408
s_add_u32 m0, s48, 57344
s_add_u32 s49, s46, 315392
buffer_load_dwordx4 v247, s[24:27], s49 offen sc1 lds
v_permlane16_swap_b32 v240, v238
v_permlane16_swap_b32 v239, v237
v_max_f32 v240, v240, v238
v_mfma_f32_16x16x32_bf16 v[204:207], v[88:91], v[52:55], v[204:207]
v_min_f32 v239, v239, v237
v_sub_f32 v246, v160, v240
v_sub_f32 v160, v239, v160
v_mfma_f32_16x16x32_bf16 v[208:211], v[92:95], v[48:51], v[208:211]
ds_read_b128 v[88:91], v248 offset:37888
v_exp_f32 v246, v246
v_exp_f32 v160, v160
v_sub_f32 v3, v161, v240
v_mfma_f32_16x16x32_bf16 v[212:215], v[92:95], v[52:55], v[212:215]
v_sub_f32 v161, v239, v161
v_exp_f32 v3, v3
v_exp_f32 v161, v161
s_setprio 0
s_waitcnt lgkmcnt(2)
v_mfma_f32_16x16x32_bf16 v[180:183], v[96:99], v[20:23], v[180:183]
ds_read_b128 v[92:95], v248 offset:38912
v_sub_f32 v2, v162, v240
v_sub_f32 v162, v239, v162
v_exp_f32 v2, v2
v_mfma_f32_16x16x32_bf16 v[184:187], v[96:99], v[24:27], v[184:187]
v_exp_f32 v162, v162
v_sub_f32 v235, v163, v240
v_sub_f32 v163, v239, v163
v_mfma_f32_16x16x32_bf16 v[200:203], v[80:83], v[20:23], v[200:203]
ds_read_b128 v[96:99], v248 offset:39936
v_exp_f32 v235, v235
v_exp_f32 v163, v163
v_sub_f32 v233, v168, v240
v_mfma_f32_16x16x32_bf16 v[204:207], v[80:83], v[24:27], v[204:207]
v_sub_f32 v168, v239, v168
v_exp_f32 v233, v233
v_exp_f32 v168, v168
s_waitcnt lgkmcnt(2)
v_mfma_f32_16x16x32_bf16 v[208:211], v[84:87], v[20:23], v[208:211]
ds_read_b128 v[80:83], v248 offset:44032
v_sub_f32 v232, v169, v240
v_sub_f32 v169, v239, v169
v_exp_f32 v232, v232
v_mfma_f32_16x16x32_bf16 v[212:215], v[84:87], v[24:27], v[212:215]
v_exp_f32 v169, v169
v_sub_f32 v243, v170, v240
v_sub_f32 v170, v239, v170
s_waitcnt vmcnt(0)
s_barrier
s_setprio 3
v_mfma_f32_16x16x32_bf16 v[180:183], v[88:91], v[56:59], v[180:183]
ds_read_b128 v[84:87], v248 offset:45056
v_exp_f32 v243, v243
v_exp_f32 v170, v170
v_sub_f32 v242, v171, v240
v_mfma_f32_16x16x32_bf16 v[184:187], v[88:91], v[60:63], v[184:187]
v_sub_f32 v171, v239, v171
v_exp_f32 v242, v242
s_waitcnt lgkmcnt(2)
v_mfma_f32_16x16x32_bf16 v[200:203], v[92:95], v[56:59], v[200:203]
ds_read_b128 v[88:91], v248 offset:46080
s_add_u32 m0, s48, 12288
s_add_u32 s49, s46, 323584
buffer_load_dwordx4 v247, s[24:27], s49 offen sc1 lds
v_exp_f32 v171, v171
v_sub_f32 v241, v176, v240
v_mfma_f32_16x16x32_bf16 v[204:207], v[92:95], v[60:63], v[204:207]
v_sub_f32 v176, v239, v176
v_exp_f32 v241, v241
v_exp_f32 v176, v176
v_mfma_f32_16x16x32_bf16 v[208:211], v[96:99], v[56:59], v[208:211]
ds_read_b128 v[92:95], v248 offset:50176
v_add_f32 v240, v246, v3
v_add_f32 v239, v160, v161
v_add_f32 v240, v240, v2
v_mfma_f32_16x16x32_bf16 v[212:215], v[96:99], v[60:63], v[212:215]
v_add_f32 v239, v239, v162
v_add_f32 v240, v240, v235
s_waitcnt lgkmcnt(2)
v_mfma_f32_16x16x32_bf16 v[180:183], v[80:83], v[100:103], v[180:183]
ds_read_b128 v[96:99], v248 offset:51200
v_add_f32 v239, v239, v163
v_add_f32 v240, v240, v233
v_add_f32 v239, v239, v168
v_mfma_f32_16x16x32_bf16 v[184:187], v[80:83], v[104:107], v[184:187]
v_add_f32 v240, v240, v232
v_add_f32 v239, v239, v169
s_setprio 2
v_mfma_f32_16x16x32_bf16 v[200:203], v[84:87], v[100:103], v[200:203]
ds_read_b128 v[80:83], v248 offset:52224
v_add_f32 v240, v240, v243
v_add_f32 v239, v239, v170
v_mfma_f32_16x16x32_bf16 v[204:207], v[84:87], v[104:107], v[204:207]
v_add_f32 v240, v240, v242
v_add_f32 v239, v239, v171
s_waitcnt lgkmcnt(2)
v_mfma_f32_16x16x32_bf16 v[208:211], v[88:91], v[100:103], v[208:211]
ds_read_b128 v[84:87], v248 offset:3072
s_add_u32 m0, s48, 28672
s_add_u32 s49, s46, 331776
buffer_load_dwordx4 v247, s[24:27], s49 offen sc1 lds
v_add_f32 v240, v240, v241
v_add_f32 v239, v239, v176
v_mfma_f32_16x16x32_bf16 v[212:215], v[88:91], v[104:107], v[212:215]
v_mov_b32 v238, v240
v_mov_b32 v237, v239
s_nop 0
v_permlane16_swap_b32 v240, v238
v_mfma_f32_16x16x32_bf16 v[180:183], v[92:95], v[108:111], v[180:183]
ds_read_b128 v[88:91], v248 offset:4096
v_permlane16_swap_b32 v239, v237
v_add_f32 v240, v240, v238
v_add_f32 v239, v239, v237
v_mfma_f32_16x16x32_bf16 v[184:187], v[92:95], v[112:115], v[184:187]
v_rcp_f32 v240, v240
v_rcp_f32 v239, v239
s_waitcnt lgkmcnt(2)
v_mfma_f32_16x16x32_bf16 v[200:203], v[96:99], v[108:111], v[200:203]
ds_read_b128 v[92:95], v248 offset:5120
v_mul_f32 v246, v246, v240
v_mul_f32 v160, v160, v239
v_mul_f32 v3, v3, v240
v_mfma_f32_16x16x32_bf16 v[204:207], v[96:99], v[112:115], v[204:207]
v_mul_f32 v161, v161, v239
v_mul_f32 v2, v2, v240
s_setprio 1
v_mfma_f32_16x16x32_bf16 v[208:211], v[80:83], v[108:111], v[208:211]
ds_read_b128 v[96:99], v248 offset:9216
v_mul_f32 v162, v162, v239
v_mul_f32 v235, v235, v240
v_mul_f32 v163, v163, v239
v_mfma_f32_16x16x32_bf16 v[212:215], v[80:83], v[112:115], v[212:215]
v_mul_f32 v233, v233, v240
v_mul_f32 v168, v168, v239
s_waitcnt lgkmcnt(2)
v_mfma_f32_16x16x32_bf16 v[180:183], v[84:87], v[28:31], v[180:183]
ds_read_b128 v[80:83], v248 offset:10240
s_add_u32 m0, s48, 65536
s_add_u32 s49, s46, 339968
buffer_load_dwordx4 v247, s[24:27], s49 offen sc1 lds
v_mul_f32 v232, v232, v240
v_mul_f32 v169, v169, v239
v_mfma_f32_16x16x32_bf16 v[184:187], v[84:87], v[32:35], v[184:187]
v_mul_f32 v243, v243, v240
v_mul_f32 v170, v170, v239
v_mfma_f32_16x16x32_bf16 v[200:203], v[88:91], v[28:31], v[200:203]
ds_read_b128 v[84:87], v248 offset:11264
v_mul_f32 v242, v242, v240
v_mul_f32 v171, v171, v239
v_mul_f32 v241, v241, v240
v_mfma_f32_16x16x32_bf16 v[204:207], v[88:91], v[32:35], v[204:207]
v_mul_f32 v176, v176, v239
v_cvt_pk_bf16_f32 v160, v160, v161
s_waitcnt lgkmcnt(2)
v_mfma_f32_16x16x32_bf16 v[208:211], v[92:95], v[28:31], v[208:211]
ds_read_b128 v[88:91], v248 offset:23552
v_cvt_pk_bf16_f32 v161, v162, v163
v_cvt_pk_bf16_f32 v162, v168, v169
v_cvt_pk_bf16_f32 v163, v170, v171
v_mfma_f32_16x16x32_bf16 v[212:215], v[92:95], v[32:35], v[212:215]
v_cvt_pk_bf16_f32 v168, v176, v246
v_cvt_pk_bf16_f32 v169, v3, v2
s_setprio 0
v_mfma_f32_16x16x32_bf16 v[180:183], v[96:99], v[64:67], v[180:183]
ds_read_b128 v[92:95], v248 offset:53248
v_cvt_pk_bf16_f32 v170, v235, v233
v_cvt_pk_bf16_f32 v171, v232, v243
v_cvt_pk_bf16_f32 v176, v242, v241
v_mfma_f32_16x16x32_bf16 v[184:187], v[96:99], v[68:71], v[184:187]
v_mov_b32 v177, 0
s_mul_i32 s50, s42, 5120
s_add_u32 s50, s50, 96768
v_mul_u32_u24 v253, 160, v251
v_mad_u32_u24 v253, v252, 40, v253
v_add_u32 v253, s50, v253
ds_write_b64 v253, v[160:161] offset:0
ds_write_b64 v253, v[162:163] offset:8
ds_write_b64 v253, v[168:169] offset:16
ds_write_b64 v253, v[170:171] offset:24
ds_write_b64 v253, v[176:177] offset:32
s_waitcnt lgkmcnt(7)
v_mfma_f32_16x16x32_bf16 v[200:203], v[80:83], v[64:67], v[200:203]
ds_read_b128 v[96:99], v248 offset:54272
v_mfma_f32_16x16x32_bf16 v[204:207], v[80:83], v[68:71], v[204:207]
v_mfma_f32_16x16x32_bf16 v[208:211], v[84:87], v[64:67], v[208:211]
ds_read_b128 v[80:83], v248 offset:58368
v_mfma_f32_16x16x32_bf16 v[212:215], v[84:87], v[68:71], v[212:215]
s_waitcnt vmcnt(0)
s_waitcnt lgkmcnt(2)
s_barrier
s_setprio 3
v_mfma_f32_16x16x32_bf16 v[180:183], v[88:91], v[116:119], v[180:183]
ds_read_b128 v[84:87], v248 offset:59392
v_lshl_add_u32 v255, v252, 2, v250
s_lshr_b32 s50, s42, 1
s_mul_i32 s51, s50, 80
s_add_u32 s51, s51, 94208
v_mul_u32_u24 v254, 160, v255
v_lshl_add_u32 v253, v249, 3, v254
v_add_u32 v2, s51, v253
s_lshl_b32 s51, s50, 5
s_add_u32 s51, s51, 216
v_lshl_add_u32 v254, v249, 3, s51
s_add_u32 s51, s51, 32
v_mov_b32 v253, s51
v_cmp_eq_u32 vcc, 0, v249
v_mov_b32 v3, 0x120
s_nop 0
v_cndmask_b32 v253, v3, v253, vcc
s_and_b32 s52, s42, 1
s_cmp_eq_u32 s52, 1
s_cselect_b64 vcc, -1, 0
v_cndmask_b32 v254, v254, v253, vcc
v_mul_u32_u24 v255, 304, v255
v_add_u32 v255, 114688, v255
v_add_u32 v3, v255, v254
v_mfma_f32_16x16x32_bf16 v[184:187], v[88:91], v[120:123], v[184:187]
ds_read_b64_tr_b16 v[168:169], v3 offset:0
ds_read_b64_tr_b16 v[170:171], v3 offset:4864
ds_read_b64_tr_b16 v[172:173], v2 offset:0
ds_read_b64_tr_b16 v[174:175], v2 offset:2560
ds_read_b64_tr_b16 v[176:177], v2 offset:32
ds_read_b64_tr_b16 v[178:179], v2 offset:2592
ds_read_b64_tr_b16 v[216:217], v2 offset:64
ds_read_b64_tr_b16 v[218:219], v2 offset:2624
v_mfma_f32_16x16x32_bf16 v[200:203], v[92:95], v[116:119], v[200:203]
ds_read_b128 v[88:91], v248 offset:60416
s_add_u32 m0, s48, 0
s_add_u32 s49, s46, 348160
buffer_load_dwordx4 v247, s[24:27], s49 offen sc1 lds
v_mfma_f32_16x16x32_bf16 v[204:207], v[92:95], v[120:123], v[204:207]
s_waitcnt lgkmcnt(1)
v_mfma_f32_16x16x32_bf16 v[156:159], v[172:175], v[168:171], 0
v_mfma_f32_16x16x32_bf16 v[160:163], v[176:179], v[168:171], 0
v_mfma_f32_16x16x32_bf16 v[164:167], v[216:219], v[168:171], 0
v_mfma_f32_16x16x32_bf16 v[208:211], v[96:99], v[116:119], v[208:211]
ds_read_b128 v[92:95], v248 offset:64512
ds_read_b64_tr_b16 v[168:169], v3 offset:9728
ds_read_b64_tr_b16 v[170:171], v3 offset:14592
ds_read_b64_tr_b16 v[172:173], v2 offset:5120
ds_read_b64_tr_b16 v[174:175], v2 offset:7680
ds_read_b64_tr_b16 v[176:177], v2 offset:5152
ds_read_b64_tr_b16 v[178:179], v2 offset:7712
ds_read_b64_tr_b16 v[216:217], v2 offset:5184
ds_read_b64_tr_b16 v[218:219], v2 offset:7744
v_mfma_f32_16x16x32_bf16 v[212:215], v[96:99], v[120:123], v[212:215]
s_setprio 2
v_mfma_f32_16x16x32_bf16 v[180:183], v[80:83], v[188:191], v[180:183]
ds_read_b128 v[96:99], v248 offset:12288
s_add_u32 m0, s48, 8192
s_add_u32 s49, s46, 356352
buffer_load_dwordx4 v247, s[24:27], s49 offen sc1 lds
v_mfma_f32_16x16x32_bf16 v[184:187], v[80:83], v[192:195], v[184:187]
s_waitcnt lgkmcnt(1)
v_mfma_f32_16x16x32_bf16 v[156:159], v[172:175], v[168:171], v[156:159]
v_mfma_f32_16x16x32_bf16 v[160:163], v[176:179], v[168:171], v[160:163]
v_mfma_f32_16x16x32_bf16 v[164:167], v[216:219], v[168:171], v[164:167]
v_mfma_f32_16x16x32_bf16 v[200:203], v[84:87], v[188:191], v[200:203]
ds_read_b128 v[80:83], v248 offset:13312
ds_read_b64_tr_b16 v[168:169], v3 offset:19456
ds_read_b64_tr_b16 v[170:171], v3 offset:24320
ds_read_b64_tr_b16 v[172:173], v2 offset:10240
ds_read_b64_tr_b16 v[174:175], v2 offset:12800
ds_read_b64_tr_b16 v[176:177], v2 offset:10272
ds_read_b64_tr_b16 v[178:179], v2 offset:12832
ds_read_b64_tr_b16 v[216:217], v2 offset:10304
ds_read_b64_tr_b16 v[218:219], v2 offset:12864
v_mfma_f32_16x16x32_bf16 v[204:207], v[84:87], v[192:195], v[204:207]
v_mfma_f32_16x16x32_bf16 v[208:211], v[88:91], v[188:191], v[208:211]
ds_read_b128 v[84:87], v248 offset:25600
s_add_u32 m0, s48, 36864
s_add_u32 s49, s46, 364544
buffer_load_dwordx4 v247, s[24:27], s49 offen sc1 lds
v_mfma_f32_16x16x32_bf16 v[212:215], v[88:91], v[192:195], v[212:215]
s_waitcnt lgkmcnt(1)
v_mfma_f32_16x16x32_bf16 v[156:159], v[172:175], v[168:171], v[156:159]
v_mfma_f32_16x16x32_bf16 v[160:163], v[176:179], v[168:171], v[160:163]
v_mfma_f32_16x16x32_bf16 v[164:167], v[216:219], v[168:171], v[164:167]
s_setprio 1
v_mfma_f32_16x16x32_bf16 v[180:183], v[92:95], v[36:39], v[180:183]
ds_read_b128 v[88:91], v248 offset:26624
ds_read_b64_tr_b16 v[168:169], v3 offset:29184
ds_read_b64_tr_b16 v[170:171], v3 offset:34048
ds_read_b64_tr_b16 v[172:173], v2 offset:15360
ds_read_b64_tr_b16 v[174:175], v2 offset:17920
ds_read_b64_tr_b16 v[176:177], v2 offset:15392
ds_read_b64_tr_b16 v[178:179], v2 offset:17952
ds_read_b64_tr_b16 v[216:217], v2 offset:15424
ds_read_b64_tr_b16 v[218:219], v2 offset:17984
v_mfma_f32_16x16x32_bf16 v[184:187], v[92:95], v[72:75], v[184:187]
s_waitcnt lgkmcnt(0)
v_mfma_f32_16x16x32_bf16 v[156:159], v[172:175], v[168:171], v[156:159]
v_mfma_f32_16x16x32_bf16 v[160:163], v[176:179], v[168:171], v[160:163]
v_mfma_f32_16x16x32_bf16 v[164:167], v[216:219], v[168:171], v[164:167]
v_mfma_f32_16x16x32_bf16 v[200:203], v[96:99], v[36:39], v[200:203]
ds_read_b128 v[92:95], v248 offset:27648
s_add_u32 m0, s48, 45056
s_add_u32 s49, s46, 372736
buffer_load_dwordx4 v247, s[24:27], s49 offen sc1 lds
v_mfma_f32_16x16x32_bf16 v[204:207], v[96:99], v[72:75], v[204:207]
v_mov_b32 v253, 4288
v_min_u32 v255, v253, v244
v_cmp_gt_u32 vcc, 2, v252
s_nop 1
v_cndmask_b32 v254, v253, v255, vcc
v_add_u32 v255, 159424, v255
v_add_u32 v254, 159424, v254
v_cvt_pk_bf16_f32 v156, v156, v157
v_cvt_pk_bf16_f32 v157, v158, v159
ds_write_b64 v255, v[156:157] offset:0
v_cvt_pk_bf16_f32 v160, v160, v161
v_cvt_pk_bf16_f32 v161, v162, v163
ds_write_b64 v255, v[160:161] offset:32
v_cvt_pk_bf16_f32 v164, v164, v165
v_cvt_pk_bf16_f32 v165, v166, v167
ds_write_b64 v254, v[164:165] offset:64
v_mfma_f32_16x16x32_bf16 v[208:211], v[80:83], v[36:39], v[208:211]
ds_read_b128 v[96:99], v248 offset:31744
v_mfma_f32_16x16x32_bf16 v[212:215], v[80:83], v[72:75], v[212:215]
s_setprio 0
v_mfma_f32_16x16x32_bf16 v[180:183], v[84:87], v[76:79], v[180:183]
ds_read_b128 v[80:83], v248 offset:32768
v_mfma_f32_16x16x32_bf16 v[184:187], v[84:87], v[196:199], v[184:187]
v_mfma_f32_16x16x32_bf16 v[200:203], v[88:91], v[76:79], v[200:203]
ds_read_b128 v[84:87], v248 offset:33792
v_mfma_f32_16x16x32_bf16 v[204:207], v[88:91], v[196:199], v[204:207]
s_waitcnt lgkmcnt(6)
v_mfma_f32_16x16x32_bf16 v[208:211], v[92:95], v[76:79], v[208:211]
ds_read_b128 v[88:91], v245 offset:1024
v_mfma_f32_16x16x32_bf16 v[212:215], v[92:95], v[196:199], v[212:215]
s_waitcnt vmcnt(1)
s_waitcnt lgkmcnt(4)
s_barrier
s_setprio 3
v_add_u32 v255, 159424, v247
ds_read_b128 v[216:219], v255
s_waitcnt lgkmcnt(3)
v_mfma_f32_16x16x32_bf16 v[156:159], v[96:99], v[124:127], 0
ds_read_b128 v[92:95], v245 offset:2048
v_mfma_f32_16x16x32_bf16 v[160:163], v[96:99], v[128:131], 0
s_waitcnt lgkmcnt(1)
s_lshl_b32 s50, s41, 6
s_add_u32 s50, s50, s40
s_mul_i32 s50, s50, 3072
s_add_u32 s50, s50, 41041920
s_cmp_lt_u32 s42, 3
s_cselect_b32 s51, 0, 1879048192
v_add_u32 v255, s51, v247
buffer_store_dwordx4 v[216:219], v255, s[24:27], s50 offen sc1
v_mfma_f32_16x16x32_bf16 v[164:167], v[80:83], v[124:127], 0
ds_read_b128 v[96:99], v245 offset:3072
s_add_u32 m0, s48, 12288
s_add_u32 s49, s46, 380928
buffer_load_dwordx4 v247, s[24:27], s49 offen sc1 lds
v_max3_f32 v241, v180, v181, v182
v_max3_f32 v241, v241, v183, v200
v_mfma_f32_16x16x32_bf16 v[168:171], v[80:83], v[128:131], 0
v_max3_f32 v241, v241, v201, v202
v_max3_f32 v241, v241, v203, v208
v_min3_f32 v240, v180, v181, v182
v_mfma_f32_16x16x32_bf16 v[172:175], v[84:87], v[124:127], 0
ds_read_b128 v[80:83], v245 offset:7168
s_add_u32 m0, s48, 24576
s_add_u32 s49, s46, 389120
buffer_load_dwordx4 v247, s[24:27], s49 offen sc1 lds
v_min3_f32 v240, v240, v183, v200
v_min3_f32 v240, v240, v201, v202
v_mfma_f32_16x16x32_bf16 v[176:179], v[84:87], v[128:131], 0
v_min3_f32 v240, v240, v203, v208
v_mov_b32 v239, v241
v_mov_b32 v238, v240
v_mfma_f32_16x16x32_bf16 v[156:159], v[88:91], v[132:135], v[156:159]
ds_read_b128 v[84:87], v248 offset:0
s_add_u32 m0, s48, 57344
s_add_u32 s49, s46, 397312
buffer_load_dwordx4 v247, s[24:27], s49 offen sc1 lds
v_permlane16_swap_b32 v241, v239
v_permlane16_swap_b32 v240, v238
v_mfma_f32_16x16x32_bf16 v[160:163], v[88:91], v[136:139], v[160:163]
v_max_f32 v241, v241, v239
v_min_f32 v240, v240, v238
v_sub_f32 v246, v180, v241
s_setprio 2
s_waitcnt lgkmcnt(2)
v_mfma_f32_16x16x32_bf16 v[164:167], v[92:95], v[132:135], v[164:167]
ds_read_b128 v[88:91], v248 offset:1024
s_add_u32 m0, s48, 73728
s_add_u32 s49, s46, 405504
buffer_load_dwordx4 v247, s[24:27], s49 offen sc1 lds
v_sub_f32 v180, v240, v180
v_exp_f32 v246, v246
v_mfma_f32_16x16x32_bf16 v[168:171], v[92:95], v[136:139], v[168:171]
v_exp_f32 v180, v180
v_sub_f32 v244, v181, v241
v_mfma_f32_16x16x32_bf16 v[172:175], v[96:99], v[132:135], v[172:175]
ds_read_b128 v[92:95], v248 offset:5120
s_add_u32 m0, s48, 81920
s_add_u32 s49, s46, 413696
buffer_load_dwordx4 v247, s[24:27], s49 offen sc1 lds
v_sub_f32 v181, v240, v181
v_exp_f32 v244, v244
v_mfma_f32_16x16x32_bf16 v[176:179], v[96:99], v[136:139], v[176:179]
v_exp_f32 v181, v181
v_sub_f32 v3, v182, v241
v_sub_f32 v182, v240, v182
s_waitcnt lgkmcnt(2)
v_mfma_f32_16x16x32_bf16 v[156:159], v[80:83], v[140:143], v[156:159]
ds_read_b128 v[96:99], v248 offset:6144
s_add_u32 m0, s48, 90112
s_add_u32 s49, s46, 421888
buffer_load_dwordx4 v247, s[24:27], s49 offen sc1 lds
v_exp_f32 v3, v3
v_exp_f32 v182, v182
v_mfma_f32_16x16x32_bf16 v[160:163], v[80:83], v[144:147], v[160:163]
v_sub_f32 v2, v183, v241
v_sub_f32 v183, v240, v183
v_exp_f32 v2, v2
v_mfma_f32_16x16x32_bf16 v[164:167], v[84:87], v[140:143], v[164:167]
ds_read_b128 v[80:83], v248 offset:7168
s_add_u32 m0, s48, 98304
s_add_u32 s49, s46, 430080
buffer_load_dwordx4 v247, s[24:27], s49 offen sc1 lds
v_exp_f32 v183, v183
v_sub_f32 v235, v200, v241
v_mfma_f32_16x16x32_bf16 v[168:171], v[84:87], v[144:147], v[168:171]
v_sub_f32 v200, v240, v200
v_exp_f32 v235, v235
v_exp_f32 v200, v200
s_setprio 1
s_waitcnt lgkmcnt(2)
v_mfma_f32_16x16x32_bf16 v[172:175], v[88:91], v[140:143], v[172:175]
ds_read_b128 v[84:87], v248 offset:11264
s_add_u32 m0, s48, 106496
s_add_u32 s49, s46, 438272
buffer_load_dwordx4 v247, s[24:27], s49 offen sc1 lds
v_sub_f32 v233, v201, v241
v_sub_f32 v201, v240, v201
v_mfma_f32_16x16x32_bf16 v[176:179], v[88:91], v[144:147], v[176:179]
v_exp_f32 v233, v233
v_exp_f32 v201, v201
v_sub_f32 v232, v202, v241
v_mfma_f32_16x16x32_bf16 v[156:159], v[92:95], v[148:151], v[156:159]
ds_read_b128 v[88:91], v248 offset:16384
v_sub_f32 v202, v240, v202
v_exp_f32 v232, v232
v_exp_f32 v202, v202
v_mfma_f32_16x16x32_bf16 v[160:163], v[92:95], v[152:155], v[160:163]
v_sub_f32 v243, v203, v241
v_and_b32 v255, 1, v1
v_lshlrev_b32 v255, 4, v255
v_mov_b32 v254, 0x3f80
v_lshlrev_b32 v255, v255, v254
v_lshrrev_b32 v254, 1, v251
v_cmp_eq_u32 vcc, 0, v254
s_nop 1
v_cndmask_b32 v124, 0, v255, vcc
v_cmp_eq_u32 vcc, 1, v254
s_nop 1
v_cndmask_b32 v125, 0, v255, vcc
v_cmp_eq_u32 vcc, 2, v254
s_nop 1
v_cndmask_b32 v126, 0, v255, vcc
v_cmp_eq_u32 vcc, 3, v254
s_nop 1
v_cndmask_b32 v127, 0, v255, vcc
v_cmp_eq_u32 vcc, 4, v254
s_nop 1
v_cndmask_b32 v128, 0, v255, vcc
v_cmp_eq_u32 vcc, 5, v254
s_nop 1
v_cndmask_b32 v129, 0, v255, vcc
v_cmp_eq_u32 vcc, 6, v254
s_nop 1
v_cndmask_b32 v130, 0, v255, vcc
v_cmp_eq_u32 vcc, 7, v254
s_nop 1
v_cndmask_b32 v131, 0, v255, vcc
v_lshlrev_b32 v255, 4, v251
v_lshl_add_u32 v237, v252, 10, v255
s_waitcnt lgkmcnt(2)
v_mfma_f32_16x16x32_bf16 v[164:167], v[96:99], v[148:151], v[164:167]
ds_read_b128 v[92:95], v248 offset:17408
v_sub_f32 v203, v240, v203
v_exp_f32 v243, v243
v_exp_f32 v203, v203
v_mfma_f32_16x16x32_bf16 v[168:171], v[96:99], v[152:155], v[168:171]
v_sub_f32 v242, v208, v241
v_sub_f32 v208, v240, v208
v_mfma_f32_16x16x32_bf16 v[172:175], v[80:83], v[148:151], v[172:175]
ds_read_b128 v[96:99], v248 offset:37888
v_exp_f32 v242, v242
v_exp_f32 v208, v208
v_add_f32 v241, v246, v244
v_mfma_f32_16x16x32_bf16 v[176:179], v[80:83], v[152:155], v[176:179]
v_add_f32 v240, v180, v181
v_add_f32 v241, v241, v3
s_setprio 0
s_waitcnt lgkmcnt(2)
v_mfma_f32_16x16x32_bf16 v[156:159], v[84:87], v[4:7], v[156:159]
ds_read_b128 v[80:83], v248 offset:38912
v_add_f32 v240, v240, v182
v_add_f32 v241, v241, v2
v_add_f32 v240, v240, v183
v_mfma_f32_16x16x32_bf16 v[160:163], v[84:87], v[8:11], v[160:163]
v_add_f32 v241, v241, v235
v_add_f32 v240, v240, v200
v_mul_u32_u24 v255, 3072, v252
v_lshl_add_u32 v255, v251, 4, v255
s_mul_i32 s50, s42, 768
s_mul_i32 s51, s41, 196608
s_add_u32 s51, s51, s50
s_add_u32 s50, s51, 40943616
buffer_load_dwordx4 v[132:135], v255, s[24:27], s50 offen offset:0 sc1
buffer_load_dwordx4 v[136:139], v255, s[24:27], s50 offen offset:256 sc1
buffer_load_dwordx4 v[140:143], v255, s[24:27], s50 offen offset:512 sc1
s_add_u32 s50, s51, 40955904
buffer_load_dwordx4 v[144:147], v255, s[24:27], s50 offen offset:0 sc1
buffer_load_dwordx4 v[148:151], v255, s[24:27], s50 offen offset:256 sc1
buffer_load_dwordx4 v[152:155], v255, s[24:27], s50 offen offset:512 sc1
v_mfma_f32_16x16x32_bf16 v[164:167], v[88:91], v[4:7], v[164:167]
ds_read_b128 v[84:87], v248 offset:39936
v_add_f32 v241, v241, v233
v_add_f32 v240, v240, v201
v_add_f32 v241, v241, v232
v_mfma_f32_16x16x32_bf16 v[168:171], v[88:91], v[8:11], v[168:171]
v_add_f32 v240, v240, v202
v_add_f32 v241, v241, v243
s_waitcnt lgkmcnt(2)
v_mfma_f32_16x16x32_bf16 v[172:175], v[92:95], v[4:7], v[172:175]
ds_read_b128 v[88:91], v248 offset:44032
v_add_f32 v240, v240, v203
v_add_f32 v241, v241, v242
v_mfma_f32_16x16x32_bf16 v[176:179], v[92:95], v[8:11], v[176:179]
v_add_f32 v240, v240, v208
v_mov_b32 v239, v241
s_waitcnt vmcnt(14)
s_waitcnt vmcnt(12)
s_barrier
s_setprio 3
s_lshl_b32 s50, s41, 7
s_add_u32 s50, s50, 46142464
s_lshl_b32 s51, s40, 3
s_add_u32 s50, s50, s51
v_mov_b32 v230, s98
v_mov_b32 v231, s99
s_cmp_eq_u32 s42, 0
s_cselect_b64 exec, 1, 0
s_cbranch_scc0 L_fsa1_4
buffer_store_dwordx2 v[230:231], v248, s[24:27], s50 offen sc1
L_fsa1_4:
s_mov_b64 exec, -1
v_mfma_f32_16x16x32_bf16 v[156:159], v[96:99], v[12:15], v[156:159]
ds_read_b128 v[92:95], v248 offset:45056
v_mov_b32 v238, v240
v_permlane16_swap_b32 v241, v239
s_nop 0
v_permlane16_swap_b32 v240, v238
v_mfma_f32_16x16x32_bf16 v[160:163], v[96:99], v[16:19], v[160:163]
v_add_f32 v241, v241, v239
v_add_f32 v240, v240, v238
v_rcp_f32 v241, v241
s_waitcnt lgkmcnt(2)
v_mfma_f32_16x16x32_bf16 v[164:167], v[80:83], v[12:15], v[164:167]
ds_read_b128 v[96:99], v248 offset:46080
v_rcp_f32 v240, v240
v_mul_f32 v246, v246, v241
v_mul_f32 v180, v180, v240
v_mfma_f32_16x16x32_bf16 v[168:171], v[80:83], v[16:19], v[168:171]
v_mul_f32 v244, v244, v241
v_mul_f32 v181, v181, v240
v_mul_f32 v3, v3, v241
v_mfma_f32_16x16x32_bf16 v[172:175], v[84:87], v[12:15], v[172:175]
ds_read_b128 v[80:83], v248 offset:50176
v_mul_f32 v182, v182, v240
v_mul_f32 v2, v2, v241
v_mul_f32 v183, v183, v240
v_mfma_f32_16x16x32_bf16 v[176:179], v[84:87], v[16:19], v[176:179]
v_mul_f32 v235, v235, v241
v_mul_f32 v200, v200, v240
v_mul_f32 v233, v233, v241
s_setprio 2
s_waitcnt lgkmcnt(2)
v_mfma_f32_16x16x32_bf16 v[156:159], v[88:91], v[40:43], v[156:159]
ds_read_b128 v[84:87], v248 offset:51200
v_mul_f32 v201, v201, v240
v_mul_f32 v232, v232, v241
v_mul_f32 v202, v202, v240
v_mul_f32 v243, v243, v241
v_mfma_f32_16x16x32_bf16 v[160:163], v[88:91], v[44:47], v[160:163]
v_mul_f32 v203, v203, v240
v_mul_f32 v242, v242, v241
v_mul_u32_u24 v255, 3072, v252
v_lshl_add_u32 v255, v251, 4, v255
s_mul_i32 s50, s42, 768
s_mul_i32 s51, s41, 196608
s_add_u32 s51, s51, s50
s_add_u32 s50, s51, 40968192
buffer_load_dwordx4 v[4:7], v255, s[24:27], s50 offen offset:0 sc1
buffer_load_dwordx4 v[8:11], v255, s[24:27], s50 offen offset:256 sc1
buffer_load_dwordx4 v[12:15], v255, s[24:27], s50 offen offset:512 sc1
s_add_u32 s50, s51, 40980480
buffer_load_dwordx4 v[16:19], v255, s[24:27], s50 offen offset:0 sc1
buffer_load_dwordx4 v[216:219], v255, s[24:27], s50 offen offset:256 sc1
buffer_load_dwordx4 v[220:223], v255, s[24:27], s50 offen offset:512 sc1
v_mfma_f32_16x16x32_bf16 v[164:167], v[92:95], v[40:43], v[164:167]
ds_read_b128 v[88:91], v248 offset:52224
v_mul_f32 v208, v208, v240
v_cvt_pk_bf16_f32 v180, v180, v181
v_cvt_pk_bf16_f32 v181, v182, v183
v_mfma_f32_16x16x32_bf16 v[168:171], v[92:95], v[44:47], v[168:171]
v_cvt_pk_bf16_f32 v182, v200, v201
v_cvt_pk_bf16_f32 v183, v202, v203
v_cvt_pk_bf16_f32 v200, v208, v246
s_waitcnt lgkmcnt(2)
v_mfma_f32_16x16x32_bf16 v[172:175], v[96:99], v[40:43], v[172:175]
ds_read_b128 v[92:95], v248 offset:15360
v_cvt_pk_bf16_f32 v201, v244, v3
v_cvt_pk_bf16_f32 v202, v2, v235
v_cvt_pk_bf16_f32 v203, v233, v232
v_mfma_f32_16x16x32_bf16 v[176:179], v[96:99], v[44:47], v[176:179]
v_cvt_pk_bf16_f32 v208, v243, v242
v_mov_b32 v209, 0
v_mov_b32 v210, 0
s_setprio 1
v_mfma_f32_16x16x32_bf16 v[156:159], v[80:83], v[48:51], v[156:159]
ds_read_b128 v[96:99], v248 offset:20480
v_mov_b32 v211, 0
v_max3_f32 v241, v184, v185, v186
v_max3_f32 v241, v241, v187, v204
v_mfma_f32_16x16x32_bf16 v[160:163], v[80:83], v[52:55], v[160:163]
v_max3_f32 v241, v241, v205, v206
v_max3_f32 v241, v241, v207, v212
v_min3_f32 v240, v184, v185, v186
s_waitcnt lgkmcnt(2)
v_mfma_f32_16x16x32_bf16 v[164:167], v[84:87], v[48:51], v[164:167]
ds_read_b128 v[80:83], v248 offset:21504
v_min3_f32 v240, v240, v187, v204
v_min3_f32 v240, v240, v205, v206
v_min3_f32 v240, v240, v207, v212
v_mfma_f32_16x16x32_bf16 v[168:171], v[84:87], v[52:55], v[168:171]
v_mov_b32 v239, v241
v_mov_b32 v238, v240
s_nop 0
v_permlane16_swap_b32 v241, v239
v_mfma_f32_16x16x32_bf16 v[172:175], v[88:91], v[48:51], v[172:175]
ds_read_b128 v[84:87], v248 offset:25600
v_permlane16_swap_b32 v240, v238
v_max_f32 v241, v241, v239
v_min_f32 v240, v240, v238
v_mfma_f32_16x16x32_bf16 v[176:179], v[88:91], v[52:55], v[176:179]
v_sub_f32 v246, v184, v241
v_sub_f32 v184, v240, v184
v_exp_f32 v246, v246
s_setprio 0
s_waitcnt lgkmcnt(2)
v_mfma_f32_16x16x32_bf16 v[156:159], v[92:95], v[20:23], v[156:159]
ds_read_b128 v[88:91], v248 offset:26624
v_exp_f32 v184, v184
v_sub_f32 v244, v185, v241
v_sub_f32 v185, v240, v185
v_mfma_f32_16x16x32_bf16 v[160:163], v[92:95], v[24:27], v[160:163]
v_exp_f32 v244, v244
v_exp_f32 v185, v185
v_sub_f32 v3, v186, v241
v_mfma_f32_16x16x32_bf16 v[164:167], v[96:99], v[20:23], v[164:167]
ds_read_b128 v[92:95], v248 offset:27648
v_sub_f32 v186, v240, v186
v_exp_f32 v3, v3
v_exp_f32 v186, v186
v_mfma_f32_16x16x32_bf16 v[168:171], v[96:99], v[24:27], v[168:171]
v_sub_f32 v2, v187, v241
v_sub_f32 v187, v240, v187
v_exp_f32 v2, v2
s_waitcnt lgkmcnt(2)
v_mfma_f32_16x16x32_bf16 v[172:175], v[80:83], v[20:23], v[172:175]
ds_read_b128 v[96:99], v248 offset:56320
v_exp_f32 v187, v187
v_sub_f32 v235, v204, v241
v_sub_f32 v204, v240, v204
v_mfma_f32_16x16x32_bf16 v[176:179], v[80:83], v[24:27], v[176:179]
v_exp_f32 v235, v235
v_exp_f32 v204, v204
v_sub_f32 v233, v205, v241
s_waitcnt vmcnt(14)
s_barrier
s_setprio 3
v_mfma_f32_16x16x32_bf16 v[156:159], v[84:87], v[56:59], v[156:159]
ds_read_b128 v[80:83], v248 offset:57344
v_sub_f32 v205, v240, v205
v_exp_f32 v233, v233
v_exp_f32 v205, v205
v_mfma_f32_16x16x32_bf16 v[160:163], v[84:87], v[60:63], v[160:163]
v_sub_f32 v232, v206, v241
v_sub_f32 v206, v240, v206
s_waitcnt lgkmcnt(2)
v_mfma_f32_16x16x32_bf16 v[164:167], v[88:91], v[56:59], v[164:167]
ds_read_b128 v[84:87], v248 offset:58368
v_exp_f32 v232, v232
v_exp_f32 v206, v206
v_sub_f32 v243, v207, v241
v_mfma_f32_16x16x32_bf16 v[168:171], v[88:91], v[60:63], v[168:171]
v_sub_f32 v207, v240, v207
v_exp_f32 v243, v243
v_mfma_f32_16x16x32_bf16 v[172:175], v[92:95], v[56:59], v[172:175]
ds_read_b128 v[88:91], v248 offset:62464
v_exp_f32 v207, v207
v_sub_f32 v242, v212, v241
v_mfma_f32_16x16x32_bf16 v[176:179], v[92:95], v[60:63], v[176:179]
v_sub_f32 v212, v240, v212
v_exp_f32 v242, v242
s_waitcnt lgkmcnt(2)
v_mfma_f32_16x16x32_bf16 v[156:159], v[96:99], v[100:103], v[156:159]
ds_read_b128 v[92:95], v248 offset:63488
v_exp_f32 v212, v212
v_add_f32 v241, v246, v244
v_add_f32 v240, v184, v185
v_mfma_f32_16x16x32_bf16 v[160:163], v[96:99], v[104:107], v[160:163]
v_add_f32 v241, v241, v3
v_add_f32 v240, v240, v186
s_waitcnt vmcnt(9)
v_mfma_f32_16x16x32_bf16 v[20:23], v[124:127], v[132:135], 0
v_mfma_f32_16x16x32_bf16 v[20:23], v[128:131], v[136:139], v[20:23]
v_mfma_f32_16x16x32_bf16 v[24:27], v[124:127], v[140:143], 0
s_waitcnt vmcnt(6)
v_mfma_f32_16x16x32_bf16 v[20:23], v[124:127], v[144:147], v[20:23]
v_mfma_f32_16x16x32_bf16 v[20:23], v[128:131], v[148:151], v[20:23]
v_mfma_f32_16x16x32_bf16 v[24:27], v[124:127], v[152:155], v[24:27]
s_waitcnt vmcnt(3)
v_mfma_f32_16x16x32_bf16 v[20:23], v[124:127], v[4:7], v[20:23]
v_mfma_f32_16x16x32_bf16 v[20:23], v[128:131], v[8:11], v[20:23]
v_mfma_f32_16x16x32_bf16 v[24:27], v[124:127], v[12:15], v[24:27]
s_waitcnt vmcnt(0)
v_mfma_f32_16x16x32_bf16 v[20:23], v[124:127], v[16:19], v[20:23]
v_mfma_f32_16x16x32_bf16 v[20:23], v[128:131], v[216:219], v[20:23]
v_mfma_f32_16x16x32_bf16 v[24:27], v[124:127], v[220:223], v[24:27]
s_setprio 2
v_mfma_f32_16x16x32_bf16 v[164:167], v[80:83], v[100:103], v[164:167]
ds_read_b128 v[96:99], v248 offset:64512
v_add_f32 v241, v241, v2
v_add_f32 v240, v240, v187
v_add_f32 v241, v241, v235
v_mfma_f32_16x16x32_bf16 v[168:171], v[80:83], v[104:107], v[168:171]
v_add_f32 v240, v240, v204
v_add_f32 v241, v241, v233
s_waitcnt lgkmcnt(2)
v_mfma_f32_16x16x32_bf16 v[172:175], v[84:87], v[100:103], v[172:175]
ds_read_b128 v[80:83], v245 offset:11264
v_add_f32 v240, v240, v205
v_add_f32 v241, v241, v232
v_mfma_f32_16x16x32_bf16 v[176:179], v[84:87], v[104:107], v[176:179]
v_add_f32 v240, v240, v206
v_add_f32 v241, v241, v243
v_mfma_f32_16x16x32_bf16 v[156:159], v[88:91], v[108:111], v[156:159]
ds_read_b128 v[84:87], v245 offset:12288
v_add_f32 v240, v240, v207
v_add_f32 v241, v241, v242
v_add_f32 v240, v240, v212
v_mfma_f32_16x16x32_bf16 v[160:163], v[88:91], v[112:115], v[160:163]
v_mov_b32 v239, v241
v_mov_b32 v238, v240
s_waitcnt lgkmcnt(2)
v_mfma_f32_16x16x32_bf16 v[164:167], v[92:95], v[108:111], v[164:167]
ds_read_b128 v[88:91], v245 offset:13312
v_permlane16_swap_b32 v241, v239
v_permlane16_swap_b32 v240, v238
v_add_f32 v241, v241, v239
v_mfma_f32_16x16x32_bf16 v[168:171], v[92:95], v[112:115], v[168:171]
v_add_f32 v240, v240, v238
v_rcp_f32 v241, v241
v_lshrrev_b32 v255, 1, v252
v_lshlrev_b32 v255, 5, v255
v_lshl_add_u32 v255, v251, 1, v255
v_and_b32 v254, 1, v252
s_mul_i32 s50, s42, 96
v_add3_u32 v255, v255, v254, s50
v_cmp_gt_u32 vcc, 380, v255
v_mul_u32_u24 v254, 205, v255
v_lshrrev_b32 v254, 10, v254
v_add_u32 v254, v255, v254
v_lshlrev_b32 v254, 3, v254
v_add_u32 v254, 159424, v254
v_mov_b32 v253, 163712
v_cndmask_b32 v236, v253, v254, vcc
v_cvt_pk_bf16_f32 v20, v20, v21
v_cvt_pk_bf16_f32 v21, v22, v23
ds_write_b64 v236, v[20:21]
v_add_u32 v255, 64, v255
v_cmp_gt_u32 vcc, 380, v255
s_mov_b32 vcc_hi, 0
v_mul_u32_u24 v254, 205, v255
v_lshrrev_b32 v254, 10, v254
v_add_u32 v254, v255, v254
v_lshlrev_b32 v254, 3, v254
v_add_u32 v254, 159424, v254
v_mov_b32 v253, 163712
v_cndmask_b32 v236, v253, v254, vcc
v_cvt_pk_bf16_f32 v24, v24, v25
v_cvt_pk_bf16_f32 v25, v26, v27
ds_write_b64 v236, v[24:25]
s_setprio 1
v_mfma_f32_16x16x32_bf16 v[172:175], v[96:99], v[108:111], v[172:175]
ds_read_b128 v[92:95], v245 offset:17408
v_rcp_f32 v240, v240
v_mul_f32 v246, v246, v241
v_mfma_f32_16x16x32_bf16 v[176:179], v[96:99], v[112:115], v[176:179]
v_mul_f32 v184, v184, v240
v_mul_f32 v244, v244, v241
s_waitcnt lgkmcnt(4)
v_mfma_f32_16x16x32_bf16 v[156:159], v[80:83], v[28:31], v[156:159]
ds_read_b128 v[96:99], v245 offset:18432
v_mul_f32 v185, v185, v240
v_mul_f32 v3, v3, v241
v_mul_f32 v186, v186, v240
v_mfma_f32_16x16x32_bf16 v[160:163], v[80:83], v[32:35], v[160:163]
v_mul_f32 v2, v2, v241
v_mul_f32 v187, v187, v240
s_lshl_b32 s50, s41, 7
s_add_u32 s50, s50, 46142464
v_min_u32 v255, 15, v1
v_lshlrev_b32 v255, 3, v255
buffer_load_dwordx2 v[230:231], v255, s[24:27], s50 offen sc1
v_mfma_f32_16x16x32_bf16 v[164:167], v[84:87], v[28:31], v[164:167]
ds_read_b128 v[80:83], v245 offset:19456
v_mul_f32 v235, v235, v241
v_mul_f32 v204, v204, v240
v_mul_f32 v233, v233, v241
v_mfma_f32_16x16x32_bf16 v[168:171], v[84:87], v[32:35], v[168:171]
v_mul_f32 v205, v205, v240
v_mul_f32 v232, v232, v241
s_waitcnt lgkmcnt(2)
v_mfma_f32_16x16x32_bf16 v[172:175], v[88:91], v[28:31], v[172:175]
ds_read_b128 v[84:87], v245 offset:23552
v_mul_f32 v206, v206, v240
v_mul_f32 v243, v243, v241
v_mfma_f32_16x16x32_bf16 v[176:179], v[88:91], v[32:35], v[176:179]
v_mul_f32 v207, v207, v240
v_mul_f32 v242, v242, v241
s_setprio 0
v_mfma_f32_16x16x32_bf16 v[156:159], v[92:95], v[64:67], v[156:159]
ds_read_b128 v[88:91], v245 offset:24576
v_mul_f32 v212, v212, v240
v_cvt_pk_bf16_f32 v184, v184, v185
v_cvt_pk_bf16_f32 v185, v186, v187
v_mfma_f32_16x16x32_bf16 v[160:163], v[92:95], v[68:71], v[160:163]
v_cvt_pk_bf16_f32 v186, v204, v205
v_cvt_pk_bf16_f32 v187, v206, v207
s_waitcnt lgkmcnt(2)
v_mfma_f32_16x16x32_bf16 v[164:167], v[96:99], v[64:67], v[164:167]
ds_read_b128 v[92:95], v245 offset:25600
v_cvt_pk_bf16_f32 v204, v212, v246
v_cvt_pk_bf16_f32 v205, v244, v3
v_cvt_pk_bf16_f32 v206, v2, v235
v_mfma_f32_16x16x32_bf16 v[168:171], v[96:99], v[68:71], v[168:171]
v_cvt_pk_bf16_f32 v207, v233, v232
v_cvt_pk_bf16_f32 v212, v243, v242
v_mfma_f32_16x16x32_bf16 v[172:175], v[80:83], v[64:67], v[172:175]
ds_read_b128 v[96:99], v245 offset:29696
v_mov_b32 v213, 0
v_mov_b32 v214, 0
v_mfma_f32_16x16x32_bf16 v[176:179], v[80:83], v[68:71], v[176:179]
v_mov_b32 v215, 0
s_barrier
s_setprio 3
s_waitcnt lgkmcnt(2)
v_mfma_f32_16x16x32_bf16 v[156:159], v[84:87], v[116:119], v[156:159]
ds_read_b128 v[80:83], v245 offset:30720
v_lshrrev_b32 v255, 1, v250
v_and_b32 v254, 1, v250
v_mul_u32_u24 v254, 9, v254
v_mad_u32_u24 v254, v255, 19, v254
v_add_u32 v254, v254, v249
v_and_b32 v253, 1, v252
v_mul_u32_u24 v253, 48, v253
v_add_u32 v253, 159424, v253
v_mul_u32_u24 v4, 96, v254
v_add_u32 v4, v4, v253
v_add_u32 v5, 384, v4
v_add_u32 v6, 768, v4
v_mul_u32_u24 v254, 1824, v255
v_add_u32 v254, v254, v253
v_add_u32 v254, 1728, v254
v_cmp_eq_u32 vcc, 0, v249
s_nop 1
v_cndmask_b32 v6, v254, v6, vcc
v_lshrrev_b32 v254, 1, v252
v_cmp_eq_u32 vcc, v255, v254
v_mov_b32 v253, 155648
s_nop 0
v_cndmask_b32 v4, v253, v4, vcc
v_cndmask_b32 v5, v253, v5, vcc
v_cndmask_b32 v6, v253, v6, vcc
ds_read_b128 v[8:11], v4 offset:0
ds_read_b128 v[12:15], v4 offset:16
ds_read_b128 v[16:19], v4 offset:32
ds_read_b128 v[20:23], v5 offset:0
ds_read_b128 v[24:27], v5 offset:16
ds_read_b128 v[28:31], v5 offset:32
ds_read_b128 v[32:35], v6 offset:0
ds_read_b128 v[40:43], v6 offset:16
ds_read_b128 v[44:47], v6 offset:32
v_mfma_f32_16x16x32_bf16 v[160:163], v[84:87], v[120:123], v[160:163]
v_mfma_f32_16x16x32_bf16 v[164:167], v[88:91], v[116:119], v[164:167]
ds_read_b128 v[84:87], v245 offset:31744
v_mfma_f32_16x16x32_bf16 v[168:171], v[88:91], v[120:123], v[168:171]
s_waitcnt lgkmcnt(11)
v_mfma_f32_16x16x32_bf16 v[172:175], v[92:95], v[116:119], v[172:175]
ds_read_b128 v[88:91], v245 offset:35840
s_waitcnt lgkmcnt(8)
v_mfma_f32_16x16x32_bf16 v[48:51], v[8:11], v[180:183], 0
v_mfma_f32_16x16x32_bf16 v[60:63], v[8:11], v[184:187], 0
v_mfma_f32_16x16x32_bf16 v[48:51], v[12:15], v[200:203], v[48:51]
v_mfma_f32_16x16x32_bf16 v[60:63], v[12:15], v[204:207], v[60:63]
v_mfma_f32_16x16x32_bf16 v[48:51], v[16:19], v[208:211], v[48:51]
v_mfma_f32_16x16x32_bf16 v[60:63], v[16:19], v[212:215], v[60:63]
v_mfma_f32_16x16x32_bf16 v[176:179], v[92:95], v[120:123], v[176:179]
s_setprio 2
v_mfma_f32_16x16x32_bf16 v[156:159], v[96:99], v[188:191], v[156:159]
ds_read_b128 v[92:95], v245 offset:36864
v_mfma_f32_16x16x32_bf16 v[160:163], v[96:99], v[192:195], v[160:163]
v_mfma_f32_16x16x32_bf16 v[164:167], v[80:83], v[188:191], v[164:167]
ds_read_b128 v[96:99], v245 offset:37888
s_waitcnt lgkmcnt(7)
v_mfma_f32_16x16x32_bf16 v[52:55], v[20:23], v[180:183], 0
v_mfma_f32_16x16x32_bf16 v[64:67], v[20:23], v[184:187], 0
v_mfma_f32_16x16x32_bf16 v[52:55], v[24:27], v[200:203], v[52:55]
v_mfma_f32_16x16x32_bf16 v[64:67], v[24:27], v[204:207], v[64:67]
v_mfma_f32_16x16x32_bf16 v[52:55], v[28:31], v[208:211], v[52:55]
v_mfma_f32_16x16x32_bf16 v[64:67], v[28:31], v[212:215], v[64:67]
v_mfma_f32_16x16x32_bf16 v[168:171], v[80:83], v[192:195], v[168:171]
s_waitcnt vmcnt(0)
s_mov_b32 s52, 0
L_spa1_5:
v_cmp_ne_u64 vcc, s[98:99], v[230:231]
s_nop 1
s_cmp_eq_u64 vcc, 0
s_cbranch_scc1 L_spa1_5x
s_add_u32 s52, s52, 1
s_cmp_ge_u32 s52, 0x10000
s_cbranch_scc1 L_spa1_5x
s_sleep 2
s_lshl_b32 s50, s41, 7
s_add_u32 s50, s50, 46142464
v_min_u32 v255, 15, v1
v_lshlrev_b32 v255, 3, v255
buffer_load_dwordx2 v[230:231], v255, s[24:27], s50 offen sc1
s_waitcnt vmcnt(0)
s_branch L_spa1_5
L_spa1_5x:
v_mul_u32_u24 v255, 3072, v252
v_lshl_add_u32 v255, v251, 4, v255
s_mul_i32 s50, s42, 768
s_mul_i32 s51, s41, 196608
s_add_u32 s51, s51, s50
s_add_u32 s50, s51, 41041920
buffer_load_dwordx4 v[100:103], v255, s[24:27], s50 offen offset:0 sc1
buffer_load_dwordx4 v[104:107], v255, s[24:27], s50 offen offset:256 sc1
buffer_load_dwordx4 v[108:111], v255, s[24:27], s50 offen offset:512 sc1
s_add_u32 s50, s51, 41054208
buffer_load_dwordx4 v[112:115], v255, s[24:27], s50 offen offset:0 sc1
buffer_load_dwordx4 v[116:119], v255, s[24:27], s50 offen offset:256 sc1
buffer_load_dwordx4 v[120:123], v255, s[24:27], s50 offen offset:512 sc1
s_add_u32 s50, s51, 41066496
buffer_load_dwordx4 v[132:135], v255, s[24:27], s50 offen offset:0 sc1
buffer_load_dwordx4 v[136:139], v255, s[24:27], s50 offen offset:256 sc1
buffer_load_dwordx4 v[140:143], v255, s[24:27], s50 offen offset:512 sc1
s_add_u32 s50, s51, 41078784
buffer_load_dwordx4 v[144:147], v255, s[24:27], s50 offen offset:0 sc1
buffer_load_dwordx4 v[148:151], v255, s[24:27], s50 offen offset:256 sc1
buffer_load_dwordx4 v[152:155], v255, s[24:27], s50 offen offset:512 sc1
s_waitcnt lgkmcnt(3)
v_mfma_f32_16x16x32_bf16 v[172:175], v[84:87], v[188:191], v[172:175]
ds_read_b128 v[80:83], v245 offset:41984
v_mfma_f32_16x16x32_bf16 v[56:59], v[32:35], v[180:183], 0
v_mfma_f32_16x16x32_bf16 v[68:71], v[32:35], v[184:187], 0
v_mfma_f32_16x16x32_bf16 v[56:59], v[40:43], v[200:203], v[56:59]
v_mfma_f32_16x16x32_bf16 v[68:71], v[40:43], v[204:207], v[68:71]
v_mfma_f32_16x16x32_bf16 v[56:59], v[44:47], v[208:211], v[56:59]
v_mfma_f32_16x16x32_bf16 v[68:71], v[44:47], v[212:215], v[68:71]
v_mfma_f32_16x16x32_bf16 v[176:179], v[84:87], v[192:195], v[176:179]
s_setprio 1
s_waitcnt lgkmcnt(2)
v_mfma_f32_16x16x32_bf16 v[156:159], v[88:91], v[36:39], v[156:159]
ds_read_b128 v[84:87], v245 offset:43008
v_mfma_f32_16x16x32_bf16 v[160:163], v[88:91], v[72:75], v[160:163]
v_mfma_f32_16x16x32_bf16 v[164:167], v[92:95], v[36:39], v[164:167]
ds_read_b128 v[88:91], v245 offset:44032
v_mfma_f32_16x16x32_bf16 v[168:171], v[92:95], v[72:75], v[168:171]
s_waitcnt lgkmcnt(2)
v_mfma_f32_16x16x32_bf16 v[172:175], v[96:99], v[36:39], v[172:175]
v_add_f32 v57, 0x358637bd, v57
v_rcp_f32 v57, v57
s_nop 0
v_mul_f32 v48, v48, v57
v_mul_f32 v49, v49, v57
v_mul_f32 v50, v50, v57
v_mul_f32 v51, v51, v57
v_mul_f32 v52, v52, v57
v_mul_f32 v53, v53, v57
v_mul_f32 v54, v54, v57
v_mul_f32 v55, v55, v57
v_mul_f32 v56, v56, v57
v_cvt_pk_bf16_f32 v48, v48, v49
v_cvt_pk_bf16_f32 v49, v50, v51
v_cvt_pk_bf16_f32 v50, v52, v53
v_cvt_pk_bf16_f32 v51, v54, v55
s_lshl_b32 s50, s41, 13
s_add_u32 s50, s50, s59
s_add_u32 s50, s50, 2048
buffer_store_dwordx4 v[48:51], v234, s[24:27], s50 offen sc1
v_mfma_f32_16x16x32_bf16 v[176:179], v[96:99], v[72:75], v[176:179]
s_setprio 0
v_mfma_f32_16x16x32_bf16 v[156:159], v[80:83], v[76:79], v[156:159]
v_add_f32 v69, 0x358637bd, v69
v_rcp_f32 v69, v69
s_nop 0
v_mul_f32 v60, v60, v69
v_mul_f32 v61, v61, v69
v_mul_f32 v62, v62, v69
v_mul_f32 v63, v63, v69
v_mul_f32 v64, v64, v69
v_mul_f32 v65, v65, v69
v_mul_f32 v66, v66, v69
v_mul_f32 v67, v67, v69
v_mul_f32 v68, v68, v69
v_cvt_pk_bf16_f32 v60, v60, v61
v_cvt_pk_bf16_f32 v61, v62, v63
v_cvt_pk_bf16_f32 v62, v64, v65
v_cvt_pk_bf16_f32 v63, v66, v67
s_lshl_b32 s50, s41, 13
s_add_u32 s50, s50, s59
s_add_u32 s50, s50, 3072
buffer_store_dwordx4 v[60:63], v234, s[24:27], s50 offen sc1
v_cvt_pk_bf16_f32 v56, v56, v68
s_mul_i32 s50, s42, 36864
s_lshl_b32 s51, s41, 10
s_add_u32 s50, s50, s51
s_add_u32 s50, s50, s59
s_add_u32 s50, s50, 33024
v_lshlrev_b32 v255, 2, v1
buffer_store_dword v56, v255, s[24:27], s50 offen sc1
s_nop 0
v_mfma_f32_16x16x32_bf16 v[160:163], v[80:83], v[196:199], v[160:163]
s_waitcnt lgkmcnt(0)
v_mfma_f32_16x16x32_bf16 v[164:167], v[84:87], v[76:79], v[164:167]
v_mfma_f32_16x16x32_bf16 v[168:171], v[84:87], v[196:199], v[168:171]
v_mfma_f32_16x16x32_bf16 v[172:175], v[88:91], v[76:79], v[172:175]
v_mfma_f32_16x16x32_bf16 v[176:179], v[88:91], v[196:199], v[176:179]
s_barrier
s_setprio 3
v_max3_f32 v232, v156, v157, v158
s_nop 1
v_max3_f32 v232, v232, v159, v164
v_max3_f32 v232, v232, v165, v166
v_max3_f32 v232, v232, v167, v172
v_min3_f32 v243, v156, v157, v158
v_min3_f32 v243, v243, v159, v164
v_min3_f32 v243, v243, v165, v166
v_min3_f32 v243, v243, v167, v172
v_mov_b32 v242, v232
v_mov_b32 v241, v243
s_nop 0
v_permlane16_swap_b32 v232, v242
v_permlane16_swap_b32 v243, v241
v_max_f32 v232, v232, v242
v_min_f32 v243, v243, v241
v_sub_f32 v246, v156, v232
v_sub_f32 v156, v243, v156
v_exp_f32 v246, v246
v_exp_f32 v156, v156
v_sub_f32 v244, v157, v232
v_sub_f32 v157, v243, v157
v_exp_f32 v244, v244
v_exp_f32 v157, v157
v_sub_f32 v3, v158, v232
v_sub_f32 v158, v243, v158
v_exp_f32 v3, v3
v_exp_f32 v158, v158
v_sub_f32 v2, v159, v232
v_sub_f32 v159, v243, v159
v_exp_f32 v2, v2
v_exp_f32 v159, v159
v_sub_f32 v239, v164, v232
v_sub_f32 v164, v243, v164
v_exp_f32 v239, v239
v_exp_f32 v164, v164
v_sub_f32 v238, v165, v232
v_sub_f32 v165, v243, v165
v_exp_f32 v238, v238
v_exp_f32 v165, v165
v_sub_f32 v236, v166, v232
v_sub_f32 v166, v243, v166
v_exp_f32 v236, v236
v_exp_f32 v166, v166
v_sub_f32 v235, v167, v232
v_sub_f32 v167, v243, v167
v_exp_f32 v235, v235
v_exp_f32 v167, v167
v_sub_f32 v233, v172, v232
v_sub_f32 v172, v243, v172
v_exp_f32 v233, v233
v_exp_f32 v172, v172
v_add_f32 v232, v246, v244
v_add_f32 v243, v156, v157
v_add_f32 v232, v232, v3
v_add_f32 v243, v243, v158
v_add_f32 v232, v232, v2
v_add_f32 v243, v243, v159
v_add_f32 v232, v232, v239
v_add_f32 v243, v243, v164
v_add_f32 v232, v232, v238
v_add_f32 v243, v243, v165
v_add_f32 v232, v232, v236
v_add_f32 v243, v243, v166
v_add_f32 v232, v232, v235
v_add_f32 v243, v243, v167
v_add_f32 v232, v232, v233
v_add_f32 v243, v243, v172
v_mov_b32 v242, v232
v_mov_b32 v241, v243
s_nop 0
v_permlane16_swap_b32 v232, v242
v_permlane16_swap_b32 v243, v241
v_add_f32 v232, v232, v242
v_add_f32 v243, v243, v241
v_rcp_f32 v232, v232
v_rcp_f32 v243, v243
v_mul_f32 v246, v246, v232
v_mul_f32 v156, v156, v243
v_mul_f32 v244, v244, v232
v_mul_f32 v157, v157, v243
v_mul_f32 v3, v3, v232
v_mul_f32 v158, v158, v243
v_mul_f32 v2, v2, v232
v_mul_f32 v159, v159, v243
v_mul_f32 v239, v239, v232
v_mul_f32 v164, v164, v243
v_mul_f32 v238, v238, v232
v_mul_f32 v165, v165, v243
v_mul_f32 v236, v236, v232
v_mul_f32 v166, v166, v243
v_mul_f32 v235, v235, v232
v_mul_f32 v167, v167, v243
v_mul_f32 v233, v233, v232
v_mul_f32 v172, v172, v243
v_cvt_pk_bf16_f32 v156, v156, v157
v_cvt_pk_bf16_f32 v157, v158, v159
v_cvt_pk_bf16_f32 v158, v164, v165
v_cvt_pk_bf16_f32 v159, v166, v167
v_cvt_pk_bf16_f32 v164, v172, v246
v_cvt_pk_bf16_f32 v165, v244, v3
v_cvt_pk_bf16_f32 v166, v2, v239
v_cvt_pk_bf16_f32 v167, v238, v236
v_cvt_pk_bf16_f32 v172, v235, v233
v_mov_b32 v173, 0
v_mov_b32 v174, 0
v_mov_b32 v175, 0
s_waitcnt vmcnt(12)
v_mfma_f32_16x16x32_bf16 v[4:7], v[124:127], v[100:103], 0
v_mfma_f32_16x16x32_bf16 v[4:7], v[128:131], v[104:107], v[4:7]
v_mfma_f32_16x16x32_bf16 v[8:11], v[124:127], v[108:111], 0
s_waitcnt vmcnt(9)
v_mfma_f32_16x16x32_bf16 v[4:7], v[124:127], v[112:115], v[4:7]
v_mfma_f32_16x16x32_bf16 v[4:7], v[128:131], v[116:119], v[4:7]
v_mfma_f32_16x16x32_bf16 v[8:11], v[124:127], v[120:123], v[8:11]
s_waitcnt vmcnt(6)
v_mfma_f32_16x16x32_bf16 v[4:7], v[124:127], v[132:135], v[4:7]
v_mfma_f32_16x16x32_bf16 v[4:7], v[128:131], v[136:139], v[4:7]
v_mfma_f32_16x16x32_bf16 v[8:11], v[124:127], v[140:143], v[8:11]
s_waitcnt vmcnt(3)
v_mfma_f32_16x16x32_bf16 v[4:7], v[124:127], v[144:147], v[4:7]
v_mfma_f32_16x16x32_bf16 v[4:7], v[128:131], v[148:151], v[4:7]
v_mfma_f32_16x16x32_bf16 v[8:11], v[124:127], v[152:155], v[8:11]
v_lshrrev_b32 v255, 1, v252
v_lshlrev_b32 v255, 5, v255
v_lshl_add_u32 v255, v251, 1, v255
v_and_b32 v254, 1, v252
s_mul_i32 s50, s42, 96
v_add3_u32 v255, v255, v254, s50
v_cmp_gt_u32 vcc, 380, v255
v_mul_u32_u24 v254, 205, v255
v_lshrrev_b32 v254, 10, v254
v_add_u32 v254, v255, v254
v_lshlrev_b32 v254, 3, v254
v_add_u32 v254, 151104, v254
v_mov_b32 v253, 163712
v_cndmask_b32 v240, v253, v254, vcc
v_cvt_pk_bf16_f32 v4, v4, v5
v_cvt_pk_bf16_f32 v5, v6, v7
ds_write_b64 v240, v[4:5]
v_add_u32 v255, 64, v255
v_cmp_gt_u32 vcc, 380, v255
s_mov_b32 vcc_hi, 0
v_mul_u32_u24 v254, 205, v255
v_lshrrev_b32 v254, 10, v254
v_add_u32 v254, v255, v254
v_lshlrev_b32 v254, 3, v254
v_add_u32 v254, 151104, v254
v_mov_b32 v253, 163712
v_cndmask_b32 v240, v253, v254, vcc
v_cvt_pk_bf16_f32 v8, v8, v9
v_cvt_pk_bf16_f32 v9, v10, v11
ds_write_b64 v240, v[8:9]
s_waitcnt vmcnt(0)
s_lshl_b32 s50, s40, 2
s_add_u32 s50, s50, s42
s_lshl_b32 s50, s50, 8
s_add_u32 s50, s50, 46153736
s_lshl_b32 s51, s41, 4
s_add_u32 s50, s50, s51
v_mov_b32 v230, s98
v_mov_b32 v231, s99
s_mov_b64 exec, 1
buffer_store_dwordx2 v[230:231], v248, s[24:27], s50 offen sc1
s_mov_b64 exec, -1
s_waitcnt lgkmcnt(0)
s_barrier
v_max3_f32 v232, v160, v161, v162
v_max3_f32 v232, v232, v163, v168
v_max3_f32 v232, v232, v169, v170
v_max3_f32 v232, v232, v171, v176
v_min3_f32 v243, v160, v161, v162
v_min3_f32 v243, v243, v163, v168
v_min3_f32 v243, v243, v169, v170
v_min3_f32 v243, v243, v171, v176
v_mov_b32 v242, v232
v_mov_b32 v241, v243
s_nop 0
v_permlane16_swap_b32 v232, v242
v_permlane16_swap_b32 v243, v241
v_max_f32 v232, v232, v242
v_min_f32 v243, v243, v241
v_sub_f32 v246, v160, v232
v_sub_f32 v160, v243, v160
v_exp_f32 v246, v246
v_exp_f32 v160, v160
v_sub_f32 v244, v161, v232
v_sub_f32 v161, v243, v161
v_exp_f32 v244, v244
v_exp_f32 v161, v161
v_sub_f32 v3, v162, v232
v_sub_f32 v162, v243, v162
v_exp_f32 v3, v3
v_exp_f32 v162, v162
v_sub_f32 v2, v163, v232
v_sub_f32 v163, v243, v163
v_exp_f32 v2, v2
v_exp_f32 v163, v163
v_sub_f32 v239, v168, v232
v_sub_f32 v168, v243, v168
v_exp_f32 v239, v239
v_exp_f32 v168, v168
v_sub_f32 v238, v169, v232
v_sub_f32 v169, v243, v169
v_exp_f32 v238, v238
v_exp_f32 v169, v169
v_sub_f32 v236, v170, v232
v_sub_f32 v170, v243, v170
v_exp_f32 v236, v236
v_exp_f32 v170, v170
v_sub_f32 v235, v171, v232
v_sub_f32 v171, v243, v171
v_exp_f32 v235, v235
v_exp_f32 v171, v171
v_sub_f32 v233, v176, v232
v_sub_f32 v176, v243, v176
v_exp_f32 v233, v233
v_exp_f32 v176, v176
v_add_f32 v232, v246, v244
v_add_f32 v243, v160, v161
v_add_f32 v232, v232, v3
v_add_f32 v243, v243, v162
v_add_f32 v232, v232, v2
v_add_f32 v243, v243, v163
v_add_f32 v232, v232, v239
v_add_f32 v243, v243, v168
v_add_f32 v232, v232, v238
v_add_f32 v243, v243, v169
v_add_f32 v232, v232, v236
v_add_f32 v243, v243, v170
v_add_f32 v232, v232, v235
v_add_f32 v243, v243, v171
v_add_f32 v232, v232, v233
v_add_f32 v243, v243, v176
v_mov_b32 v242, v232
v_mov_b32 v241, v243
s_nop 0
v_permlane16_swap_b32 v232, v242
v_permlane16_swap_b32 v243, v241
v_add_f32 v232, v232, v242
v_add_f32 v243, v243, v241
v_rcp_f32 v232, v232
v_rcp_f32 v243, v243
v_mul_f32 v246, v246, v232
v_mul_f32 v160, v160, v243
v_mul_f32 v244, v244, v232
v_mul_f32 v161, v161, v243
v_mul_f32 v3, v3, v232
v_mul_f32 v162, v162, v243
v_mul_f32 v2, v2, v232
v_mul_f32 v163, v163, v243
v_mul_f32 v239, v239, v232
v_mul_f32 v168, v168, v243
v_mul_f32 v238, v238, v232
v_mul_f32 v169, v169, v243
v_mul_f32 v236, v236, v232
v_mul_f32 v170, v170, v243
v_mul_f32 v235, v235, v232
v_mul_f32 v171, v171, v243
v_mul_f32 v233, v233, v232
v_mul_f32 v176, v176, v243
v_cvt_pk_bf16_f32 v160, v160, v161
v_cvt_pk_bf16_f32 v161, v162, v163
v_cvt_pk_bf16_f32 v162, v168, v169
v_cvt_pk_bf16_f32 v163, v170, v171
v_cvt_pk_bf16_f32 v168, v176, v246
v_cvt_pk_bf16_f32 v169, v244, v3
v_cvt_pk_bf16_f32 v170, v2, v239
v_cvt_pk_bf16_f32 v171, v238, v236
v_cvt_pk_bf16_f32 v176, v235, v233
v_mov_b32 v177, 0
v_mov_b32 v178, 0
v_mov_b32 v179, 0
v_lshrrev_b32 v255, 1, v250
v_and_b32 v254, 1, v250
v_mul_u32_u24 v254, 9, v254
v_mad_u32_u24 v254, v255, 19, v254
v_add_u32 v254, v254, v249
v_and_b32 v253, 1, v252
v_mul_u32_u24 v253, 48, v253
v_add_u32 v253, 151104, v253
v_mul_u32_u24 v4, 96, v254
v_add_u32 v4, v4, v253
v_add_u32 v5, 384, v4
v_add_u32 v6, 768, v4
v_mul_u32_u24 v254, 1824, v255
v_add_u32 v254, v254, v253
v_add_u32 v254, 1728, v254
v_cmp_eq_u32 vcc, 0, v249
s_nop 1
v_cndmask_b32 v6, v254, v6, vcc
v_lshrrev_b32 v254, 1, v252
v_cmp_eq_u32 vcc, v255, v254
v_mov_b32 v253, 155648
s_nop 0
v_cndmask_b32 v4, v253, v4, vcc
v_cndmask_b32 v5, v253, v5, vcc
v_cndmask_b32 v6, v253, v6, vcc
ds_read_b128 v[8:11], v4 offset:0
ds_read_b128 v[12:15], v4 offset:16
ds_read_b128 v[16:19], v4 offset:32
ds_read_b128 v[20:23], v5 offset:0
ds_read_b128 v[24:27], v5 offset:16
ds_read_b128 v[28:31], v5 offset:32
ds_read_b128 v[32:35], v6 offset:0
ds_read_b128 v[36:39], v6 offset:16
ds_read_b128 v[40:43], v6 offset:32
s_waitcnt lgkmcnt(6)
v_mfma_f32_16x16x32_bf16 v[44:47], v[8:11], v[156:159], 0
v_mfma_f32_16x16x32_bf16 v[56:59], v[8:11], v[160:163], 0
v_mfma_f32_16x16x32_bf16 v[44:47], v[12:15], v[164:167], v[44:47]
v_mfma_f32_16x16x32_bf16 v[56:59], v[12:15], v[168:171], v[56:59]
v_mfma_f32_16x16x32_bf16 v[44:47], v[16:19], v[172:175], v[44:47]
v_mfma_f32_16x16x32_bf16 v[56:59], v[16:19], v[176:179], v[56:59]
s_waitcnt lgkmcnt(3)
v_mfma_f32_16x16x32_bf16 v[48:51], v[20:23], v[156:159], 0
v_mfma_f32_16x16x32_bf16 v[60:63], v[20:23], v[160:163], 0
v_mfma_f32_16x16x32_bf16 v[48:51], v[24:27], v[164:167], v[48:51]
v_mfma_f32_16x16x32_bf16 v[60:63], v[24:27], v[168:171], v[60:63]
v_mfma_f32_16x16x32_bf16 v[48:51], v[28:31], v[172:175], v[48:51]
v_mfma_f32_16x16x32_bf16 v[60:63], v[28:31], v[176:179], v[60:63]
s_waitcnt lgkmcnt(0)
v_mfma_f32_16x16x32_bf16 v[52:55], v[32:35], v[156:159], 0
v_mfma_f32_16x16x32_bf16 v[64:67], v[32:35], v[160:163], 0
v_mfma_f32_16x16x32_bf16 v[52:55], v[36:39], v[164:167], v[52:55]
v_mfma_f32_16x16x32_bf16 v[64:67], v[36:39], v[168:171], v[64:67]
v_mfma_f32_16x16x32_bf16 v[52:55], v[40:43], v[172:175], v[52:55]
v_mfma_f32_16x16x32_bf16 v[64:67], v[40:43], v[176:179], v[64:67]
s_nop 6
v_add_f32 v53, 0x358637bd, v53
v_rcp_f32 v53, v53
s_nop 0
v_mul_f32 v44, v44, v53
v_mul_f32 v45, v45, v53
v_mul_f32 v46, v46, v53
v_mul_f32 v47, v47, v53
v_mul_f32 v48, v48, v53
v_mul_f32 v49, v49, v53
v_mul_f32 v50, v50, v53
v_mul_f32 v51, v51, v53
v_mul_f32 v52, v52, v53
v_cvt_pk_bf16_f32 v44, v44, v45
v_cvt_pk_bf16_f32 v45, v46, v47
v_cvt_pk_bf16_f32 v46, v48, v49
v_cvt_pk_bf16_f32 v47, v50, v51
s_lshl_b32 s50, s41, 13
s_add_u32 s50, s50, s59
s_add_u32 s50, s50, 6144
buffer_store_dwordx4 v[44:47], v234, s[24:27], s50 offen sc1
v_add_f32 v65, 0x358637bd, v65
v_rcp_f32 v65, v65
s_nop 0
v_mul_f32 v56, v56, v65
v_mul_f32 v57, v57, v65
v_mul_f32 v58, v58, v65
v_mul_f32 v59, v59, v65
v_mul_f32 v60, v60, v65
v_mul_f32 v61, v61, v65
v_mul_f32 v62, v62, v65
v_mul_f32 v63, v63, v65
v_mul_f32 v64, v64, v65
v_cvt_pk_bf16_f32 v56, v56, v57
v_cvt_pk_bf16_f32 v57, v58, v59
v_cvt_pk_bf16_f32 v58, v60, v61
v_cvt_pk_bf16_f32 v59, v62, v63
s_lshl_b32 s50, s41, 13
s_add_u32 s50, s50, s59
s_add_u32 s50, s50, 7168
buffer_store_dwordx4 v[56:59], v234, s[24:27], s50 offen sc1
v_cvt_pk_bf16_f32 v52, v52, v64
s_mul_i32 s50, s42, 36864
s_lshl_b32 s51, s41, 10
s_add_u32 s50, s50, s51
s_add_u32 s50, s50, s59
s_add_u32 s50, s50, 33536
v_lshlrev_b32 v255, 2, v1
buffer_store_dword v52, v255, s[24:27], s50 offen sc1
s_nop 0
s_waitcnt vmcnt(0)
s_lshl_b32 s50, s40, 2
s_add_u32 s50, s50, s42
s_lshl_b32 s50, s50, 8
s_add_u32 s50, s50, 46153800
s_lshl_b32 s51, s41, 4
s_add_u32 s50, s50, s51
v_mov_b32 v2, s98
v_mov_b32 v3, s99
s_mov_b64 exec, 1
buffer_store_dwordx2 v[2:3], v248, s[24:27], s50 offen sc1
s_mov_b64 exec, -1
s_endpgm
L_end:
s_endpgm
.p2align 7
.type L_tbl,@object
L_tbl:
.long 0x0, 0x50, 0xa0, 0xf0, 0x140, 0x190, 0x1e0, 0x230
.long 0x280, 0x2d0, 0x320, 0x370, 0x3c0, 0x410, 0x460, 0x4b0
.long 0x8, 0x58, 0xa8, 0xf8, 0x148, 0x198, 0x1e8, 0x238
.long 0x288, 0x2d8, 0x328, 0x378, 0x3c8, 0x418, 0x468, 0x4b8
.long 0x10, 0x60, 0xb0, 0x100, 0x150, 0x1a0, 0x1f0, 0x240
.long 0x290, 0x2e0, 0x330, 0x380, 0x3d0, 0x420, 0x470, 0x4c0
.long 0x18, 0x68, 0xb8, 0x108, 0x158, 0x1a8, 0x1f8, 0x248
.long 0x298, 0x2e8, 0x338, 0x388, 0x3d8, 0x428, 0x478, 0x4c8
.long 0x500, 0x550, 0x7ffffff0, 0x7ffffff0, 0x5a0, 0x7ffffff0, 0x7ffffff0, 0x7ffffff0
.long 0x7ffffff0, 0x7ffffff0, 0x7ffffff0, 0x7ffffff0, 0x7ffffff0, 0x7ffffff0, 0x7ffffff0, 0x7ffffff0
.long 0x508, 0x558, 0x7ffffff0, 0x7ffffff0, 0x5a8, 0x7ffffff0, 0x7ffffff0, 0x7ffffff0
.long 0x7ffffff0, 0x7ffffff0, 0x7ffffff0, 0x7ffffff0, 0x7ffffff0, 0x7ffffff0, 0x7ffffff0, 0x7ffffff0
.long 0x510, 0x560, 0x7ffffff0, 0x7ffffff0, 0x5b0, 0x7ffffff0, 0x7ffffff0, 0x7ffffff0
.long 0x7ffffff0, 0x7ffffff0, 0x7ffffff0, 0x7ffffff0, 0x7ffffff0, 0x7ffffff0, 0x7ffffff0, 0x7ffffff0
.long 0x518, 0x568, 0x7ffffff0, 0x7ffffff0, 0x5b8, 0x7ffffff0, 0x7ffffff0, 0x7ffffff0
.long 0x7ffffff0, 0x7ffffff0, 0x7ffffff0, 0x7ffffff0, 0x7ffffff0, 0x7ffffff0, 0x7ffffff0, 0x7ffffff0
.long 0x7ffffff0, 0x7ffffff0, 0x5f0, 0x640, 0x690, 0x6e0, 0x730, 0x780
.long 0x7d0, 0x820, 0x870, 0x8c0, 0x910, 0x960, 0x9b0, 0xa00
.long 0x7ffffff0, 0x7ffffff0, 0x5f8, 0x648, 0x698, 0x6e8, 0x738, 0x788
.long 0x7d8, 0x828, 0x878, 0x8c8, 0x918, 0x968, 0x9b8, 0xa08
.long 0x7ffffff0, 0x7ffffff0, 0x600, 0x650, 0x6a0, 0x6f0, 0x740, 0x790
.long 0x7e0, 0x830, 0x880, 0x8d0, 0x920, 0x970, 0x9c0, 0xa10
.long 0x7ffffff0, 0x7ffffff0, 0x608, 0x658, 0x6a8, 0x6f8, 0x748, 0x798
.long 0x7e8, 0x838, 0x888, 0x8d8, 0x928, 0x978, 0x9c8, 0xa18
.long 0xa50, 0xaa0, 0xaf0, 0xb40, 0xb90, 0x7ffffff0, 0x7ffffff0, 0x7ffffff0
.long 0x7ffffff0, 0x7ffffff0, 0x7ffffff0, 0x7ffffff0, 0x7ffffff0, 0x7ffffff0, 0x7ffffff0, 0x7ffffff0
.long 0xa58, 0xaa8, 0xaf8, 0xb48, 0xb98, 0x7ffffff0, 0x7ffffff0, 0x7ffffff0
.long 0x7ffffff0, 0x7ffffff0, 0x7ffffff0, 0x7ffffff0, 0x7ffffff0, 0x7ffffff0, 0x7ffffff0, 0x7ffffff0
.long 0xa60, 0xab0, 0xb00, 0xb50, 0xba0, 0x7ffffff0, 0x7ffffff0, 0x7ffffff0
.long 0x7ffffff0, 0x7ffffff0, 0x7ffffff0, 0x7ffffff0, 0x7ffffff0, 0x7ffffff0, 0x7ffffff0, 0x7ffffff0
.long 0xa68, 0xab8, 0xb08, 0xb58, 0xba8, 0x7ffffff0, 0x7ffffff0, 0x7ffffff0
.long 0x7ffffff0, 0x7ffffff0, 0x7ffffff0, 0x7ffffff0, 0x7ffffff0, 0x7ffffff0, 0x7ffffff0, 0x7ffffff0
.section .rodata,"a"
.p2align 6
.amdhsa_kernel recurrent_scan__linear_kernel_hedgehog__dense_activation_silu__prompt_kernel
  .amdhsa_next_free_vgpr 256
  .amdhsa_next_free_sgpr 102
  .amdhsa_accum_offset 256
  .amdhsa_group_segment_fixed_size 0
  .amdhsa_kernarg_size 80
  .amdhsa_user_sgpr_count 2
  .amdhsa_user_sgpr_kernarg_segment_ptr 1
  .amdhsa_system_sgpr_workgroup_id_x 1
.end_amdhsa_kernel
```
